```python
import torch

def _softmax(x, axis=-1):
    return torch.softmax(x, dim=axis)

def _gelu(x):
    return torch.nn.functional.gelu(x, approximate='tanh')

def _silu(x):
    return torch.nn.functional.silu(x)

def _sigmoid(x):
    return torch.sigmoid(x)

def _layernorm(x, axis=-1, eps=1e-05):
    m = x.mean(dim=axis, keepdim=True)
    v = x.var(dim=axis, keepdim=True, unbiased=False)
    return (x - m) / torch.sqrt(v + eps)

def _scatter_add(tgt, idx, src, axis=0):
    return tgt.clone().index_add_(axis, idx, src)

def _segment_sum(src, seg, n):
    out = torch.zeros((n,) + src.shape[1:], dtype=src.dtype)
    return out.index_add_(0, seg, src)

def _pad(x, pw):
    flat = tuple((v for pair in reversed(pw) for v in pair))
    return torch.nn.functional.pad(x, flat)
kernel_name = 'gated_mix__softmax_full_mha__memory_aug_recurrent_mem_tr__prompt'

def setup_inputs():

    _w = lambda a: (lambda t: t.to(torch.bfloat16) if t.is_floating_point() else t)(torch.as_tensor(a))

    def _A_setup():
        B, S, D = (1, 2048, 576)
        return {'x': _w((lambda *s: torch.randn(*s, dtype=torch.bfloat16) * 0.05)(B, S, D)), 'wqkv': _w((lambda *s: torch.randn(*s, dtype=torch.bfloat16) * 0.8)(D, 3 * D)), 'wo': _w((lambda *s: torch.randn(*s, dtype=torch.bfloat16) * 0.05)(D, D))}
    _A_in = _A_setup()

    def _B_setup():
        B, S, Dm = (1, 2048, 576)
        H, Dh = (32, 128)
        M, seg = (8, 32)
        seg = min(seg, S)
        S = S // seg * seg
        return {'x': _w((lambda *s: torch.randn(*s, dtype=torch.bfloat16) * 0.05)(B, S, Dm)), 'mem0': _w((lambda *s: torch.randn(*s, dtype=torch.bfloat16) * 0.8)(B, M, Dm)), 'Wq': _w((lambda *s: torch.randn(*s, dtype=torch.bfloat16) * 3.2)(Dm, H, Dh) * Dm ** (-0.5)), 'Wk': _w((lambda *s: torch.randn(*s, dtype=torch.bfloat16) * 3.2)(Dm, H, Dh) * Dm ** (-0.5)), 'Wv': _w((lambda *s: torch.randn(*s, dtype=torch.bfloat16) * 0.8)(Dm, H, Dh) * Dm ** (-0.5)), 'Wo': _w((lambda *s: torch.randn(*s, dtype=torch.bfloat16) * 0.8)(H, Dh, Dm) * (H * Dh) ** (-0.5)), 'seg_len': seg}
    _B_in = _B_setup()
    return {'A_x': _A_in['x'], 'A_wqkv': _A_in['wqkv'], 'A_wo': _A_in['wo'], 'B_x': _B_in['x'], 'B_mem0': _B_in['mem0'], 'B_Wq': _B_in['Wq'], 'B_Wk': _B_in['Wk'], 'B_Wv': _B_in['Wv'], 'B_Wo': _B_in['Wo'], 'B_seg_len': _B_in['seg_len'], 'gate_w': _w((lambda *s: torch.randn(*s, dtype=torch.bfloat16) * 0.05)(576) * 16.0)}

def reference(A_x, A_wqkv, A_wo, B_x, B_mem0, B_Wq, B_Wk, B_Wv, B_Wo, B_seg_len, gate_w):

    def _A_ref(x, wqkv, wo):
        B, S, D = x.shape
        H = 32
        Dh = D // H
        qkv = (lambda x, *d: x.permute(*d))((x @ wqkv).reshape(B, S, 3, H, Dh), 2, 0, 3, 1, 4)
        q, k, v = (qkv[0], qkv[1], qkv[2])
        scale = Dh ** (-0.5)
        scores = torch.einsum('bhqd,bhkd->bhqk', q, k) * scale
        p = _softmax(scores, axis=-1)
        o = torch.einsum('bhqk,bhkd->bhqd', p, v)
        return (lambda x, *d: x.permute(*d))(o, 0, 2, 1, 3).reshape(B, S, D) @ wo

    def _B_ref(x, mem0, Wq, Wk, Wv, Wo, seg_len):
        B, S, Dm = x.shape
        H, Dh = (Wq.shape[1], Wq.shape[2])
        M = mem0.shape[1]
        scale = Dh ** (-0.5)
        n_seg = S // seg_len
        L = M + seg_len
        idx = torch.arange(L)
        mask = (idx[:, None] < M) | (idx[:, None] >= idx[None, :])
        mem = mem0
        outs = []
        for s in range(n_seg):
            xs = x[:, s * seg_len:(s + 1) * seg_len, :].clone()
            h = torch.concatenate([mem, xs], axis=1)
            q = torch.einsum('btd,dhe->bhte', h, Wq)
            k = torch.einsum('btd,dhe->bhte', h, Wk)
            v = torch.einsum('btd,dhe->bhte', h, Wv)
            scores = torch.einsum('bhqe,bhke->bhqk', q, k) * scale
            scores = torch.where(mask[None, None], scores, -1000000000.0)
            p = _softmax(scores, axis=-1)
            o = torch.einsum('bhqk,bhke->bhqe', p, v)
            o = torch.einsum('bhte,hed->btd', o, Wo)
            mem = o[:, :M, :].clone()
            outs.append(o[:, M:, :])
        return torch.concatenate(outs, axis=1)
    x = A_x
    g = _sigmoid((x * gate_w).sum(-1, keepdims=True))
    a = _A_ref(x, A_wqkv, A_wo)
    b = _B_ref(x, B_mem0, B_Wq, B_Wk, B_Wv, B_Wo, B_seg_len)
    return g * a + (1 - g) * b
```

```asm
; @launch grid=(256,1,1) block=(256,1,1) lds=163840
.amdgcn_target "amdgcn-amd-amdhsa--gfx950"
.text
.globl gated_mix__softmax_full_mha__memory_aug_recurrent_mem_tr__prompt_kernel
.p2align 8
.type gated_mix__softmax_full_mha__memory_aug_recurrent_mem_tr__prompt_kernel,@function
gated_mix__softmax_full_mha__memory_aug_recurrent_mem_tr__prompt_kernel:
    s_cmp_ge_u32 s2, 256
    s_cbranch_scc1 L_endA
    s_load_dwordx2 s[4:5], s[0:1], 104
    s_load_dwordx2 s[8:9], s[0:1], 96
    s_getreg_b32 s3, hwreg(HW_REG_XCC_ID)
    s_and_b32 s3, s3, 7
    v_lshrrev_b32 v1, 6, v0
    s_waitcnt lgkmcnt(0)
    v_readfirstlane_b32 s13, v1
    s_and_b32 s5, s5, 0xffff
    s_mov_b32 s6, 268435456
    s_mov_b32 s7, 0x20000
    s_and_b32 s9, s9, 0xffff
    s_mov_b32 s10, 256
    s_mov_b32 s11, 0x20000
    s_mov_b32 s59, 0
    s_cmp_eq_u32 s2, 1
    s_cbranch_scc0 L_noinit
    v_lshlrev_b32 v4, 4, v0
    v_mov_b32 v8, 0
    v_mov_b32 v9, 0
    v_mov_b32 v10, 0
    v_mov_b32 v11, 0
    s_mov_b32 s16, 0
    buffer_store_dwordx4 v[8:11], v4, s[4:7], s16 offen sc1
    s_mov_b32 s16, 4096
    buffer_store_dwordx4 v[8:11], v4, s[4:7], s16 offen sc1
    s_mov_b32 s16, 8192
    buffer_store_dwordx4 v[8:11], v4, s[4:7], s16 offen sc1
    s_mov_b32 s16, 12288
    buffer_store_dwordx4 v[8:11], v4, s[4:7], s16 offen sc1
    s_mov_b32 s16, 16384
    buffer_store_dwordx4 v[8:11], v4, s[4:7], s16 offen sc1
    s_waitcnt vmcnt(0)
    s_barrier
    v_mov_b32 v2, 1
    buffer_store_dword v2, off, s[8:11], 0 offset:8 sc1
    L_noinit:
    s_getreg_b32 s12, hwreg(HW_REG_HW_ID)
    s_bfe_u32 s17, s12, 0x2000d
    s_bfe_u32 s12, s12, 0x30008
    s_lshl_b32 s17, s17, 3
    s_or_b32 s12, s12, s17
    s_and_b32 s12, s12, 31
    s_cmp_eq_u32 s3, 0
    s_cbranch_scc1 L_fast
    L_notx0:
    s_sub_u32 s17, s3, 1
    s_lshl_b32 s17, s17, 5
    s_add_u32 s17, s17, s12
    s_mul_i32 s17, s17, 21120
    v_lshlrev_b32 v9, 7, v0
    v_cmp_gt_u32 vcc, 165, v0
    v_mov_b32 v10, 1073741824
    s_mov_b32 m0, 163264
    v_cndmask_b32 v9, v10, v9, vcc
    s_load_dwordx2 s[68:69], s[0:1], 64
    s_waitcnt lgkmcnt(0)
    s_and_b32 s69, s69, 0xffff
    s_mov_b32 s70, 4718592
    s_mov_b32 s71, 0x20000
    buffer_load_dword v9, s[68:71], s17 offen lds
    s_load_dwordx2 s[68:69], s[0:1], 40
    s_waitcnt lgkmcnt(0)
    s_and_b32 s69, s69, 0xffff
    s_mov_b32 s70, 4718592
    s_mov_b32 s71, 0x20000
    buffer_load_dword v9, s[68:71], s17 offen lds
    s_branch L_work
    L_fast:
    s_mov_b32 s63, 0
    s_cmp_eq_u32 s13, 0
    s_cbranch_scc0 L_fast2
    s_lshl_b32 s17, 1, s12
    s_mov_b64 exec, 1
    v_mov_b32 v24, s17
    v_mov_b32 v25, 1
    buffer_atomic_or v24, off, s[8:11], 0 offset:140 sc0 sc1
    buffer_atomic_add v25, off, s[8:11], 0 offset:128 sc0 sc1
    s_mov_b64 exec, -1
    L_fast2:
    s_load_dwordx2 s[64:65], s[0:1], 40
    s_waitcnt lgkmcnt(0)
    s_and_b32 s65, s65, 0xffff
    s_mov_b32 s66, 4718592
    s_mov_b32 s67, 0x20000
    s_load_dwordx2 s[68:69], s[0:1], 48
    s_waitcnt lgkmcnt(0)
    s_and_b32 s69, s69, 0xffff
    s_mov_b32 s70, 4718592
    s_mov_b32 s71, 0x20000
    s_load_dwordx2 s[72:73], s[0:1], 56
    s_waitcnt lgkmcnt(0)
    s_and_b32 s73, s73, 0xffff
    s_mov_b32 s74, 4718592
    s_mov_b32 s75, 0x20000
    s_load_dwordx2 s[76:77], s[0:1], 64
    s_waitcnt lgkmcnt(0)
    s_and_b32 s77, s77, 0xffff
    s_mov_b32 s78, 4718592
    s_mov_b32 s79, 0x20000
    s_load_dwordx2 s[80:81], s[0:1], 32
    s_waitcnt lgkmcnt(0)
    s_and_b32 s81, s81, 0xffff
    s_mov_b32 s82, 9216
    s_mov_b32 s83, 0x20000
L_fast3:
    s_mov_b32 s50, 1048576
    s_mov_b32 s51, 5242880
    s_mov_b32 s52, 5242880
    s_mov_b32 s14, 0
    s_mov_b32 s15, 64
    s_lshl_b32 s53, s12, 7
    s_add_u32 s53, s53, 4096
    s_lshl_b32 s58, s12, 7
    s_add_u32 s58, s58, 0
    v_and_b32 v11, 63, v0
    v_lshrrev_b32 v12, 4, v11
    v_and_b32 v13, 15, v11
    v_lshlrev_b32 v1, 13, v12
    v_lshl_add_u32 v1, v13, 4, v1
    s_lshl_b32 s46, s13, 10
    v_lshlrev_b32 v14, 8, v12
    v_add_u32 v14, s46, v14
    v_bfe_u32 v15, v13, 1, 1
    v_and_b32 v16, 1, v12
    v_xor_b32 v15, v15, v16
    v_lshl_add_u32 v14, v15, 5, v14
    v_and_b32 v15, 1, v13
    v_lshl_add_u32 v14, v15, 4, v14
    v_lshrrev_b32 v15, 2, v13
    v_lshl_add_u32 v3, v15, 12, v14
    v_add_u32 v3, 147456, v3
    v_mul_u32_u24 v15, 36864, v15
    v_add_u32 v19, v15, v14
    v_add_u32 v19, 20480, v19
    v_lshrrev_b32 v12, 3, v11
    v_and_b32 v13, 7, v11
    v_mul_u32_u24 v2, 1152, v12
    v_lshl_add_u32 v2, v13, 4, v2
    v_lshlrev_b32 v14, 5, v12
    v_add_u32 v14, s46, v14
    v_and_b32 v15, 1, v13
    v_lshl_add_u32 v14, v15, 4, v14
    v_lshrrev_b32 v15, 1, v13
    v_lshl_add_u32 v4, v15, 12, v14
    v_add_u32 v4, 147456, v4
    v_mul_u32_u24 v15, 36864, v15
    v_add_u32 v20, v15, v14
    v_add_u32 v20, 20480, v20
    v_lshrrev_b32 v12, 4, v11
    v_bfe_u32 v13, v11, 2, 2
    v_and_b32 v14, 3, v11
    v_lshrrev_b32 v17, 1, v12
    v_and_b32 v18, 1, v12
    v_and_b32 v15, 1, v13
    v_lshrrev_b32 v16, 1, v13
    v_lshlrev_b32 v9, 4, v17
    v_lshl_add_u32 v9, v15, 2, v9
    v_lshl_add_u32 v9, v16, 1, v9
    v_add_u32 v9, v9, v18
    v_lshlrev_b32 v9, 6, v9
    v_lshl_add_u32 v9, v15, 5, v9
    v_lshl_add_u32 v9, v14, 3, v9
    s_lshl_b32 s47, s13, 12
    s_add_u32 s47, s47, 147456
    s_mul_i32 s48, s13, 36864
    v_add_u32 v5, s47, v9
    v_xor_b32 v6, 32, v5
    v_add_u32 v21, s48, v9
    v_add_u32 v21, 20480, v21
    v_xor_b32 v22, 32, v21
    v_lshlrev_b32 v9, 4, v18
    v_lshl_add_u32 v9, v17, 3, v9
    v_lshl_add_u32 v9, v16, 2, v9
    v_add_u32 v9, v9, v15
    v_lshlrev_b32 v9, 5, v9
    v_lshl_add_u32 v9, v14, 3, v9
    v_add_u32 v7, s47, v9
    v_add_u32 v23, s48, v9
    v_add_u32 v23, 20480, v23
    v_lshlrev_b32 v10, 4, v11
    v_add_u32 v10, s48, v10
    s_lshl_b32 s49, s12, 8
    s_lshl_b32 s47, s13, 17
    s_add_u32 s49, s49, s47
    s_mul_i32 s48, s12, 147456
    s_mul_i32 s47, s13, 36864
    s_add_u32 s48, s48, s47
    v_mov_b32 v28, -1
    v_mov_b32 v29, -1
    v_mov_b32 v30, -1
    v_mov_b32 v31, -1
    v_lshrrev_b32 v11, 1, v0
    v_and_b32 v12, 1, v0
    s_bfe_u32 s46, s12, 0x20001
    s_mul_i32 s46, s46, 2304
    s_lshr_b32 s47, s12, 3
    s_lshl_b32 s47, s47, 5
    s_add_u32 s46, s46, s47
    s_and_b32 s47, s12, 1
    s_lshl_b32 s47, s47, 4
    s_add_u32 s46, s46, s47
    v_mul_u32_u24 v13, 1152, v12
    v_lshl_add_u32 v13, v11, 7, v13
    v_cmp_gt_u32 vcc, 9, v11
    s_and_saveexec_b64 s[84:85], vcc
    buffer_load_dwordx4 v[28:31], v13, s[80:83], s46 offen
    s_mov_b64 exec, s[84:85]
    s_add_u32 s46, s49, 0
    buffer_load_dwordx4 v[96:99], v1, s[68:71], s46 offen
    s_add_u32 s46, s49, 32768
    buffer_load_dwordx4 v[100:103], v1, s[68:71], s46 offen
    s_add_u32 s46, s49, 65536
    buffer_load_dwordx4 v[104:107], v1, s[68:71], s46 offen
    s_add_u32 s46, s49, 98304
    buffer_load_dwordx4 v[108:111], v1, s[68:71], s46 offen
    s_add_u32 s46, s49, 524288
    buffer_load_dwordx4 v[128:131], v1, s[68:71], s46 offen
    s_add_u32 s46, s49, 557056
    buffer_load_dwordx4 v[132:135], v1, s[68:71], s46 offen
    s_add_u32 s46, s49, 589824
    buffer_load_dwordx4 v[136:139], v1, s[68:71], s46 offen
    s_add_u32 s46, s49, 622592
    buffer_load_dwordx4 v[140:143], v1, s[68:71], s46 offen
    s_add_u32 s46, s49, 1048576
    buffer_load_dwordx4 v[160:163], v1, s[68:71], s46 offen
    s_add_u32 s46, s49, 1081344
    buffer_load_dwordx4 v[164:167], v1, s[68:71], s46 offen
    s_add_u32 s46, s49, 1114112
    buffer_load_dwordx4 v[168:171], v1, s[68:71], s46 offen
    s_add_u32 s46, s49, 1146880
    buffer_load_dwordx4 v[172:175], v1, s[68:71], s46 offen
    s_add_u32 s46, s49, 0
    buffer_load_dwordx4 v[32:35], v1, s[72:75], s46 offen
    s_add_u32 s46, s49, 32768
    buffer_load_dwordx4 v[36:39], v1, s[72:75], s46 offen
    s_add_u32 s46, s49, 65536
    buffer_load_dwordx4 v[40:43], v1, s[72:75], s46 offen
    s_add_u32 s46, s49, 98304
    buffer_load_dwordx4 v[44:47], v1, s[72:75], s46 offen
    s_cmp_eq_u32 s63, 0
    s_cbranch_scc0 L_fast_ok
    s_mov_b32 s63, 1
    v_mov_b32 v26, 0
    s_cmp_eq_u32 s13, 0
    s_cbranch_scc0 L_fast_v2
    s_waitcnt vmcnt(17)
    v_readfirstlane_b32 s60, v24
    v_readfirstlane_b32 s61, v25
    s_mov_b32 s62, 64
    s_cmp_lt_u32 s61, 32
    s_cbranch_scc0 L_fast_v1
    s_mov_b32 s62, s12
        L_fast_v0:
    s_bitcmp1_b32 s60, s62
    s_cbranch_scc0 L_fast_v1
    s_ff0_i32_b32 s62, s60
    s_lshl_b32 s17, 1, s62
    s_mov_b64 exec, 1
    v_mov_b32 v24, s17
    buffer_atomic_or v24, off, s[8:11], 0 offset:140 sc0 sc1
    s_mov_b64 exec, -1
    s_waitcnt vmcnt(0)
    v_readfirstlane_b32 s60, v24
    s_branch L_fast_v0
        L_fast_v1:
    v_mov_b32 v24, s62
    ds_write_b32 v26, v24
    s_waitcnt lgkmcnt(0)
        L_fast_v2:
    s_barrier
    ds_read_b32 v24, v26
    s_waitcnt lgkmcnt(0)
    v_readfirstlane_b32 s62, v24
    s_cmp_eq_u32 s62, s12
    s_cbranch_scc1 L_fast_ok
    s_waitcnt vmcnt(0)
    s_barrier
    s_cmp_eq_u32 s62, 64
    s_cbranch_scc1 L_work
    s_mov_b32 s12, s62
    s_branch L_fast3
        L_fast_ok:
    s_waitcnt vmcnt(16)
    v_lshrrev_b32 v11, 1, v0
    v_cmp_gt_u32 vcc, 9, v11
    v_min_u32 v12, -2, v28
    v_min_u32 v13, -2, v29
    v_min_u32 v14, -2, v30
    v_min_u32 v15, -2, v31
    v_cndmask_b32 v28, v28, v12, vcc
    v_cndmask_b32 v29, v29, v13, vcc
    v_cndmask_b32 v30, v30, v14, vcc
    v_cndmask_b32 v31, v31, v15, vcc
    v_and_b32 v12, 1, v0
    v_lshlrev_b32 v13, 10, v11
    v_lshl_add_u32 v13, v12, 4, v13
    v_cmp_gt_u32 vcc, 27, v11
    v_mov_b32 v18, 1073741824
    s_lshl_b32 s46, s12, 5
    v_cndmask_b32 v13, v18, v13, vcc
    s_add_u32 s46, s46, s51
    buffer_store_dwordx4 v[28:31], v13, s[4:7], s46 offen sc1
    v_mov_b32 v24, 1
    v_mov_b32 v25, 1
    v_mov_b32 v26, 1
    v_mov_b32 v27, 1
    v_lshrrev_b32 v14, 7, v0
    v_lshlrev_b32 v15, 4, v0
    v_and_b32 v15, 0x7f0, v15
    s_mov_b32 s46, 294912
    v_mul_lo_u32 v14, v14, s46
    v_add_u32 v14, v15, v14
    s_lshl_b32 s46, s12, 11
    s_add_u32 s46, s46, s50
    buffer_store_dwordx4 v[24:27], v14, s[4:7], s46 offen sc1
    s_add_u32 s46, s46, 65536
    buffer_store_dwordx4 v[24:27], v14, s[4:7], s46 offen sc1
    s_add_u32 s46, s46, 65536
    buffer_store_dwordx4 v[24:27], v14, s[4:7], s46 offen sc1
    s_add_u32 s46, s46, 65536
    buffer_store_dwordx4 v[24:27], v14, s[4:7], s46 offen sc1
    v_cmp_gt_u32 vcc, 0x400, v15
    s_lshl_b32 s46, s12, 10
    s_add_u32 s46, s46, s50
    v_cndmask_b32 v16, v18, v14, vcc
    s_add_u32 s46, s46, 262144
    buffer_store_dwordx4 v[24:27], v16, s[4:7], s46 offen sc1
    s_waitcnt vmcnt(18)
    ds_write_b128 v19, v[96:99] offset:0
    ds_write_b128 v19, v[100:103] offset:64
    ds_write_b128 v19, v[104:107] offset:128
    ds_write_b128 v19, v[108:111] offset:192
    s_waitcnt lgkmcnt(0)
    s_barrier
    ds_read_b64_tr_b16 v[96:97], v21 offset:0
    ds_read_b64_tr_b16 v[98:99], v21 offset:512
    ds_read_b64_tr_b16 v[100:101], v21 offset:2048
    ds_read_b64_tr_b16 v[102:103], v21 offset:2560
    ds_read_b64_tr_b16 v[104:105], v22 offset:0
    ds_read_b64_tr_b16 v[106:107], v22 offset:512
    ds_read_b64_tr_b16 v[108:109], v22 offset:2048
    ds_read_b64_tr_b16 v[110:111], v22 offset:2560
    s_waitcnt lgkmcnt(0)
    s_add_u32 s46, s49, 1572864
    buffer_load_dwordx4 v[192:195], v1, s[68:71], s46 offen
    s_add_u32 s46, s49, 1605632
    buffer_load_dwordx4 v[196:199], v1, s[68:71], s46 offen
    s_add_u32 s46, s49, 1638400
    buffer_load_dwordx4 v[200:203], v1, s[68:71], s46 offen
    s_add_u32 s46, s49, 1671168
    buffer_load_dwordx4 v[204:207], v1, s[68:71], s46 offen
    s_waitcnt vmcnt(18)
    ds_write_b128 v3, v[128:131] offset:0
    ds_write_b128 v3, v[132:135] offset:64
    ds_write_b128 v3, v[136:139] offset:128
    ds_write_b128 v3, v[140:143] offset:192
    s_waitcnt lgkmcnt(0)
    s_barrier
    ds_read_b64_tr_b16 v[128:129], v5 offset:0
    ds_read_b64_tr_b16 v[130:131], v5 offset:512
    ds_read_b64_tr_b16 v[132:133], v5 offset:2048
    ds_read_b64_tr_b16 v[134:135], v5 offset:2560
    ds_read_b64_tr_b16 v[136:137], v6 offset:0
    ds_read_b64_tr_b16 v[138:139], v6 offset:512
    ds_read_b64_tr_b16 v[140:141], v6 offset:2048
    ds_read_b64_tr_b16 v[142:143], v6 offset:2560
    s_waitcnt lgkmcnt(0)
    s_add_u32 s46, s49, 2097152
    buffer_load_dwordx4 v[224:227], v1, s[68:71], s46 offen
    s_add_u32 s46, s49, 2129920
    buffer_load_dwordx4 v[228:231], v1, s[68:71], s46 offen
    s_add_u32 s46, s49, 2162688
    buffer_load_dwordx4 v[232:235], v1, s[68:71], s46 offen
    s_add_u32 s46, s49, 2195456
    buffer_load_dwordx4 v[236:239], v1, s[68:71], s46 offen
    s_waitcnt vmcnt(18)
    ds_write_b128 v19, v[160:163] offset:0
    ds_write_b128 v19, v[164:167] offset:64
    ds_write_b128 v19, v[168:171] offset:128
    ds_write_b128 v19, v[172:175] offset:192
    s_waitcnt lgkmcnt(0)
    s_barrier
    ds_read_b64_tr_b16 v[160:161], v21 offset:0
    ds_read_b64_tr_b16 v[162:163], v21 offset:512
    ds_read_b64_tr_b16 v[164:165], v21 offset:2048
    ds_read_b64_tr_b16 v[166:167], v21 offset:2560
    ds_read_b64_tr_b16 v[168:169], v22 offset:0
    ds_read_b64_tr_b16 v[170:171], v22 offset:512
    ds_read_b64_tr_b16 v[172:173], v22 offset:2048
    ds_read_b64_tr_b16 v[174:175], v22 offset:2560
    s_waitcnt lgkmcnt(0)
    s_add_u32 s46, s49, 2621440
    buffer_load_dwordx4 a[0:3], v1, s[68:71], s46 offen
    s_add_u32 s46, s49, 2654208
    buffer_load_dwordx4 a[4:7], v1, s[68:71], s46 offen
    s_add_u32 s46, s49, 2686976
    buffer_load_dwordx4 a[8:11], v1, s[68:71], s46 offen
    s_add_u32 s46, s49, 2719744
    buffer_load_dwordx4 a[12:15], v1, s[68:71], s46 offen
    s_waitcnt vmcnt(18)
    ds_write_b128 v3, v[32:35] offset:0
    ds_write_b128 v3, v[36:39] offset:64
    ds_write_b128 v3, v[40:43] offset:128
    ds_write_b128 v3, v[44:47] offset:192
    s_waitcnt lgkmcnt(0)
    s_barrier
    ds_read_b64_tr_b16 v[32:33], v5 offset:0
    ds_read_b64_tr_b16 v[34:35], v5 offset:512
    ds_read_b64_tr_b16 v[36:37], v5 offset:2048
    ds_read_b64_tr_b16 v[38:39], v5 offset:2560
    ds_read_b64_tr_b16 v[40:41], v6 offset:0
    ds_read_b64_tr_b16 v[42:43], v6 offset:512
    ds_read_b64_tr_b16 v[44:45], v6 offset:2048
    ds_read_b64_tr_b16 v[46:47], v6 offset:2560
    s_waitcnt lgkmcnt(0)
    ds_write_b128 v10, v[32:35] offset:12288
    ds_write_b128 v10, v[36:39] offset:13312
    ds_write_b128 v10, v[40:43] offset:14336
    ds_write_b128 v10, v[44:47] offset:15360
    s_waitcnt lgkmcnt(0)
    s_add_u32 s46, s49, 524288
    buffer_load_dwordx4 v[48:51], v1, s[72:75], s46 offen
    s_add_u32 s46, s49, 557056
    buffer_load_dwordx4 v[52:55], v1, s[72:75], s46 offen
    s_add_u32 s46, s49, 589824
    buffer_load_dwordx4 v[56:59], v1, s[72:75], s46 offen
    s_add_u32 s46, s49, 622592
    buffer_load_dwordx4 v[60:63], v1, s[72:75], s46 offen
    s_waitcnt vmcnt(12)
    ds_write_b128 v19, v[192:195] offset:0
    ds_write_b128 v19, v[196:199] offset:64
    ds_write_b128 v19, v[200:203] offset:128
    ds_write_b128 v19, v[204:207] offset:192
    s_waitcnt lgkmcnt(0)
    s_barrier
    s_cmp_eq_u32 s13, 0
    s_cbranch_scc0 L_arr_1
    s_mov_b64 exec, 1
    v_mov_b32 v11, 1
    buffer_atomic_add v11, off, s[8:11], 0 offset:132 sc1
    s_mov_b64 exec, -1
            L_arr_1:
    ds_read_b64_tr_b16 v[192:193], v21 offset:0
    ds_read_b64_tr_b16 v[194:195], v21 offset:512
    ds_read_b64_tr_b16 v[196:197], v21 offset:2048
    ds_read_b64_tr_b16 v[198:199], v21 offset:2560
    ds_read_b64_tr_b16 v[200:201], v22 offset:0
    ds_read_b64_tr_b16 v[202:203], v22 offset:512
    ds_read_b64_tr_b16 v[204:205], v22 offset:2048
    ds_read_b64_tr_b16 v[206:207], v22 offset:2560
    s_waitcnt lgkmcnt(0)
    s_add_u32 s46, s49, 3145728
    buffer_load_dwordx4 a[32:35], v1, s[68:71], s46 offen
    s_add_u32 s46, s49, 3178496
    buffer_load_dwordx4 a[36:39], v1, s[68:71], s46 offen
    s_add_u32 s46, s49, 3211264
    buffer_load_dwordx4 a[40:43], v1, s[68:71], s46 offen
    s_add_u32 s46, s49, 3244032
    buffer_load_dwordx4 a[44:47], v1, s[68:71], s46 offen
    s_waitcnt vmcnt(12)
    ds_write_b128 v3, v[224:227] offset:0
    ds_write_b128 v3, v[228:231] offset:64
    ds_write_b128 v3, v[232:235] offset:128
    ds_write_b128 v3, v[236:239] offset:192
    s_waitcnt lgkmcnt(0)
    s_barrier
    ds_read_b64_tr_b16 v[224:225], v5 offset:0
    ds_read_b64_tr_b16 v[226:227], v5 offset:512
    ds_read_b64_tr_b16 v[228:229], v5 offset:2048
    ds_read_b64_tr_b16 v[230:231], v5 offset:2560
    ds_read_b64_tr_b16 v[232:233], v6 offset:0
    ds_read_b64_tr_b16 v[234:235], v6 offset:512
    ds_read_b64_tr_b16 v[236:237], v6 offset:2048
    ds_read_b64_tr_b16 v[238:239], v6 offset:2560
    s_waitcnt lgkmcnt(0)
    s_add_u32 s46, s49, 3670016
    buffer_load_dwordx4 a[64:67], v1, s[68:71], s46 offen
    s_add_u32 s46, s49, 3702784
    buffer_load_dwordx4 a[68:71], v1, s[68:71], s46 offen
    s_add_u32 s46, s49, 3735552
    buffer_load_dwordx4 a[72:75], v1, s[68:71], s46 offen
    s_add_u32 s46, s49, 3768320
    buffer_load_dwordx4 a[76:79], v1, s[68:71], s46 offen
    s_waitcnt vmcnt(12)
    ds_write_b128 v19, a[0:3] offset:0
    ds_write_b128 v19, a[4:7] offset:64
    ds_write_b128 v19, a[8:11] offset:128
    ds_write_b128 v19, a[12:15] offset:192
    s_waitcnt lgkmcnt(0)
    s_barrier
    ds_read_b64_tr_b16 a[0:1], v21 offset:0
    ds_read_b64_tr_b16 a[2:3], v21 offset:512
    ds_read_b64_tr_b16 a[4:5], v21 offset:2048
    ds_read_b64_tr_b16 a[6:7], v21 offset:2560
    ds_read_b64_tr_b16 a[8:9], v22 offset:0
    ds_read_b64_tr_b16 a[10:11], v22 offset:512
    ds_read_b64_tr_b16 a[12:13], v22 offset:2048
    ds_read_b64_tr_b16 a[14:15], v22 offset:2560
    s_waitcnt lgkmcnt(0)
    s_add_u32 s46, s49, 4194304
    buffer_load_dwordx4 a[96:99], v1, s[68:71], s46 offen
    s_add_u32 s46, s49, 4227072
    buffer_load_dwordx4 a[100:103], v1, s[68:71], s46 offen
    s_add_u32 s46, s49, 4259840
    buffer_load_dwordx4 a[104:107], v1, s[68:71], s46 offen
    s_add_u32 s46, s49, 4292608
    buffer_load_dwordx4 a[108:111], v1, s[68:71], s46 offen
    s_waitcnt vmcnt(12)
    ds_write_b128 v3, v[48:51] offset:0
    ds_write_b128 v3, v[52:55] offset:64
    ds_write_b128 v3, v[56:59] offset:128
    ds_write_b128 v3, v[60:63] offset:192
    s_waitcnt lgkmcnt(0)
    s_barrier
    ds_read_b64_tr_b16 v[48:49], v5 offset:0
    ds_read_b64_tr_b16 v[50:51], v5 offset:512
    ds_read_b64_tr_b16 v[52:53], v5 offset:2048
    ds_read_b64_tr_b16 v[54:55], v5 offset:2560
    ds_read_b64_tr_b16 v[56:57], v6 offset:0
    ds_read_b64_tr_b16 v[58:59], v6 offset:512
    ds_read_b64_tr_b16 v[60:61], v6 offset:2048
    ds_read_b64_tr_b16 v[62:63], v6 offset:2560
    s_waitcnt lgkmcnt(0)
    ds_write_b128 v10, v[48:51] offset:32768
    ds_write_b128 v10, v[52:55] offset:33792
    ds_write_b128 v10, v[56:59] offset:34816
    ds_write_b128 v10, v[60:63] offset:35840
    s_waitcnt lgkmcnt(0)
    s_add_u32 s46, s49, 1048576
    buffer_load_dwordx4 v[64:67], v1, s[72:75], s46 offen
    s_add_u32 s46, s49, 1081344
    buffer_load_dwordx4 v[68:71], v1, s[72:75], s46 offen
    s_add_u32 s46, s49, 1114112
    buffer_load_dwordx4 v[72:75], v1, s[72:75], s46 offen
    s_add_u32 s46, s49, 1146880
    buffer_load_dwordx4 v[76:79], v1, s[72:75], s46 offen
    s_waitcnt vmcnt(12)
    ds_write_b128 v19, a[32:35] offset:0
    ds_write_b128 v19, a[36:39] offset:64
    ds_write_b128 v19, a[40:43] offset:128
    ds_write_b128 v19, a[44:47] offset:192
    s_waitcnt lgkmcnt(0)
    s_barrier
    ds_read_b64_tr_b16 a[32:33], v21 offset:0
    ds_read_b64_tr_b16 a[34:35], v21 offset:512
    ds_read_b64_tr_b16 a[36:37], v21 offset:2048
    ds_read_b64_tr_b16 a[38:39], v21 offset:2560
    ds_read_b64_tr_b16 a[40:41], v22 offset:0
    ds_read_b64_tr_b16 a[42:43], v22 offset:512
    ds_read_b64_tr_b16 a[44:45], v22 offset:2048
    ds_read_b64_tr_b16 a[46:47], v22 offset:2560
    s_waitcnt lgkmcnt(0)
    s_add_u32 s46, s49, 2097152
    buffer_load_dwordx4 a[112:115], v1, s[72:75], s46 offen
    s_add_u32 s46, s49, 2129920
    buffer_load_dwordx4 a[116:119], v1, s[72:75], s46 offen
    s_add_u32 s46, s49, 2162688
    buffer_load_dwordx4 a[120:123], v1, s[72:75], s46 offen
    s_add_u32 s46, s49, 2195456
    buffer_load_dwordx4 a[124:127], v1, s[72:75], s46 offen
    s_waitcnt vmcnt(12)
    ds_write_b128 v3, a[64:67] offset:0
    ds_write_b128 v3, a[68:71] offset:64
    ds_write_b128 v3, a[72:75] offset:128
    ds_write_b128 v3, a[76:79] offset:192
    s_waitcnt lgkmcnt(0)
    s_barrier
    ds_read_b64_tr_b16 a[64:65], v5 offset:0
    ds_read_b64_tr_b16 a[66:67], v5 offset:512
    ds_read_b64_tr_b16 a[68:69], v5 offset:2048
    ds_read_b64_tr_b16 a[70:71], v5 offset:2560
    ds_read_b64_tr_b16 a[72:73], v6 offset:0
    ds_read_b64_tr_b16 a[74:75], v6 offset:512
    ds_read_b64_tr_b16 a[76:77], v6 offset:2048
    ds_read_b64_tr_b16 a[78:79], v6 offset:2560
    s_waitcnt lgkmcnt(0)
    s_add_u32 s46, s49, 2621440
    buffer_load_dwordx4 a[128:131], v1, s[72:75], s46 offen
    s_add_u32 s46, s49, 2654208
    buffer_load_dwordx4 a[132:135], v1, s[72:75], s46 offen
    s_add_u32 s46, s49, 2686976
    buffer_load_dwordx4 a[136:139], v1, s[72:75], s46 offen
    s_add_u32 s46, s49, 2719744
    buffer_load_dwordx4 a[140:143], v1, s[72:75], s46 offen
    s_waitcnt vmcnt(12)
    ds_write_b128 v19, a[96:99] offset:0
    ds_write_b128 v19, a[100:103] offset:64
    ds_write_b128 v19, a[104:107] offset:128
    ds_write_b128 v19, a[108:111] offset:192
    s_waitcnt lgkmcnt(0)
    s_barrier
    ds_read_b64_tr_b16 a[96:97], v21 offset:0
    ds_read_b64_tr_b16 a[98:99], v21 offset:512
    ds_read_b64_tr_b16 a[100:101], v21 offset:2048
    ds_read_b64_tr_b16 a[102:103], v21 offset:2560
    ds_read_b64_tr_b16 a[104:105], v22 offset:0
    ds_read_b64_tr_b16 a[106:107], v22 offset:512
    ds_read_b64_tr_b16 a[108:109], v22 offset:2048
    ds_read_b64_tr_b16 a[110:111], v22 offset:2560
    s_waitcnt lgkmcnt(0)
    s_add_u32 s46, s49, 3145728
    buffer_load_dwordx4 a[144:147], v1, s[72:75], s46 offen
    s_add_u32 s46, s49, 3178496
    buffer_load_dwordx4 a[148:151], v1, s[72:75], s46 offen
    s_add_u32 s46, s49, 3211264
    buffer_load_dwordx4 a[152:155], v1, s[72:75], s46 offen
    s_add_u32 s46, s49, 3244032
    buffer_load_dwordx4 a[156:159], v1, s[72:75], s46 offen
    s_waitcnt vmcnt(12)
    ds_write_b128 v3, v[64:67] offset:0
    ds_write_b128 v3, v[68:71] offset:64
    ds_write_b128 v3, v[72:75] offset:128
    ds_write_b128 v3, v[76:79] offset:192
    s_waitcnt lgkmcnt(0)
    s_barrier
    ds_read_b64_tr_b16 v[64:65], v5 offset:0
    ds_read_b64_tr_b16 v[66:67], v5 offset:512
    ds_read_b64_tr_b16 v[68:69], v5 offset:2048
    ds_read_b64_tr_b16 v[70:71], v5 offset:2560
    ds_read_b64_tr_b16 v[72:73], v6 offset:0
    ds_read_b64_tr_b16 v[74:75], v6 offset:512
    ds_read_b64_tr_b16 v[76:77], v6 offset:2048
    ds_read_b64_tr_b16 v[78:79], v6 offset:2560
    s_waitcnt lgkmcnt(0)
    ds_write_b128 v10, v[64:67] offset:16384
    ds_write_b128 v10, v[68:71] offset:17408
    ds_write_b128 v10, v[72:75] offset:18432
    ds_write_b128 v10, v[76:79] offset:19456
    s_waitcnt lgkmcnt(0)
    s_add_u32 s46, s48, 0
    buffer_load_dwordx4 v[32:35], v2, s[76:79], s46 offen
    s_add_u32 s46, s48, 9216
    buffer_load_dwordx4 v[36:39], v2, s[76:79], s46 offen
    s_add_u32 s46, s48, 18432
    buffer_load_dwordx4 v[40:43], v2, s[76:79], s46 offen
    s_add_u32 s46, s48, 27648
    buffer_load_dwordx4 v[44:47], v2, s[76:79], s46 offen
    s_waitcnt vmcnt(12)
    ds_write_b128 v19, a[112:115] offset:0
    ds_write_b128 v19, a[116:119] offset:64
    ds_write_b128 v19, a[120:123] offset:128
    ds_write_b128 v19, a[124:127] offset:192
    s_waitcnt lgkmcnt(0)
    s_barrier
    ds_read_b64_tr_b16 a[112:113], v21 offset:0
    ds_read_b64_tr_b16 a[114:115], v21 offset:512
    ds_read_b64_tr_b16 a[116:117], v21 offset:2048
    ds_read_b64_tr_b16 a[118:119], v21 offset:2560
    ds_read_b64_tr_b16 a[120:121], v22 offset:0
    ds_read_b64_tr_b16 a[122:123], v22 offset:512
    ds_read_b64_tr_b16 a[124:125], v22 offset:2048
    ds_read_b64_tr_b16 a[126:127], v22 offset:2560
    s_waitcnt lgkmcnt(0)
    s_add_u32 s46, s49, 3670016
    buffer_load_dwordx4 a[160:163], v1, s[72:75], s46 offen
    s_add_u32 s46, s49, 3702784
    buffer_load_dwordx4 a[164:167], v1, s[72:75], s46 offen
    s_add_u32 s46, s49, 3735552
    buffer_load_dwordx4 a[168:171], v1, s[72:75], s46 offen
    s_add_u32 s46, s49, 3768320
    buffer_load_dwordx4 a[172:175], v1, s[72:75], s46 offen
    s_waitcnt vmcnt(12)
    ds_write_b128 v3, a[128:131] offset:0
    ds_write_b128 v3, a[132:135] offset:64
    ds_write_b128 v3, a[136:139] offset:128
    ds_write_b128 v3, a[140:143] offset:192
    s_waitcnt lgkmcnt(0)
    s_barrier
    ds_read_b64_tr_b16 a[128:129], v5 offset:0
    ds_read_b64_tr_b16 a[130:131], v5 offset:512
    ds_read_b64_tr_b16 a[132:133], v5 offset:2048
    ds_read_b64_tr_b16 a[134:135], v5 offset:2560
    ds_read_b64_tr_b16 a[136:137], v6 offset:0
    ds_read_b64_tr_b16 a[138:139], v6 offset:512
    ds_read_b64_tr_b16 a[140:141], v6 offset:2048
    ds_read_b64_tr_b16 a[142:143], v6 offset:2560
    s_waitcnt lgkmcnt(0)
    s_add_u32 s46, s49, 4194304
    buffer_load_dwordx4 a[176:179], v1, s[72:75], s46 offen
    s_add_u32 s46, s49, 4227072
    buffer_load_dwordx4 a[180:183], v1, s[72:75], s46 offen
    s_add_u32 s46, s49, 4259840
    buffer_load_dwordx4 a[184:187], v1, s[72:75], s46 offen
    s_add_u32 s46, s49, 4292608
    buffer_load_dwordx4 a[188:191], v1, s[72:75], s46 offen
    s_waitcnt vmcnt(12)
    ds_write_b128 v19, a[144:147] offset:0
    ds_write_b128 v19, a[148:151] offset:64
    ds_write_b128 v19, a[152:155] offset:128
    ds_write_b128 v19, a[156:159] offset:192
    s_waitcnt lgkmcnt(0)
    s_barrier
    ds_read_b64_tr_b16 a[144:145], v21 offset:0
    ds_read_b64_tr_b16 a[146:147], v21 offset:512
    ds_read_b64_tr_b16 a[148:149], v21 offset:2048
    ds_read_b64_tr_b16 a[150:151], v21 offset:2560
    ds_read_b64_tr_b16 a[152:153], v22 offset:0
    ds_read_b64_tr_b16 a[154:155], v22 offset:512
    ds_read_b64_tr_b16 a[156:157], v22 offset:2048
    ds_read_b64_tr_b16 a[158:159], v22 offset:2560
    s_waitcnt lgkmcnt(0)
    s_add_u32 s46, s48, 384
    buffer_load_dwordx4 a[192:195], v2, s[76:79], s46 offen
    s_add_u32 s46, s48, 9600
    buffer_load_dwordx4 a[196:199], v2, s[76:79], s46 offen
    s_add_u32 s46, s48, 18816
    buffer_load_dwordx4 a[200:203], v2, s[76:79], s46 offen
    s_add_u32 s46, s48, 28032
    buffer_load_dwordx4 a[204:207], v2, s[76:79], s46 offen
    s_waitcnt vmcnt(12)
    ds_write_b128 v4, v[32:35] offset:0
    ds_write_b128 v4, v[36:39] offset:256
    ds_write_b128 v4, v[40:43] offset:512
    ds_write_b128 v4, v[44:47] offset:768
    s_waitcnt lgkmcnt(0)
    s_barrier
    ds_read_b64_tr_b16 v[32:33], v7 offset:0
    ds_read_b64_tr_b16 v[34:35], v7 offset:64
    ds_read_b64_tr_b16 v[36:37], v7 offset:1024
    ds_read_b64_tr_b16 v[38:39], v7 offset:1088
    ds_read_b64_tr_b16 v[40:41], v7 offset:2048
    ds_read_b64_tr_b16 v[42:43], v7 offset:2112
    ds_read_b64_tr_b16 v[44:45], v7 offset:3072
    ds_read_b64_tr_b16 v[46:47], v7 offset:3136
    s_waitcnt lgkmcnt(0)
    ds_write_b128 v10, v[32:35] offset:0
    ds_write_b128 v10, v[36:39] offset:1024
    ds_write_b128 v10, v[40:43] offset:2048
    ds_write_b128 v10, v[44:47] offset:3072
    s_waitcnt lgkmcnt(0)
    s_add_u32 s46, s48, 128
    buffer_load_dwordx4 v[48:51], v2, s[76:79], s46 offen
    s_add_u32 s46, s48, 9344
    buffer_load_dwordx4 v[52:55], v2, s[76:79], s46 offen
    s_add_u32 s46, s48, 18560
    buffer_load_dwordx4 v[56:59], v2, s[76:79], s46 offen
    s_add_u32 s46, s48, 27776
    buffer_load_dwordx4 v[60:63], v2, s[76:79], s46 offen
    s_waitcnt vmcnt(12)
    ds_write_b128 v19, a[160:163] offset:0
    ds_write_b128 v19, a[164:167] offset:64
    ds_write_b128 v19, a[168:171] offset:128
    ds_write_b128 v19, a[172:175] offset:192
    s_waitcnt lgkmcnt(0)
    s_barrier
    ds_read_b64_tr_b16 a[160:161], v21 offset:0
    ds_read_b64_tr_b16 a[162:163], v21 offset:512
    ds_read_b64_tr_b16 a[164:165], v21 offset:2048
    ds_read_b64_tr_b16 a[166:167], v21 offset:2560
    ds_read_b64_tr_b16 a[168:169], v22 offset:0
    ds_read_b64_tr_b16 a[170:171], v22 offset:512
    ds_read_b64_tr_b16 a[172:173], v22 offset:2048
    ds_read_b64_tr_b16 a[174:175], v22 offset:2560
    s_waitcnt lgkmcnt(0)
    s_add_u32 s46, s48, 1024
    buffer_load_dwordx4 a[208:211], v2, s[76:79], s46 offen
    s_add_u32 s46, s48, 10240
    buffer_load_dwordx4 a[212:215], v2, s[76:79], s46 offen
    s_add_u32 s46, s48, 19456
    buffer_load_dwordx4 a[216:219], v2, s[76:79], s46 offen
    s_add_u32 s46, s48, 28672
    buffer_load_dwordx4 a[220:223], v2, s[76:79], s46 offen
    s_waitcnt vmcnt(12)
    ds_write_b128 v3, a[176:179] offset:0
    ds_write_b128 v3, a[180:183] offset:64
    ds_write_b128 v3, a[184:187] offset:128
    ds_write_b128 v3, a[188:191] offset:192
    s_waitcnt lgkmcnt(0)
    s_barrier
    ds_read_b64_tr_b16 a[176:177], v5 offset:0
    ds_read_b64_tr_b16 a[178:179], v5 offset:512
    ds_read_b64_tr_b16 a[180:181], v5 offset:2048
    ds_read_b64_tr_b16 a[182:183], v5 offset:2560
    ds_read_b64_tr_b16 a[184:185], v6 offset:0
    ds_read_b64_tr_b16 a[186:187], v6 offset:512
    ds_read_b64_tr_b16 a[188:189], v6 offset:2048
    ds_read_b64_tr_b16 a[190:191], v6 offset:2560
    s_waitcnt lgkmcnt(0)
    s_add_u32 s46, s48, 512
    buffer_load_dwordx4 a[224:227], v2, s[76:79], s46 offen
    s_add_u32 s46, s48, 9728
    buffer_load_dwordx4 a[228:231], v2, s[76:79], s46 offen
    s_add_u32 s46, s48, 18944
    buffer_load_dwordx4 a[232:235], v2, s[76:79], s46 offen
    s_add_u32 s46, s48, 28160
    buffer_load_dwordx4 a[236:239], v2, s[76:79], s46 offen
    s_waitcnt vmcnt(12)
    ds_write_b128 v20, a[192:195] offset:0
    ds_write_b128 v20, a[196:199] offset:256
    ds_write_b128 v20, a[200:203] offset:512
    ds_write_b128 v20, a[204:207] offset:768
    s_waitcnt lgkmcnt(0)
    s_barrier
    ds_read_b64_tr_b16 a[192:193], v23 offset:0
    ds_read_b64_tr_b16 a[194:195], v23 offset:64
    ds_read_b64_tr_b16 a[196:197], v23 offset:1024
    ds_read_b64_tr_b16 a[198:199], v23 offset:1088
    ds_read_b64_tr_b16 a[200:201], v23 offset:2048
    ds_read_b64_tr_b16 a[202:203], v23 offset:2112
    ds_read_b64_tr_b16 a[204:205], v23 offset:3072
    ds_read_b64_tr_b16 a[206:207], v23 offset:3136
    s_waitcnt lgkmcnt(0)
    s_add_u32 s46, s48, 640
    buffer_load_dwordx4 a[240:243], v2, s[76:79], s46 offen
    s_add_u32 s46, s48, 9856
    buffer_load_dwordx4 a[244:247], v2, s[76:79], s46 offen
    s_add_u32 s46, s48, 19072
    buffer_load_dwordx4 a[248:251], v2, s[76:79], s46 offen
    s_add_u32 s46, s48, 28288
    buffer_load_dwordx4 a[252:255], v2, s[76:79], s46 offen
    s_waitcnt vmcnt(12)
    ds_write_b128 v4, v[48:51] offset:0
    ds_write_b128 v4, v[52:55] offset:256
    ds_write_b128 v4, v[56:59] offset:512
    ds_write_b128 v4, v[60:63] offset:768
    s_waitcnt lgkmcnt(0)
    s_barrier
    ds_read_b64_tr_b16 v[48:49], v7 offset:0
    ds_read_b64_tr_b16 v[50:51], v7 offset:64
    ds_read_b64_tr_b16 v[52:53], v7 offset:1024
    ds_read_b64_tr_b16 v[54:55], v7 offset:1088
    ds_read_b64_tr_b16 v[56:57], v7 offset:2048
    ds_read_b64_tr_b16 v[58:59], v7 offset:2112
    ds_read_b64_tr_b16 v[60:61], v7 offset:3072
    ds_read_b64_tr_b16 v[62:63], v7 offset:3136
    s_waitcnt lgkmcnt(0)
    ds_write_b128 v10, v[48:51] offset:4096
    ds_write_b128 v10, v[52:55] offset:5120
    ds_write_b128 v10, v[56:59] offset:6144
    ds_write_b128 v10, v[60:63] offset:7168
    s_waitcnt lgkmcnt(0)
    s_add_u32 s46, s48, 256
    buffer_load_dwordx4 v[64:67], v2, s[76:79], s46 offen
    s_add_u32 s46, s48, 9472
    buffer_load_dwordx4 v[68:71], v2, s[76:79], s46 offen
    s_add_u32 s46, s48, 18688
    buffer_load_dwordx4 v[72:75], v2, s[76:79], s46 offen
    s_add_u32 s46, s48, 27904
    buffer_load_dwordx4 v[76:79], v2, s[76:79], s46 offen
    s_waitcnt vmcnt(12)
    ds_write_b128 v20, a[208:211] offset:0
    ds_write_b128 v20, a[212:215] offset:256
    ds_write_b128 v20, a[216:219] offset:512
    ds_write_b128 v20, a[220:223] offset:768
    s_waitcnt lgkmcnt(0)
    s_barrier
    ds_read_b64_tr_b16 a[208:209], v23 offset:0
    ds_read_b64_tr_b16 a[210:211], v23 offset:64
    ds_read_b64_tr_b16 a[212:213], v23 offset:1024
    ds_read_b64_tr_b16 a[214:215], v23 offset:1088
    ds_read_b64_tr_b16 a[216:217], v23 offset:2048
    ds_read_b64_tr_b16 a[218:219], v23 offset:2112
    ds_read_b64_tr_b16 a[220:221], v23 offset:3072
    ds_read_b64_tr_b16 a[222:223], v23 offset:3136
    s_waitcnt lgkmcnt(0)
    s_add_u32 s46, s49, 0
    buffer_load_dwordx4 v[80:83], v1, s[64:67], s46 offen
    s_add_u32 s46, s49, 32768
    buffer_load_dwordx4 v[84:87], v1, s[64:67], s46 offen
    s_add_u32 s46, s49, 65536
    buffer_load_dwordx4 v[88:91], v1, s[64:67], s46 offen
    s_add_u32 s46, s49, 98304
    buffer_load_dwordx4 v[92:95], v1, s[64:67], s46 offen
    s_waitcnt vmcnt(12)
    ds_write_b128 v4, a[224:227] offset:0
    ds_write_b128 v4, a[228:231] offset:256
    ds_write_b128 v4, a[232:235] offset:512
    ds_write_b128 v4, a[236:239] offset:768
    s_waitcnt lgkmcnt(0)
    s_barrier
    ds_read_b64_tr_b16 a[224:225], v7 offset:0
    ds_read_b64_tr_b16 a[226:227], v7 offset:64
    ds_read_b64_tr_b16 a[228:229], v7 offset:1024
    ds_read_b64_tr_b16 a[230:231], v7 offset:1088
    ds_read_b64_tr_b16 a[232:233], v7 offset:2048
    ds_read_b64_tr_b16 a[234:235], v7 offset:2112
    ds_read_b64_tr_b16 a[236:237], v7 offset:3072
    ds_read_b64_tr_b16 a[238:239], v7 offset:3136
    s_waitcnt lgkmcnt(0)
    s_add_u32 s46, s49, 524288
    buffer_load_dwordx4 v[112:115], v1, s[64:67], s46 offen
    s_add_u32 s46, s49, 557056
    buffer_load_dwordx4 v[116:119], v1, s[64:67], s46 offen
    s_add_u32 s46, s49, 589824
    buffer_load_dwordx4 v[120:123], v1, s[64:67], s46 offen
    s_add_u32 s46, s49, 622592
    buffer_load_dwordx4 v[124:127], v1, s[64:67], s46 offen
    s_waitcnt vmcnt(12)
    ds_write_b128 v20, a[240:243] offset:0
    ds_write_b128 v20, a[244:247] offset:256
    ds_write_b128 v20, a[248:251] offset:512
    ds_write_b128 v20, a[252:255] offset:768
    s_waitcnt lgkmcnt(0)
    s_barrier
    ds_read_b64_tr_b16 a[240:241], v23 offset:0
    ds_read_b64_tr_b16 a[242:243], v23 offset:64
    ds_read_b64_tr_b16 a[244:245], v23 offset:1024
    ds_read_b64_tr_b16 a[246:247], v23 offset:1088
    ds_read_b64_tr_b16 a[248:249], v23 offset:2048
    ds_read_b64_tr_b16 a[250:251], v23 offset:2112
    ds_read_b64_tr_b16 a[252:253], v23 offset:3072
    ds_read_b64_tr_b16 a[254:255], v23 offset:3136
    s_waitcnt lgkmcnt(0)
    s_add_u32 s46, s49, 1048576
    buffer_load_dwordx4 v[144:147], v1, s[64:67], s46 offen
    s_add_u32 s46, s49, 1081344
    buffer_load_dwordx4 v[148:151], v1, s[64:67], s46 offen
    s_add_u32 s46, s49, 1114112
    buffer_load_dwordx4 v[152:155], v1, s[64:67], s46 offen
    s_add_u32 s46, s49, 1146880
    buffer_load_dwordx4 v[156:159], v1, s[64:67], s46 offen
    s_waitcnt vmcnt(12)
    ds_write_b128 v4, v[64:67] offset:0
    ds_write_b128 v4, v[68:71] offset:256
    ds_write_b128 v4, v[72:75] offset:512
    ds_write_b128 v4, v[76:79] offset:768
    s_waitcnt lgkmcnt(0)
    s_barrier
    ds_read_b64_tr_b16 v[64:65], v7 offset:0
    ds_read_b64_tr_b16 v[66:67], v7 offset:64
    ds_read_b64_tr_b16 v[68:69], v7 offset:1024
    ds_read_b64_tr_b16 v[70:71], v7 offset:1088
    ds_read_b64_tr_b16 v[72:73], v7 offset:2048
    ds_read_b64_tr_b16 v[74:75], v7 offset:2112
    ds_read_b64_tr_b16 v[76:77], v7 offset:3072
    ds_read_b64_tr_b16 v[78:79], v7 offset:3136
    s_waitcnt lgkmcnt(0)
    ds_write_b128 v10, v[64:67] offset:8192
    ds_write_b128 v10, v[68:71] offset:9216
    ds_write_b128 v10, v[72:75] offset:10240
    ds_write_b128 v10, v[76:79] offset:11264
    s_waitcnt lgkmcnt(0)
    s_add_u32 s46, s48, 768
    buffer_load_dwordx4 v[32:35], v2, s[76:79], s46 offen
    s_add_u32 s46, s48, 9984
    buffer_load_dwordx4 v[36:39], v2, s[76:79], s46 offen
    s_add_u32 s46, s48, 19200
    buffer_load_dwordx4 v[40:43], v2, s[76:79], s46 offen
    s_add_u32 s46, s48, 28416
    buffer_load_dwordx4 v[44:47], v2, s[76:79], s46 offen
    s_waitcnt vmcnt(12)
    ds_write_b128 v19, v[80:83] offset:0
    ds_write_b128 v19, v[84:87] offset:64
    ds_write_b128 v19, v[88:91] offset:128
    ds_write_b128 v19, v[92:95] offset:192
    s_waitcnt lgkmcnt(0)
    s_barrier
    ds_read_b64_tr_b16 v[80:81], v21 offset:0
    ds_read_b64_tr_b16 v[82:83], v21 offset:512
    ds_read_b64_tr_b16 v[84:85], v21 offset:2048
    ds_read_b64_tr_b16 v[86:87], v21 offset:2560
    ds_read_b64_tr_b16 v[88:89], v22 offset:0
    ds_read_b64_tr_b16 v[90:91], v22 offset:512
    ds_read_b64_tr_b16 v[92:93], v22 offset:2048
    ds_read_b64_tr_b16 v[94:95], v22 offset:2560
    s_waitcnt lgkmcnt(0)
    s_add_u32 s46, s49, 1572864
    buffer_load_dwordx4 v[176:179], v1, s[64:67], s46 offen
    s_add_u32 s46, s49, 1605632
    buffer_load_dwordx4 v[180:183], v1, s[64:67], s46 offen
    s_add_u32 s46, s49, 1638400
    buffer_load_dwordx4 v[184:187], v1, s[64:67], s46 offen
    s_add_u32 s46, s49, 1671168
    buffer_load_dwordx4 v[188:191], v1, s[64:67], s46 offen
    s_waitcnt vmcnt(12)
    ds_write_b128 v3, v[112:115] offset:0
    ds_write_b128 v3, v[116:119] offset:64
    ds_write_b128 v3, v[120:123] offset:128
    ds_write_b128 v3, v[124:127] offset:192
    s_waitcnt lgkmcnt(0)
    s_barrier
    ds_read_b64_tr_b16 v[112:113], v5 offset:0
    ds_read_b64_tr_b16 v[114:115], v5 offset:512
    ds_read_b64_tr_b16 v[116:117], v5 offset:2048
    ds_read_b64_tr_b16 v[118:119], v5 offset:2560
    ds_read_b64_tr_b16 v[120:121], v6 offset:0
    ds_read_b64_tr_b16 v[122:123], v6 offset:512
    ds_read_b64_tr_b16 v[124:125], v6 offset:2048
    ds_read_b64_tr_b16 v[126:127], v6 offset:2560
    s_waitcnt lgkmcnt(0)
    s_add_u32 s46, s49, 2097152
    buffer_load_dwordx4 v[208:211], v1, s[64:67], s46 offen
    s_add_u32 s46, s49, 2129920
    buffer_load_dwordx4 v[212:215], v1, s[64:67], s46 offen
    s_add_u32 s46, s49, 2162688
    buffer_load_dwordx4 v[216:219], v1, s[64:67], s46 offen
    s_add_u32 s46, s49, 2195456
    buffer_load_dwordx4 v[220:223], v1, s[64:67], s46 offen
    s_waitcnt vmcnt(12)
    ds_write_b128 v19, v[144:147] offset:0
    ds_write_b128 v19, v[148:151] offset:64
    ds_write_b128 v19, v[152:155] offset:128
    ds_write_b128 v19, v[156:159] offset:192
    s_waitcnt lgkmcnt(0)
    s_barrier
    ds_read_b64_tr_b16 v[144:145], v21 offset:0
    ds_read_b64_tr_b16 v[146:147], v21 offset:512
    ds_read_b64_tr_b16 v[148:149], v21 offset:2048
    ds_read_b64_tr_b16 v[150:151], v21 offset:2560
    ds_read_b64_tr_b16 v[152:153], v22 offset:0
    ds_read_b64_tr_b16 v[154:155], v22 offset:512
    ds_read_b64_tr_b16 v[156:157], v22 offset:2048
    ds_read_b64_tr_b16 v[158:159], v22 offset:2560
    s_waitcnt lgkmcnt(0)
    s_add_u32 s46, s49, 2621440
    buffer_load_dwordx4 v[240:243], v1, s[64:67], s46 offen
    s_add_u32 s46, s49, 2654208
    buffer_load_dwordx4 v[244:247], v1, s[64:67], s46 offen
    s_add_u32 s46, s49, 2686976
    buffer_load_dwordx4 v[248:251], v1, s[64:67], s46 offen
    s_add_u32 s46, s49, 2719744
    buffer_load_dwordx4 v[252:255], v1, s[64:67], s46 offen
    s_waitcnt vmcnt(12)
    ds_write_b128 v4, v[32:35] offset:0
    ds_write_b128 v4, v[36:39] offset:256
    ds_write_b128 v4, v[40:43] offset:512
    ds_write_b128 v4, v[44:47] offset:768
    s_waitcnt lgkmcnt(0)
    s_barrier
    ds_read_b64_tr_b16 v[32:33], v7 offset:0
    ds_read_b64_tr_b16 v[34:35], v7 offset:64
    ds_read_b64_tr_b16 v[36:37], v7 offset:1024
    ds_read_b64_tr_b16 v[38:39], v7 offset:1088
    ds_read_b64_tr_b16 v[40:41], v7 offset:2048
    ds_read_b64_tr_b16 v[42:43], v7 offset:2112
    ds_read_b64_tr_b16 v[44:45], v7 offset:3072
    ds_read_b64_tr_b16 v[46:47], v7 offset:3136
    s_waitcnt lgkmcnt(0)
    ds_write_b128 v10, v[32:35] offset:24576
    ds_write_b128 v10, v[36:39] offset:25600
    ds_write_b128 v10, v[40:43] offset:26624
    ds_write_b128 v10, v[44:47] offset:27648
    s_waitcnt lgkmcnt(0)
    s_add_u32 s46, s48, 896
    buffer_load_dwordx4 v[48:51], v2, s[76:79], s46 offen
    s_add_u32 s46, s48, 10112
    buffer_load_dwordx4 v[52:55], v2, s[76:79], s46 offen
    s_add_u32 s46, s48, 19328
    buffer_load_dwordx4 v[56:59], v2, s[76:79], s46 offen
    s_add_u32 s46, s48, 28544
    buffer_load_dwordx4 v[60:63], v2, s[76:79], s46 offen
    s_waitcnt vmcnt(12)
    ds_write_b128 v19, v[176:179] offset:0
    ds_write_b128 v19, v[180:183] offset:64
    ds_write_b128 v19, v[184:187] offset:128
    ds_write_b128 v19, v[188:191] offset:192
    s_waitcnt lgkmcnt(0)
    s_barrier
    ds_read_b64_tr_b16 v[176:177], v21 offset:0
    ds_read_b64_tr_b16 v[178:179], v21 offset:512
    ds_read_b64_tr_b16 v[180:181], v21 offset:2048
    ds_read_b64_tr_b16 v[182:183], v21 offset:2560
    ds_read_b64_tr_b16 v[184:185], v22 offset:0
    ds_read_b64_tr_b16 v[186:187], v22 offset:512
    ds_read_b64_tr_b16 v[188:189], v22 offset:2048
    ds_read_b64_tr_b16 v[190:191], v22 offset:2560
    s_waitcnt lgkmcnt(0)
    s_add_u32 s46, s49, 3145728
    buffer_load_dwordx4 a[16:19], v1, s[64:67], s46 offen
    s_add_u32 s46, s49, 3178496
    buffer_load_dwordx4 a[20:23], v1, s[64:67], s46 offen
    s_add_u32 s46, s49, 3211264
    buffer_load_dwordx4 a[24:27], v1, s[64:67], s46 offen
    s_add_u32 s46, s49, 3244032
    buffer_load_dwordx4 a[28:31], v1, s[64:67], s46 offen
    s_waitcnt vmcnt(12)
    ds_write_b128 v3, v[208:211] offset:0
    ds_write_b128 v3, v[212:215] offset:64
    ds_write_b128 v3, v[216:219] offset:128
    ds_write_b128 v3, v[220:223] offset:192
    s_waitcnt lgkmcnt(0)
    s_barrier
    ds_read_b64_tr_b16 v[208:209], v5 offset:0
    ds_read_b64_tr_b16 v[210:211], v5 offset:512
    ds_read_b64_tr_b16 v[212:213], v5 offset:2048
    ds_read_b64_tr_b16 v[214:215], v5 offset:2560
    ds_read_b64_tr_b16 v[216:217], v6 offset:0
    ds_read_b64_tr_b16 v[218:219], v6 offset:512
    ds_read_b64_tr_b16 v[220:221], v6 offset:2048
    ds_read_b64_tr_b16 v[222:223], v6 offset:2560
    s_waitcnt lgkmcnt(0)
    s_add_u32 s46, s49, 3670016
    buffer_load_dwordx4 a[48:51], v1, s[64:67], s46 offen
    s_add_u32 s46, s49, 3702784
    buffer_load_dwordx4 a[52:55], v1, s[64:67], s46 offen
    s_add_u32 s46, s49, 3735552
    buffer_load_dwordx4 a[56:59], v1, s[64:67], s46 offen
    s_add_u32 s46, s49, 3768320
    buffer_load_dwordx4 a[60:63], v1, s[64:67], s46 offen
    s_waitcnt vmcnt(12)
    ds_write_b128 v19, v[240:243] offset:0
    ds_write_b128 v19, v[244:247] offset:64
    ds_write_b128 v19, v[248:251] offset:128
    ds_write_b128 v19, v[252:255] offset:192
    s_waitcnt lgkmcnt(0)
    s_barrier
    ds_read_b64_tr_b16 v[240:241], v21 offset:0
    ds_read_b64_tr_b16 v[242:243], v21 offset:512
    ds_read_b64_tr_b16 v[244:245], v21 offset:2048
    ds_read_b64_tr_b16 v[246:247], v21 offset:2560
    ds_read_b64_tr_b16 v[248:249], v22 offset:0
    ds_read_b64_tr_b16 v[250:251], v22 offset:512
    ds_read_b64_tr_b16 v[252:253], v22 offset:2048
    ds_read_b64_tr_b16 v[254:255], v22 offset:2560
    s_waitcnt lgkmcnt(0)
    s_add_u32 s46, s49, 4194304
    buffer_load_dwordx4 a[80:83], v1, s[64:67], s46 offen
    s_add_u32 s46, s49, 4227072
    buffer_load_dwordx4 a[84:87], v1, s[64:67], s46 offen
    s_add_u32 s46, s49, 4259840
    buffer_load_dwordx4 a[88:91], v1, s[64:67], s46 offen
    s_add_u32 s46, s49, 4292608
    buffer_load_dwordx4 a[92:95], v1, s[64:67], s46 offen
    s_waitcnt vmcnt(12)
    ds_write_b128 v4, v[48:51] offset:0
    ds_write_b128 v4, v[52:55] offset:256
    ds_write_b128 v4, v[56:59] offset:512
    ds_write_b128 v4, v[60:63] offset:768
    s_waitcnt lgkmcnt(0)
    s_barrier
    ds_read_b64_tr_b16 v[48:49], v7 offset:0
    ds_read_b64_tr_b16 v[50:51], v7 offset:64
    ds_read_b64_tr_b16 v[52:53], v7 offset:1024
    ds_read_b64_tr_b16 v[54:55], v7 offset:1088
    ds_read_b64_tr_b16 v[56:57], v7 offset:2048
    ds_read_b64_tr_b16 v[58:59], v7 offset:2112
    ds_read_b64_tr_b16 v[60:61], v7 offset:3072
    ds_read_b64_tr_b16 v[62:63], v7 offset:3136
    s_waitcnt lgkmcnt(0)
    ds_write_b128 v10, v[48:51] offset:28672
    ds_write_b128 v10, v[52:55] offset:29696
    ds_write_b128 v10, v[56:59] offset:30720
    ds_write_b128 v10, v[60:63] offset:31744
    s_waitcnt lgkmcnt(0)
    s_add_u32 s46, s49, 1572864
    buffer_load_dwordx4 v[64:67], v1, s[72:75], s46 offen
    s_add_u32 s46, s49, 1605632
    buffer_load_dwordx4 v[68:71], v1, s[72:75], s46 offen
    s_add_u32 s46, s49, 1638400
    buffer_load_dwordx4 v[72:75], v1, s[72:75], s46 offen
    s_add_u32 s46, s49, 1671168
    buffer_load_dwordx4 v[76:79], v1, s[72:75], s46 offen
    s_waitcnt vmcnt(12)
    ds_write_b128 v19, a[16:19] offset:0
    ds_write_b128 v19, a[20:23] offset:64
    ds_write_b128 v19, a[24:27] offset:128
    ds_write_b128 v19, a[28:31] offset:192
    s_waitcnt lgkmcnt(0)
    s_barrier
    ds_read_b64_tr_b16 a[16:17], v21 offset:0
    ds_read_b64_tr_b16 a[18:19], v21 offset:512
    ds_read_b64_tr_b16 a[20:21], v21 offset:2048
    ds_read_b64_tr_b16 a[22:23], v21 offset:2560
    ds_read_b64_tr_b16 a[24:25], v22 offset:0
    ds_read_b64_tr_b16 a[26:27], v22 offset:512
    ds_read_b64_tr_b16 a[28:29], v22 offset:2048
    ds_read_b64_tr_b16 a[30:31], v22 offset:2560
    s_waitcnt lgkmcnt(0)
    s_waitcnt vmcnt(8)
    ds_write_b128 v3, a[48:51] offset:0
    ds_write_b128 v3, a[52:55] offset:64
    ds_write_b128 v3, a[56:59] offset:128
    ds_write_b128 v3, a[60:63] offset:192
    s_waitcnt lgkmcnt(0)
    s_barrier
    ds_read_b64_tr_b16 a[48:49], v5 offset:0
    ds_read_b64_tr_b16 a[50:51], v5 offset:512
    ds_read_b64_tr_b16 a[52:53], v5 offset:2048
    ds_read_b64_tr_b16 a[54:55], v5 offset:2560
    ds_read_b64_tr_b16 a[56:57], v6 offset:0
    ds_read_b64_tr_b16 a[58:59], v6 offset:512
    ds_read_b64_tr_b16 a[60:61], v6 offset:2048
    ds_read_b64_tr_b16 a[62:63], v6 offset:2560
    s_waitcnt lgkmcnt(0)
    s_waitcnt vmcnt(4)
    ds_write_b128 v19, a[80:83] offset:0
    ds_write_b128 v19, a[84:87] offset:64
    ds_write_b128 v19, a[88:91] offset:128
    ds_write_b128 v19, a[92:95] offset:192
    s_waitcnt lgkmcnt(0)
    s_barrier
    ds_read_b64_tr_b16 a[80:81], v21 offset:0
    ds_read_b64_tr_b16 a[82:83], v21 offset:512
    ds_read_b64_tr_b16 a[84:85], v21 offset:2048
    ds_read_b64_tr_b16 a[86:87], v21 offset:2560
    ds_read_b64_tr_b16 a[88:89], v22 offset:0
    ds_read_b64_tr_b16 a[90:91], v22 offset:512
    ds_read_b64_tr_b16 a[92:93], v22 offset:2048
    ds_read_b64_tr_b16 a[94:95], v22 offset:2560
    s_waitcnt lgkmcnt(0)
    s_waitcnt vmcnt(0)
    ds_write_b128 v3, v[64:67] offset:0
    ds_write_b128 v3, v[68:71] offset:64
    ds_write_b128 v3, v[72:75] offset:128
    ds_write_b128 v3, v[76:79] offset:192
    s_waitcnt lgkmcnt(0)
    s_barrier
    ds_read_b64_tr_b16 v[64:65], v5 offset:0
    ds_read_b64_tr_b16 v[66:67], v5 offset:512
    ds_read_b64_tr_b16 v[68:69], v5 offset:2048
    ds_read_b64_tr_b16 v[70:71], v5 offset:2560
    ds_read_b64_tr_b16 v[72:73], v6 offset:0
    ds_read_b64_tr_b16 v[74:75], v6 offset:512
    ds_read_b64_tr_b16 v[76:77], v6 offset:2048
    ds_read_b64_tr_b16 v[78:79], v6 offset:2560
    s_waitcnt lgkmcnt(0)
    s_barrier
    ds_write_b128 v10, v[64:67] offset:20480
    ds_write_b128 v10, v[68:71] offset:21504
    ds_write_b128 v10, v[72:75] offset:22528
    ds_write_b128 v10, v[76:79] offset:23552
    s_waitcnt lgkmcnt(0)
    v_mov_b32 v6, 163728
    s_cmp_eq_u32 s13, 0
    s_cbranch_scc0 L_twd_3
    s_mov_b32 s21, 0
        L_tw_2:
    buffer_load_dword v2, off, s[8:11], 0 offset:8 sc1
    buffer_load_dword v3, off, s[8:11], 0 offset:132 sc1
    buffer_load_dword v4, off, s[8:11], 0 offset:128 sc1
    s_add_u32 s21, s21, 1
    s_cmp_gt_u32 s21, 3000000
    s_cbranch_scc1 L_failA
    s_waitcnt vmcnt(0)
    v_readfirstlane_b32 s60, v2
    v_readfirstlane_b32 s61, v3
    v_readfirstlane_b32 s62, v4
    s_cmp_ge_u32 s62, 0x10000
    s_cbranch_scc1 L_tw_2_out
    s_cmp_lt_u32 s62, 32
    s_cbranch_scc1 L_tw_2
    s_cmp_lt_u32 s61, 32
    s_cbranch_scc1 L_tw_2
    s_cmp_eq_u32 s60, 0
    s_cbranch_scc1 L_tw_2
        L_tw_2_out:
    ds_write_b32 v6, v4
    s_waitcnt lgkmcnt(0)
        L_twd_3:
    s_barrier
    ds_read_b32 v4, v6
    s_waitcnt lgkmcnt(0)
    v_readfirstlane_b32 s62, v4
    s_cmp_ge_u32 s62, 0x10000
    s_cbranch_scc1 L_work
    s_mov_b32 s60, 3
    s_mov_b32 s15, 5
    v_mov_b32 v3, 163744
    s_cmp_eq_u32 s13, 0
    s_cbranch_scc0 L_wkd_5
    s_mov_b32 s21, 0
    v_mbcnt_lo_u32_b32 v4, -1, 0
    v_min_u32 v4, 3, v4
    v_lshlrev_b32 v4, 2, v4
        L_wk_4:
    buffer_load_dword v2, v4, s[4:7], s58 offen sc1
    s_add_u32 s21, s21, 1
    s_cmp_gt_u32 s21, 3000000
    s_cbranch_scc1 L_failA
    s_waitcnt vmcnt(0)
    v_cmp_gt_u32 vcc, s60, v2
    s_cbranch_vccnz L_wk_4
    s_nop 0
    v_min_u32_dpp v2, v2, v2 quad_perm:[1,0,3,2] row_mask:0xf bank_mask:0xf
    s_nop 1
    v_min_u32_dpp v2, v2, v2 quad_perm:[2,3,0,1] row_mask:0xf bank_mask:0xf
    s_nop 1
    v_min_u32_dpp v2, v2, v2 row_half_mirror row_mask:0xf bank_mask:0xf
    s_mov_b64 exec, 1
    ds_write_b32 v3, v2
    s_mov_b64 exec, -1
    s_waitcnt lgkmcnt(0)
        L_wkd_5:
    s_barrier
    ds_read_b32 v2, v3
    s_waitcnt lgkmcnt(0)
    v_readfirstlane_b32 s61, v2
    v_and_b32 v1, 63, v0
    v_lshlrev_b32 v78, 4, v1
    v_add_u32 v78, 147456, v78
    v_and_b32 v2, 15, v1
    v_lshrrev_b32 v3, 4, v1
    v_mov_b32 v20, 1073741824
    v_mov_b32 v21, 0x3f80
    v_mov_b32 v22, 0x3f800000
    v_mov_b32 v23, 0
    v_and_b32 v4, 2, v2
    v_cmp_ne_u32 vcc, 0, v4
    v_mov_b32 v5, 0x4444
    v_mov_b32 v6, 0xeeee
    v_cndmask_b32 v79, v5, v6, vcc
    v_lshrrev_b32 v4, 2, v2
    v_lshlrev_b32 v4, 1, v4
    v_and_b32 v7, 1, v2
    v_add_u32 v19, v4, v7
    v_lshlrev_b32 v5, 1, v3
    v_add_u32 v6, 1, v5
    v_cmp_eq_u32 vcc, v19, v5
    v_cmp_eq_u32 s[46:47], v19, v6
    s_nop 0
    v_cndmask_b32 v7, v23, v21, vcc
    v_cndmask_b32 v76, v7, v22, s[46:47]
    v_and_b32 v5, 1, v3
    v_lshl_add_u32 v4, v5, 1, v2
    v_lshlrev_b32 v4, 4, v4
    v_lshrrev_b32 v5, 1, v3
    v_lshl_add_u32 v4, v5, 8, v4
    v_add_u32 v4, 151552, v4
    v_and_b32 v5, 2, v2
    v_cmp_eq_u32 vcc, 0, v5
    v_mov_b32 v5, 160768
    v_lshl_add_u32 v6, v3, 3, v19
    v_cndmask_b32 v10, v5, v4, vcc
    v_lshlrev_b32 v6, 4, v6
    v_cndmask_b32 v12, v20, v6, vcc
    v_lshrrev_b32 v4, 3, v1
    v_lshlrev_b32 v4, 11, v4
    v_and_b32 v5, 7, v1
    v_lshl_add_u32 v11, v5, 3, v4
    v_lshlrev_b32 v4, 6, v2
    v_lshl_add_u32 v13, v3, 4, v4
    ds_write_b128 v78, v[10:13] offset:9216
    v_and_b32 v4, 3, v1
    v_bfe_u32 v5, v1, 2, 2
    v_lshl_add_u32 v6, v3, 2, v4
    v_lshlrev_b32 v6, 6, v6
    v_lshl_add_u32 v14, v5, 4, v6
    v_lshrrev_b32 v6, 1, v2
    v_lshlrev_b32 v6, 10, v6
    v_and_b32 v7, 1, v2
    v_lshl_add_u32 v6, v7, 4, v6
    v_lshl_add_u32 v6, v3, 2, v6
    v_cmp_gt_u32 vcc, 4, v2
    s_nop 1
    v_cndmask_b32 v15, v20, v6, vcc
    v_lshrrev_b32 v6, 1, v5
    v_lshl_add_u32 v6, v6, 2, v4
    v_lshl_add_u32 v6, v3, 3, v6
    v_lshlrev_b32 v6, 5, v6
    v_and_b32 v7, 1, v5
    v_lshl_add_u32 v16, v7, 4, v6
    v_and_b32 v6, 1, v2
    v_lshlrev_b32 v6, 4, v6
    v_lshrrev_b32 v7, 2, v2
    v_lshl_add_u32 v7, v3, 1, v7
    v_lshl_add_u32 v6, v7, 2, v6
    v_and_b32 v7, 0x2a, v1
    v_cmp_eq_u32 vcc, 0, v7
    s_nop 1
    v_cndmask_b32 v17, v20, v6, vcc
    ds_write_b128 v78, v[14:17] offset:10240
    v_and_b32 v4, 7, v2
    v_lshrrev_b32 v5, 1, v4
    v_and_b32 v6, 1, v4
    v_cmp_eq_u32 vcc, 1, v6
    s_nop 1
    v_cndmask_b32 v6, v21, v22, vcc
    v_cmp_eq_u32 vcc, 0, v5
    s_nop 1
    v_cndmask_b32 v24, v23, v6, vcc
    v_cmp_eq_u32 vcc, 1, v5
    s_nop 1
    v_cndmask_b32 v25, v23, v6, vcc
    v_cmp_eq_u32 vcc, 2, v5
    s_nop 1
    v_cndmask_b32 v26, v23, v6, vcc
    v_cmp_eq_u32 vcc, 3, v5
    s_nop 1
    v_cndmask_b32 v27, v23, v6, vcc
    ds_write_b128 v78, v[24:27] offset:11264
    v_mov_b32 v77, v76
    ds_write_b64 v78, v[76:77] offset:12288
    s_mov_b32 s22, 0xcccccccc
    s_mov_b32 s23, 0xcccccccc
    s_mov_b32 s56, 0x3f803f80
    s_mov_b32 s57, 0x3f803f80
    s_mov_b32 s42, 0x3e0293ee
    s_mov_b32 s44, 0x42700000
    s_lshl_b32 s46, s13, 14
    s_lshl_b32 s47, s12, 6
    s_add_u32 s46, s46, s47
    s_add_u32 s21, s46, s50
    s_mov_b32 m0, 162816
    s_sub_u32 s31, s52, 147456
    s_add_u32 s32, s31, 4096
    s_add_u32 s33, s31, 8192
    s_and_b32 s46, s14, 1
    s_mul_i32 s39, s46, 294912
    s_add_u32 s46, s14, 1
    s_mul_hi_u32 s47, s46, 0x55555556
    s_mul_i32 s47, s47, 3
    s_sub_u32 s46, s46, s47
    s_mul_i32 s40, s46, 9216
    s_add_u32 s41, s40, 9216
    s_cmp_eq_u32 s41, 27648
    s_cselect_b32 s41, 0, s41
    s_lshl_b32 s54, s14, 5
    s_add_u32 s54, s54, s12
    s_lshl_b32 s47, s54, 14
    s_lshl_b32 s48, s13, 11
    s_add_u32 s47, s47, s48
    s_add_u32 s34, s47, 16629760
    s_waitcnt lgkmcnt(0)
    s_barrier
        L_runF:
    s_cmp_eq_u32 s13, 1
    s_cbranch_scc1 L_entryF1
    s_cmp_eq_u32 s13, 2
    s_cbranch_scc1 L_entryF2
    s_cmp_eq_u32 s13, 3
    s_cbranch_scc1 L_entryF3
L_entryF0:
    ds_read_b128 v[8:11], v78 offset:10240
    v_mov_b32 v65, -1
    s_waitcnt lgkmcnt(0)
    v_mov_b32 v64, v9
    v_mov_b32 v66, v11
    s_branch L_stepF0
.p2align 6
L_stepF0:
    s_add_u32 s38, s34, 4294451200
    s_cmp_lt_u32 s14, 62
    s_cselect_b32 s38, s38, 1073741824
    s_lshl_b32 s47, s54, 11
    s_add_u32 s36, s47, 50331648
    s_lshl_b32 s47, s47, 1
    s_add_u32 s37, s47, 54525952
    s_add_u32 s16, s21, s39
    s_add_u32 s17, s16, 65536
    s_add_u32 s18, s16, 131072
    s_add_u32 s19, s16, 196608
    s_lshl_b32 s46, s12, 5
    s_add_u32 s48, s50, s39
    s_add_u32 s49, s48, s46
    s_add_u32 s20, s49, 262144
    s_add_u32 s46, s46, s51
    s_add_u32 s47, s46, s40
    s_add_u32 s27, s47, 0
    s_add_u32 s28, s47, 8192
    s_lshl_b32 s46, s12, 11
    s_add_u32 s46, s46, s48
    s_add_u32 s25, s46, 0
    s_lshl_b32 s46, s12, 10
    s_add_u32 s46, s46, s48
    s_add_u32 s26, s46, 262144
    s_bfe_u32 s24, s14, 0x10001
    s_waitcnt vmcnt(1)
    v_mov_b64 v[36:37], 0
    v_mov_b64 v[38:39], 0
    v_mov_b64 v[40:41], 0
    v_mov_b64 v[42:43], 0
    v_mov_b64 v[44:45], 0
    v_mov_b64 v[46:47], 0
    v_mov_b64 v[48:49], 0
    v_mov_b64 v[50:51], 0
    v_mov_b64 v[52:53], 0
    v_mov_b64 v[54:55], 0
    v_mov_b64 v[56:57], 0
    v_mov_b64 v[58:59], 0
    v_add_u32 v77, 4294819840, v78
    s_nop 15
    s_nop 3
    buffer_load_dwordx4 v[0:3], v78, s[4:7], s31 offen offset:0 sc1
    buffer_load_dwordx4 v[8:11], v78, s[4:7], s31 offen offset:2048 sc1
    s_nop 15
    s_nop 13
    buffer_load_dwordx4 v[68:71], v78, s[4:7], s31 offen offset:0 sc1
    buffer_load_dwordx4 v[72:75], v78, s[4:7], s31 offen offset:2048 sc1
    s_waitcnt vmcnt(2)
    v_max3_u32 v76, v0, v1, v2
    v_max3_u32 v76, v76, v3, v8
    v_max3_u32 v76, v76, v9, v10
    v_max_u32 v76, v76, v11
    v_cmp_eq_u32 vcc, -1, v76
    ds_write_b128 v78, v[0:3] offset:0
    ds_write_b128 v78, v[8:11] offset:2048
    s_cbranch_vccnz L_mpF0_6
L_mdF0_7:
    s_nop 0
    v_smfmac_f32_16x16x64_bf16 v[48:51], v[0:3], v[104:111], v79
    s_add_u32 s35, s34, 8192
    v_smfmac_f32_16x16x64_bf16 v[36:39], v[0:3], v[80:87], v79
    v_smfmac_f32_16x16x64_bf16 v[40:43], v[0:3], v[88:95], v79
    v_smfmac_f32_16x16x64_bf16 v[48:51], v[8:11], v[168:175], v79
    buffer_load_dwordx4 v[16:19], v78, s[4:7], s32 offen offset:0 sc1
    s_waitcnt lgkmcnt(0)
    s_barrier
    ds_read_b128 v[4:7], v78 offset:1024
    v_smfmac_f32_16x16x64_bf16 v[44:47], v[0:3], v[96:103], v79
    ds_read_b128 v[12:15], v78 offset:3072
    v_smfmac_f32_16x16x64_bf16 v[36:39], v[8:11], v[144:151], v79
    s_waitcnt vmcnt(1)
    buffer_load_dwordx4 v[32:35], v78, s[4:7], s33 offen offset:0 sc1
    ds_read_b128 v[68:71], v77 offset:12288
    v_smfmac_f32_16x16x64_bf16 v[40:43], v[8:11], v[152:159], v79
    ds_read_b128 v[72:75], v77 offset:13312
    v_smfmac_f32_16x16x64_bf16 v[44:47], v[8:11], v[160:167], v79
    ds_read_b128 v[24:27], v77 offset:14336
    s_waitcnt lgkmcnt(4)
    v_smfmac_f32_16x16x64_bf16 v[36:39], v[4:7], v[112:119], v79
    ds_read_b128 v[28:31], v77 offset:15360
    buffer_store_dword v65, v64, s[4:7], s27 offen
    v_smfmac_f32_16x16x64_bf16 v[40:43], v[4:7], v[120:127], v79
    buffer_load_dwordx4 v[60:63], v78, s[4:7], s34 offen sc1
    s_waitcnt lgkmcnt(2)
    v_smfmac_f32_16x16x64_bf16 v[52:55], v[0:3], v[68:75], v79
    ds_read_b128 v[72:75], v77 offset:17408
    v_smfmac_f32_16x16x64_bf16 v[36:39], v[12:15], v[176:183], v79
    ds_read_b128 v[68:71], v77 offset:16384
    s_waitcnt lgkmcnt(2)
    v_smfmac_f32_16x16x64_bf16 v[56:59], v[0:3], v[24:31], v79
    ds_read_b128 v[28:31], v77 offset:19456
    buffer_load_dwordx4 v[64:67], v78, s[4:7], s34 offen offset:1024 sc1
    ds_read_b128 v[24:27], v77 offset:18432
    v_smfmac_f32_16x16x64_bf16 v[44:47], v[4:7], v[128:135], v79
    v_smfmac_f32_16x16x64_bf16 v[48:51], v[4:7], v[136:143], v79
    v_smfmac_f32_16x16x64_bf16 v[40:43], v[12:15], v[184:191], v79
    s_waitcnt lgkmcnt(2)
    v_smfmac_f32_16x16x64_bf16 v[52:55], v[8:11], v[68:75], v79
    ds_read_b128 v[68:71], v77 offset:32768
    v_smfmac_f32_16x16x64_bf16 v[44:47], v[12:15], v[192:199], v79
    ds_read_b128 v[72:75], v77 offset:33792
    s_waitcnt lgkmcnt(2)
    v_smfmac_f32_16x16x64_bf16 v[56:59], v[8:11], v[24:31], v79
    ds_read_b128 v[28:31], v77 offset:35840
    s_waitcnt vmcnt(4)
    v_max3_u32 v76, v16, v17, v18
    v_max_u32 v76, v76, v19
    ds_read_b128 v[24:27], v77 offset:34816
    v_cmp_eq_u32 vcc, -1, v76
    v_smfmac_f32_16x16x64_bf16 v[48:51], v[12:15], v[200:207], v79
    ds_write_b128 v78, v[16:19] offset:4096
    s_cbranch_vccnz L_rtF_11
L_bkF_12:
    s_waitcnt lgkmcnt(3)
    v_smfmac_f32_16x16x64_bf16 v[52:55], v[4:7], v[68:75], v79
    ds_read_b128 v[72:75], v77 offset:21504
    s_waitcnt vmcnt(3)
    v_max3_u32 v76, v32, v33, v34
    v_max_u32 v76, v76, v35
    ds_read_b128 v[68:71], v77 offset:20480
    v_cmp_eq_u32 vcc, -1, v76
    s_waitcnt lgkmcnt(3)
    v_smfmac_f32_16x16x64_bf16 v[56:59], v[4:7], v[24:31], v79
    ds_read_b128 v[28:31], v77 offset:23552
    v_smfmac_f32_16x16x64_bf16 v[36:39], v[16:19], v[208:215], v79
    ds_read_b128 v[24:27], v77 offset:22528
    s_cbranch_vccnz L_rtF_14
L_bkF_15:
    v_smfmac_f32_16x16x64_bf16 v[44:47], v[16:19], v[224:231], v79
    ds_read_b64 v[76:77], v78 offset:12288
    v_smfmac_f32_16x16x64_bf16 v[40:43], v[16:19], v[216:223], v79
    s_waitcnt lgkmcnt(3)
    v_smfmac_f32_16x16x64_bf16 v[52:55], v[12:15], v[68:75], v79
    buffer_load_dwordx4 v[68:71], v78, s[4:7], s35 offen sc1
    v_smfmac_f32_16x16x64_bf16 v[48:51], v[16:19], v[232:239], v79
    v_smfmac_f32_16x16x64_bf16 v[40:43], v[32:35], a[88:95], v79
    s_waitcnt lgkmcnt(1)
    v_smfmac_f32_16x16x64_bf16 v[56:59], v[12:15], v[24:31], v79
    v_smfmac_f32_16x16x64_bf16 v[36:39], v[32:35], a[80:87], v79
    buffer_load_dwordx4 v[72:75], v78, s[4:7], s35 offen offset:1024 sc1
    s_barrier
    ds_read_b128 v[20:23], v78 offset:5120
    v_smfmac_f32_16x16x64_bf16 v[44:47], v[32:35], a[96:103], v79
    ds_read_b128 v[24:27], v78 offset:6144
    v_smfmac_f32_16x16x64_bf16 v[48:51], v[32:35], a[104:111], v79
    ds_read_b128 v[28:31], v78 offset:7168
    v_smfmac_f32_16x16x64_bf16 v[52:55], v[16:19], a[112:119], v79
    v_smfmac_f32_16x16x64_bf16 v[56:59], v[16:19], a[120:127], v79
    v_smfmac_f32_16x16x64_bf16 v[52:55], v[32:35], a[176:183], v79
    s_waitcnt lgkmcnt(2)
    v_smfmac_f32_16x16x64_bf16 v[36:39], v[20:23], v[240:247], v79
    v_smfmac_f32_16x16x64_bf16 v[40:43], v[20:23], v[248:255], v79
    v_smfmac_f32_16x16x64_bf16 v[44:47], v[20:23], a[0:7], v79
    v_smfmac_f32_16x16x64_bf16 v[48:51], v[20:23], a[8:15], v79
    s_waitcnt lgkmcnt(1)
    v_smfmac_f32_16x16x64_bf16 v[36:39], v[24:27], a[16:23], v79
    v_smfmac_f32_16x16x64_bf16 v[40:43], v[24:27], a[24:31], v79
    v_smfmac_f32_16x16x64_bf16 v[48:51], v[24:27], a[40:47], v79
    v_smfmac_f32_16x16x64_bf16 v[44:47], v[24:27], a[32:39], v79
    s_waitcnt lgkmcnt(0)
    v_smfmac_f32_16x16x64_bf16 v[36:39], v[28:31], a[48:55], v79
    v_smfmac_f32_16x16x64_bf16 v[40:43], v[28:31], a[56:63], v79
    v_smfmac_f32_16x16x64_bf16 v[44:47], v[28:31], a[64:71], v79
    v_smfmac_f32_16x16x64_bf16 v[48:51], v[28:31], a[72:79], v79
    s_nop 1
    v_cvt_pk_bf16_f32 v36, v36, v37
    v_cvt_pk_bf16_f32 v37, v38, v39
    v_cvt_pk_bf16_f32 v40, v40, v41
    v_cvt_pk_bf16_f32 v41, v42, v43
    v_mfma_f32_16x16x16_bf16 v[0:3], v[36:37], v[76:77], 0
    v_cvt_pk_bf16_f32 v44, v44, v45
    v_cvt_pk_bf16_f32 v45, v46, v47
    v_mfma_f32_16x16x16_bf16 v[4:7], v[40:41], v[76:77], 0
    v_cvt_pk_bf16_f32 v48, v48, v49
    v_cvt_pk_bf16_f32 v49, v50, v51
    v_mfma_f32_16x16x16_bf16 v[8:11], v[44:45], v[76:77], 0
    v_cvt_pk_bf16_f32 v37, v2, v3
    v_cvt_pk_bf16_f32 v36, v0, v1
    v_mfma_f32_16x16x16_bf16 v[12:15], v[48:49], v[76:77], 0
    v_cvt_pk_bf16_f32 v38, v4, v5
    v_cvt_pk_bf16_f32 v39, v6, v7
    v_add_u32 v77, 4294819840, v78
    ds_read_b128 v[16:19], v77 offset:0
    v_cvt_pk_bf16_f32 v44, v8, v9
    v_cvt_pk_bf16_f32 v45, v10, v11
    s_waitcnt vmcnt(3)
    v_mfma_f32_16x16x32_bf16 v[0:3], v[60:63], v[36:39], 0
    v_cvt_pk_bf16_f32 v46, v12, v13
    v_cvt_pk_bf16_f32 v47, v14, v15
    s_waitcnt vmcnt(2)
    v_mfma_f32_16x16x32_bf16 v[4:7], v[64:67], v[36:39], 0
    v_lshrrev_b32 v64, 2, v78
    v_add_u32 v64, 118784, v64
    v_mfma_f32_16x16x32_bf16 v[48:51], v[44:47], v[36:39], 0
    ds_read_b128 v[36:39], v77 offset:8192
    s_nop 2
    v_cndmask_b32 v0, v0, v4, s[22:23]
    v_cndmask_b32 v3, v3, v7, s[22:23]
    v_cndmask_b32 v2, v2, v6, s[22:23]
    v_cndmask_b32 v1, v1, v5, s[22:23]
    ds_write_b128 v78, v[0:3] offset:0
    v_cndmask_b32 v48, v48, v49, s[22:23]
    v_smfmac_f32_16x16x64_bf16 v[56:59], v[32:35], a[184:191], v79
    ds_write_b32 v64, v48 offset:0
    v_smfmac_f32_16x16x64_bf16 v[52:55], v[20:23], a[128:135], v79
    ds_read_b128 v[32:35], v78 offset:9216
    v_smfmac_f32_16x16x64_bf16 v[56:59], v[20:23], a[136:143], v79
    ds_read_b128 v[20:23], v77 offset:1024
    v_smfmac_f32_16x16x64_bf16 v[52:55], v[24:27], a[144:151], v79
    s_waitcnt lgkmcnt(2)
    s_barrier
    ds_read_b128 v[4:7], v78 offset:1024
    v_smfmac_f32_16x16x64_bf16 v[56:59], v[24:27], a[152:159], v79
    ds_read_b128 v[12:15], v78 offset:3072
    v_smfmac_f32_16x16x64_bf16 v[52:55], v[28:31], a[160:167], v79
    ds_read_b128 v[8:11], v78 offset:2048
    s_waitcnt lgkmcnt(4)
    buffer_store_dwordx4 v[44:47], v34, s[4:7], s36 offen sc1
    ds_read_b32 v51, v64 offset:768
    v_smfmac_f32_16x16x64_bf16 v[56:59], v[28:31], a[168:175], v79
    ds_read_b32 v49, v64 offset:256
    ds_read_b32 v50, v64 offset:512
    v_cvt_pk_bf16_f32 v52, v52, v53
    v_cvt_pk_bf16_f32 v53, v54, v55
    ds_read_b128 v[24:27], v77 offset:2048
    s_waitcnt lgkmcnt(6)
    v_pk_add_f32 v[0:1], v[0:1], v[4:5]
    v_pk_add_f32 v[2:3], v[2:3], v[6:7]
    v_cvt_pk_bf16_f32 v54, v56, v57
    v_cvt_pk_bf16_f32 v55, v58, v59
    ds_read_b128 v[28:31], v77 offset:3072
    s_waitcnt lgkmcnt(5)
    v_pk_add_f32 v[8:9], v[8:9], v[12:13]
    v_pk_add_f32 v[10:11], v[10:11], v[14:15]
    v_pk_add_f32 v[0:1], v[0:1], v[8:9]
    v_pk_add_f32 v[2:3], v[2:3], v[10:11]
    v_mov_b64 v[12:13], s[56:57]
    v_exp_f32 v7, v3
    v_exp_f32 v6, v2
    v_exp_f32 v5, v1
    v_exp_f32 v4, v0
    v_cvt_pk_bf16_f32 v9, v6, v7
    v_max3_f32 v40, |v0|, |v1|, |v2|
    v_cvt_pk_bf16_f32 v8, v4, v5
    v_mov_b32_dpp v11, v9 quad_perm:[2,3,0,1] row_mask:0xf bank_mask:0xf
    v_mov_b64 v[14:15], s[56:57]
    v_mov_b32_dpp v10, v8 quad_perm:[2,3,0,1] row_mask:0xf bank_mask:0xf
    s_waitcnt lgkmcnt(2)
    v_add_f32 v50, v50, v51
    v_add_f32 v48, v48, v49
    v_add_f32 v48, v48, v50
    v_mul_f32 v48, s42, v48
    v_max3_f32 v40, v40, |v3|, |v48|
    v_cmp_lt_f32 vcc, s44, v40
    s_waitcnt vmcnt(1)
    v_mfma_f32_16x16x32_bf16 v[64:67], v[72:75], v[8:11], 0
    v_exp_f32 v49, v48
    v_mfma_f32_16x16x32_bf16 v[60:63], v[68:71], v[8:11], 0
    v_mov_b32_dpp v50, v49 quad_perm:[2,3,0,1] row_mask:0xf bank_mask:0xf
    v_cvt_pk_bf16_f32 v51, v49, v50
    v_cvt_pk_bf16_f32 v50, v49, v50
    buffer_store_dwordx4 v[52:55], v35, s[4:7], s37 offen sc1
    s_nop 1
    v_mfma_f32_16x16x16_bf16 v[60:63], v[52:53], v[50:51], v[60:63]
    v_mfma_f32_16x16x16_bf16 v[64:67], v[54:55], v[50:51], v[64:67]
    s_cbranch_vccnz L_fbF0_17
L_fbkF0_18:
    v_mov_b64 v[70:71], 0
    ds_read_b128 v[0:3], v77 offset:4096
    v_mfma_f32_16x16x16_bf16 v[40:43], v[50:51], v[12:13], 0
    s_cmp_eq_u32 s14, 63
    v_cvt_pk_bf16_f32 v60, v60, v61
    v_cvt_pk_bf16_f32 v61, v62, v63
    v_cvt_pk_bf16_f32 v62, v64, v65
    v_cvt_pk_bf16_f32 v63, v66, v67
    v_mfma_f32_16x16x32_bf16 v[44:47], v[8:11], v[12:15], 0
    ds_write_b128 v32, v[60:63] offset:0
    v_mov_b64 v[68:69], 0
    v_mov_b64 v[72:73], 0
    ds_read_b128 v[4:7], v77 offset:5120
    v_mov_b64 v[74:75], 0
    v_mov_b64 v[66:67], 0
    v_mov_b64 v[64:65], 0
    ds_read_b128 v[12:15], v77 offset:7168
    v_fma_f32 v41, v41, 0.5, v45
    v_rcp_f32 v35, v41
    ds_read_b128 v[8:11], v77 offset:6144
    v_fma_f32 v40, v40, 0.5, v44
    v_rcp_f32 v34, v40
    ds_read_b128 v[40:43], v77 offset:9216
    s_waitcnt lgkmcnt(4)
    s_barrier
    ds_read_b128 v[52:55], v78 offset:4096
    ds_read_b128 v[56:59], v78 offset:5120
    s_cbranch_scc1 L_doneF
    ds_read_b128 v[44:47], v77 offset:10240
    ds_read_b128 v[48:51], v77 offset:11264
    s_waitcnt lgkmcnt(3)
    v_smfmac_f32_16x16x64_bf16 v[72:75], v[52:55], v[0:7], v79
    v_smfmac_f32_16x16x64_bf16 v[68:71], v[52:55], v[16:23], v79
    ds_read_b128 v[20:23], v77 offset:25600
    v_smfmac_f32_16x16x64_bf16 v[64:67], v[52:55], v[36:43], v79
    ds_read_b128 v[36:39], v77 offset:28672
    ds_read_b128 v[16:19], v77 offset:24576
    s_waitcnt lgkmcnt(5)
    v_smfmac_f32_16x16x64_bf16 v[68:71], v[56:59], v[24:31], v79
    ds_read_b128 v[40:43], v77 offset:29696
    v_smfmac_f32_16x16x64_bf16 v[72:75], v[56:59], v[8:15], v79
    ds_read_b128 v[24:27], v77 offset:26624
    s_waitcnt lgkmcnt(5)
    v_smfmac_f32_16x16x64_bf16 v[64:67], v[56:59], v[44:51], v79
    ds_read_b128 v[44:47], v77 offset:30720
    v_add_f32 v68, v68, v70
    v_add_f32 v69, v69, v71
    v_mov_b64 v[70:71], 0
    v_add_f32 v72, v72, v74
    v_add_f32 v73, v73, v75
    v_mul_f32 v68, v68, v34
    v_mul_f32 v73, v73, v35
    v_mov_b64 v[74:75], 0
    v_mul_f32 v69, v69, v35
    v_mul_f32 v72, v72, v34
    v_cvt_pk_bf16_f32 v60, v68, v69
    v_cvt_pk_bf16_f32 v61, v72, v73
    v_mov_b64 v[72:73], 0
    v_mov_b64 v[68:69], 0
    v_and_or_b32 v61, v61, -2, s24
    v_and_or_b32 v60, v60, -2, s24
    v_smfmac_f32_16x16x64_bf16 v[68:71], v[52:55], a[192:199], v79
    ds_read_b128 v[28:31], v77 offset:27648
    v_add_f32 v64, v64, v66
    v_smfmac_f32_16x16x64_bf16 v[72:75], v[52:55], a[208:215], v79
    buffer_store_dwordx2 v[60:61], v33, s[4:7], s16 offen
    v_smfmac_f32_16x16x64_bf16 v[68:71], v[56:59], a[200:207], v79
    ds_read_b128 v[48:51], v77 offset:31744
    v_add_f32 v65, v65, v67
    v_smfmac_f32_16x16x64_bf16 v[72:75], v[56:59], a[216:223], v79
    ds_read_b128 v[8:11], v78 offset:10240
    v_mul_f32 v64, v64, v34
    v_mul_f32 v65, v65, v35
    v_cvt_pk_bf16_f32 v62, v64, v65
    v_and_or_b32 v62, v62, -2, s24
    v_add_f32 v68, v68, v70
    v_add_f32 v69, v69, v71
    v_mul_f32 v68, v68, v34
    v_add_f32 v72, v72, v74
    v_add_f32 v73, v73, v75
    v_mul_f32 v72, v72, v34
    v_mul_f32 v73, v73, v35
    v_mul_f32 v69, v69, v35
    v_cvt_pk_bf16_f32 v32, v72, v73
    v_cvt_pk_bf16_f32 v63, v68, v69
    v_and_or_b32 v32, v32, -2, s24
    v_and_or_b32 v63, v63, -2, s24
    v_lshrrev_b32 v72, 1, v33
    buffer_store_dwordx2 v[62:63], v33, s[4:7], s17 offen
    v_mov_b64 v[64:65], 0
    v_mov_b64 v[68:69], 0
    v_mov_b64 v[66:67], 0
    v_mov_b64 v[70:71], 0
    v_mov_b64 v[74:75], 0
    v_smfmac_f32_16x16x64_bf16 v[64:67], v[52:55], a[224:231], v79
    ds_read_b128 v[12:15], v78 offset:11264
    v_smfmac_f32_16x16x64_bf16 v[68:71], v[52:55], a[240:247], v79
    buffer_store_dword v32, v72, s[4:7], s20 offen
    v_smfmac_f32_16x16x64_bf16 v[64:67], v[56:59], a[232:239], v79
    v_mov_b64 v[72:73], 0
    v_smfmac_f32_16x16x64_bf16 v[68:71], v[56:59], a[248:255], v79
    s_waitcnt lgkmcnt(7)
    v_smfmac_f32_16x16x64_bf16 v[72:75], v[52:55], v[16:23], v79
    s_nop 1
    v_add_f32 v64, v64, v66
    v_add_f32 v65, v65, v67
    v_mul_f32 v64, v64, v34
    v_add_f32 v68, v68, v70
    v_add_f32 v69, v69, v71
    v_mul_f32 v65, v65, v35
    v_mul_f32 v69, v69, v35
    v_cvt_pk_bf16_f32 v60, v64, v65
    v_mul_f32 v68, v68, v34
    v_mov_b64 v[64:65], 0
    v_cvt_pk_bf16_f32 v61, v68, v69
    v_mov_b64 v[66:67], 0
    v_and_or_b32 v61, v61, -2, s24
    v_and_or_b32 v60, v60, -2, s24
    s_waitcnt lgkmcnt(6)
    v_smfmac_f32_16x16x64_bf16 v[64:67], v[52:55], v[36:43], v79
    buffer_store_dwordx2 v[60:61], v33, s[4:7], s18 offen
    s_waitcnt lgkmcnt(3)
    v_smfmac_f32_16x16x64_bf16 v[72:75], v[56:59], v[24:31], v79
    s_waitcnt lgkmcnt(2)
    v_smfmac_f32_16x16x64_bf16 v[64:67], v[56:59], v[44:51], v79
    s_nop 4
    v_add_f32 v72, v72, v74
    v_add_f32 v73, v73, v75
    v_mul_f32 v73, v73, v35
    v_mul_f32 v72, v72, v34
    v_add_f32 v64, v64, v66
    v_add_f32 v65, v65, v67
    v_mul_f32 v64, v64, v34
    v_mul_f32 v65, v65, v35
    v_cvt_pk_bf16_f32 v62, v72, v73
    v_cvt_pk_bf16_f32 v63, v64, v65
    v_and_or_b32 v62, v62, -2, s24
    v_and_or_b32 v63, v63, -2, s24
    buffer_store_dwordx2 v[62:63], v33, s[4:7], s19 offen
    s_waitcnt lgkmcnt(0)
    s_add_u32 s54, s54, 32
    s_add_u32 s34, s34, 524288
    s_sub_u32 s31, s51, 147456
    s_add_u32 s31, s31, s40
    s_add_u32 s32, s31, 4096
    s_add_u32 s33, s31, 8192
    s_add_u32 s14, s14, 1
    s_xor_b32 s39, s39, 294912
    s_mov_b32 s40, s41
    s_add_u32 s41, s41, 9216
    s_cmp_eq_u32 s41, 27648
    s_cselect_b32 s41, 0, s41
    v_mov_b32 v65, -1
    s_nop 6
    buffer_load_dwordx4 v[0:3], v8, s[4:7], s25 offen sc1
    buffer_load_dwordx4 v[4:7], v8, s[4:7], s25 offen offset:1024 sc1
    s_waitcnt vmcnt(0)
    v_mfma_f32_16x16x32_bf16 v[20:23], v[0:3], v[12:15], 0
    v_mfma_f32_16x16x32_bf16 v[20:23], v[4:7], v[12:15], v[20:23]
    v_bitop3_b32 v16, v0, v1, s24 bitop3:0x7e
    v_bitop3_b32 v17, v2, v3, s24 bitop3:0x7e
    v_bitop3_b32 v18, v4, v5, s24 bitop3:0x7e
    v_bitop3_b32 v19, v6, v7, s24 bitop3:0x7e
    v_or3_b32 v16, v16, v17, v18
    v_bitop3_b32 v16, v16, v19, 1 bitop3:0xa8
    v_cmp_ne_u32 vcc, 0, v16
    s_nop 0
    v_add_f32 v20, v20, v21
    v_add_f32 v22, v22, v23
    v_add_f32 v20, v20, v22
    s_nop 1
    v_mov_b32_dpp v21, v20 row_shl:4 row_mask:0xf bank_mask:0xf
    v_cvt_pk_bf16_f32 v20, v20, v21
    v_min_u32 v20, -2, v20
    s_cbranch_vccnz L_rtF_19
L_bkF_20:
    buffer_store_dword v20, v9, s[4:7], s27 offen
    v_mov_b32 v64, v9
    v_mov_b32 v66, v11
    s_cmp_eq_u32 s14, s15
    s_cbranch_scc0 L_stepF0
    s_branch L_doneF
L_entryF1:
    ds_read_b128 v[8:11], v78 offset:10240
    v_mov_b32 v65, -1
    s_waitcnt lgkmcnt(0)
    v_mov_b32 v64, v9
    v_mov_b32 v66, v11
    s_branch L_stepF1
.p2align 6
L_stepF1:
    s_add_u32 s38, s34, 4294457344
    s_cmp_lt_u32 s14, 62
    s_cselect_b32 s38, s38, 1073741824
    s_lshl_b32 s47, s54, 11
    s_add_u32 s36, s47, 50332160
    s_lshl_b32 s47, s47, 1
    s_add_u32 s37, s47, 54526976
    s_add_u32 s16, s21, s39
    s_add_u32 s17, s16, 65536
    s_add_u32 s18, s16, 131072
    s_add_u32 s19, s16, 196608
    s_lshl_b32 s46, s12, 5
    s_add_u32 s48, s50, s39
    s_add_u32 s49, s48, s46
    s_add_u32 s20, s49, 270336
    s_add_u32 s46, s46, s51
    s_add_u32 s47, s46, s40
    s_add_u32 s27, s47, 2048
    s_add_u32 s28, s47, 8192
    s_lshl_b32 s46, s12, 11
    s_add_u32 s46, s46, s48
    s_add_u32 s25, s46, 65536
    s_lshl_b32 s46, s12, 10
    s_add_u32 s46, s46, s48
    s_add_u32 s26, s46, 262144
    s_bfe_u32 s24, s14, 0x10001
    s_waitcnt vmcnt(1)
    v_mov_b64 v[36:37], 0
    v_mov_b64 v[38:39], 0
    v_mov_b64 v[40:41], 0
    v_mov_b64 v[42:43], 0
    v_mov_b64 v[44:45], 0
    v_mov_b64 v[46:47], 0
    v_mov_b64 v[48:49], 0
    v_mov_b64 v[50:51], 0
    v_mov_b64 v[52:53], 0
    v_mov_b64 v[54:55], 0
    v_mov_b64 v[56:57], 0
    v_mov_b64 v[58:59], 0
    v_add_u32 v77, 4294856704, v78
    s_nop 9
    buffer_load_dwordx4 v[4:7], v78, s[4:7], s31 offen offset:1024 sc1
    buffer_load_dwordx4 v[12:15], v78, s[4:7], s31 offen offset:3072 sc1
    s_nop 15
    s_nop 13
    buffer_load_dwordx4 v[68:71], v78, s[4:7], s31 offen offset:1024 sc1
    buffer_load_dwordx4 v[72:75], v78, s[4:7], s31 offen offset:3072 sc1
    s_waitcnt vmcnt(2)
    v_max3_u32 v76, v4, v5, v6
    v_max3_u32 v76, v76, v7, v12
    v_max3_u32 v76, v76, v13, v14
    v_max_u32 v76, v76, v15
    v_cmp_eq_u32 vcc, -1, v76
    ds_write_b128 v78, v[4:7] offset:1024
    ds_write_b128 v78, v[12:15] offset:3072
    s_cbranch_vccnz L_mpF1_22
L_mdF1_23:
    s_nop 0
    v_smfmac_f32_16x16x64_bf16 v[48:51], v[4:7], v[136:143], v79
    s_add_u32 s35, s34, 8192
    v_smfmac_f32_16x16x64_bf16 v[40:43], v[4:7], v[120:127], v79
    v_smfmac_f32_16x16x64_bf16 v[48:51], v[12:15], v[200:207], v79
    buffer_load_dwordx4 v[20:23], v78, s[4:7], s32 offen offset:1024 sc1
    v_smfmac_f32_16x16x64_bf16 v[44:47], v[4:7], v[128:135], v79
    s_waitcnt lgkmcnt(0)
    s_barrier
    ds_read_b128 v[8:11], v78 offset:2048
    v_smfmac_f32_16x16x64_bf16 v[40:43], v[12:15], v[184:191], v79
    ds_read_b128 v[0:3], v78 offset:0
    v_smfmac_f32_16x16x64_bf16 v[36:39], v[4:7], v[112:119], v79
    buffer_load_dwordx4 v[32:35], v78, s[4:7], s33 offen offset:0 sc1
    s_waitcnt vmcnt(2)
    ds_read_b128 v[68:71], v77 offset:32768
    v_smfmac_f32_16x16x64_bf16 v[44:47], v[12:15], v[192:199], v79
    ds_read_b128 v[72:75], v77 offset:33792
    v_smfmac_f32_16x16x64_bf16 v[36:39], v[12:15], v[176:183], v79
    ds_read_b128 v[24:27], v77 offset:34816
    ds_read_b128 v[28:31], v77 offset:35840
    buffer_store_dword v65, v64, s[4:7], s27 offen
    s_waitcnt lgkmcnt(5)
    v_smfmac_f32_16x16x64_bf16 v[36:39], v[8:11], v[144:151], v79
    buffer_load_dwordx4 v[60:63], v78, s[4:7], s34 offen sc1
    v_smfmac_f32_16x16x64_bf16 v[40:43], v[8:11], v[152:159], v79
    s_waitcnt lgkmcnt(2)
    v_smfmac_f32_16x16x64_bf16 v[52:55], v[4:7], v[68:75], v79
    ds_read_b128 v[68:71], v77 offset:20480
    v_smfmac_f32_16x16x64_bf16 v[44:47], v[8:11], v[160:167], v79
    ds_read_b128 v[72:75], v77 offset:21504
    s_waitcnt lgkmcnt(2)
    v_smfmac_f32_16x16x64_bf16 v[56:59], v[4:7], v[24:31], v79
    ds_read_b128 v[28:31], v77 offset:23552
    buffer_load_dwordx4 v[64:67], v78, s[4:7], s34 offen offset:1024 sc1
    v_smfmac_f32_16x16x64_bf16 v[36:39], v[0:3], v[80:87], v79
    ds_read_b128 v[24:27], v77 offset:22528
    v_smfmac_f32_16x16x64_bf16 v[44:47], v[0:3], v[96:103], v79
    v_smfmac_f32_16x16x64_bf16 v[40:43], v[0:3], v[88:95], v79
    v_smfmac_f32_16x16x64_bf16 v[48:51], v[8:11], v[168:175], v79
    s_waitcnt lgkmcnt(2)
    v_smfmac_f32_16x16x64_bf16 v[52:55], v[12:15], v[68:75], v79
    ds_read_b128 v[68:71], v77 offset:16384
    ds_read_b128 v[72:75], v77 offset:17408
    s_waitcnt lgkmcnt(2)
    v_smfmac_f32_16x16x64_bf16 v[56:59], v[12:15], v[24:31], v79
    ds_read_b128 v[28:31], v77 offset:19456
    s_waitcnt vmcnt(4)
    v_max3_u32 v76, v20, v21, v22
    v_max_u32 v76, v76, v23
    ds_read_b128 v[24:27], v77 offset:18432
    v_cmp_eq_u32 vcc, -1, v76
    v_smfmac_f32_16x16x64_bf16 v[48:51], v[0:3], v[104:111], v79
    ds_write_b128 v78, v[20:23] offset:5120
    s_cbranch_vccnz L_rtF_27
L_bkF_28:
    s_waitcnt vmcnt(3)
    v_max3_u32 v76, v32, v33, v34
    v_max_u32 v76, v76, v35
    v_cmp_eq_u32 vcc, -1, v76
    s_waitcnt lgkmcnt(3)
    v_smfmac_f32_16x16x64_bf16 v[52:55], v[8:11], v[68:75], v79
    ds_read_b128 v[72:75], v77 offset:13312
    v_smfmac_f32_16x16x64_bf16 v[40:43], v[20:23], v[248:255], v79
    ds_read_b128 v[68:71], v77 offset:12288
    s_waitcnt lgkmcnt(3)
    v_smfmac_f32_16x16x64_bf16 v[56:59], v[8:11], v[24:31], v79
    ds_read_b128 v[24:27], v77 offset:14336
    s_cbranch_vccnz L_rtF_30
L_bkF_31:
    ds_read_b128 v[28:31], v77 offset:15360
    v_smfmac_f32_16x16x64_bf16 v[36:39], v[20:23], v[240:247], v79
    ds_read_b64 v[76:77], v78 offset:12288
    v_smfmac_f32_16x16x64_bf16 v[44:47], v[20:23], a[0:7], v79
    v_smfmac_f32_16x16x64_bf16 v[48:51], v[20:23], a[8:15], v79
    s_waitcnt lgkmcnt(3)
    v_smfmac_f32_16x16x64_bf16 v[52:55], v[0:3], v[68:75], v79
    buffer_load_dwordx4 v[68:71], v78, s[4:7], s35 offen sc1
    v_smfmac_f32_16x16x64_bf16 v[40:43], v[32:35], a[88:95], v79
    s_waitcnt lgkmcnt(1)
    v_smfmac_f32_16x16x64_bf16 v[56:59], v[0:3], v[24:31], v79
    v_lshlrev_b32 v0, 3, v78
    v_smfmac_f32_16x16x64_bf16 v[36:39], v[32:35], a[80:87], v79
    v_smfmac_f32_16x16x64_bf16 v[48:51], v[32:35], a[104:111], v79
    buffer_load_dwordx4 v[72:75], v78, s[4:7], s35 offen offset:1024 sc1
    s_barrier
    ds_read_b128 v[24:27], v78 offset:6144
    v_smfmac_f32_16x16x64_bf16 v[44:47], v[32:35], a[96:103], v79
    ds_read_b128 v[28:31], v78 offset:7168
    v_smfmac_f32_16x16x64_bf16 v[56:59], v[20:23], a[136:143], v79
    ds_read_b128 v[16:19], v78 offset:4096
    v_smfmac_f32_16x16x64_bf16 v[52:55], v[20:23], a[128:135], v79
    buffer_load_dword v0, s[4:7], s38 offen lds
    v_smfmac_f32_16x16x64_bf16 v[56:59], v[32:35], a[184:191], v79
    v_smfmac_f32_16x16x64_bf16 v[52:55], v[32:35], a[176:183], v79
    ds_read_b128 v[32:35], v78 offset:9216
    s_waitcnt lgkmcnt(3)
    v_smfmac_f32_16x16x64_bf16 v[40:43], v[24:27], a[24:31], v79
    v_smfmac_f32_16x16x64_bf16 v[36:39], v[24:27], a[16:23], v79
    v_smfmac_f32_16x16x64_bf16 v[44:47], v[24:27], a[32:39], v79
    v_smfmac_f32_16x16x64_bf16 v[48:51], v[24:27], a[40:47], v79
    s_waitcnt lgkmcnt(2)
    v_smfmac_f32_16x16x64_bf16 v[40:43], v[28:31], a[56:63], v79
    v_smfmac_f32_16x16x64_bf16 v[36:39], v[28:31], a[48:55], v79
    v_smfmac_f32_16x16x64_bf16 v[44:47], v[28:31], a[64:71], v79
    v_smfmac_f32_16x16x64_bf16 v[48:51], v[28:31], a[72:79], v79
    s_waitcnt lgkmcnt(1)
    v_smfmac_f32_16x16x64_bf16 v[36:39], v[16:19], v[208:215], v79
    v_smfmac_f32_16x16x64_bf16 v[40:43], v[16:19], v[216:223], v79
    v_smfmac_f32_16x16x64_bf16 v[44:47], v[16:19], v[224:231], v79
    v_smfmac_f32_16x16x64_bf16 v[48:51], v[16:19], v[232:239], v79
    s_nop 1
    v_cvt_pk_bf16_f32 v36, v36, v37
    v_cvt_pk_bf16_f32 v37, v38, v39
    v_cvt_pk_bf16_f32 v40, v40, v41
    v_cvt_pk_bf16_f32 v41, v42, v43
    v_mfma_f32_16x16x16_bf16 v[0:3], v[36:37], v[76:77], 0
    v_cvt_pk_bf16_f32 v44, v44, v45
    v_cvt_pk_bf16_f32 v45, v46, v47
    v_mfma_f32_16x16x16_bf16 v[4:7], v[40:41], v[76:77], 0
    v_cvt_pk_bf16_f32 v48, v48, v49
    v_cvt_pk_bf16_f32 v49, v50, v51
    v_mfma_f32_16x16x16_bf16 v[8:11], v[44:45], v[76:77], 0
    v_cvt_pk_bf16_f32 v36, v0, v1
    v_cvt_pk_bf16_f32 v37, v2, v3
    v_mfma_f32_16x16x16_bf16 v[12:15], v[48:49], v[76:77], 0
    v_cvt_pk_bf16_f32 v39, v6, v7
    v_cvt_pk_bf16_f32 v38, v4, v5
    v_smfmac_f32_16x16x64_bf16 v[52:55], v[24:27], a[144:151], v79
    s_waitcnt vmcnt(3)
    v_mfma_f32_16x16x32_bf16 v[4:7], v[64:67], v[36:39], 0
    s_nop 0
    v_cvt_pk_bf16_f32 v46, v12, v13
    v_lshrrev_b32 v64, 2, v78
    v_mfma_f32_16x16x32_bf16 v[0:3], v[60:63], v[36:39], 0
    v_cvt_pk_bf16_f32 v47, v14, v15
    v_cvt_pk_bf16_f32 v44, v8, v9
    v_cvt_pk_bf16_f32 v45, v10, v11
    v_add_u32 v64, 118784, v64
    v_add_u32 v77, 4294856704, v78
    v_mfma_f32_16x16x32_bf16 v[48:51], v[44:47], v[36:39], 0
    ds_read_b128 v[20:23], v77 offset:1024
    v_cndmask_b32 v1, v1, v5, s[22:23]
    v_cndmask_b32 v0, v0, v4, s[22:23]
    ds_read_b128 v[36:39], v77 offset:8192
    v_cndmask_b32 v3, v3, v7, s[22:23]
    v_cndmask_b32 v2, v2, v6, s[22:23]
    ds_write_b128 v78, v[0:3] offset:1024
    s_nop 0
    v_cndmask_b32 v48, v48, v49, s[22:23]
    ds_write_b32 v64, v48 offset:256
    v_smfmac_f32_16x16x64_bf16 v[56:59], v[24:27], a[152:159], v79
    s_waitcnt lgkmcnt(4)
    buffer_store_dwordx4 v[44:47], v34, s[4:7], s36 offen sc1
    v_smfmac_f32_16x16x64_bf16 v[52:55], v[28:31], a[160:167], v79
    ds_read_b128 v[24:27], v77 offset:2048
    v_smfmac_f32_16x16x64_bf16 v[56:59], v[28:31], a[168:175], v79
    ds_read_b128 v[28:31], v77 offset:3072
    s_waitcnt lgkmcnt(2)
    s_barrier
    ds_read_b128 v[8:11], v78 offset:3072
    v_smfmac_f32_16x16x64_bf16 v[52:55], v[16:19], a[112:119], v79
    ds_read_b128 v[4:7], v78 offset:2048
    v_smfmac_f32_16x16x64_bf16 v[56:59], v[16:19], a[120:127], v79
    ds_read_b128 v[12:15], v78 offset:0
    ds_read_b32 v49, v64 offset:512
    ds_read_b32 v50, v64 offset:768
    ds_read_b32 v51, v64 offset:0
    s_nop 0
    v_cvt_pk_bf16_f32 v52, v52, v53
    v_cvt_pk_bf16_f32 v53, v54, v55
    ds_read_b128 v[16:19], v77 offset:0
    v_cvt_pk_bf16_f32 v54, v56, v57
    v_cvt_pk_bf16_f32 v55, v58, v59
    s_waitcnt lgkmcnt(5)
    v_pk_add_f32 v[0:1], v[0:1], v[4:5]
    v_pk_add_f32 v[2:3], v[2:3], v[6:7]
    s_waitcnt lgkmcnt(3)
    v_add_f32 v48, v48, v49
    v_pk_add_f32 v[10:11], v[10:11], v[14:15]
    v_pk_add_f32 v[8:9], v[8:9], v[12:13]
    v_pk_add_f32 v[2:3], v[2:3], v[10:11]
    v_pk_add_f32 v[0:1], v[0:1], v[8:9]
    v_mov_b64 v[14:15], s[56:57]
    v_exp_f32 v4, v0
    v_exp_f32 v5, v1
    v_exp_f32 v7, v3
    v_exp_f32 v6, v2
    v_max3_f32 v40, |v0|, |v1|, |v2|
    v_cvt_pk_bf16_f32 v8, v4, v5
    v_cvt_pk_bf16_f32 v9, v6, v7
    v_mov_b64 v[12:13], s[56:57]
    v_mov_b32_dpp v10, v8 quad_perm:[2,3,0,1] row_mask:0xf bank_mask:0xf
    v_mov_b32_dpp v11, v9 quad_perm:[2,3,0,1] row_mask:0xf bank_mask:0xf
    s_waitcnt lgkmcnt(1)
    v_add_f32 v50, v50, v51
    v_add_f32 v48, v48, v50
    v_mul_f32 v48, s42, v48
    v_max3_f32 v40, v40, |v3|, |v48|
    v_cmp_lt_f32 vcc, s44, v40
    s_waitcnt vmcnt(3)
    v_mfma_f32_16x16x32_bf16 v[60:63], v[68:71], v[8:11], 0
    v_exp_f32 v49, v48
    s_waitcnt vmcnt(2)
    v_mfma_f32_16x16x32_bf16 v[64:67], v[72:75], v[8:11], 0
    v_mov_b32_dpp v50, v49 quad_perm:[2,3,0,1] row_mask:0xf bank_mask:0xf
    v_cvt_pk_bf16_f32 v51, v49, v50
    v_cvt_pk_bf16_f32 v50, v49, v50
    s_nop 1
    v_mfma_f32_16x16x16_bf16 v[60:63], v[52:53], v[50:51], v[60:63]
    v_mfma_f32_16x16x16_bf16 v[64:67], v[54:55], v[50:51], v[64:67]
    s_cbranch_vccnz L_fbF1_33
L_fbkF1_34:
    buffer_store_dwordx4 v[52:55], v35, s[4:7], s37 offen sc1
    ds_read_b128 v[0:3], v77 offset:4096
    v_mfma_f32_16x16x32_bf16 v[44:47], v[8:11], v[12:15], 0
    s_cmp_eq_u32 s14, 63
    v_cvt_pk_bf16_f32 v60, v60, v61
    v_cvt_pk_bf16_f32 v61, v62, v63
    v_cvt_pk_bf16_f32 v62, v64, v65
    v_cvt_pk_bf16_f32 v63, v66, v67
    v_mov_b64 v[70:71], 0
    ds_write_b128 v32, v[60:63] offset:512
    v_mov_b64 v[74:75], 0
    v_mov_b64 v[72:73], 0
    ds_read_b128 v[4:7], v77 offset:5120
    v_mov_b64 v[68:69], 0
    v_mov_b64 v[64:65], 0
    v_mfma_f32_16x16x16_bf16 v[40:43], v[50:51], v[12:13], 0
    ds_read_b128 v[8:11], v77 offset:6144
    v_mov_b64 v[66:67], 0
    ds_read_b128 v[12:15], v77 offset:7168
    ds_read_b128 v[48:51], v77 offset:11264
    s_waitcnt lgkmcnt(4)
    s_barrier
    ds_read_b128 v[52:55], v78 offset:4096
    s_nop 0
    v_fma_f32 v40, v40, 0.5, v44
    v_fma_f32 v41, v41, 0.5, v45
    ds_read_b128 v[56:59], v78 offset:5120
    s_cbranch_scc1 L_doneF
    v_rcp_f32 v35, v41
    v_rcp_f32 v34, v40
    ds_read_b128 v[40:43], v77 offset:9216
    ds_read_b128 v[44:47], v77 offset:10240
    s_waitcnt lgkmcnt(3)
    v_smfmac_f32_16x16x64_bf16 v[72:75], v[52:55], v[0:7], v79
    v_smfmac_f32_16x16x64_bf16 v[68:71], v[52:55], v[16:23], v79
    ds_read_b128 v[20:23], v77 offset:25600
    ds_read_b128 v[16:19], v77 offset:24576
    s_waitcnt lgkmcnt(4)
    v_smfmac_f32_16x16x64_bf16 v[72:75], v[56:59], v[8:15], v79
    ds_read_b128 v[8:11], v78 offset:10240
    v_smfmac_f32_16x16x64_bf16 v[68:71], v[56:59], v[24:31], v79
    ds_read_b128 v[24:27], v77 offset:26624
    s_waitcnt lgkmcnt(5)
    v_smfmac_f32_16x16x64_bf16 v[64:67], v[52:55], v[36:43], v79
    ds_read_b128 v[36:39], v77 offset:28672
    v_add_f32 v72, v72, v74
    v_add_f32 v73, v73, v75
    v_mov_b64 v[74:75], 0
    v_add_f32 v68, v68, v70
    v_add_f32 v69, v69, v71
    v_mul_f32 v72, v72, v34
    v_mul_f32 v69, v69, v35
    v_mov_b64 v[70:71], 0
    v_mul_f32 v68, v68, v34
    v_mul_f32 v73, v73, v35
    v_cvt_pk_bf16_f32 v60, v68, v69
    v_cvt_pk_bf16_f32 v61, v72, v73
    v_mov_b64 v[72:73], 0
    v_mov_b64 v[68:69], 0
    v_and_or_b32 v60, v60, -2, s24
    v_and_or_b32 v61, v61, -2, s24
    v_smfmac_f32_16x16x64_bf16 v[68:71], v[52:55], a[192:199], v79
    ds_read_b128 v[40:43], v77 offset:29696
    v_smfmac_f32_16x16x64_bf16 v[72:75], v[52:55], a[208:215], v79
    buffer_store_dwordx2 v[60:61], v33, s[4:7], s16 offen
    ds_read_b128 v[28:31], v77 offset:27648
    v_smfmac_f32_16x16x64_bf16 v[68:71], v[56:59], a[200:207], v79
    ds_read_b128 v[12:15], v78 offset:11264
    v_smfmac_f32_16x16x64_bf16 v[72:75], v[56:59], a[216:223], v79
    s_waitcnt lgkmcnt(8)
    v_smfmac_f32_16x16x64_bf16 v[64:67], v[56:59], v[44:51], v79
    ds_read_b128 v[44:47], v77 offset:30720
    s_nop 0
    v_add_f32 v68, v68, v70
    v_add_f32 v69, v69, v71
    v_mul_f32 v69, v69, v35
    v_mul_f32 v68, v68, v34
    v_cvt_pk_bf16_f32 v63, v68, v69
    v_and_or_b32 v63, v63, -2, s24
    v_add_f32 v64, v64, v66
    v_add_f32 v65, v65, v67
    v_mul_f32 v64, v64, v34
    v_mul_f32 v65, v65, v35
    v_mov_b64 v[66:67], 0
    v_cvt_pk_bf16_f32 v62, v64, v65
    v_mov_b64 v[64:65], 0
    v_and_or_b32 v62, v62, -2, s24
    v_mov_b64 v[68:69], 0
    buffer_store_dwordx2 v[62:63], v33, s[4:7], s17 offen
    v_smfmac_f32_16x16x64_bf16 v[64:67], v[52:55], a[224:231], v79
    ds_read_b128 v[48:51], v77 offset:31744
    v_mov_b64 v[70:71], 0
    v_add_f32 v72, v72, v74
    v_add_f32 v73, v73, v75
    v_mul_f32 v72, v72, v34
    v_mul_f32 v73, v73, v35
    v_mov_b64 v[74:75], 0
    v_cvt_pk_bf16_f32 v32, v72, v73
    v_lshrrev_b32 v72, 1, v33
    v_and_or_b32 v32, v32, -2, s24
    v_smfmac_f32_16x16x64_bf16 v[68:71], v[52:55], a[240:247], v79
    buffer_store_dword v32, v72, s[4:7], s20 offen
    v_smfmac_f32_16x16x64_bf16 v[64:67], v[56:59], a[232:239], v79
    v_mov_b64 v[72:73], 0
    v_smfmac_f32_16x16x64_bf16 v[68:71], v[56:59], a[248:255], v79
    s_waitcnt lgkmcnt(8)
    v_smfmac_f32_16x16x64_bf16 v[72:75], v[52:55], v[16:23], v79
    s_nop 1
    v_add_f32 v64, v64, v66
    v_add_f32 v65, v65, v67
    v_mov_b64 v[66:67], 0
    v_add_f32 v68, v68, v70
    v_add_f32 v69, v69, v71
    v_mul_f32 v68, v68, v34
    v_mul_f32 v64, v64, v34
    v_mul_f32 v69, v69, v35
    v_mul_f32 v65, v65, v35
    v_cvt_pk_bf16_f32 v61, v68, v69
    v_cvt_pk_bf16_f32 v60, v64, v65
    v_mov_b64 v[64:65], 0
    v_and_or_b32 v60, v60, -2, s24
    v_and_or_b32 v61, v61, -2, s24
    s_waitcnt lgkmcnt(4)
    v_smfmac_f32_16x16x64_bf16 v[64:67], v[52:55], v[36:43], v79
    buffer_store_dwordx2 v[60:61], v33, s[4:7], s18 offen
    s_waitcnt lgkmcnt(3)
    v_smfmac_f32_16x16x64_bf16 v[72:75], v[56:59], v[24:31], v79
    s_waitcnt lgkmcnt(0)
    v_smfmac_f32_16x16x64_bf16 v[64:67], v[56:59], v[44:51], v79
    s_nop 4
    v_add_f32 v72, v72, v74
    v_mul_f32 v72, v72, v34
    v_add_f32 v73, v73, v75
    v_add_f32 v64, v64, v66
    v_mul_f32 v73, v73, v35
    v_mul_f32 v64, v64, v34
    v_cvt_pk_bf16_f32 v62, v72, v73
    v_add_f32 v65, v65, v67
    v_and_or_b32 v62, v62, -2, s24
    v_mul_f32 v65, v65, v35
    v_cvt_pk_bf16_f32 v63, v64, v65
    v_and_or_b32 v63, v63, -2, s24
    buffer_store_dwordx2 v[62:63], v33, s[4:7], s19 offen
    s_waitcnt lgkmcnt(0)
    s_add_u32 s54, s54, 32
    s_add_u32 s34, s34, 524288
    s_sub_u32 s31, s51, 147456
    s_add_u32 s31, s31, s40
    s_add_u32 s32, s31, 4096
    s_add_u32 s33, s31, 8192
    s_add_u32 s14, s14, 1
    s_xor_b32 s39, s39, 294912
    s_mov_b32 s40, s41
    s_add_u32 s41, s41, 9216
    s_cmp_eq_u32 s41, 27648
    s_cselect_b32 s41, 0, s41
    v_mov_b32 v65, -1
    s_nop 15
    s_nop 0
    buffer_load_dwordx4 v[0:3], v8, s[4:7], s25 offen sc1
    buffer_load_dwordx4 v[4:7], v8, s[4:7], s25 offen offset:1024 sc1
    s_waitcnt vmcnt(0)
    v_mfma_f32_16x16x32_bf16 v[20:23], v[0:3], v[12:15], 0
    v_mfma_f32_16x16x32_bf16 v[20:23], v[4:7], v[12:15], v[20:23]
    v_bitop3_b32 v16, v0, v1, s24 bitop3:0x7e
    v_bitop3_b32 v17, v2, v3, s24 bitop3:0x7e
    v_bitop3_b32 v18, v4, v5, s24 bitop3:0x7e
    v_bitop3_b32 v19, v6, v7, s24 bitop3:0x7e
    v_or3_b32 v16, v16, v17, v18
    v_bitop3_b32 v16, v16, v19, 1 bitop3:0xa8
    v_cmp_ne_u32 vcc, 0, v16
    s_nop 0
    v_add_f32 v20, v20, v21
    v_add_f32 v22, v22, v23
    v_add_f32 v20, v20, v22
    s_nop 1
    v_mov_b32_dpp v21, v20 row_shl:4 row_mask:0xf bank_mask:0xf
    v_cvt_pk_bf16_f32 v20, v20, v21
    v_min_u32 v20, -2, v20
    s_cbranch_vccnz L_rtF_35
L_bkF_36:
    buffer_store_dword v20, v9, s[4:7], s27 offen
    v_mov_b32 v64, v9
    v_mov_b32 v66, v11
    s_cmp_eq_u32 s14, s15
    s_cbranch_scc0 L_stepF1
    s_branch L_doneF
L_entryF2:
    ds_read_b128 v[8:11], v78 offset:10240
    v_mov_b32 v65, -1
    s_waitcnt lgkmcnt(0)
    v_mov_b32 v64, v9
    v_mov_b32 v66, v11
    s_branch L_stepF2
.p2align 6
L_stepF2:
    s_add_u32 s38, s34, 4294463488
    s_cmp_lt_u32 s14, 62
    s_cselect_b32 s38, s38, 1073741824
    s_lshl_b32 s47, s54, 11
    s_add_u32 s36, s47, 50332672
    s_lshl_b32 s47, s47, 1
    s_add_u32 s37, s47, 54528000
    s_add_u32 s16, s21, s39
    s_add_u32 s17, s16, 65536
    s_add_u32 s18, s16, 131072
    s_add_u32 s19, s16, 196608
    s_lshl_b32 s46, s12, 5
    s_add_u32 s48, s50, s39
    s_add_u32 s49, s48, s46
    s_add_u32 s20, s49, 278528
    s_add_u32 s46, s46, s51
    s_add_u32 s47, s46, s40
    s_add_u32 s27, s47, 4096
    s_add_u32 s28, s47, 8192
    s_lshl_b32 s46, s12, 11
    s_add_u32 s46, s46, s48
    s_add_u32 s25, s46, 131072
    s_lshl_b32 s46, s12, 10
    s_add_u32 s46, s46, s48
    s_add_u32 s26, s46, 262144
    s_bfe_u32 s24, s14, 0x10001
    s_waitcnt vmcnt(1)
    v_mov_b64 v[36:37], 0
    v_mov_b64 v[38:39], 0
    v_mov_b64 v[40:41], 0
    v_mov_b64 v[42:43], 0
    v_mov_b64 v[44:45], 0
    v_mov_b64 v[46:47], 0
    v_mov_b64 v[48:49], 0
    v_mov_b64 v[50:51], 0
    v_mov_b64 v[52:53], 0
    v_mov_b64 v[54:55], 0
    v_mov_b64 v[56:57], 0
    v_mov_b64 v[58:59], 0
    v_add_u32 v77, 4294893568, v78
    s_nop 0
    s_add_u32 s35, s34, 8192
    ds_read_b128 v[68:71], v77 offset:16384
    ds_read_b128 v[72:75], v77 offset:17408
    ds_read_b128 v[20:23], v77 offset:19456
    ds_read_b128 v[16:19], v77 offset:18432
    s_waitcnt lgkmcnt(4)
    s_barrier
    ds_read_b128 v[8:11], v78 offset:2048
    ds_read_b128 v[12:15], v78 offset:3072
    ds_read_b128 v[0:3], v78 offset:0
    ds_read_b128 v[4:7], v78 offset:1024
    s_waitcnt lgkmcnt(3)
    v_smfmac_f32_16x16x64_bf16 v[48:51], v[8:11], v[168:175], v79
    v_smfmac_f32_16x16x64_bf16 v[52:55], v[8:11], v[68:75], v79
    ds_read_b128 v[68:71], v77 offset:20480
    ds_read_b128 v[72:75], v77 offset:21504
    s_waitcnt lgkmcnt(4)
    v_smfmac_f32_16x16x64_bf16 v[48:51], v[12:15], v[200:207], v79
    buffer_load_dwordx4 v[24:27], v78, s[4:7], s32 offen offset:2048 sc1
    v_smfmac_f32_16x16x64_bf16 v[56:59], v[8:11], v[16:23], v79
    ds_read_b128 v[20:23], v77 offset:23552
    v_smfmac_f32_16x16x64_bf16 v[40:43], v[8:11], v[152:159], v79
    ds_read_b128 v[16:19], v77 offset:22528
    v_smfmac_f32_16x16x64_bf16 v[36:39], v[8:11], v[144:151], v79
    v_smfmac_f32_16x16x64_bf16 v[44:47], v[8:11], v[160:167], v79
    buffer_load_dwordx4 v[32:35], v78, s[4:7], s33 offen offset:0 sc1
    s_waitcnt lgkmcnt(2)
    v_smfmac_f32_16x16x64_bf16 v[52:55], v[12:15], v[68:75], v79
    ds_read_b128 v[72:75], v77 offset:13312
    v_smfmac_f32_16x16x64_bf16 v[40:43], v[12:15], v[184:191], v79
    ds_read_b128 v[68:71], v77 offset:12288
    v_smfmac_f32_16x16x64_bf16 v[44:47], v[12:15], v[192:199], v79
    s_waitcnt lgkmcnt(2)
    v_smfmac_f32_16x16x64_bf16 v[56:59], v[12:15], v[16:23], v79
    ds_read_b128 v[20:23], v77 offset:15360
    buffer_store_dword v65, v64, s[4:7], s27 offen
    v_smfmac_f32_16x16x64_bf16 v[40:43], v[0:3], v[88:95], v79
    ds_read_b128 v[16:19], v77 offset:14336
    buffer_store_dword v65, v66, s[4:7], s28 offen
    v_smfmac_f32_16x16x64_bf16 v[44:47], v[0:3], v[96:103], v79
    buffer_load_dwordx4 v[60:63], v78, s[4:7], s34 offen sc1
    v_smfmac_f32_16x16x64_bf16 v[48:51], v[0:3], v[104:111], v79
    s_waitcnt lgkmcnt(2)
    v_smfmac_f32_16x16x64_bf16 v[52:55], v[0:3], v[68:75], v79
    ds_read_b128 v[68:71], v77 offset:32768
    v_smfmac_f32_16x16x64_bf16 v[36:39], v[12:15], v[176:183], v79
    ds_read_b128 v[72:75], v77 offset:33792
    s_waitcnt lgkmcnt(2)
    v_smfmac_f32_16x16x64_bf16 v[56:59], v[0:3], v[16:23], v79
    ds_read_b128 v[16:19], v77 offset:34816
    buffer_load_dwordx4 v[64:67], v78, s[4:7], s34 offen offset:1024 sc1
    v_smfmac_f32_16x16x64_bf16 v[40:43], v[4:7], v[120:127], v79
    ds_read_b128 v[20:23], v77 offset:35840
    v_smfmac_f32_16x16x64_bf16 v[36:39], v[0:3], v[80:87], v79
    v_lshlrev_b32 v0, 3, v78
    v_smfmac_f32_16x16x64_bf16 v[44:47], v[4:7], v[128:135], v79
    v_smfmac_f32_16x16x64_bf16 v[48:51], v[4:7], v[136:143], v79
    s_waitcnt vmcnt(5)
    v_max3_u32 v76, v24, v25, v26
    ds_write_b128 v78, v[24:27] offset:6144
    v_max_u32 v76, v76, v27
    v_cmp_eq_u32 vcc, -1, v76
    v_smfmac_f32_16x16x64_bf16 v[36:39], v[4:7], v[112:119], v79
    s_cbranch_vccnz L_rtF_38
L_bkF_39:
    s_waitcnt vmcnt(4)
    v_max3_u32 v76, v32, v33, v34
    v_max_u32 v76, v76, v35
    v_cmp_eq_u32 vcc, -1, v76
    s_waitcnt lgkmcnt(3)
    v_smfmac_f32_16x16x64_bf16 v[52:55], v[4:7], v[68:75], v79
    buffer_load_dwordx4 v[68:71], v78, s[4:7], s35 offen sc1
    s_cbranch_vccnz L_rtF_41
L_bkF_42:
    v_smfmac_f32_16x16x64_bf16 v[36:39], v[24:27], a[16:23], v79
    ds_read_b64 v[76:77], v78 offset:12288
    v_smfmac_f32_16x16x64_bf16 v[44:47], v[24:27], a[32:39], v79
    v_smfmac_f32_16x16x64_bf16 v[40:43], v[24:27], a[24:31], v79
    buffer_load_dwordx4 v[72:75], v78, s[4:7], s35 offen offset:1024 sc1
    v_smfmac_f32_16x16x64_bf16 v[48:51], v[24:27], a[40:47], v79
    s_waitcnt lgkmcnt(1)
    s_barrier
    ds_read_b128 v[28:31], v78 offset:7168
    v_smfmac_f32_16x16x64_bf16 v[40:43], v[32:35], a[88:95], v79
    v_smfmac_f32_16x16x64_bf16 v[36:39], v[32:35], a[80:87], v79
    v_smfmac_f32_16x16x64_bf16 v[56:59], v[4:7], v[16:23], v79
    buffer_load_dword v0, s[4:7], s38 offen lds
    ds_read_b128 v[16:19], v78 offset:4096
    v_smfmac_f32_16x16x64_bf16 v[48:51], v[32:35], a[104:111], v79
    ds_read_b128 v[20:23], v78 offset:5120
    v_smfmac_f32_16x16x64_bf16 v[44:47], v[32:35], a[96:103], v79
    s_waitcnt lgkmcnt(2)
    v_smfmac_f32_16x16x64_bf16 v[36:39], v[28:31], a[48:55], v79
    v_smfmac_f32_16x16x64_bf16 v[40:43], v[28:31], a[56:63], v79
    v_smfmac_f32_16x16x64_bf16 v[44:47], v[28:31], a[64:71], v79
    v_smfmac_f32_16x16x64_bf16 v[48:51], v[28:31], a[72:79], v79
    s_waitcnt lgkmcnt(1)
    v_smfmac_f32_16x16x64_bf16 v[40:43], v[16:19], v[216:223], v79
    v_smfmac_f32_16x16x64_bf16 v[36:39], v[16:19], v[208:215], v79
    v_smfmac_f32_16x16x64_bf16 v[44:47], v[16:19], v[224:231], v79
    s_waitcnt lgkmcnt(0)
    v_smfmac_f32_16x16x64_bf16 v[40:43], v[20:23], v[248:255], v79
    v_smfmac_f32_16x16x64_bf16 v[48:51], v[16:19], v[232:239], v79
    v_smfmac_f32_16x16x64_bf16 v[36:39], v[20:23], v[240:247], v79
    s_nop 3
    v_cvt_pk_bf16_f32 v40, v40, v41
    v_smfmac_f32_16x16x64_bf16 v[48:51], v[20:23], a[8:15], v79
    v_cvt_pk_bf16_f32 v41, v42, v43
    v_smfmac_f32_16x16x64_bf16 v[44:47], v[20:23], a[0:7], v79
    v_cvt_pk_bf16_f32 v36, v36, v37
    v_mfma_f32_16x16x16_bf16 v[4:7], v[40:41], v[76:77], 0
    v_cvt_pk_bf16_f32 v37, v38, v39
    s_nop 0
    v_cvt_pk_bf16_f32 v48, v48, v49
    v_mfma_f32_16x16x16_bf16 v[0:3], v[36:37], v[76:77], 0
    v_cvt_pk_bf16_f32 v49, v50, v51
    v_cvt_pk_bf16_f32 v44, v44, v45
    v_cvt_pk_bf16_f32 v45, v46, v47
    v_mfma_f32_16x16x16_bf16 v[12:15], v[48:49], v[76:77], 0
    v_cvt_pk_bf16_f32 v38, v4, v5
    v_cvt_pk_bf16_f32 v39, v6, v7
    v_mfma_f32_16x16x16_bf16 v[8:11], v[44:45], v[76:77], 0
    v_cvt_pk_bf16_f32 v36, v0, v1
    v_cvt_pk_bf16_f32 v37, v2, v3
    v_add_u32 v77, 4294893568, v78
    s_waitcnt vmcnt(3)
    v_mfma_f32_16x16x32_bf16 v[4:7], v[64:67], v[36:39], 0
    v_cvt_pk_bf16_f32 v47, v14, v15
    v_cvt_pk_bf16_f32 v46, v12, v13
    v_cvt_pk_bf16_f32 v45, v10, v11
    v_mfma_f32_16x16x32_bf16 v[0:3], v[60:63], v[36:39], 0
    v_cvt_pk_bf16_f32 v44, v8, v9
    v_lshrrev_b32 v64, 2, v78
    v_add_u32 v64, 118784, v64
    v_mfma_f32_16x16x32_bf16 v[48:51], v[44:47], v[36:39], 0
    ds_read_b128 v[36:39], v77 offset:8192
    s_nop 1
    v_cndmask_b32 v0, v0, v4, s[22:23]
    v_cndmask_b32 v3, v3, v7, s[22:23]
    v_cndmask_b32 v2, v2, v6, s[22:23]
    v_cndmask_b32 v1, v1, v5, s[22:23]
    ds_write_b128 v78, v[0:3] offset:2048
    v_cndmask_b32 v48, v48, v49, s[22:23]
    v_smfmac_f32_16x16x64_bf16 v[52:55], v[24:27], a[144:151], v79
    ds_write_b32 v64, v48 offset:512
    v_smfmac_f32_16x16x64_bf16 v[56:59], v[24:27], a[152:159], v79
    ds_read_b128 v[24:27], v77 offset:2048
    v_smfmac_f32_16x16x64_bf16 v[52:55], v[32:35], a[176:183], v79
    v_smfmac_f32_16x16x64_bf16 v[56:59], v[32:35], a[184:191], v79
    ds_read_b128 v[32:35], v78 offset:9216
    s_waitcnt lgkmcnt(2)
    s_barrier
    ds_read_b128 v[4:7], v78 offset:3072
    v_smfmac_f32_16x16x64_bf16 v[52:55], v[28:31], a[160:167], v79
    ds_read_b128 v[8:11], v78 offset:0
    v_smfmac_f32_16x16x64_bf16 v[56:59], v[28:31], a[168:175], v79
    ds_read_b32 v50, v64 offset:0
    ds_read_b32 v49, v64 offset:768
    v_smfmac_f32_16x16x64_bf16 v[52:55], v[16:19], a[112:119], v79
    ds_read_b32 v51, v64 offset:256
    ds_read_b128 v[12:15], v78 offset:1024
    v_smfmac_f32_16x16x64_bf16 v[56:59], v[16:19], a[120:127], v79
    s_waitcnt lgkmcnt(6)
    buffer_store_dwordx4 v[44:47], v34, s[4:7], s36 offen sc1
    v_smfmac_f32_16x16x64_bf16 v[52:55], v[20:23], a[128:135], v79
    ds_read_b128 v[16:19], v77 offset:0
    v_smfmac_f32_16x16x64_bf16 v[56:59], v[20:23], a[136:143], v79
    ds_read_b128 v[20:23], v77 offset:1024
    s_waitcnt lgkmcnt(3)
    v_add_f32 v50, v50, v51
    v_add_f32 v48, v48, v49
    v_add_f32 v48, v48, v50
    v_pk_add_f32 v[2:3], v[2:3], v[6:7]
    v_pk_add_f32 v[0:1], v[0:1], v[4:5]
    v_mul_f32 v48, s42, v48
    v_cvt_pk_bf16_f32 v52, v52, v53
    v_cvt_pk_bf16_f32 v53, v54, v55
    v_cvt_pk_bf16_f32 v54, v56, v57
    v_cvt_pk_bf16_f32 v55, v58, v59
    ds_read_b128 v[28:31], v77 offset:3072
    s_waitcnt lgkmcnt(3)
    v_pk_add_f32 v[10:11], v[10:11], v[14:15]
    v_pk_add_f32 v[8:9], v[8:9], v[12:13]
    v_pk_add_f32 v[2:3], v[2:3], v[10:11]
    v_pk_add_f32 v[0:1], v[0:1], v[8:9]
    v_mov_b64 v[14:15], s[56:57]
    v_exp_f32 v4, v0
    v_exp_f32 v7, v3
    v_exp_f32 v6, v2
    v_exp_f32 v5, v1
    v_exp_f32 v49, v48
    v_cvt_pk_bf16_f32 v8, v4, v5
    v_max3_f32 v40, |v0|, |v1|, |v2|
    v_mov_b32_dpp v50, v49 quad_perm:[2,3,0,1] row_mask:0xf bank_mask:0xf
    v_max3_f32 v40, v40, |v3|, |v48|
    v_cvt_pk_bf16_f32 v51, v49, v50
    v_cvt_pk_bf16_f32 v50, v49, v50
    v_cvt_pk_bf16_f32 v9, v6, v7
    v_cmp_lt_f32 vcc, s44, v40
    v_mov_b32_dpp v10, v8 quad_perm:[2,3,0,1] row_mask:0xf bank_mask:0xf
    v_mov_b32_dpp v11, v9 quad_perm:[2,3,0,1] row_mask:0xf bank_mask:0xf
    v_mov_b64 v[12:13], s[56:57]
    s_waitcnt vmcnt(3)
    v_mfma_f32_16x16x32_bf16 v[60:63], v[68:71], v[8:11], 0
    buffer_store_dwordx4 v[52:55], v35, s[4:7], s37 offen sc1
    s_waitcnt vmcnt(3)
    v_mfma_f32_16x16x32_bf16 v[64:67], v[72:75], v[8:11], 0
    s_nop 1
    v_mfma_f32_16x16x16_bf16 v[60:63], v[52:53], v[50:51], v[60:63]
    s_nop 1
    v_mfma_f32_16x16x16_bf16 v[64:67], v[54:55], v[50:51], v[64:67]
    s_cbranch_vccnz L_fbF2_44
L_fbkF2_45:
    ds_read_b128 v[0:3], v77 offset:4096
    v_mfma_f32_16x16x16_bf16 v[40:43], v[50:51], v[12:13], 0
    s_cmp_eq_u32 s14, 63
    v_cvt_pk_bf16_f32 v60, v60, v61
    v_cvt_pk_bf16_f32 v61, v62, v63
    ds_read_b128 v[4:7], v77 offset:5120
    v_cvt_pk_bf16_f32 v62, v64, v65
    v_cvt_pk_bf16_f32 v63, v66, v67
    v_mfma_f32_16x16x32_bf16 v[44:47], v[8:11], v[12:15], 0
    ds_write_b128 v32, v[60:63] offset:1024
    v_mov_b64 v[68:69], 0
    v_mov_b64 v[74:75], 0
    ds_read_b128 v[8:11], v77 offset:6144
    v_mov_b64 v[70:71], 0
    v_mov_b64 v[72:73], 0
    v_mov_b64 v[64:65], 0
    ds_read_b128 v[12:15], v77 offset:7168
    v_fma_f32 v41, v41, 0.5, v45
    v_fma_f32 v40, v40, 0.5, v44
    ds_read_b128 v[48:51], v77 offset:11264
    v_rcp_f32 v34, v40
    v_rcp_f32 v35, v41
    ds_read_b128 v[44:47], v77 offset:10240
    v_mov_b64 v[66:67], 0
    s_waitcnt lgkmcnt(4)
    s_barrier
    ds_read_b128 v[52:55], v78 offset:4096
    ds_read_b128 v[56:59], v78 offset:5120
    s_cbranch_scc1 L_doneF
    ds_read_b128 v[40:43], v77 offset:9216
    s_waitcnt lgkmcnt(2)
    v_smfmac_f32_16x16x64_bf16 v[68:71], v[52:55], v[16:23], v79
    ds_read_b128 v[20:23], v77 offset:25600
    v_smfmac_f32_16x16x64_bf16 v[72:75], v[52:55], v[0:7], v79
    ds_read_b128 v[16:19], v77 offset:24576
    s_waitcnt lgkmcnt(2)
    v_smfmac_f32_16x16x64_bf16 v[64:67], v[52:55], v[36:43], v79
    ds_read_b128 v[36:39], v77 offset:28672
    ds_read_b128 v[40:43], v77 offset:29696
    v_smfmac_f32_16x16x64_bf16 v[72:75], v[56:59], v[8:15], v79
    ds_read_b128 v[12:15], v78 offset:11264
    v_smfmac_f32_16x16x64_bf16 v[68:71], v[56:59], v[24:31], v79
    ds_read_b128 v[24:27], v77 offset:26624
    v_smfmac_f32_16x16x64_bf16 v[64:67], v[56:59], v[44:51], v79
    s_nop 1
    v_add_f32 v72, v72, v74
    v_mul_f32 v72, v72, v34
    v_add_f32 v73, v73, v75
    v_mov_b64 v[74:75], 0
    v_add_f32 v68, v68, v70
    v_add_f32 v69, v69, v71
    v_mul_f32 v73, v73, v35
    v_mul_f32 v68, v68, v34
    v_mul_f32 v69, v69, v35
    v_cvt_pk_bf16_f32 v61, v72, v73
    v_cvt_pk_bf16_f32 v60, v68, v69
    v_mov_b64 v[68:69], 0
    v_mov_b64 v[72:73], 0
    v_mov_b64 v[70:71], 0
    v_and_or_b32 v60, v60, -2, s24
    v_and_or_b32 v61, v61, -2, s24
    v_smfmac_f32_16x16x64_bf16 v[68:71], v[52:55], a[192:199], v79
    ds_read_b128 v[44:47], v77 offset:30720
    v_add_f32 v64, v64, v66
    v_smfmac_f32_16x16x64_bf16 v[72:75], v[52:55], a[208:215], v79
    buffer_store_dwordx2 v[60:61], v33, s[4:7], s16 offen
    v_smfmac_f32_16x16x64_bf16 v[68:71], v[56:59], a[200:207], v79
    ds_read_b128 v[48:51], v77 offset:31744
    v_add_f32 v65, v65, v67
    v_smfmac_f32_16x16x64_bf16 v[72:75], v[56:59], a[216:223], v79
    ds_read_b128 v[28:31], v77 offset:27648
    v_mul_f32 v65, v65, v35
    v_mul_f32 v64, v64, v34
    v_mov_b64 v[66:67], 0
    v_cvt_pk_bf16_f32 v62, v64, v65
    v_and_or_b32 v62, v62, -2, s24
    v_mov_b64 v[64:65], 0
    v_add_f32 v68, v68, v70
    v_add_f32 v69, v69, v71
    v_mul_f32 v68, v68, v34
    v_mul_f32 v69, v69, v35
    v_add_f32 v72, v72, v74
    v_add_f32 v73, v73, v75
    v_cvt_pk_bf16_f32 v63, v68, v69
    v_mul_f32 v73, v73, v35
    v_and_or_b32 v63, v63, -2, s24
    v_mul_f32 v72, v72, v34
    buffer_store_dwordx2 v[62:63], v33, s[4:7], s17 offen
    v_cvt_pk_bf16_f32 v32, v72, v73
    v_lshrrev_b32 v72, 1, v33
    v_and_or_b32 v32, v32, -2, s24
    v_mov_b64 v[68:69], 0
    v_smfmac_f32_16x16x64_bf16 v[64:67], v[52:55], a[224:231], v79
    ds_read_b128 v[8:11], v78 offset:10240
    v_mov_b64 v[70:71], 0
    v_mov_b64 v[74:75], 0
    s_nop 0
    v_smfmac_f32_16x16x64_bf16 v[68:71], v[52:55], a[240:247], v79
    buffer_store_dword v32, v72, s[4:7], s20 offen
    v_smfmac_f32_16x16x64_bf16 v[64:67], v[56:59], a[232:239], v79
    v_mov_b64 v[72:73], 0
    v_smfmac_f32_16x16x64_bf16 v[68:71], v[56:59], a[248:255], v79
    s_nop 4
    v_add_f32 v64, v64, v66
    v_add_f32 v65, v65, v67
    v_mov_b64 v[66:67], 0
    v_mul_f32 v65, v65, v35
    v_add_f32 v68, v68, v70
    v_add_f32 v69, v69, v71
    v_mul_f32 v68, v68, v34
    v_mul_f32 v69, v69, v35
    v_mul_f32 v64, v64, v34
    v_cvt_pk_bf16_f32 v61, v68, v69
    v_cvt_pk_bf16_f32 v60, v64, v65
    v_mov_b64 v[64:65], 0
    v_and_or_b32 v60, v60, -2, s24
    v_and_or_b32 v61, v61, -2, s24
    s_waitcnt lgkmcnt(8)
    v_smfmac_f32_16x16x64_bf16 v[72:75], v[52:55], v[16:23], v79
    buffer_store_dwordx2 v[60:61], v33, s[4:7], s18 offen
    s_waitcnt lgkmcnt(6)
    v_smfmac_f32_16x16x64_bf16 v[64:67], v[52:55], v[36:43], v79
    s_waitcnt lgkmcnt(1)
    v_smfmac_f32_16x16x64_bf16 v[72:75], v[56:59], v[24:31], v79
    v_smfmac_f32_16x16x64_bf16 v[64:67], v[56:59], v[44:51], v79
    s_nop 5
    v_add_f32 v72, v72, v74
    v_add_f32 v73, v73, v75
    v_mul_f32 v72, v72, v34
    v_add_f32 v64, v64, v66
    v_add_f32 v65, v65, v67
    v_mul_f32 v73, v73, v35
    v_mul_f32 v64, v64, v34
    v_cvt_pk_bf16_f32 v62, v72, v73
    v_mul_f32 v65, v65, v35
    v_and_or_b32 v62, v62, -2, s24
    v_cvt_pk_bf16_f32 v63, v64, v65
    v_and_or_b32 v63, v63, -2, s24
    buffer_store_dwordx2 v[62:63], v33, s[4:7], s19 offen
    s_waitcnt lgkmcnt(0)
    buffer_load_dwordx4 v[0:3], v10, s[4:7], s26 offen sc1
    s_add_u32 s54, s54, 32
    s_add_u32 s34, s34, 524288
    s_sub_u32 s31, s51, 147456
    s_add_u32 s31, s31, s40
    s_add_u32 s32, s31, 4096
    s_add_u32 s33, s31, 8192
    s_add_u32 s14, s14, 1
    s_xor_b32 s39, s39, 294912
    s_mov_b32 s40, s41
    s_add_u32 s41, s41, 9216
    s_cmp_eq_u32 s41, 27648
    s_cselect_b32 s41, 0, s41
    v_mov_b32 v65, -1
    s_nop 15
    s_nop 15
    s_nop 15
    s_nop 8
    buffer_load_dwordx4 v[36:39], v8, s[4:7], s25 offen sc1
    buffer_load_dwordx4 v[40:43], v8, s[4:7], s25 offen offset:1024 sc1
    s_waitcnt vmcnt(2)
    v_mfma_f32_16x16x32_bf16 v[24:27], v[0:3], v[12:15], 0
    v_bitop3_b32 v28, v0, v1, s24 bitop3:0x7e
    v_bitop3_b32 v29, v2, v3, s24 bitop3:0x7e
    v_bitop3_b32 v28, v28, v29, 1 bitop3:0xa8
    v_cmp_ne_u32 vcc, 0, v28
    s_nop 2
    s_cbranch_vccnz L_rtF_46
L_bkF_47:
    v_add_f32 v24, v24, v25
    v_add_f32 v26, v26, v27
    v_add_f32 v24, v24, v26
    v_mov_b32 v25, v24
    s_nop 1
    v_permlane32_swap_b32 v24, v25
    v_add_f32 v24, v24, v25
    s_nop 1
    v_mov_b32_dpp v25, v24 row_shl:2 row_mask:0xf bank_mask:0xf
    v_cvt_pk_bf16_f32 v24, v24, v25
    v_min_u32 v24, -2, v24
    buffer_store_dword v24, v11, s[4:7], s28 offen
    s_waitcnt vmcnt(1)
    v_mfma_f32_16x16x32_bf16 v[20:23], v[36:39], v[12:15], 0
    v_mfma_f32_16x16x32_bf16 v[20:23], v[40:43], v[12:15], v[20:23]
    v_bitop3_b32 v16, v36, v37, s24 bitop3:0x7e
    v_bitop3_b32 v17, v38, v39, s24 bitop3:0x7e
    v_bitop3_b32 v18, v40, v41, s24 bitop3:0x7e
    v_bitop3_b32 v19, v42, v43, s24 bitop3:0x7e
    v_or3_b32 v16, v16, v17, v18
    v_bitop3_b32 v16, v16, v19, 1 bitop3:0xa8
    v_cmp_ne_u32 vcc, 0, v16
    s_nop 0
    v_add_f32 v20, v20, v21
    v_add_f32 v22, v22, v23
    v_add_f32 v20, v20, v22
    s_nop 1
    v_mov_b32_dpp v21, v20 row_shl:4 row_mask:0xf bank_mask:0xf
    v_cvt_pk_bf16_f32 v20, v20, v21
    v_min_u32 v20, -2, v20
    s_cbranch_vccnz L_rtF_49
L_bkF_50:
    buffer_store_dword v20, v9, s[4:7], s27 offen
    v_mov_b32 v64, v9
    v_mov_b32 v66, v11
    s_cmp_eq_u32 s14, s15
    s_cbranch_scc0 L_stepF2
    s_branch L_doneF
L_entryF3:
    ds_read_b128 v[8:11], v78 offset:10240
    v_mov_b32 v65, -1
    s_waitcnt lgkmcnt(0)
    v_mov_b32 v64, v9
    v_mov_b32 v66, v11
    s_branch L_stepF3
.p2align 6
L_stepF3:
    s_add_u32 s38, s34, 4294469632
    s_cmp_lt_u32 s14, 62
    s_cselect_b32 s38, s38, 1073741824
    s_lshl_b32 s47, s54, 11
    s_add_u32 s36, s47, 50333184
    s_lshl_b32 s47, s47, 1
    s_add_u32 s37, s47, 54529024
    s_add_u32 s16, s21, s39
    s_add_u32 s17, s16, 65536
    s_add_u32 s18, s16, 131072
    s_add_u32 s19, s16, 196608
    s_lshl_b32 s46, s12, 5
    s_add_u32 s48, s50, s39
    s_add_u32 s49, s48, s46
    s_add_u32 s20, s49, 286720
    s_add_u32 s46, s46, s51
    s_add_u32 s47, s46, s40
    s_add_u32 s27, s47, 6144
    s_add_u32 s28, s47, 8192
    s_lshl_b32 s46, s12, 11
    s_add_u32 s46, s46, s48
    s_add_u32 s25, s46, 196608
    s_lshl_b32 s46, s12, 10
    s_add_u32 s46, s46, s48
    s_add_u32 s26, s46, 262144
    s_bfe_u32 s24, s14, 0x10001
    s_waitcnt vmcnt(1)
    v_mov_b64 v[36:37], 0
    v_mov_b64 v[38:39], 0
    v_mov_b64 v[40:41], 0
    v_mov_b64 v[42:43], 0
    v_mov_b64 v[44:45], 0
    v_mov_b64 v[46:47], 0
    v_mov_b64 v[48:49], 0
    v_mov_b64 v[50:51], 0
    v_mov_b64 v[52:53], 0
    v_mov_b64 v[54:55], 0
    v_mov_b64 v[56:57], 0
    v_mov_b64 v[58:59], 0
    v_add_u32 v77, 4294930432, v78
    s_nop 0
    s_add_u32 s35, s34, 8192
    ds_read_b128 v[72:75], v77 offset:21504
    ds_read_b128 v[68:71], v77 offset:20480
    ds_read_b128 v[16:19], v77 offset:22528
    ds_read_b128 v[20:23], v77 offset:23552
    s_waitcnt lgkmcnt(4)
    s_barrier
    ds_read_b128 v[12:15], v78 offset:3072
    ds_read_b128 v[0:3], v78 offset:0
    ds_read_b128 v[4:7], v78 offset:1024
    ds_read_b128 v[8:11], v78 offset:2048
    s_waitcnt lgkmcnt(3)
    v_smfmac_f32_16x16x64_bf16 v[48:51], v[12:15], v[200:207], v79
    v_smfmac_f32_16x16x64_bf16 v[52:55], v[12:15], v[68:75], v79
    ds_read_b128 v[72:75], v77 offset:13312
    ds_read_b128 v[68:71], v77 offset:12288
    s_waitcnt lgkmcnt(4)
    v_smfmac_f32_16x16x64_bf16 v[48:51], v[0:3], v[104:111], v79
    buffer_load_dwordx4 v[28:31], v78, s[4:7], s32 offen offset:3072 sc1
    v_smfmac_f32_16x16x64_bf16 v[56:59], v[12:15], v[16:23], v79
    ds_read_b128 v[20:23], v77 offset:15360
    v_smfmac_f32_16x16x64_bf16 v[36:39], v[12:15], v[176:183], v79
    ds_read_b128 v[16:19], v77 offset:14336
    v_smfmac_f32_16x16x64_bf16 v[40:43], v[12:15], v[184:191], v79
    v_smfmac_f32_16x16x64_bf16 v[44:47], v[12:15], v[192:199], v79
    buffer_load_dwordx4 v[32:35], v78, s[4:7], s33 offen offset:0 sc1
    s_waitcnt lgkmcnt(2)
    v_smfmac_f32_16x16x64_bf16 v[52:55], v[0:3], v[68:75], v79
    ds_read_b128 v[68:71], v77 offset:32768
    v_smfmac_f32_16x16x64_bf16 v[40:43], v[0:3], v[88:95], v79
    ds_read_b128 v[72:75], v77 offset:33792
    s_waitcnt lgkmcnt(2)
    v_smfmac_f32_16x16x64_bf16 v[56:59], v[0:3], v[16:23], v79
    ds_read_b128 v[16:19], v77 offset:34816
    v_smfmac_f32_16x16x64_bf16 v[36:39], v[0:3], v[80:87], v79
    ds_read_b128 v[20:23], v77 offset:35840
    buffer_store_dword v65, v64, s[4:7], s27 offen
    v_smfmac_f32_16x16x64_bf16 v[44:47], v[0:3], v[96:103], v79
    buffer_load_dwordx4 v[60:63], v78, s[4:7], s34 offen sc1
    v_smfmac_f32_16x16x64_bf16 v[36:39], v[4:7], v[112:119], v79
    s_waitcnt lgkmcnt(2)
    v_smfmac_f32_16x16x64_bf16 v[52:55], v[4:7], v[68:75], v79
    ds_read_b128 v[68:71], v77 offset:16384
    v_smfmac_f32_16x16x64_bf16 v[40:43], v[4:7], v[120:127], v79
    ds_read_b128 v[72:75], v77 offset:17408
    s_waitcnt lgkmcnt(2)
    v_smfmac_f32_16x16x64_bf16 v[56:59], v[4:7], v[16:23], v79
    ds_read_b128 v[16:19], v77 offset:18432
    buffer_load_dwordx4 v[64:67], v78, s[4:7], s34 offen offset:1024 sc1
    v_smfmac_f32_16x16x64_bf16 v[44:47], v[4:7], v[128:135], v79
    ds_read_b128 v[20:23], v77 offset:19456
    v_smfmac_f32_16x16x64_bf16 v[40:43], v[8:11], v[152:159], v79
    v_smfmac_f32_16x16x64_bf16 v[36:39], v[8:11], v[144:151], v79
    v_smfmac_f32_16x16x64_bf16 v[44:47], v[8:11], v[160:167], v79
    s_waitcnt lgkmcnt(2)
    v_smfmac_f32_16x16x64_bf16 v[52:55], v[8:11], v[68:75], v79
    buffer_load_dwordx4 v[68:71], v78, s[4:7], s35 offen sc1
    s_waitcnt vmcnt(5)
    v_max3_u32 v76, v28, v29, v30
    v_max_u32 v76, v76, v31
    ds_write_b128 v78, v[28:31] offset:7168
    v_cmp_eq_u32 vcc, -1, v76
    v_smfmac_f32_16x16x64_bf16 v[48:51], v[4:7], v[136:143], v79
    s_cbranch_vccnz L_rtF_52
L_bkF_53:
    buffer_load_dwordx4 v[72:75], v78, s[4:7], s35 offen offset:1024 sc1
    s_waitcnt vmcnt(5)
    v_max3_u32 v76, v32, v33, v34
    v_max_u32 v76, v76, v35
    v_cmp_eq_u32 vcc, -1, v76
    v_smfmac_f32_16x16x64_bf16 v[48:51], v[8:11], v[168:175], v79
    s_cbranch_vccnz L_rtF_55
L_bkF_56:
    v_smfmac_f32_16x16x64_bf16 v[40:43], v[28:31], a[56:63], v79
    s_waitcnt lgkmcnt(0)
    s_barrier
    v_smfmac_f32_16x16x64_bf16 v[56:59], v[8:11], v[16:23], v79
    ds_read_b128 v[16:19], v78 offset:4096
    v_mov_b32 v76, s14
    v_smfmac_f32_16x16x64_bf16 v[36:39], v[28:31], a[48:55], v79
    ds_read_b128 v[20:23], v78 offset:5120
    v_smfmac_f32_16x16x64_bf16 v[44:47], v[28:31], a[64:71], v79
    ds_read_b128 v[24:27], v78 offset:6144
    v_smfmac_f32_16x16x64_bf16 v[48:51], v[28:31], a[72:79], v79
    v_smfmac_f32_16x16x64_bf16 v[36:39], v[32:35], a[80:87], v79
    v_smfmac_f32_16x16x64_bf16 v[44:47], v[32:35], a[96:103], v79
    v_smfmac_f32_16x16x64_bf16 v[48:51], v[32:35], a[104:111], v79
    s_waitcnt lgkmcnt(2)
    v_smfmac_f32_16x16x64_bf16 v[36:39], v[16:19], v[208:215], v79
    v_smfmac_f32_16x16x64_bf16 v[40:43], v[32:35], a[88:95], v79
    buffer_store_dword v76, off, s[4:7], s53 sc1
    v_smfmac_f32_16x16x64_bf16 v[44:47], v[16:19], v[224:231], v79
    ds_read_b64 v[76:77], v78 offset:12288
    v_smfmac_f32_16x16x64_bf16 v[40:43], v[16:19], v[216:223], v79
    v_smfmac_f32_16x16x64_bf16 v[48:51], v[16:19], v[232:239], v79
    s_waitcnt lgkmcnt(2)
    v_smfmac_f32_16x16x64_bf16 v[36:39], v[20:23], v[240:247], v79
    v_smfmac_f32_16x16x64_bf16 v[40:43], v[20:23], v[248:255], v79
    v_smfmac_f32_16x16x64_bf16 v[44:47], v[20:23], a[0:7], v79
    v_smfmac_f32_16x16x64_bf16 v[48:51], v[20:23], a[8:15], v79
    s_waitcnt lgkmcnt(1)
    v_smfmac_f32_16x16x64_bf16 v[36:39], v[24:27], a[16:23], v79
    v_smfmac_f32_16x16x64_bf16 v[44:47], v[24:27], a[32:39], v79
    v_smfmac_f32_16x16x64_bf16 v[48:51], v[24:27], a[40:47], v79
    s_nop 3
    v_cvt_pk_bf16_f32 v36, v36, v37
    v_cvt_pk_bf16_f32 v37, v38, v39
    v_cvt_pk_bf16_f32 v44, v44, v45
    v_cvt_pk_bf16_f32 v45, v46, v47
    s_waitcnt lgkmcnt(0)
    v_mfma_f32_16x16x16_bf16 v[0:3], v[36:37], v[76:77], 0
    v_cvt_pk_bf16_f32 v48, v48, v49
    v_cvt_pk_bf16_f32 v49, v50, v51
    v_smfmac_f32_16x16x64_bf16 v[40:43], v[24:27], a[24:31], v79
    v_mfma_f32_16x16x16_bf16 v[8:11], v[44:45], v[76:77], 0
    s_nop 1
    v_cvt_pk_bf16_f32 v36, v0, v1
    v_mfma_f32_16x16x16_bf16 v[12:15], v[48:49], v[76:77], 0
    s_nop 0
    v_cvt_pk_bf16_f32 v40, v40, v41
    v_cvt_pk_bf16_f32 v41, v42, v43
    v_cvt_pk_bf16_f32 v37, v2, v3
    v_cvt_pk_bf16_f32 v44, v8, v9
    v_mfma_f32_16x16x16_bf16 v[4:7], v[40:41], v[76:77], 0
    s_nop 0
    v_cvt_pk_bf16_f32 v47, v14, v15
    v_cvt_pk_bf16_f32 v46, v12, v13
    v_smfmac_f32_16x16x64_bf16 v[52:55], v[28:31], a[160:167], v79
    v_cvt_pk_bf16_f32 v45, v10, v11
    v_add_u32 v77, 4294930432, v78
    s_nop 0
    v_cvt_pk_bf16_f32 v38, v4, v5
    v_cvt_pk_bf16_f32 v39, v6, v7
    s_waitcnt vmcnt(4)
    s_nop 0
    v_mfma_f32_16x16x32_bf16 v[0:3], v[60:63], v[36:39], 0
    s_waitcnt vmcnt(3)
    v_mfma_f32_16x16x32_bf16 v[4:7], v[64:67], v[36:39], 0
    v_lshrrev_b32 v64, 2, v78
    v_add_u32 v64, 118784, v64
    v_mfma_f32_16x16x32_bf16 v[48:51], v[44:47], v[36:39], 0
    ds_read_b128 v[36:39], v77 offset:8192
    s_nop 2
    v_cndmask_b32 v0, v0, v4, s[22:23]
    v_cndmask_b32 v1, v1, v5, s[22:23]
    v_cndmask_b32 v3, v3, v7, s[22:23]
    v_cndmask_b32 v2, v2, v6, s[22:23]
    ds_write_b128 v78, v[0:3] offset:3072
    v_cndmask_b32 v48, v48, v49, s[22:23]
    v_smfmac_f32_16x16x64_bf16 v[56:59], v[28:31], a[168:175], v79
    ds_write_b32 v64, v48 offset:768
    v_smfmac_f32_16x16x64_bf16 v[52:55], v[32:35], a[176:183], v79
    ds_read_b128 v[28:31], v77 offset:3072
    v_smfmac_f32_16x16x64_bf16 v[56:59], v[32:35], a[184:191], v79
    ds_read_b128 v[32:35], v78 offset:9216
    v_smfmac_f32_16x16x64_bf16 v[52:55], v[16:19], a[112:119], v79
    s_waitcnt lgkmcnt(2)
    s_barrier
    ds_read_b128 v[4:7], v78 offset:0
    v_smfmac_f32_16x16x64_bf16 v[56:59], v[16:19], a[120:127], v79
    ds_read_b128 v[8:11], v78 offset:1024
    v_smfmac_f32_16x16x64_bf16 v[52:55], v[20:23], a[128:135], v79
    ds_read_b128 v[12:15], v78 offset:2048
    v_smfmac_f32_16x16x64_bf16 v[56:59], v[20:23], a[136:143], v79
    ds_read_b32 v49, v64 offset:0
    ds_read_b32 v50, v64 offset:256
    v_smfmac_f32_16x16x64_bf16 v[52:55], v[24:27], a[144:151], v79
    ds_read_b32 v51, v64 offset:512
    s_waitcnt lgkmcnt(6)
    buffer_store_dwordx4 v[44:47], v34, s[4:7], s36 offen sc1
    ds_read_b128 v[16:19], v77 offset:0
    s_waitcnt lgkmcnt(6)
    v_pk_add_f32 v[2:3], v[2:3], v[6:7]
    v_pk_add_f32 v[0:1], v[0:1], v[4:5]
    ds_read_b128 v[20:23], v77 offset:1024
    v_cvt_pk_bf16_f32 v52, v52, v53
    v_cvt_pk_bf16_f32 v53, v54, v55
    s_waitcnt lgkmcnt(4)
    v_add_f32 v48, v48, v49
    v_pk_add_f32 v[10:11], v[10:11], v[14:15]
    v_pk_add_f32 v[8:9], v[8:9], v[12:13]
    v_pk_add_f32 v[2:3], v[2:3], v[10:11]
    v_pk_add_f32 v[0:1], v[0:1], v[8:9]
    v_mov_b64 v[14:15], s[56:57]
    v_exp_f32 v4, v0
    v_exp_f32 v5, v1
    v_exp_f32 v6, v2
    v_exp_f32 v7, v3
    v_cvt_pk_bf16_f32 v8, v4, v5
    v_max3_f32 v40, |v0|, |v1|, |v2|
    v_cvt_pk_bf16_f32 v9, v6, v7
    v_mov_b32_dpp v10, v8 quad_perm:[2,3,0,1] row_mask:0xf bank_mask:0xf
    v_mov_b64 v[12:13], s[56:57]
    v_mov_b32_dpp v11, v9 quad_perm:[2,3,0,1] row_mask:0xf bank_mask:0xf
    s_waitcnt lgkmcnt(2)
    v_add_f32 v50, v50, v51
    v_add_f32 v48, v48, v50
    v_mul_f32 v48, s42, v48
    v_max3_f32 v40, v40, |v3|, |v48|
    v_cmp_lt_f32 vcc, s44, v40
    s_waitcnt vmcnt(3)
    v_mfma_f32_16x16x32_bf16 v[60:63], v[68:71], v[8:11], 0
    v_exp_f32 v49, v48
    v_smfmac_f32_16x16x64_bf16 v[56:59], v[24:27], a[152:159], v79
    ds_read_b128 v[24:27], v77 offset:2048
    v_mov_b32_dpp v50, v49 quad_perm:[2,3,0,1] row_mask:0xf bank_mask:0xf
    v_cvt_pk_bf16_f32 v51, v49, v50
    v_cvt_pk_bf16_f32 v50, v49, v50
    s_waitcnt vmcnt(2)
    v_mfma_f32_16x16x32_bf16 v[64:67], v[72:75], v[8:11], 0
    s_nop 0
    v_cvt_pk_bf16_f32 v55, v58, v59
    v_cvt_pk_bf16_f32 v54, v56, v57
    v_mfma_f32_16x16x16_bf16 v[60:63], v[52:53], v[50:51], v[60:63]
    buffer_store_dwordx4 v[52:55], v35, s[4:7], s37 offen sc1
    v_mfma_f32_16x16x16_bf16 v[64:67], v[54:55], v[50:51], v[64:67]
    s_cbranch_vccnz L_fbF3_58
L_fbkF3_59:
    v_mfma_f32_16x16x16_bf16 v[40:43], v[50:51], v[12:13], 0
    ds_read_b128 v[0:3], v77 offset:4096
    s_cmp_eq_u32 s14, 63
    v_cvt_pk_bf16_f32 v60, v60, v61
    v_cvt_pk_bf16_f32 v61, v62, v63
    ds_read_b128 v[4:7], v77 offset:5120
    v_cvt_pk_bf16_f32 v63, v66, v67
    v_cvt_pk_bf16_f32 v62, v64, v65
    v_mfma_f32_16x16x32_bf16 v[44:47], v[8:11], v[12:15], 0
    ds_write_b128 v32, v[60:63] offset:1536
    v_mov_b64 v[72:73], 0
    v_mov_b64 v[70:71], 0
    ds_read_b128 v[8:11], v77 offset:6144
    v_mov_b64 v[68:69], 0
    v_mov_b64 v[74:75], 0
    v_mov_b64 v[64:65], 0
    ds_read_b128 v[12:15], v77 offset:7168
    v_fma_f32 v40, v40, 0.5, v44
    v_fma_f32 v41, v41, 0.5, v45
    v_rcp_f32 v34, v40
    v_rcp_f32 v35, v41
    ds_read_b128 v[40:43], v77 offset:9216
    v_mov_b64 v[66:67], 0
    s_waitcnt lgkmcnt(3)
    s_barrier
    ds_read_b128 v[52:55], v78 offset:4096
    ds_read_b128 v[56:59], v78 offset:5120
    s_cbranch_scc1 L_doneF
    ds_read_b128 v[48:51], v77 offset:11264
    ds_read_b128 v[44:47], v77 offset:10240
    s_waitcnt lgkmcnt(3)
    v_smfmac_f32_16x16x64_bf16 v[72:75], v[52:55], v[0:7], v79
    v_smfmac_f32_16x16x64_bf16 v[68:71], v[52:55], v[16:23], v79
    ds_read_b128 v[16:19], v77 offset:24576
    v_smfmac_f32_16x16x64_bf16 v[64:67], v[52:55], v[36:43], v79
    ds_read_b128 v[36:39], v77 offset:28672
    ds_read_b128 v[40:43], v77 offset:29696
    s_waitcnt lgkmcnt(5)
    v_smfmac_f32_16x16x64_bf16 v[68:71], v[56:59], v[24:31], v79
    ds_read_b128 v[20:23], v77 offset:25600
    v_smfmac_f32_16x16x64_bf16 v[72:75], v[56:59], v[8:15], v79
    ds_read_b128 v[24:27], v77 offset:26624
    s_waitcnt lgkmcnt(5)
    v_smfmac_f32_16x16x64_bf16 v[64:67], v[56:59], v[44:51], v79
    ds_read_b128 v[28:31], v77 offset:27648
    v_add_f32 v68, v68, v70
    v_add_f32 v69, v69, v71
    v_mov_b64 v[70:71], 0
    v_mul_f32 v69, v69, v35
    v_mul_f32 v68, v68, v34
    v_add_f32 v72, v72, v74
    v_add_f32 v73, v73, v75
    v_mul_f32 v72, v72, v34
    v_mul_f32 v73, v73, v35
    v_cvt_pk_bf16_f32 v60, v68, v69
    v_mov_b64 v[68:69], 0
    v_mov_b64 v[74:75], 0
    v_and_or_b32 v60, v60, -2, s24
    v_smfmac_f32_16x16x64_bf16 v[68:71], v[52:55], a[192:199], v79
    ds_read_b128 v[44:47], v77 offset:30720
    v_cvt_pk_bf16_f32 v61, v72, v73
    v_mov_b64 v[72:73], 0
    v_and_or_b32 v61, v61, -2, s24
    v_add_f32 v64, v64, v66
    v_smfmac_f32_16x16x64_bf16 v[72:75], v[52:55], a[208:215], v79
    buffer_store_dwordx2 v[60:61], v33, s[4:7], s16 offen
    v_smfmac_f32_16x16x64_bf16 v[68:71], v[56:59], a[200:207], v79
    ds_read_b128 v[48:51], v77 offset:31744
    v_add_f32 v65, v65, v67
    v_mul_f32 v65, v65, v35
    v_smfmac_f32_16x16x64_bf16 v[72:75], v[56:59], a[216:223], v79
    ds_read_b128 v[8:11], v78 offset:10240
    v_mov_b64 v[66:67], 0
    v_mul_f32 v64, v64, v34
    v_add_f32 v68, v68, v70
    v_add_f32 v69, v69, v71
    v_mul_f32 v68, v68, v34
    v_mul_f32 v69, v69, v35
    v_cvt_pk_bf16_f32 v62, v64, v65
    v_add_f32 v72, v72, v74
    v_add_f32 v73, v73, v75
    v_mul_f32 v72, v72, v34
    v_mul_f32 v73, v73, v35
    v_cvt_pk_bf16_f32 v63, v68, v69
    v_and_or_b32 v62, v62, -2, s24
    v_and_or_b32 v63, v63, -2, s24
    v_mov_b64 v[70:71], 0
    buffer_store_dwordx2 v[62:63], v33, s[4:7], s17 offen
    v_cvt_pk_bf16_f32 v32, v72, v73
    v_lshrrev_b32 v72, 1, v33
    v_and_or_b32 v32, v32, -2, s24
    v_mov_b64 v[64:65], 0
    v_mov_b64 v[68:69], 0
    v_mov_b64 v[74:75], 0
    v_smfmac_f32_16x16x64_bf16 v[64:67], v[52:55], a[224:231], v79
    ds_read_b128 v[12:15], v78 offset:11264
    v_smfmac_f32_16x16x64_bf16 v[68:71], v[52:55], a[240:247], v79
    buffer_store_dword v32, v72, s[4:7], s20 offen
    v_smfmac_f32_16x16x64_bf16 v[64:67], v[56:59], a[232:239], v79
    v_mov_b64 v[72:73], 0
    v_smfmac_f32_16x16x64_bf16 v[68:71], v[56:59], a[248:255], v79
    s_waitcnt lgkmcnt(6)
    v_smfmac_f32_16x16x64_bf16 v[72:75], v[52:55], v[16:23], v79
    s_nop 1
    v_add_f32 v64, v64, v66
    v_add_f32 v65, v65, v67
    v_mul_f32 v64, v64, v34
    v_add_f32 v68, v68, v70
    v_add_f32 v69, v69, v71
    v_mov_b64 v[66:67], 0
    v_mul_f32 v68, v68, v34
    v_mul_f32 v69, v69, v35
    v_mul_f32 v65, v65, v35
    v_cvt_pk_bf16_f32 v61, v68, v69
    v_cvt_pk_bf16_f32 v60, v64, v65
    v_mov_b64 v[64:65], 0
    v_and_or_b32 v61, v61, -2, s24
    v_and_or_b32 v60, v60, -2, s24
    v_smfmac_f32_16x16x64_bf16 v[64:67], v[52:55], v[36:43], v79
    buffer_store_dwordx2 v[60:61], v33, s[4:7], s18 offen
    s_waitcnt lgkmcnt(4)
    v_smfmac_f32_16x16x64_bf16 v[72:75], v[56:59], v[24:31], v79
    s_waitcnt lgkmcnt(2)
    v_smfmac_f32_16x16x64_bf16 v[64:67], v[56:59], v[44:51], v79
    s_nop 4
    v_add_f32 v72, v72, v74
    v_mul_f32 v72, v72, v34
    v_add_f32 v73, v73, v75
    v_add_f32 v64, v64, v66
    v_add_f32 v65, v65, v67
    v_mul_f32 v64, v64, v34
    v_mul_f32 v73, v73, v35
    v_mul_f32 v65, v65, v35
    v_cvt_pk_bf16_f32 v62, v72, v73
    v_cvt_pk_bf16_f32 v63, v64, v65
    v_and_or_b32 v62, v62, -2, s24
    v_and_or_b32 v63, v63, -2, s24
    buffer_store_dwordx2 v[62:63], v33, s[4:7], s19 offen
    s_waitcnt lgkmcnt(0)
    s_add_u32 s54, s54, 32
    s_add_u32 s34, s34, 524288
    s_sub_u32 s31, s51, 147456
    s_add_u32 s31, s31, s40
    s_add_u32 s32, s31, 4096
    s_add_u32 s33, s31, 8192
    s_add_u32 s14, s14, 1
    s_xor_b32 s39, s39, 294912
    s_mov_b32 s40, s41
    s_add_u32 s41, s41, 9216
    s_cmp_eq_u32 s41, 27648
    s_cselect_b32 s41, 0, s41
    v_mov_b32 v65, -1
    s_nop 15
    s_nop 15
    s_nop 15
    s_nop 15
    s_nop 12
    buffer_load_dwordx4 v[0:3], v8, s[4:7], s25 offen sc1
    buffer_load_dwordx4 v[4:7], v8, s[4:7], s25 offen offset:1024 sc1
    s_waitcnt vmcnt(0)
    v_mfma_f32_16x16x32_bf16 v[20:23], v[0:3], v[12:15], 0
    v_mfma_f32_16x16x32_bf16 v[20:23], v[4:7], v[12:15], v[20:23]
    v_bitop3_b32 v16, v0, v1, s24 bitop3:0x7e
    v_bitop3_b32 v17, v2, v3, s24 bitop3:0x7e
    v_bitop3_b32 v18, v4, v5, s24 bitop3:0x7e
    v_bitop3_b32 v19, v6, v7, s24 bitop3:0x7e
    v_or3_b32 v16, v16, v17, v18
    v_bitop3_b32 v16, v16, v19, 1 bitop3:0xa8
    v_cmp_ne_u32 vcc, 0, v16
    s_nop 0
    v_add_f32 v20, v20, v21
    v_add_f32 v22, v22, v23
    v_add_f32 v20, v20, v22
    s_nop 1
    v_mov_b32_dpp v21, v20 row_shl:4 row_mask:0xf bank_mask:0xf
    v_cvt_pk_bf16_f32 v20, v20, v21
    v_min_u32 v20, -2, v20
    s_cbranch_vccnz L_rtF_60
L_bkF_61:
    buffer_store_dword v20, v9, s[4:7], s27 offen
    v_mov_b32 v64, v9
    v_mov_b32 v66, v11
    s_cmp_eq_u32 s14, s15
    s_cbranch_scc0 L_stepF3
    s_branch L_doneF
L_mpF0_6:
    s_mov_b32 s43, 0
L_mqF0_8:
    buffer_load_dwordx4 v[16:19], v78, s[4:7], s31 offen offset:0 sc1
    buffer_load_dwordx4 v[20:23], v78, s[4:7], s31 offen offset:2048 sc1
    s_waitcnt vmcnt(2)
    v_max3_u32 v76, v68, v69, v70
    v_max3_u32 v76, v76, v71, v72
    v_max3_u32 v76, v76, v73, v74
    v_max_u32 v76, v76, v75
    v_cmp_eq_u32 vcc, -1, v76
    s_cbranch_vccz L_moF0_9
    buffer_load_dwordx4 v[68:71], v78, s[4:7], s31 offen offset:0 sc1
    buffer_load_dwordx4 v[72:75], v78, s[4:7], s31 offen offset:2048 sc1
    s_waitcnt vmcnt(2)
    v_max3_u32 v76, v16, v17, v18
    v_max3_u32 v76, v76, v19, v20
    v_max3_u32 v76, v76, v21, v22
    v_max_u32 v76, v76, v23
    v_cmp_eq_u32 vcc, -1, v76
    s_cbranch_vccz L_moF0_10
    s_add_u32 s43, s43, 1
    s_cmp_gt_u32 s43, 2000000
    s_cbranch_scc1 L_failA
    s_branch L_mqF0_8
L_moF0_9:
    v_mov_b64 v[0:1], v[68:69]
    v_mov_b64 v[2:3], v[70:71]
    v_mov_b64 v[8:9], v[72:73]
    v_mov_b64 v[10:11], v[74:75]
    ds_write_b128 v78, v[0:3] offset:0
    ds_write_b128 v78, v[8:11] offset:2048
    s_nop 0
    s_branch L_mdF0_7
L_moF0_10:
    v_mov_b64 v[0:1], v[16:17]
    v_mov_b64 v[2:3], v[18:19]
    v_mov_b64 v[8:9], v[20:21]
    v_mov_b64 v[10:11], v[22:23]
    ds_write_b128 v78, v[0:3] offset:0
    ds_write_b128 v78, v[8:11] offset:2048
    s_nop 0
    s_branch L_mdF0_7
        L_rtF_11:
    s_mov_b32 s43, 0
        L_rlF_13:
    buffer_load_dwordx4 v[16:19], v78, s[4:7], s32 offen offset:0 sc1
    s_add_u32 s43, s43, 1
    s_cmp_gt_u32 s43, 2000000
    s_cbranch_scc1 L_failA
    s_waitcnt vmcnt(0)
    v_max3_u32 v76, v16, v17, v18
    v_max_u32 v76, v76, v19
    v_cmp_eq_u32 vcc, -1, v76
    s_cbranch_vccnz L_rlF_13
    ds_write_b128 v78, v[16:19] offset:4096
    s_branch L_bkF_12
        L_rtF_14:
    s_mov_b32 s43, 0
        L_rlF_16:
    buffer_load_dwordx4 v[32:35], v78, s[4:7], s33 offen offset:0 sc1
    s_add_u32 s43, s43, 1
    s_cmp_gt_u32 s43, 2000000
    s_cbranch_scc1 L_failA
    s_waitcnt vmcnt(0)
    v_max3_u32 v76, v32, v33, v34
    v_max_u32 v76, v76, v35
    v_cmp_eq_u32 vcc, -1, v76
    s_cbranch_vccnz L_rlF_16
    s_branch L_bkF_15
        L_fbF0_17:
    s_nop 7
    v_max3_f32 v40, v0, v1, v2
    v_max3_f32 v40, v40, v3, v48
    s_nop 1
    v_max_f32_dpp v40, v40, v40 quad_perm:[2,3,0,1] row_mask:0xf bank_mask:0xf
    v_mov_b32 v41, v40
    s_nop 1
    v_permlane16_swap_b32 v40, v41
    v_max_f32 v40, v40, v41
    v_mov_b32 v41, v40
    s_nop 1
    v_permlane32_swap_b32 v40, v41
    v_max_f32 v40, v40, v41
    v_sub_f32 v4, v0, v40
    v_sub_f32 v5, v1, v40
    v_sub_f32 v6, v2, v40
    v_sub_f32 v7, v3, v40
    v_sub_f32 v49, v48, v40
    v_exp_f32 v4, v4
    v_exp_f32 v5, v5
    v_exp_f32 v6, v6
    v_exp_f32 v7, v7
    v_exp_f32 v49, v49
    v_cvt_pk_bf16_f32 v8, v4, v5
    v_cvt_pk_bf16_f32 v9, v6, v7
    s_nop 1
    v_mov_b32_dpp v10, v8 quad_perm:[2,3,0,1] row_mask:0xf bank_mask:0xf
    v_mov_b32_dpp v11, v9 quad_perm:[2,3,0,1] row_mask:0xf bank_mask:0xf
    v_mov_b32_dpp v50, v49 quad_perm:[2,3,0,1] row_mask:0xf bank_mask:0xf
    v_cvt_pk_bf16_f32 v51, v49, v50
    v_cvt_pk_bf16_f32 v50, v49, v50
    s_nop 1
    v_mfma_f32_16x16x32_bf16 v[60:63], v[68:71], v[8:11], 0
    v_mfma_f32_16x16x32_bf16 v[64:67], v[72:75], v[8:11], 0
    s_nop 5
    v_mfma_f32_16x16x16_bf16 v[60:63], v[52:53], v[50:51], v[60:63]
    v_mfma_f32_16x16x16_bf16 v[64:67], v[54:55], v[50:51], v[64:67]
    s_nop 7
    s_branch L_fbkF0_18
        L_rtF_19:
    s_mov_b32 s43, 0
        L_rlF_21:
    buffer_load_dwordx4 v[0:3], v8, s[4:7], s25 offen sc1
    buffer_load_dwordx4 v[4:7], v8, s[4:7], s25 offen offset:1024 sc1
    s_add_u32 s43, s43, 1
    s_cmp_gt_u32 s43, 2000000
    s_cbranch_scc1 L_failA
    s_waitcnt vmcnt(0)
    v_bitop3_b32 v16, v0, v1, s24 bitop3:0x7e
    v_bitop3_b32 v17, v2, v3, s24 bitop3:0x7e
    v_bitop3_b32 v18, v4, v5, s24 bitop3:0x7e
    v_bitop3_b32 v19, v6, v7, s24 bitop3:0x7e
    v_or3_b32 v16, v16, v17, v18
    v_bitop3_b32 v16, v16, v19, 1 bitop3:0xa8
    v_cmp_ne_u32 vcc, 0, v16
    s_cbranch_vccnz L_rlF_21
    v_mfma_f32_16x16x32_bf16 v[20:23], v[0:3], v[12:15], 0
    v_mfma_f32_16x16x32_bf16 v[20:23], v[4:7], v[12:15], v[20:23]
    s_nop 7
    v_add_f32 v20, v20, v21
    v_add_f32 v22, v22, v23
    v_add_f32 v20, v20, v22
    s_nop 1
    v_mov_b32_dpp v21, v20 row_shl:4 row_mask:0xf bank_mask:0xf
    v_cvt_pk_bf16_f32 v20, v20, v21
    v_min_u32 v20, -2, v20
    s_branch L_bkF_20
L_mpF1_22:
    s_mov_b32 s43, 0
L_mqF1_24:
    buffer_load_dwordx4 v[16:19], v78, s[4:7], s31 offen offset:1024 sc1
    buffer_load_dwordx4 v[20:23], v78, s[4:7], s31 offen offset:3072 sc1
    s_waitcnt vmcnt(2)
    v_max3_u32 v76, v68, v69, v70
    v_max3_u32 v76, v76, v71, v72
    v_max3_u32 v76, v76, v73, v74
    v_max_u32 v76, v76, v75
    v_cmp_eq_u32 vcc, -1, v76
    s_cbranch_vccz L_moF1_25
    buffer_load_dwordx4 v[68:71], v78, s[4:7], s31 offen offset:1024 sc1
    buffer_load_dwordx4 v[72:75], v78, s[4:7], s31 offen offset:3072 sc1
    s_waitcnt vmcnt(2)
    v_max3_u32 v76, v16, v17, v18
    v_max3_u32 v76, v76, v19, v20
    v_max3_u32 v76, v76, v21, v22
    v_max_u32 v76, v76, v23
    v_cmp_eq_u32 vcc, -1, v76
    s_cbranch_vccz L_moF1_26
    s_add_u32 s43, s43, 1
    s_cmp_gt_u32 s43, 2000000
    s_cbranch_scc1 L_failA
    s_branch L_mqF1_24
L_moF1_25:
    v_mov_b64 v[4:5], v[68:69]
    v_mov_b64 v[6:7], v[70:71]
    v_mov_b64 v[12:13], v[72:73]
    v_mov_b64 v[14:15], v[74:75]
    ds_write_b128 v78, v[4:7] offset:1024
    ds_write_b128 v78, v[12:15] offset:3072
    s_nop 0
    s_branch L_mdF1_23
L_moF1_26:
    v_mov_b64 v[4:5], v[16:17]
    v_mov_b64 v[6:7], v[18:19]
    v_mov_b64 v[12:13], v[20:21]
    v_mov_b64 v[14:15], v[22:23]
    ds_write_b128 v78, v[4:7] offset:1024
    ds_write_b128 v78, v[12:15] offset:3072
    s_nop 0
    s_branch L_mdF1_23
        L_rtF_27:
    s_mov_b32 s43, 0
        L_rlF_29:
    buffer_load_dwordx4 v[20:23], v78, s[4:7], s32 offen offset:1024 sc1
    s_add_u32 s43, s43, 1
    s_cmp_gt_u32 s43, 2000000
    s_cbranch_scc1 L_failA
    s_waitcnt vmcnt(0)
    v_max3_u32 v76, v20, v21, v22
    v_max_u32 v76, v76, v23
    v_cmp_eq_u32 vcc, -1, v76
    s_cbranch_vccnz L_rlF_29
    ds_write_b128 v78, v[20:23] offset:5120
    s_branch L_bkF_28
        L_rtF_30:
    s_mov_b32 s43, 0
        L_rlF_32:
    buffer_load_dwordx4 v[32:35], v78, s[4:7], s33 offen offset:0 sc1
    s_add_u32 s43, s43, 1
    s_cmp_gt_u32 s43, 2000000
    s_cbranch_scc1 L_failA
    s_waitcnt vmcnt(0)
    v_max3_u32 v76, v32, v33, v34
    v_max_u32 v76, v76, v35
    v_cmp_eq_u32 vcc, -1, v76
    s_cbranch_vccnz L_rlF_32
    s_branch L_bkF_31
        L_fbF1_33:
    s_nop 7
    v_max3_f32 v40, v0, v1, v2
    v_max3_f32 v40, v40, v3, v48
    s_nop 1
    v_max_f32_dpp v40, v40, v40 quad_perm:[2,3,0,1] row_mask:0xf bank_mask:0xf
    v_mov_b32 v41, v40
    s_nop 1
    v_permlane16_swap_b32 v40, v41
    v_max_f32 v40, v40, v41
    v_mov_b32 v41, v40
    s_nop 1
    v_permlane32_swap_b32 v40, v41
    v_max_f32 v40, v40, v41
    v_sub_f32 v4, v0, v40
    v_sub_f32 v5, v1, v40
    v_sub_f32 v6, v2, v40
    v_sub_f32 v7, v3, v40
    v_sub_f32 v49, v48, v40
    v_exp_f32 v4, v4
    v_exp_f32 v5, v5
    v_exp_f32 v6, v6
    v_exp_f32 v7, v7
    v_exp_f32 v49, v49
    v_cvt_pk_bf16_f32 v8, v4, v5
    v_cvt_pk_bf16_f32 v9, v6, v7
    s_nop 1
    v_mov_b32_dpp v10, v8 quad_perm:[2,3,0,1] row_mask:0xf bank_mask:0xf
    v_mov_b32_dpp v11, v9 quad_perm:[2,3,0,1] row_mask:0xf bank_mask:0xf
    v_mov_b32_dpp v50, v49 quad_perm:[2,3,0,1] row_mask:0xf bank_mask:0xf
    v_cvt_pk_bf16_f32 v51, v49, v50
    v_cvt_pk_bf16_f32 v50, v49, v50
    s_nop 1
    v_mfma_f32_16x16x32_bf16 v[60:63], v[68:71], v[8:11], 0
    v_mfma_f32_16x16x32_bf16 v[64:67], v[72:75], v[8:11], 0
    s_nop 5
    v_mfma_f32_16x16x16_bf16 v[60:63], v[52:53], v[50:51], v[60:63]
    v_mfma_f32_16x16x16_bf16 v[64:67], v[54:55], v[50:51], v[64:67]
    s_nop 7
    s_branch L_fbkF1_34
        L_rtF_35:
    s_mov_b32 s43, 0
        L_rlF_37:
    buffer_load_dwordx4 v[0:3], v8, s[4:7], s25 offen sc1
    buffer_load_dwordx4 v[4:7], v8, s[4:7], s25 offen offset:1024 sc1
    s_add_u32 s43, s43, 1
    s_cmp_gt_u32 s43, 2000000
    s_cbranch_scc1 L_failA
    s_waitcnt vmcnt(0)
    v_bitop3_b32 v16, v0, v1, s24 bitop3:0x7e
    v_bitop3_b32 v17, v2, v3, s24 bitop3:0x7e
    v_bitop3_b32 v18, v4, v5, s24 bitop3:0x7e
    v_bitop3_b32 v19, v6, v7, s24 bitop3:0x7e
    v_or3_b32 v16, v16, v17, v18
    v_bitop3_b32 v16, v16, v19, 1 bitop3:0xa8
    v_cmp_ne_u32 vcc, 0, v16
    s_cbranch_vccnz L_rlF_37
    v_mfma_f32_16x16x32_bf16 v[20:23], v[0:3], v[12:15], 0
    v_mfma_f32_16x16x32_bf16 v[20:23], v[4:7], v[12:15], v[20:23]
    s_nop 7
    v_add_f32 v20, v20, v21
    v_add_f32 v22, v22, v23
    v_add_f32 v20, v20, v22
    s_nop 1
    v_mov_b32_dpp v21, v20 row_shl:4 row_mask:0xf bank_mask:0xf
    v_cvt_pk_bf16_f32 v20, v20, v21
    v_min_u32 v20, -2, v20
    s_branch L_bkF_36
        L_rtF_38:
    s_mov_b32 s43, 0
        L_rlF_40:
    buffer_load_dwordx4 v[24:27], v78, s[4:7], s32 offen offset:2048 sc1
    s_add_u32 s43, s43, 1
    s_cmp_gt_u32 s43, 2000000
    s_cbranch_scc1 L_failA
    s_waitcnt vmcnt(0)
    v_max3_u32 v76, v24, v25, v26
    v_max_u32 v76, v76, v27
    v_cmp_eq_u32 vcc, -1, v76
    s_cbranch_vccnz L_rlF_40
    ds_write_b128 v78, v[24:27] offset:6144
    s_branch L_bkF_39
        L_rtF_41:
    s_mov_b32 s43, 0
        L_rlF_43:
    buffer_load_dwordx4 v[32:35], v78, s[4:7], s33 offen offset:0 sc1
    s_add_u32 s43, s43, 1
    s_cmp_gt_u32 s43, 2000000
    s_cbranch_scc1 L_failA
    s_waitcnt vmcnt(0)
    v_max3_u32 v76, v32, v33, v34
    v_max_u32 v76, v76, v35
    v_cmp_eq_u32 vcc, -1, v76
    s_cbranch_vccnz L_rlF_43
    s_branch L_bkF_42
        L_fbF2_44:
    s_nop 7
    v_max3_f32 v40, v0, v1, v2
    v_max3_f32 v40, v40, v3, v48
    s_nop 1
    v_max_f32_dpp v40, v40, v40 quad_perm:[2,3,0,1] row_mask:0xf bank_mask:0xf
    v_mov_b32 v41, v40
    s_nop 1
    v_permlane16_swap_b32 v40, v41
    v_max_f32 v40, v40, v41
    v_mov_b32 v41, v40
    s_nop 1
    v_permlane32_swap_b32 v40, v41
    v_max_f32 v40, v40, v41
    v_sub_f32 v4, v0, v40
    v_sub_f32 v5, v1, v40
    v_sub_f32 v6, v2, v40
    v_sub_f32 v7, v3, v40
    v_sub_f32 v49, v48, v40
    v_exp_f32 v4, v4
    v_exp_f32 v5, v5
    v_exp_f32 v6, v6
    v_exp_f32 v7, v7
    v_exp_f32 v49, v49
    v_cvt_pk_bf16_f32 v8, v4, v5
    v_cvt_pk_bf16_f32 v9, v6, v7
    s_nop 1
    v_mov_b32_dpp v10, v8 quad_perm:[2,3,0,1] row_mask:0xf bank_mask:0xf
    v_mov_b32_dpp v11, v9 quad_perm:[2,3,0,1] row_mask:0xf bank_mask:0xf
    v_mov_b32_dpp v50, v49 quad_perm:[2,3,0,1] row_mask:0xf bank_mask:0xf
    v_cvt_pk_bf16_f32 v51, v49, v50
    v_cvt_pk_bf16_f32 v50, v49, v50
    s_nop 1
    v_mfma_f32_16x16x32_bf16 v[60:63], v[68:71], v[8:11], 0
    v_mfma_f32_16x16x32_bf16 v[64:67], v[72:75], v[8:11], 0
    s_nop 5
    v_mfma_f32_16x16x16_bf16 v[60:63], v[52:53], v[50:51], v[60:63]
    v_mfma_f32_16x16x16_bf16 v[64:67], v[54:55], v[50:51], v[64:67]
    s_nop 7
    s_branch L_fbkF2_45
        L_rtF_46:
    s_mov_b32 s43, 0
        L_rlF_48:
    buffer_load_dwordx4 v[0:3], v10, s[4:7], s26 offen sc1
    s_add_u32 s43, s43, 1
    s_cmp_gt_u32 s43, 2000000
    s_cbranch_scc1 L_failA
    s_waitcnt vmcnt(0)
    v_bitop3_b32 v28, v0, v1, s24 bitop3:0x7e
    v_bitop3_b32 v29, v2, v3, s24 bitop3:0x7e
    v_bitop3_b32 v28, v28, v29, 1 bitop3:0xa8
    v_cmp_ne_u32 vcc, 0, v28
    s_cbranch_vccnz L_rlF_48
    v_mfma_f32_16x16x32_bf16 v[24:27], v[0:3], v[12:15], 0
    s_nop 7
    s_branch L_bkF_47
        L_rtF_49:
    s_mov_b32 s43, 0
        L_rlF_51:
    buffer_load_dwordx4 v[36:39], v8, s[4:7], s25 offen sc1
    buffer_load_dwordx4 v[40:43], v8, s[4:7], s25 offen offset:1024 sc1
    s_add_u32 s43, s43, 1
    s_cmp_gt_u32 s43, 2000000
    s_cbranch_scc1 L_failA
    s_waitcnt vmcnt(0)
    v_bitop3_b32 v16, v36, v37, s24 bitop3:0x7e
    v_bitop3_b32 v17, v38, v39, s24 bitop3:0x7e
    v_bitop3_b32 v18, v40, v41, s24 bitop3:0x7e
    v_bitop3_b32 v19, v42, v43, s24 bitop3:0x7e
    v_or3_b32 v16, v16, v17, v18
    v_bitop3_b32 v16, v16, v19, 1 bitop3:0xa8
    v_cmp_ne_u32 vcc, 0, v16
    s_cbranch_vccnz L_rlF_51
    v_mfma_f32_16x16x32_bf16 v[20:23], v[36:39], v[12:15], 0
    v_mfma_f32_16x16x32_bf16 v[20:23], v[40:43], v[12:15], v[20:23]
    s_nop 7
    v_add_f32 v20, v20, v21
    v_add_f32 v22, v22, v23
    v_add_f32 v20, v20, v22
    s_nop 1
    v_mov_b32_dpp v21, v20 row_shl:4 row_mask:0xf bank_mask:0xf
    v_cvt_pk_bf16_f32 v20, v20, v21
    v_min_u32 v20, -2, v20
    s_branch L_bkF_50
        L_rtF_52:
    s_mov_b32 s43, 0
        L_rlF_54:
    buffer_load_dwordx4 v[28:31], v78, s[4:7], s32 offen offset:3072 sc1
    s_add_u32 s43, s43, 1
    s_cmp_gt_u32 s43, 2000000
    s_cbranch_scc1 L_failA
    s_waitcnt vmcnt(0)
    v_max3_u32 v76, v28, v29, v30
    v_max_u32 v76, v76, v31
    v_cmp_eq_u32 vcc, -1, v76
    s_cbranch_vccnz L_rlF_54
    ds_write_b128 v78, v[28:31] offset:7168
    s_branch L_bkF_53
        L_rtF_55:
    s_mov_b32 s43, 0
        L_rlF_57:
    buffer_load_dwordx4 v[32:35], v78, s[4:7], s33 offen offset:0 sc1
    s_add_u32 s43, s43, 1
    s_cmp_gt_u32 s43, 2000000
    s_cbranch_scc1 L_failA
    s_waitcnt vmcnt(0)
    v_max3_u32 v76, v32, v33, v34
    v_max_u32 v76, v76, v35
    v_cmp_eq_u32 vcc, -1, v76
    s_cbranch_vccnz L_rlF_57
    s_branch L_bkF_56
        L_fbF3_58:
    s_nop 7
    v_max3_f32 v40, v0, v1, v2
    v_max3_f32 v40, v40, v3, v48
    s_nop 1
    v_max_f32_dpp v40, v40, v40 quad_perm:[2,3,0,1] row_mask:0xf bank_mask:0xf
    v_mov_b32 v41, v40
    s_nop 1
    v_permlane16_swap_b32 v40, v41
    v_max_f32 v40, v40, v41
    v_mov_b32 v41, v40
    s_nop 1
    v_permlane32_swap_b32 v40, v41
    v_max_f32 v40, v40, v41
    v_sub_f32 v4, v0, v40
    v_sub_f32 v5, v1, v40
    v_sub_f32 v6, v2, v40
    v_sub_f32 v7, v3, v40
    v_sub_f32 v49, v48, v40
    v_exp_f32 v4, v4
    v_exp_f32 v5, v5
    v_exp_f32 v6, v6
    v_exp_f32 v7, v7
    v_exp_f32 v49, v49
    v_cvt_pk_bf16_f32 v8, v4, v5
    v_cvt_pk_bf16_f32 v9, v6, v7
    s_nop 1
    v_mov_b32_dpp v10, v8 quad_perm:[2,3,0,1] row_mask:0xf bank_mask:0xf
    v_mov_b32_dpp v11, v9 quad_perm:[2,3,0,1] row_mask:0xf bank_mask:0xf
    v_mov_b32_dpp v50, v49 quad_perm:[2,3,0,1] row_mask:0xf bank_mask:0xf
    v_cvt_pk_bf16_f32 v51, v49, v50
    v_cvt_pk_bf16_f32 v50, v49, v50
    s_nop 1
    v_mfma_f32_16x16x32_bf16 v[60:63], v[68:71], v[8:11], 0
    v_mfma_f32_16x16x32_bf16 v[64:67], v[72:75], v[8:11], 0
    s_nop 5
    v_mfma_f32_16x16x16_bf16 v[60:63], v[52:53], v[50:51], v[60:63]
    v_mfma_f32_16x16x16_bf16 v[64:67], v[54:55], v[50:51], v[64:67]
    s_nop 7
    s_branch L_fbkF3_59
        L_rtF_60:
    s_mov_b32 s43, 0
        L_rlF_62:
    buffer_load_dwordx4 v[0:3], v8, s[4:7], s25 offen sc1
    buffer_load_dwordx4 v[4:7], v8, s[4:7], s25 offen offset:1024 sc1
    s_add_u32 s43, s43, 1
    s_cmp_gt_u32 s43, 2000000
    s_cbranch_scc1 L_failA
    s_waitcnt vmcnt(0)
    v_bitop3_b32 v16, v0, v1, s24 bitop3:0x7e
    v_bitop3_b32 v17, v2, v3, s24 bitop3:0x7e
    v_bitop3_b32 v18, v4, v5, s24 bitop3:0x7e
    v_bitop3_b32 v19, v6, v7, s24 bitop3:0x7e
    v_or3_b32 v16, v16, v17, v18
    v_bitop3_b32 v16, v16, v19, 1 bitop3:0xa8
    v_cmp_ne_u32 vcc, 0, v16
    s_cbranch_vccnz L_rlF_62
    v_mfma_f32_16x16x32_bf16 v[20:23], v[0:3], v[12:15], 0
    v_mfma_f32_16x16x32_bf16 v[20:23], v[4:7], v[12:15], v[20:23]
    s_nop 7
    v_add_f32 v20, v20, v21
    v_add_f32 v22, v22, v23
    v_add_f32 v20, v20, v22
    s_nop 1
    v_mov_b32_dpp v21, v20 row_shl:4 row_mask:0xf bank_mask:0xf
    v_cvt_pk_bf16_f32 v20, v20, v21
    v_min_u32 v20, -2, v20
    s_branch L_bkF_61
        L_doneF:
    s_cmp_eq_u32 s15, 64
    s_cbranch_scc1 L_finF
    s_mov_b32 s55, s21
    s_mov_b32 s60, 255
    s_mov_b32 s61, 64
    s_cmp_eq_u32 s15, 5
    s_cselect_b32 s60, 8, s60
    s_cselect_b32 s61, 15, s61
    s_cmp_eq_u32 s15, 15
    s_cselect_b32 s60, 20, s60
    s_cselect_b32 s61, 39, s61
    s_mov_b32 s15, s61
    v_mov_b32 v3, 163744
    s_cmp_eq_u32 s13, 0
    s_cbranch_scc0 L_wkd_64
    s_mov_b32 s21, 0
    v_mbcnt_lo_u32_b32 v4, -1, 0
    v_min_u32 v4, 3, v4
    v_lshlrev_b32 v4, 2, v4
        L_wk_63:
    buffer_load_dword v2, v4, s[4:7], s58 offen sc1
    s_add_u32 s21, s21, 1
    s_cmp_gt_u32 s21, 3000000
    s_cbranch_scc1 L_failA
    s_waitcnt vmcnt(0)
    v_cmp_gt_u32 vcc, s60, v2
    s_cbranch_vccnz L_wk_63
    s_nop 0
    v_min_u32_dpp v2, v2, v2 quad_perm:[1,0,3,2] row_mask:0xf bank_mask:0xf
    s_nop 1
    v_min_u32_dpp v2, v2, v2 quad_perm:[2,3,0,1] row_mask:0xf bank_mask:0xf
    s_nop 1
    v_min_u32_dpp v2, v2, v2 row_half_mirror row_mask:0xf bank_mask:0xf
    s_mov_b64 exec, 1
    ds_write_b32 v3, v2
    s_mov_b64 exec, -1
    s_waitcnt lgkmcnt(0)
        L_wkd_64:
    s_barrier
    ds_read_b32 v2, v3
    s_waitcnt lgkmcnt(0)
    v_readfirstlane_b32 s61, v2
    s_mov_b32 s21, s55
    s_branch L_runF
L_finF:
    s_waitcnt vmcnt(0) lgkmcnt(0)
    s_barrier
    s_cmp_eq_u32 s13, 0
    s_cbranch_scc0 L_fin_65
    v_mov_b32 v2, 64
    s_mov_b64 exec, 1
    buffer_atomic_umax v2, off, s[4:7], s53 sc1
    s_mov_b64 exec, -1
        L_fin_65:
    s_branch L_endA
    L_failA:
    s_mov_b64 exec, -1
    v_mov_b32 v4, 0xdead
    buffer_store_dword v4, off, s[8:11], 0 offset:20
    L_endA:
    s_waitcnt vmcnt(0)
    s_endpgm
L_work:
    v_mbcnt_lo_u32_b32 v0, -1, 0
    v_mbcnt_hi_u32_b32 v0, -1, v0
    s_lshl_b32 s17, s13, 6
    v_add_u32 v0, s17, v0
    s_mov_b32 s58, 0
    L_next:
    s_waitcnt vmcnt(0) lgkmcnt(0)
    s_barrier
    v_mov_b32 v6, 163776
    s_cmp_eq_u32 s13, 0
    s_cbranch_scc0 L_clm_66
    s_mov_b64 exec, 1
    v_mov_b32 v2, 1
    buffer_atomic_add v2, off, s[8:11], 0 offset:64 sc0 sc1
    buffer_load_dwordx2 v[4:5], off, s[8:11], 0 offset:128 sc1
    s_waitcnt vmcnt(0)
    ds_write_b128 v6, v[2:5]
    s_waitcnt lgkmcnt(0)
    s_mov_b64 exec, -1
        L_clm_66:
    s_barrier
    ds_read_b128 v[2:5], v6
    s_waitcnt lgkmcnt(0)
    v_readfirstlane_b32 s16, v2
    v_readfirstlane_b32 s14, v4
    v_readfirstlane_b32 s15, v5
    s_cmp_lt_u32 s16, 84
    s_cbranch_scc1 L_do_aq
    s_sub_u32 s16, s16, 84
    s_cmp_lt_u32 s16, 128
    s_cbranch_scc1 L_do_g1
    s_sub_u32 s16, s16, 128
    s_cmp_eq_u32 s59, 0
    s_cbranch_scc0 L_counted
    s_mov_b32 s59, 1
    s_cmp_eq_u32 s13, 0
    s_cbranch_scc0 L_counted
    s_lshl_b32 s17, s3, 2
    s_mov_b64 exec, 1
    v_mov_b32 v2, 1
    buffer_atomic_add v2, off, s[8:11], s17 offset:32 sc1
    s_mov_b64 exec, -1
    L_counted:
    s_cmp_lt_u32 s16, 256
    s_cbranch_scc0 L_chkslow
    s_cmp_eq_u32 s13, 0
    s_cbranch_scc0 L_wfd_68
    s_mov_b32 s21, 0
        L_wf_67:
    buffer_load_dword v2, off, s[8:11], 0 offset:8 sc1
    s_add_u32 s21, s21, 1
    s_cmp_gt_u32 s21, 3000000
    s_cbranch_scc1 L_failA
    s_waitcnt vmcnt(0)
    v_cmp_gt_u32 vcc, 1, v2
    s_cbranch_vccz L_wfd_68
    s_sleep 2
    s_branch L_wf_67
        L_wfd_68:
    s_mov_b32 s30, 17408
    s_cmp_eq_u32 s13, 0
    s_cbranch_scc0 L_wfd_70
    s_mov_b32 s21, 0
        L_wf_69:
    buffer_load_dword v2, off, s[4:7], s30 offset:0 sc1
    s_add_u32 s21, s21, 1
    s_cmp_gt_u32 s21, 3000000
    s_cbranch_scc1 L_failA
    s_waitcnt vmcnt(0)
    v_cmp_gt_u32 vcc, 84, v2
    s_cbranch_vccz L_wfd_70
    s_sleep 2
    s_branch L_wf_69
        L_wfd_70:
    s_barrier
    s_and_b32 s27, s16, 31
    s_lshr_b32 s29, s16, 5
    s_lshl_b32 s31, s29, 3
    s_lshl_b32 s17, s13, 1
    s_add_u32 s31, s31, s17
    v_and_b32 v1, 63, v0
    v_lshlrev_b32 v4, 4, v1
    v_and_b32 v9, 31, v1
    v_lshlrev_b32 v5, 2, v9
    v_lshrrev_b32 v10, 5, v1
    v_mul_u32_u24 v6, 18, v10
    v_add_u32 v6, v6, v9
    v_lshlrev_b32 v6, 4, v6
    s_lshl_b32 s32, s27, 16
    s_lshl_b32 s33, s27, 13
    s_mul_i32 s34, s27, 73728
    s_add_u32 s34, s34, 12582912
    s_lshl_b32 s17, s31, 10
    s_add_u32 s17, s17, s32
    s_add_u32 s17, s17, 7340032
    s_lshl_b32 s20, s31, 7
    s_add_u32 s20, s20, s33
    s_add_u32 s20, s20, 11534336
    buffer_load_dwordx4 v[16:19], v4, s[4:7], s17 offen
    buffer_load_dwordx4 v[24:27], v4, s[4:7], s17 offen offset:1024 sc1
    buffer_load_dword v20, v5, s[4:7], s20 offen sc1
    buffer_load_dword v28, v5, s[4:7], s20 offen offset:128 sc1
    s_lshl_b32 s17, s31, 8
    s_add_u32 s17, s17, 262144
    v_lshlrev_b32 v7, 1, v5
    buffer_load_dword v162, v7, s[4:7], s17 offen sc1
    buffer_load_dword v163, v7, s[4:7], s17 offen offset:256 sc1
    s_add_u32 s32, s32, 9437184
    s_add_u32 s33, s33, 11796480
    s_mov_b32 s36, 0x0003ffff
    s_mov_b32 s37, 0x0003ffff
    s_mov_b32 s38, 0
    s_mov_b32 s39, -1
    s_mov_b32 s40, 0x41000000
    s_mov_b32 s41, 0xffff0000
    v_cmp_eq_u32 vcc, 18, v9
    v_mov_b32 v11, 0x3f803f80
    v_mov_b32 v12, 0
    v_cndmask_b32 v13, v12, v11, vcc
    v_mov_b32 v181, v11
    v_mov_b32 v182, 0
    v_mov_b32 v183, 0
    v_mov_b32 v184, v13
    v_mov_b32 v185, v13
    v_mov_b32 v186, v13
    v_mov_b32 v187, v13
    v_mov_b32 v188, v13
    v_mov_b32 v189, v13
    v_mov_b32 v190, v13
    v_mov_b32 v191, v13
    v_mov_b32 v197, v11
    v_mov_b32 v198, 0
    v_mov_b32 v199, 0
    v_mov_b32 v200, v13
    v_mov_b32 v201, v13
    v_mov_b32 v202, v13
    v_mov_b32 v203, v13
    v_mov_b32 v204, v13
    v_mov_b32 v205, v13
    v_mov_b32 v206, v13
    v_mov_b32 v207, v13
    v_mov_b32 v213, v11
    v_mov_b32 v214, 0
    v_mov_b32 v215, 0
    v_mov_b32 v216, v13
    v_mov_b32 v217, v13
    v_mov_b32 v218, v13
    v_mov_b32 v219, v13
    v_mov_b32 v220, v13
    v_mov_b32 v221, v13
    v_mov_b32 v222, v13
    v_mov_b32 v223, v13
    v_mov_b32 v229, v11
    v_mov_b32 v230, 0
    v_mov_b32 v231, 0
    v_mov_b32 v232, v13
    v_mov_b32 v233, v13
    v_mov_b32 v234, v13
    v_mov_b32 v235, v13
    v_mov_b32 v236, v13
    v_mov_b32 v237, v13
    v_mov_b32 v238, v13
    v_mov_b32 v239, v13
    v_mov_b32 v32, 0
    v_mov_b32 v33, 0
    v_mov_b32 v34, 0
    v_mov_b32 v35, 0
    v_mov_b32 v36, 0
    v_mov_b32 v37, 0
    v_mov_b32 v38, 0
    v_mov_b32 v39, 0
    v_mov_b32 v40, 0
    v_mov_b32 v41, 0
    v_mov_b32 v42, 0
    v_mov_b32 v43, 0
    v_mov_b32 v44, 0
    v_mov_b32 v45, 0
    v_mov_b32 v46, 0
    v_mov_b32 v47, 0
    v_mov_b32 v48, 0
    v_mov_b32 v49, 0
    v_mov_b32 v50, 0
    v_mov_b32 v51, 0
    v_mov_b32 v52, 0
    v_mov_b32 v53, 0
    v_mov_b32 v54, 0
    v_mov_b32 v55, 0
    v_mov_b32 v56, 0
    v_mov_b32 v57, 0
    v_mov_b32 v58, 0
    v_mov_b32 v59, 0
    v_mov_b32 v60, 0
    v_mov_b32 v61, 0
    v_mov_b32 v62, 0
    v_mov_b32 v63, 0
    v_mov_b32 v160, 0
    v_mov_b32 v161, 0
    s_waitcnt vmcnt(0)
    v_cndmask_b32 v20, v20, v12, s[38:39]
    v_cndmask_b32 v28, v28, v12, s[38:39]
    v_mov_b32 v21, 0
    v_mov_b32 v22, 0
    v_mov_b32 v23, 0
    v_mov_b32 v29, 0
    v_mov_b32 v30, 0
    v_mov_b32 v31, 0
    buffer_load_dwordx4 v[176:179], v4, s[4:7], s32 offen
    buffer_load_dword v180, v5, s[4:7], s33 offen
    s_mov_b64 exec, s[36:37]
    buffer_load_dwordx4 v[184:187], v6, s[4:7], s34 offen
    buffer_load_dwordx4 v[188:191], v6, s[4:7], s34 offen offset:576
    s_mov_b64 exec, -1
    s_add_u32 s32, s32, 1024
    s_add_u32 s33, s33, 128
    s_add_u32 s34, s34, 1152
    buffer_load_dwordx4 v[192:195], v4, s[4:7], s32 offen
    buffer_load_dword v196, v5, s[4:7], s33 offen
    s_mov_b64 exec, s[36:37]
    buffer_load_dwordx4 v[200:203], v6, s[4:7], s34 offen
    buffer_load_dwordx4 v[204:207], v6, s[4:7], s34 offen offset:576
    s_mov_b64 exec, -1
    s_add_u32 s32, s32, 1024
    s_add_u32 s33, s33, 128
    s_add_u32 s34, s34, 1152
    buffer_load_dwordx4 v[208:211], v4, s[4:7], s32 offen
    buffer_load_dword v212, v5, s[4:7], s33 offen
    s_mov_b64 exec, s[36:37]
    buffer_load_dwordx4 v[216:219], v6, s[4:7], s34 offen
    buffer_load_dwordx4 v[220:223], v6, s[4:7], s34 offen offset:576
    s_mov_b64 exec, -1
    s_add_u32 s32, s32, 1024
    s_add_u32 s33, s33, 128
    s_add_u32 s34, s34, 1152
    s_waitcnt vmcnt(8)
    v_mfma_f32_32x32x16_bf16 v[64:79], v[176:179], v[16:19], 0
    v_mfma_f32_32x32x16_bf16 v[64:79], v[180:183], v[20:23], v[64:79]
    v_mfma_f32_32x32x16_bf16 v[80:95], v[176:179], v[24:27], 0
    v_mfma_f32_32x32x16_bf16 v[80:95], v[180:183], v[28:31], v[80:95]
    s_nop 7
    s_nop 3
    v_max3_f32 v164, v64, v65, v66
    v_max3_f32 v164, v164, v67, v68
    v_max3_f32 v164, v164, v69, v70
    v_max3_f32 v164, v164, v71, v72
    v_max3_f32 v164, v164, v73, v74
    v_max3_f32 v164, v164, v75, v76
    v_max3_f32 v164, v164, v77, v78
    v_max_f32 v164, v164, v79
    v_max3_f32 v165, v80, v81, v82
    v_max3_f32 v165, v165, v83, v84
    v_max3_f32 v165, v165, v85, v86
    v_max3_f32 v165, v165, v87, v88
    v_max3_f32 v165, v165, v89, v90
    v_max3_f32 v165, v165, v91, v92
    v_max3_f32 v165, v165, v93, v94
    v_max_f32 v165, v165, v95
    v_max_f32 v166, v164, v165
    v_cmp_lt_f32 vcc, s40, v166
L_aa0_71:
    s_nop 7
    s_nop 7
    v_mov_b32 v166, v164
    s_nop 1
    v_permlane32_swap_b32 v164, v166
    v_max_f32 v164, v164, v166
    v_add_f32 v166, v160, v164
    v_sub_f32 v167, 0, v166
    v_cvt_pk_bf16_f32 v168, v167, v167
    v_and_b32 v168, s41, v168
    v_sub_f32 v167, v167, v168
    v_cvt_pk_bf16_f32 v169, v167, v167
    v_and_b32 v169, s41, v169
    v_add_f32 v167, v168, v169
    v_lshrrev_b32 v168, 16, v168
    v_or_b32 v168, v168, v169
    v_cndmask_b32 v21, v168, v12, s[38:39]
    v_add_f32 v166, v167, v160
    v_sub_f32 v160, 0, v167
    v_exp_f32 v167, v166
    v_add_f32 v64, v64, v166
    v_add_f32 v65, v65, v166
    v_add_f32 v66, v66, v166
    v_add_f32 v67, v67, v166
    v_add_f32 v68, v68, v166
    v_add_f32 v69, v69, v166
    v_add_f32 v70, v70, v166
    v_add_f32 v71, v71, v166
    v_add_f32 v72, v72, v166
    v_add_f32 v73, v73, v166
    v_add_f32 v74, v74, v166
    v_add_f32 v75, v75, v166
    v_add_f32 v76, v76, v166
    v_add_f32 v77, v77, v166
    v_add_f32 v78, v78, v166
    v_add_f32 v79, v79, v166
    v_mov_b32 v166, v165
    s_nop 1
    v_permlane32_swap_b32 v165, v166
    v_max_f32 v165, v165, v166
    v_add_f32 v166, v161, v165
    v_sub_f32 v167, 0, v166
    v_cvt_pk_bf16_f32 v168, v167, v167
    v_and_b32 v168, s41, v168
    v_sub_f32 v167, v167, v168
    v_cvt_pk_bf16_f32 v169, v167, v167
    v_and_b32 v169, s41, v169
    v_add_f32 v167, v168, v169
    v_lshrrev_b32 v168, 16, v168
    v_or_b32 v168, v168, v169
    v_cndmask_b32 v29, v168, v12, s[38:39]
    v_add_f32 v166, v167, v161
    v_sub_f32 v161, 0, v167
    v_exp_f32 v167, v166
    v_add_f32 v80, v80, v166
    v_add_f32 v81, v81, v166
    v_add_f32 v82, v82, v166
    v_add_f32 v83, v83, v166
    v_add_f32 v84, v84, v166
    v_add_f32 v85, v85, v166
    v_add_f32 v86, v86, v166
    v_add_f32 v87, v87, v166
    v_add_f32 v88, v88, v166
    v_add_f32 v89, v89, v166
    v_add_f32 v90, v90, v166
    v_add_f32 v91, v91, v166
    v_add_f32 v92, v92, v166
    v_add_f32 v93, v93, v166
    v_add_f32 v94, v94, v166
    v_add_f32 v95, v95, v166
    s_nop 1
    s_mov_b32 s26, 0
L_aa_lp:
    buffer_load_dwordx4 v[224:227], v4, s[4:7], s32 offen
    buffer_load_dword v228, v5, s[4:7], s33 offen
    s_mov_b64 exec, s[36:37]
    buffer_load_dwordx4 v[232:235], v6, s[4:7], s34 offen
    buffer_load_dwordx4 v[236:239], v6, s[4:7], s34 offen offset:576
    s_mov_b64 exec, -1
    s_add_u32 s32, s32, 1024
    s_add_u32 s33, s33, 128
    s_add_u32 s34, s34, 1152
    s_waitcnt vmcnt(8)
    v_exp_f32 v70, v70
    v_mfma_f32_32x32x16_bf16 v[96:111], v[192:195], v[16:19], 0
    s_add_u32 s26, s26, 1
    v_exp_f32 v83, v83
    v_exp_f32 v76, v76
    v_exp_f32 v68, v68
    v_mfma_f32_32x32x16_bf16 v[112:127], v[192:195], v[24:27], 0
    v_exp_f32 v80, v80
    v_exp_f32 v67, v67
    v_exp_f32 v81, v81
    v_mfma_f32_32x32x16_bf16 v[96:111], v[196:199], v[20:23], v[96:111]
    v_exp_f32 v64, v64
    v_exp_f32 v86, v86
    v_exp_f32 v82, v82
    v_mfma_f32_32x32x16_bf16 v[112:127], v[196:199], v[28:31], v[112:127]
    v_exp_f32 v84, v84
    v_exp_f32 v69, v69
    v_exp_f32 v87, v87
    v_cvt_pk_bf16_f32 v146, v68, v69
    v_exp_f32 v65, v65
    v_cvt_pk_bf16_f32 v155, v86, v87
    v_cvt_pk_bf16_f32 v153, v82, v83
    v_cvt_pk_bf16_f32 v144, v64, v65
    v_exp_f32 v66, v66
    v_max3_f32 v164, v96, v97, v98
    v_cvt_pk_bf16_f32 v152, v80, v81
    v_max3_f32 v164, v164, v99, v100
    v_cvt_pk_bf16_f32 v145, v66, v67
    v_max3_f32 v165, v112, v113, v114
    v_max3_f32 v164, v164, v101, v102
    v_max3_f32 v165, v165, v115, v116
    v_exp_f32 v85, v85
    v_max3_f32 v164, v164, v103, v104
    v_max3_f32 v165, v165, v117, v118
    v_max3_f32 v164, v164, v105, v106
    v_cvt_pk_bf16_f32 v154, v84, v85
    v_exp_f32 v71, v71
    v_exp_f32 v89, v89
    v_cvt_pk_bf16_f32 v147, v70, v71
    v_mfma_f32_32x32x16_bf16 v[48:63], v[184:187], v[152:155], v[48:63]
    v_exp_f32 v74, v74
    v_exp_f32 v75, v75
    v_exp_f32 v92, v92
    v_mfma_f32_32x32x16_bf16 v[32:47], v[184:187], v[144:147], v[32:47]
    v_exp_f32 v94, v94
    v_exp_f32 v72, v72
    v_exp_f32 v88, v88
    v_exp_f32 v95, v95
    v_exp_f32 v93, v93
    v_exp_f32 v77, v77
    v_exp_f32 v91, v91
    v_cvt_pk_bf16_f32 v150, v76, v77
    v_exp_f32 v79, v79
    v_exp_f32 v73, v73
    v_cvt_pk_bf16_f32 v158, v92, v93
    v_cvt_pk_bf16_f32 v149, v74, v75
    v_cvt_pk_bf16_f32 v148, v72, v73
    v_exp_f32 v78, v78
    v_max3_f32 v164, v164, v107, v108
    v_cvt_pk_bf16_f32 v159, v94, v95
    v_max3_f32 v164, v164, v109, v110
    v_cvt_pk_bf16_f32 v156, v88, v89
    v_max_f32 v164, v164, v111
    v_exp_f32 v90, v90
    v_cvt_pk_bf16_f32 v151, v78, v79
    v_max3_f32 v165, v165, v119, v120
    v_cvt_pk_bf16_f32 v157, v90, v91
    v_max3_f32 v165, v165, v121, v122
    v_max3_f32 v165, v165, v123, v124
    v_mfma_f32_32x32x16_bf16 v[32:47], v[188:191], v[148:151], v[32:47]
    v_max3_f32 v165, v165, v125, v126
    v_max_f32 v165, v165, v127
    v_max_f32 v166, v164, v165
    v_cmp_lt_f32 vcc, s40, v166
    v_mfma_f32_32x32x16_bf16 v[48:63], v[188:191], v[156:159], v[48:63]
    s_cbranch_vccnz L_aars_72
L_aabk_73:
    buffer_load_dwordx4 v[176:179], v4, s[4:7], s32 offen
    buffer_load_dword v180, v5, s[4:7], s33 offen
    s_mov_b64 exec, s[36:37]
    buffer_load_dwordx4 v[184:187], v6, s[4:7], s34 offen
    buffer_load_dwordx4 v[188:191], v6, s[4:7], s34 offen offset:576
    s_mov_b64 exec, -1
    s_add_u32 s32, s32, 1024
    s_add_u32 s33, s33, 128
    s_add_u32 s34, s34, 1152
    s_waitcnt vmcnt(8)
    v_exp_f32 v102, v102
    v_mfma_f32_32x32x16_bf16 v[64:79], v[208:211], v[16:19], 0
    s_add_u32 s26, s26, 1
    v_exp_f32 v115, v115
    v_exp_f32 v108, v108
    v_exp_f32 v100, v100
    v_mfma_f32_32x32x16_bf16 v[80:95], v[208:211], v[24:27], 0
    v_exp_f32 v112, v112
    v_exp_f32 v99, v99
    v_exp_f32 v113, v113
    v_mfma_f32_32x32x16_bf16 v[64:79], v[212:215], v[20:23], v[64:79]
    v_exp_f32 v96, v96
    v_exp_f32 v118, v118
    v_exp_f32 v114, v114
    v_mfma_f32_32x32x16_bf16 v[80:95], v[212:215], v[28:31], v[80:95]
    v_exp_f32 v116, v116
    v_exp_f32 v101, v101
    v_exp_f32 v119, v119
    v_cvt_pk_bf16_f32 v146, v100, v101
    v_exp_f32 v97, v97
    v_cvt_pk_bf16_f32 v155, v118, v119
    v_cvt_pk_bf16_f32 v153, v114, v115
    v_cvt_pk_bf16_f32 v144, v96, v97
    v_exp_f32 v98, v98
    v_max3_f32 v164, v64, v65, v66
    v_cvt_pk_bf16_f32 v152, v112, v113
    v_max3_f32 v164, v164, v67, v68
    v_cvt_pk_bf16_f32 v145, v98, v99
    v_max3_f32 v165, v80, v81, v82
    v_max3_f32 v164, v164, v69, v70
    v_max3_f32 v165, v165, v83, v84
    v_exp_f32 v117, v117
    v_max3_f32 v164, v164, v71, v72
    v_max3_f32 v165, v165, v85, v86
    v_max3_f32 v164, v164, v73, v74
    v_cvt_pk_bf16_f32 v154, v116, v117
    v_exp_f32 v103, v103
    v_exp_f32 v121, v121
    v_cvt_pk_bf16_f32 v147, v102, v103
    v_mfma_f32_32x32x16_bf16 v[48:63], v[200:203], v[152:155], v[48:63]
    v_exp_f32 v106, v106
    v_exp_f32 v107, v107
    v_exp_f32 v124, v124
    v_mfma_f32_32x32x16_bf16 v[32:47], v[200:203], v[144:147], v[32:47]
    v_exp_f32 v126, v126
    v_exp_f32 v104, v104
    v_exp_f32 v120, v120
    v_exp_f32 v127, v127
    v_exp_f32 v125, v125
    v_exp_f32 v109, v109
    v_exp_f32 v123, v123
    v_cvt_pk_bf16_f32 v150, v108, v109
    v_exp_f32 v111, v111
    v_exp_f32 v105, v105
    v_cvt_pk_bf16_f32 v158, v124, v125
    v_cvt_pk_bf16_f32 v149, v106, v107
    v_cvt_pk_bf16_f32 v148, v104, v105
    v_exp_f32 v110, v110
    v_max3_f32 v164, v164, v75, v76
    v_cvt_pk_bf16_f32 v159, v126, v127
    v_max3_f32 v164, v164, v77, v78
    v_cvt_pk_bf16_f32 v156, v120, v121
    v_max_f32 v164, v164, v79
    v_exp_f32 v122, v122
    v_cvt_pk_bf16_f32 v151, v110, v111
    v_max3_f32 v165, v165, v87, v88
    v_cvt_pk_bf16_f32 v157, v122, v123
    v_max3_f32 v165, v165, v89, v90
    v_max3_f32 v165, v165, v91, v92
    v_mfma_f32_32x32x16_bf16 v[32:47], v[204:207], v[148:151], v[32:47]
    v_max3_f32 v165, v165, v93, v94
    v_max_f32 v165, v165, v95
    v_max_f32 v166, v164, v165
    v_cmp_lt_f32 vcc, s40, v166
    v_mfma_f32_32x32x16_bf16 v[48:63], v[204:207], v[156:159], v[48:63]
    s_cbranch_vccnz L_aars_74
L_aabk_75:
    buffer_load_dwordx4 v[192:195], v4, s[4:7], s32 offen
    buffer_load_dword v196, v5, s[4:7], s33 offen
    s_mov_b64 exec, s[36:37]
    buffer_load_dwordx4 v[200:203], v6, s[4:7], s34 offen
    buffer_load_dwordx4 v[204:207], v6, s[4:7], s34 offen offset:576
    s_mov_b64 exec, -1
    s_add_u32 s32, s32, 1024
    s_add_u32 s33, s33, 128
    s_add_u32 s34, s34, 1152
    s_waitcnt vmcnt(8)
    v_exp_f32 v70, v70
    v_mfma_f32_32x32x16_bf16 v[96:111], v[224:227], v[16:19], 0
    s_add_u32 s26, s26, 1
    v_exp_f32 v83, v83
    v_exp_f32 v76, v76
    v_exp_f32 v68, v68
    v_mfma_f32_32x32x16_bf16 v[112:127], v[224:227], v[24:27], 0
    v_exp_f32 v80, v80
    v_exp_f32 v67, v67
    v_exp_f32 v81, v81
    v_mfma_f32_32x32x16_bf16 v[96:111], v[228:231], v[20:23], v[96:111]
    v_exp_f32 v64, v64
    v_exp_f32 v86, v86
    v_exp_f32 v82, v82
    v_mfma_f32_32x32x16_bf16 v[112:127], v[228:231], v[28:31], v[112:127]
    v_exp_f32 v84, v84
    v_exp_f32 v69, v69
    v_exp_f32 v87, v87
    v_cvt_pk_bf16_f32 v146, v68, v69
    v_exp_f32 v65, v65
    v_cvt_pk_bf16_f32 v155, v86, v87
    v_cvt_pk_bf16_f32 v153, v82, v83
    v_cvt_pk_bf16_f32 v144, v64, v65
    v_exp_f32 v66, v66
    v_max3_f32 v164, v96, v97, v98
    v_cvt_pk_bf16_f32 v152, v80, v81
    v_max3_f32 v164, v164, v99, v100
    v_cvt_pk_bf16_f32 v145, v66, v67
    v_max3_f32 v165, v112, v113, v114
    v_max3_f32 v164, v164, v101, v102
    v_max3_f32 v165, v165, v115, v116
    v_exp_f32 v85, v85
    v_max3_f32 v164, v164, v103, v104
    v_max3_f32 v165, v165, v117, v118
    v_max3_f32 v164, v164, v105, v106
    v_cvt_pk_bf16_f32 v154, v84, v85
    v_exp_f32 v71, v71
    v_exp_f32 v89, v89
    v_cvt_pk_bf16_f32 v147, v70, v71
    v_mfma_f32_32x32x16_bf16 v[48:63], v[216:219], v[152:155], v[48:63]
    v_exp_f32 v74, v74
    v_exp_f32 v75, v75
    v_exp_f32 v92, v92
    v_mfma_f32_32x32x16_bf16 v[32:47], v[216:219], v[144:147], v[32:47]
    v_exp_f32 v94, v94
    v_exp_f32 v72, v72
    v_exp_f32 v88, v88
    v_exp_f32 v95, v95
    v_exp_f32 v93, v93
    v_exp_f32 v77, v77
    v_exp_f32 v91, v91
    v_cvt_pk_bf16_f32 v150, v76, v77
    v_exp_f32 v79, v79
    v_exp_f32 v73, v73
    v_cvt_pk_bf16_f32 v158, v92, v93
    v_cvt_pk_bf16_f32 v149, v74, v75
    v_cvt_pk_bf16_f32 v148, v72, v73
    v_exp_f32 v78, v78
    v_max3_f32 v164, v164, v107, v108
    v_cvt_pk_bf16_f32 v159, v94, v95
    v_max3_f32 v164, v164, v109, v110
    v_cvt_pk_bf16_f32 v156, v88, v89
    v_max_f32 v164, v164, v111
    v_exp_f32 v90, v90
    v_cvt_pk_bf16_f32 v151, v78, v79
    v_max3_f32 v165, v165, v119, v120
    v_cvt_pk_bf16_f32 v157, v90, v91
    v_max3_f32 v165, v165, v121, v122
    v_max3_f32 v165, v165, v123, v124
    v_mfma_f32_32x32x16_bf16 v[32:47], v[220:223], v[148:151], v[32:47]
    v_max3_f32 v165, v165, v125, v126
    v_max_f32 v165, v165, v127
    v_max_f32 v166, v164, v165
    v_cmp_lt_f32 vcc, s40, v166
    v_mfma_f32_32x32x16_bf16 v[48:63], v[220:223], v[156:159], v[48:63]
    s_cbranch_vccnz L_aars_76
L_aabk_77:
    buffer_load_dwordx4 v[208:211], v4, s[4:7], s32 offen
    buffer_load_dword v212, v5, s[4:7], s33 offen
    s_mov_b64 exec, s[36:37]
    buffer_load_dwordx4 v[216:219], v6, s[4:7], s34 offen
    buffer_load_dwordx4 v[220:223], v6, s[4:7], s34 offen offset:576
    s_mov_b64 exec, -1
    s_add_u32 s32, s32, 1024
    s_add_u32 s33, s33, 128
    s_add_u32 s34, s34, 1152
    s_waitcnt vmcnt(8)
    v_exp_f32 v102, v102
    v_mfma_f32_32x32x16_bf16 v[64:79], v[176:179], v[16:19], 0
    s_add_u32 s26, s26, 1
    v_exp_f32 v115, v115
    v_exp_f32 v108, v108
    v_exp_f32 v100, v100
    v_mfma_f32_32x32x16_bf16 v[80:95], v[176:179], v[24:27], 0
    v_exp_f32 v112, v112
    v_exp_f32 v99, v99
    v_exp_f32 v113, v113
    v_mfma_f32_32x32x16_bf16 v[64:79], v[180:183], v[20:23], v[64:79]
    v_exp_f32 v96, v96
    v_exp_f32 v118, v118
    v_exp_f32 v114, v114
    v_mfma_f32_32x32x16_bf16 v[80:95], v[180:183], v[28:31], v[80:95]
    v_exp_f32 v116, v116
    v_exp_f32 v101, v101
    v_exp_f32 v119, v119
    v_cvt_pk_bf16_f32 v146, v100, v101
    v_exp_f32 v97, v97
    v_cvt_pk_bf16_f32 v155, v118, v119
    v_cvt_pk_bf16_f32 v153, v114, v115
    v_cvt_pk_bf16_f32 v144, v96, v97
    v_exp_f32 v98, v98
    v_max3_f32 v164, v64, v65, v66
    v_cvt_pk_bf16_f32 v152, v112, v113
    v_max3_f32 v164, v164, v67, v68
    v_cvt_pk_bf16_f32 v145, v98, v99
    v_max3_f32 v165, v80, v81, v82
    v_max3_f32 v164, v164, v69, v70
    v_max3_f32 v165, v165, v83, v84
    v_exp_f32 v117, v117
    v_max3_f32 v164, v164, v71, v72
    v_max3_f32 v165, v165, v85, v86
    v_max3_f32 v164, v164, v73, v74
    v_cvt_pk_bf16_f32 v154, v116, v117
    v_exp_f32 v103, v103
    v_exp_f32 v121, v121
    v_cvt_pk_bf16_f32 v147, v102, v103
    v_mfma_f32_32x32x16_bf16 v[48:63], v[232:235], v[152:155], v[48:63]
    v_exp_f32 v106, v106
    v_exp_f32 v107, v107
    v_exp_f32 v124, v124
    v_mfma_f32_32x32x16_bf16 v[32:47], v[232:235], v[144:147], v[32:47]
    v_exp_f32 v126, v126
    v_exp_f32 v104, v104
    v_exp_f32 v120, v120
    v_exp_f32 v127, v127
    v_exp_f32 v125, v125
    v_exp_f32 v109, v109
    v_exp_f32 v123, v123
    v_cvt_pk_bf16_f32 v150, v108, v109
    v_exp_f32 v111, v111
    v_exp_f32 v105, v105
    v_cvt_pk_bf16_f32 v158, v124, v125
    v_cvt_pk_bf16_f32 v149, v106, v107
    v_cvt_pk_bf16_f32 v148, v104, v105
    v_exp_f32 v110, v110
    v_max3_f32 v164, v164, v75, v76
    v_cvt_pk_bf16_f32 v159, v126, v127
    v_max3_f32 v164, v164, v77, v78
    v_cvt_pk_bf16_f32 v156, v120, v121
    v_max_f32 v164, v164, v79
    v_exp_f32 v122, v122
    v_cvt_pk_bf16_f32 v151, v110, v111
    v_max3_f32 v165, v165, v87, v88
    v_cvt_pk_bf16_f32 v157, v122, v123
    v_max3_f32 v165, v165, v89, v90
    v_max3_f32 v165, v165, v91, v92
    v_mfma_f32_32x32x16_bf16 v[32:47], v[236:239], v[148:151], v[32:47]
    v_max3_f32 v165, v165, v93, v94
    v_max_f32 v165, v165, v95
    v_max_f32 v166, v164, v165
    v_cmp_lt_f32 vcc, s40, v166
    v_mfma_f32_32x32x16_bf16 v[48:63], v[236:239], v[156:159], v[48:63]
    s_cmp_eq_u32 s26, 64
    s_cbranch_scc1 L_aa_end
    s_cbranch_vccnz L_aars_78
L_aabk_79:
    s_branch L_aa_lp
L_aars_72:
    s_nop 7
    s_nop 7
    v_mov_b32 v166, v164
    s_nop 1
    v_permlane32_swap_b32 v164, v166
    v_max_f32 v164, v164, v166
    v_max_f32 v164, 0, v164
    v_add_f32 v166, v160, v164
    v_sub_f32 v167, 0, v166
    v_cvt_pk_bf16_f32 v168, v167, v167
    v_and_b32 v168, s41, v168
    v_sub_f32 v167, v167, v168
    v_cvt_pk_bf16_f32 v169, v167, v167
    v_and_b32 v169, s41, v169
    v_add_f32 v167, v168, v169
    v_lshrrev_b32 v168, 16, v168
    v_or_b32 v168, v168, v169
    v_cndmask_b32 v21, v168, v12, s[38:39]
    v_add_f32 v166, v167, v160
    v_sub_f32 v160, 0, v167
    v_exp_f32 v167, v166
    v_add_f32 v96, v96, v166
    v_add_f32 v97, v97, v166
    v_add_f32 v98, v98, v166
    v_add_f32 v99, v99, v166
    v_add_f32 v100, v100, v166
    v_add_f32 v101, v101, v166
    v_add_f32 v102, v102, v166
    v_add_f32 v103, v103, v166
    v_add_f32 v104, v104, v166
    v_add_f32 v105, v105, v166
    v_add_f32 v106, v106, v166
    v_add_f32 v107, v107, v166
    v_add_f32 v108, v108, v166
    v_add_f32 v109, v109, v166
    v_add_f32 v110, v110, v166
    v_add_f32 v111, v111, v166
    v_mul_f32 v32, v32, v167
    v_mul_f32 v33, v33, v167
    v_mul_f32 v34, v34, v167
    v_mul_f32 v35, v35, v167
    v_mul_f32 v36, v36, v167
    v_mul_f32 v37, v37, v167
    v_mul_f32 v38, v38, v167
    v_mul_f32 v39, v39, v167
    v_mul_f32 v40, v40, v167
    v_mul_f32 v41, v41, v167
    v_mul_f32 v42, v42, v167
    v_mul_f32 v43, v43, v167
    v_mov_b32 v166, v165
    s_nop 1
    v_permlane32_swap_b32 v165, v166
    v_max_f32 v165, v165, v166
    v_max_f32 v165, 0, v165
    v_add_f32 v166, v161, v165
    v_sub_f32 v167, 0, v166
    v_cvt_pk_bf16_f32 v168, v167, v167
    v_and_b32 v168, s41, v168
    v_sub_f32 v167, v167, v168
    v_cvt_pk_bf16_f32 v169, v167, v167
    v_and_b32 v169, s41, v169
    v_add_f32 v167, v168, v169
    v_lshrrev_b32 v168, 16, v168
    v_or_b32 v168, v168, v169
    v_cndmask_b32 v29, v168, v12, s[38:39]
    v_add_f32 v166, v167, v161
    v_sub_f32 v161, 0, v167
    v_exp_f32 v167, v166
    v_add_f32 v112, v112, v166
    v_add_f32 v113, v113, v166
    v_add_f32 v114, v114, v166
    v_add_f32 v115, v115, v166
    v_add_f32 v116, v116, v166
    v_add_f32 v117, v117, v166
    v_add_f32 v118, v118, v166
    v_add_f32 v119, v119, v166
    v_add_f32 v120, v120, v166
    v_add_f32 v121, v121, v166
    v_add_f32 v122, v122, v166
    v_add_f32 v123, v123, v166
    v_add_f32 v124, v124, v166
    v_add_f32 v125, v125, v166
    v_add_f32 v126, v126, v166
    v_add_f32 v127, v127, v166
    v_mul_f32 v48, v48, v167
    v_mul_f32 v49, v49, v167
    v_mul_f32 v50, v50, v167
    v_mul_f32 v51, v51, v167
    v_mul_f32 v52, v52, v167
    v_mul_f32 v53, v53, v167
    v_mul_f32 v54, v54, v167
    v_mul_f32 v55, v55, v167
    v_mul_f32 v56, v56, v167
    v_mul_f32 v57, v57, v167
    v_mul_f32 v58, v58, v167
    v_mul_f32 v59, v59, v167
    s_nop 1
    s_branch L_aabk_73
L_aars_74:
    s_nop 7
    s_nop 7
    v_mov_b32 v166, v164
    s_nop 1
    v_permlane32_swap_b32 v164, v166
    v_max_f32 v164, v164, v166
    v_max_f32 v164, 0, v164
    v_add_f32 v166, v160, v164
    v_sub_f32 v167, 0, v166
    v_cvt_pk_bf16_f32 v168, v167, v167
    v_and_b32 v168, s41, v168
    v_sub_f32 v167, v167, v168
    v_cvt_pk_bf16_f32 v169, v167, v167
    v_and_b32 v169, s41, v169
    v_add_f32 v167, v168, v169
    v_lshrrev_b32 v168, 16, v168
    v_or_b32 v168, v168, v169
    v_cndmask_b32 v21, v168, v12, s[38:39]
    v_add_f32 v166, v167, v160
    v_sub_f32 v160, 0, v167
    v_exp_f32 v167, v166
    v_add_f32 v64, v64, v166
    v_add_f32 v65, v65, v166
    v_add_f32 v66, v66, v166
    v_add_f32 v67, v67, v166
    v_add_f32 v68, v68, v166
    v_add_f32 v69, v69, v166
    v_add_f32 v70, v70, v166
    v_add_f32 v71, v71, v166
    v_add_f32 v72, v72, v166
    v_add_f32 v73, v73, v166
    v_add_f32 v74, v74, v166
    v_add_f32 v75, v75, v166
    v_add_f32 v76, v76, v166
    v_add_f32 v77, v77, v166
    v_add_f32 v78, v78, v166
    v_add_f32 v79, v79, v166
    v_mul_f32 v32, v32, v167
    v_mul_f32 v33, v33, v167
    v_mul_f32 v34, v34, v167
    v_mul_f32 v35, v35, v167
    v_mul_f32 v36, v36, v167
    v_mul_f32 v37, v37, v167
    v_mul_f32 v38, v38, v167
    v_mul_f32 v39, v39, v167
    v_mul_f32 v40, v40, v167
    v_mul_f32 v41, v41, v167
    v_mul_f32 v42, v42, v167
    v_mul_f32 v43, v43, v167
    v_mov_b32 v166, v165
    s_nop 1
    v_permlane32_swap_b32 v165, v166
    v_max_f32 v165, v165, v166
    v_max_f32 v165, 0, v165
    v_add_f32 v166, v161, v165
    v_sub_f32 v167, 0, v166
    v_cvt_pk_bf16_f32 v168, v167, v167
    v_and_b32 v168, s41, v168
    v_sub_f32 v167, v167, v168
    v_cvt_pk_bf16_f32 v169, v167, v167
    v_and_b32 v169, s41, v169
    v_add_f32 v167, v168, v169
    v_lshrrev_b32 v168, 16, v168
    v_or_b32 v168, v168, v169
    v_cndmask_b32 v29, v168, v12, s[38:39]
    v_add_f32 v166, v167, v161
    v_sub_f32 v161, 0, v167
    v_exp_f32 v167, v166
    v_add_f32 v80, v80, v166
    v_add_f32 v81, v81, v166
    v_add_f32 v82, v82, v166
    v_add_f32 v83, v83, v166
    v_add_f32 v84, v84, v166
    v_add_f32 v85, v85, v166
    v_add_f32 v86, v86, v166
    v_add_f32 v87, v87, v166
    v_add_f32 v88, v88, v166
    v_add_f32 v89, v89, v166
    v_add_f32 v90, v90, v166
    v_add_f32 v91, v91, v166
    v_add_f32 v92, v92, v166
    v_add_f32 v93, v93, v166
    v_add_f32 v94, v94, v166
    v_add_f32 v95, v95, v166
    v_mul_f32 v48, v48, v167
    v_mul_f32 v49, v49, v167
    v_mul_f32 v50, v50, v167
    v_mul_f32 v51, v51, v167
    v_mul_f32 v52, v52, v167
    v_mul_f32 v53, v53, v167
    v_mul_f32 v54, v54, v167
    v_mul_f32 v55, v55, v167
    v_mul_f32 v56, v56, v167
    v_mul_f32 v57, v57, v167
    v_mul_f32 v58, v58, v167
    v_mul_f32 v59, v59, v167
    s_nop 1
    s_branch L_aabk_75
L_aars_76:
    s_nop 7
    s_nop 7
    v_mov_b32 v166, v164
    s_nop 1
    v_permlane32_swap_b32 v164, v166
    v_max_f32 v164, v164, v166
    v_max_f32 v164, 0, v164
    v_add_f32 v166, v160, v164
    v_sub_f32 v167, 0, v166
    v_cvt_pk_bf16_f32 v168, v167, v167
    v_and_b32 v168, s41, v168
    v_sub_f32 v167, v167, v168
    v_cvt_pk_bf16_f32 v169, v167, v167
    v_and_b32 v169, s41, v169
    v_add_f32 v167, v168, v169
    v_lshrrev_b32 v168, 16, v168
    v_or_b32 v168, v168, v169
    v_cndmask_b32 v21, v168, v12, s[38:39]
    v_add_f32 v166, v167, v160
    v_sub_f32 v160, 0, v167
    v_exp_f32 v167, v166
    v_add_f32 v96, v96, v166
    v_add_f32 v97, v97, v166
    v_add_f32 v98, v98, v166
    v_add_f32 v99, v99, v166
    v_add_f32 v100, v100, v166
    v_add_f32 v101, v101, v166
    v_add_f32 v102, v102, v166
    v_add_f32 v103, v103, v166
    v_add_f32 v104, v104, v166
    v_add_f32 v105, v105, v166
    v_add_f32 v106, v106, v166
    v_add_f32 v107, v107, v166
    v_add_f32 v108, v108, v166
    v_add_f32 v109, v109, v166
    v_add_f32 v110, v110, v166
    v_add_f32 v111, v111, v166
    v_mul_f32 v32, v32, v167
    v_mul_f32 v33, v33, v167
    v_mul_f32 v34, v34, v167
    v_mul_f32 v35, v35, v167
    v_mul_f32 v36, v36, v167
    v_mul_f32 v37, v37, v167
    v_mul_f32 v38, v38, v167
    v_mul_f32 v39, v39, v167
    v_mul_f32 v40, v40, v167
    v_mul_f32 v41, v41, v167
    v_mul_f32 v42, v42, v167
    v_mul_f32 v43, v43, v167
    v_mov_b32 v166, v165
    s_nop 1
    v_permlane32_swap_b32 v165, v166
    v_max_f32 v165, v165, v166
    v_max_f32 v165, 0, v165
    v_add_f32 v166, v161, v165
    v_sub_f32 v167, 0, v166
    v_cvt_pk_bf16_f32 v168, v167, v167
    v_and_b32 v168, s41, v168
    v_sub_f32 v167, v167, v168
    v_cvt_pk_bf16_f32 v169, v167, v167
    v_and_b32 v169, s41, v169
    v_add_f32 v167, v168, v169
    v_lshrrev_b32 v168, 16, v168
    v_or_b32 v168, v168, v169
    v_cndmask_b32 v29, v168, v12, s[38:39]
    v_add_f32 v166, v167, v161
    v_sub_f32 v161, 0, v167
    v_exp_f32 v167, v166
    v_add_f32 v112, v112, v166
    v_add_f32 v113, v113, v166
    v_add_f32 v114, v114, v166
    v_add_f32 v115, v115, v166
    v_add_f32 v116, v116, v166
    v_add_f32 v117, v117, v166
    v_add_f32 v118, v118, v166
    v_add_f32 v119, v119, v166
    v_add_f32 v120, v120, v166
    v_add_f32 v121, v121, v166
    v_add_f32 v122, v122, v166
    v_add_f32 v123, v123, v166
    v_add_f32 v124, v124, v166
    v_add_f32 v125, v125, v166
    v_add_f32 v126, v126, v166
    v_add_f32 v127, v127, v166
    v_mul_f32 v48, v48, v167
    v_mul_f32 v49, v49, v167
    v_mul_f32 v50, v50, v167
    v_mul_f32 v51, v51, v167
    v_mul_f32 v52, v52, v167
    v_mul_f32 v53, v53, v167
    v_mul_f32 v54, v54, v167
    v_mul_f32 v55, v55, v167
    v_mul_f32 v56, v56, v167
    v_mul_f32 v57, v57, v167
    v_mul_f32 v58, v58, v167
    v_mul_f32 v59, v59, v167
    s_nop 1
    s_branch L_aabk_77
L_aars_78:
    s_nop 7
    s_nop 7
    v_mov_b32 v166, v164
    s_nop 1
    v_permlane32_swap_b32 v164, v166
    v_max_f32 v164, v164, v166
    v_max_f32 v164, 0, v164
    v_add_f32 v166, v160, v164
    v_sub_f32 v167, 0, v166
    v_cvt_pk_bf16_f32 v168, v167, v167
    v_and_b32 v168, s41, v168
    v_sub_f32 v167, v167, v168
    v_cvt_pk_bf16_f32 v169, v167, v167
    v_and_b32 v169, s41, v169
    v_add_f32 v167, v168, v169
    v_lshrrev_b32 v168, 16, v168
    v_or_b32 v168, v168, v169
    v_cndmask_b32 v21, v168, v12, s[38:39]
    v_add_f32 v166, v167, v160
    v_sub_f32 v160, 0, v167
    v_exp_f32 v167, v166
    v_add_f32 v64, v64, v166
    v_add_f32 v65, v65, v166
    v_add_f32 v66, v66, v166
    v_add_f32 v67, v67, v166
    v_add_f32 v68, v68, v166
    v_add_f32 v69, v69, v166
    v_add_f32 v70, v70, v166
    v_add_f32 v71, v71, v166
    v_add_f32 v72, v72, v166
    v_add_f32 v73, v73, v166
    v_add_f32 v74, v74, v166
    v_add_f32 v75, v75, v166
    v_add_f32 v76, v76, v166
    v_add_f32 v77, v77, v166
    v_add_f32 v78, v78, v166
    v_add_f32 v79, v79, v166
    v_mul_f32 v32, v32, v167
    v_mul_f32 v33, v33, v167
    v_mul_f32 v34, v34, v167
    v_mul_f32 v35, v35, v167
    v_mul_f32 v36, v36, v167
    v_mul_f32 v37, v37, v167
    v_mul_f32 v38, v38, v167
    v_mul_f32 v39, v39, v167
    v_mul_f32 v40, v40, v167
    v_mul_f32 v41, v41, v167
    v_mul_f32 v42, v42, v167
    v_mul_f32 v43, v43, v167
    v_mov_b32 v166, v165
    s_nop 1
    v_permlane32_swap_b32 v165, v166
    v_max_f32 v165, v165, v166
    v_max_f32 v165, 0, v165
    v_add_f32 v166, v161, v165
    v_sub_f32 v167, 0, v166
    v_cvt_pk_bf16_f32 v168, v167, v167
    v_and_b32 v168, s41, v168
    v_sub_f32 v167, v167, v168
    v_cvt_pk_bf16_f32 v169, v167, v167
    v_and_b32 v169, s41, v169
    v_add_f32 v167, v168, v169
    v_lshrrev_b32 v168, 16, v168
    v_or_b32 v168, v168, v169
    v_cndmask_b32 v29, v168, v12, s[38:39]
    v_add_f32 v166, v167, v161
    v_sub_f32 v161, 0, v167
    v_exp_f32 v167, v166
    v_add_f32 v80, v80, v166
    v_add_f32 v81, v81, v166
    v_add_f32 v82, v82, v166
    v_add_f32 v83, v83, v166
    v_add_f32 v84, v84, v166
    v_add_f32 v85, v85, v166
    v_add_f32 v86, v86, v166
    v_add_f32 v87, v87, v166
    v_add_f32 v88, v88, v166
    v_add_f32 v89, v89, v166
    v_add_f32 v90, v90, v166
    v_add_f32 v91, v91, v166
    v_add_f32 v92, v92, v166
    v_add_f32 v93, v93, v166
    v_add_f32 v94, v94, v166
    v_add_f32 v95, v95, v166
    v_mul_f32 v48, v48, v167
    v_mul_f32 v49, v49, v167
    v_mul_f32 v50, v50, v167
    v_mul_f32 v51, v51, v167
    v_mul_f32 v52, v52, v167
    v_mul_f32 v53, v53, v167
    v_mul_f32 v54, v54, v167
    v_mul_f32 v55, v55, v167
    v_mul_f32 v56, v56, v167
    v_mul_f32 v57, v57, v167
    v_mul_f32 v58, v58, v167
    v_mul_f32 v59, v59, v167
    s_nop 1
    s_branch L_aabk_79
L_aa_end:
    s_waitcnt vmcnt(0)
    s_nop 7
    s_nop 3
    s_mul_i32 s17, s27, 18
    v_and_b32 v9, 31, v1
    v_lshrrev_b32 v10, 5, v1
    v_lshl_add_u32 v11, v10, 2, s17
    v_add_u32 v11, 0, v11
    v_lshrrev_b32 v14, 4, v11
    v_lshlrev_b32 v14, 10, v14
    v_bfe_u32 v15, v11, 3, 1
    v_lshl_add_u32 v14, v15, 9, v14
    v_lshl_add_u32 v14, v9, 4, v14
    v_and_b32 v15, 7, v11
    v_lshl_add_u32 v96, v15, 1, v14
    v_lshl_add_u32 v11, v10, 2, s17
    v_add_u32 v11, 2, v11
    v_lshrrev_b32 v14, 4, v11
    v_lshlrev_b32 v14, 10, v14
    v_bfe_u32 v15, v11, 3, 1
    v_lshl_add_u32 v14, v15, 9, v14
    v_lshl_add_u32 v14, v9, 4, v14
    v_and_b32 v15, 7, v11
    v_lshl_add_u32 v97, v15, 1, v14
    v_lshl_add_u32 v11, v10, 2, s17
    v_add_u32 v11, 8, v11
    v_lshrrev_b32 v14, 4, v11
    v_lshlrev_b32 v14, 10, v14
    v_bfe_u32 v15, v11, 3, 1
    v_lshl_add_u32 v14, v15, 9, v14
    v_lshl_add_u32 v14, v9, 4, v14
    v_and_b32 v15, 7, v11
    v_lshl_add_u32 v98, v15, 1, v14
    v_lshl_add_u32 v11, v10, 2, s17
    v_add_u32 v11, 10, v11
    v_lshrrev_b32 v14, 4, v11
    v_lshlrev_b32 v14, 10, v14
    v_bfe_u32 v15, v11, 3, 1
    v_lshl_add_u32 v14, v15, 9, v14
    v_lshl_add_u32 v14, v9, 4, v14
    v_and_b32 v15, 7, v11
    v_lshl_add_u32 v99, v15, 1, v14
    v_lshl_add_u32 v11, v10, 2, s17
    v_add_u32 v11, 16, v11
    v_lshrrev_b32 v14, 4, v11
    v_lshlrev_b32 v14, 10, v14
    v_bfe_u32 v15, v11, 3, 1
    v_lshl_add_u32 v14, v15, 9, v14
    v_lshl_add_u32 v14, v9, 4, v14
    v_and_b32 v15, 7, v11
    v_lshl_add_u32 v100, v15, 1, v14
    v_mov_b32 v11, 1073741824
    v_cndmask_b32 v100, v100, v11, s[38:39]
    v_mov_b32 v11, v42
    v_mov_b32 v14, v42
    s_add_u32 s20, s31, 0
    s_mul_i32 s20, s20, 299008
    v_permlane32_swap_b32 v11, v14
    v_rcp_f32 v11, v11
    s_add_u32 s20, s20, 67371008
    v_mul_f32 v11, v11, v162
    v_mul_f32 v32, v32, v11
    v_mul_f32 v33, v33, v11
    v_mul_f32 v34, v34, v11
    v_mul_f32 v35, v35, v11
    v_mul_f32 v36, v36, v11
    v_mul_f32 v37, v37, v11
    v_mul_f32 v38, v38, v11
    v_mul_f32 v39, v39, v11
    v_mul_f32 v40, v40, v11
    v_mul_f32 v41, v41, v11
    v_cvt_pk_bf16_f32 v104, v32, v33
    v_cvt_pk_bf16_f32 v105, v34, v35
    v_cvt_pk_bf16_f32 v106, v36, v37
    v_cvt_pk_bf16_f32 v107, v38, v39
    v_cvt_pk_bf16_f32 v108, v40, v41
    buffer_store_dword v104, v96, s[4:7], s20 offen sc1
    buffer_store_dword v105, v97, s[4:7], s20 offen sc1
    buffer_store_dword v106, v98, s[4:7], s20 offen sc1
    buffer_store_dword v107, v99, s[4:7], s20 offen sc1
    buffer_store_dword v108, v100, s[4:7], s20 offen sc1
    v_mov_b32 v11, v58
    v_mov_b32 v14, v58
    s_add_u32 s20, s31, 1
    s_mul_i32 s20, s20, 299008
    v_permlane32_swap_b32 v11, v14
    v_rcp_f32 v11, v11
    s_add_u32 s20, s20, 67371008
    v_mul_f32 v11, v11, v163
    v_mul_f32 v48, v48, v11
    v_mul_f32 v49, v49, v11
    v_mul_f32 v50, v50, v11
    v_mul_f32 v51, v51, v11
    v_mul_f32 v52, v52, v11
    v_mul_f32 v53, v53, v11
    v_mul_f32 v54, v54, v11
    v_mul_f32 v55, v55, v11
    v_mul_f32 v56, v56, v11
    v_mul_f32 v57, v57, v11
    v_cvt_pk_bf16_f32 v109, v48, v49
    v_cvt_pk_bf16_f32 v110, v50, v51
    v_cvt_pk_bf16_f32 v111, v52, v53
    v_cvt_pk_bf16_f32 v112, v54, v55
    v_cvt_pk_bf16_f32 v113, v56, v57
    buffer_store_dword v109, v96, s[4:7], s20 offen sc1
    buffer_store_dword v110, v97, s[4:7], s20 offen sc1
    buffer_store_dword v111, v98, s[4:7], s20 offen sc1
    buffer_store_dword v112, v99, s[4:7], s20 offen sc1
    buffer_store_dword v113, v100, s[4:7], s20 offen sc1
    s_lshl_b32 s30, s29, 7
    s_add_u32 s30, s30, 16384
    s_waitcnt vmcnt(0)
    s_barrier
    s_cmp_eq_u32 s13, 0
    s_cbranch_scc0 L_sig_80
    s_mov_b64 exec, 1
    v_mov_b32 v2, 1
    buffer_atomic_add v2, off, s[4:7], s30 sc1
    s_mov_b64 exec, -1
        L_sig_80:
    s_branch L_next
L_do_aq:
    s_load_dwordx2 s[68:69], s[0:1], 0
    s_waitcnt lgkmcnt(0)
    s_and_b32 s69, s69, 0xffff
    s_mov_b32 s70, 2359296
    s_mov_b32 s71, 0x20000
    v_lshlrev_b32 v9, 7, v0
    s_mul_i32 s17, s12, 73728
    s_mov_b32 m0, 163264
    v_cmp_gt_u32 vcc, 64, v0
    buffer_load_dword v9, s[68:71], s17 offen lds
    s_add_u32 s17, s17, 32768
    v_mov_b32 v10, 1073741824
    buffer_load_dword v9, s[68:71], s17 offen lds
    s_add_u32 s17, s17, 32768
    v_cndmask_b32 v9, v10, v9, vcc
    buffer_load_dword v9, s[68:71], s17 offen lds
    s_load_dwordx2 s[64:65], s[0:1], 8
    s_waitcnt lgkmcnt(0)
    s_and_b32 s65, s65, 0xffff
    s_mov_b32 s66, 1990656
    s_mov_b32 s67, 0x20000
    s_mul_hi_u32 s22, s16, 306783379
    s_mul_i32 s17, s22, 14
    s_sub_u32 s27, s16, s17
    s_lshl_b32 s17, s27, 8
    s_cmp_eq_u32 s27, 13
    s_cselect_b32 s20, 8, 16
    v_and_b32 v1, 63, v0
    v_lshrrev_b32 v9, 4, v1
    v_and_b32 v10, 15, v1
    v_lshlrev_b32 v11, 2, v9
    v_xor_b32 v10, v10, v11
    v_mul_u32_u24 v9, 3456, v9
    v_lshl_add_u32 v9, v10, 4, v9
    v_cmp_gt_u32 vcc, s20, v10
    v_mov_b32 v11, 1073741824
    s_nop 0
    v_cndmask_b32 v9, v11, v9, vcc
    s_mul_i32 s18, s13, 497664
    s_add_u32 s17, s17, s18
    s_mul_i32 s18, s13, 36864
    s_mov_b32 m0, s18
    s_nop 0
    buffer_load_dwordx4 v9, s[64:67], s17 offen lds
    s_add_u32 m0, m0, 1024
    s_add_u32 s17, s17, 13824
    buffer_load_dwordx4 v9, s[64:67], s17 offen lds
    s_add_u32 m0, m0, 1024
    s_add_u32 s17, s17, 13824
    buffer_load_dwordx4 v9, s[64:67], s17 offen lds
    s_add_u32 m0, m0, 1024
    s_add_u32 s17, s17, 13824
    buffer_load_dwordx4 v9, s[64:67], s17 offen lds
    s_add_u32 m0, m0, 1024
    s_add_u32 s17, s17, 13824
    buffer_load_dwordx4 v9, s[64:67], s17 offen lds
    s_add_u32 m0, m0, 1024
    s_add_u32 s17, s17, 13824
    buffer_load_dwordx4 v9, s[64:67], s17 offen lds
    s_add_u32 m0, m0, 1024
    s_add_u32 s17, s17, 13824
    buffer_load_dwordx4 v9, s[64:67], s17 offen lds
    s_add_u32 m0, m0, 1024
    s_add_u32 s17, s17, 13824
    buffer_load_dwordx4 v9, s[64:67], s17 offen lds
    s_add_u32 m0, m0, 1024
    s_add_u32 s17, s17, 13824
    buffer_load_dwordx4 v9, s[64:67], s17 offen lds
    s_add_u32 m0, m0, 1024
    s_add_u32 s17, s17, 13824
    buffer_load_dwordx4 v9, s[64:67], s17 offen lds
    s_add_u32 m0, m0, 1024
    s_add_u32 s17, s17, 13824
    buffer_load_dwordx4 v9, s[64:67], s17 offen lds
    s_add_u32 m0, m0, 1024
    s_add_u32 s17, s17, 13824
    buffer_load_dwordx4 v9, s[64:67], s17 offen lds
    s_add_u32 m0, m0, 1024
    s_add_u32 s17, s17, 13824
    buffer_load_dwordx4 v9, s[64:67], s17 offen lds
    s_add_u32 m0, m0, 1024
    s_add_u32 s17, s17, 13824
    buffer_load_dwordx4 v9, s[64:67], s17 offen lds
    s_add_u32 m0, m0, 1024
    s_add_u32 s17, s17, 13824
    buffer_load_dwordx4 v9, s[64:67], s17 offen lds
    s_add_u32 m0, m0, 1024
    s_add_u32 s17, s17, 13824
    buffer_load_dwordx4 v9, s[64:67], s17 offen lds
    s_add_u32 m0, m0, 1024
    s_add_u32 s17, s17, 13824
    buffer_load_dwordx4 v9, s[64:67], s17 offen lds
    s_add_u32 m0, m0, 1024
    s_add_u32 s17, s17, 13824
    buffer_load_dwordx4 v9, s[64:67], s17 offen lds
    s_add_u32 m0, m0, 1024
    s_add_u32 s17, s17, 13824
    buffer_load_dwordx4 v9, s[64:67], s17 offen lds
    s_add_u32 m0, m0, 1024
    s_add_u32 s17, s17, 13824
    buffer_load_dwordx4 v9, s[64:67], s17 offen lds
    s_add_u32 m0, m0, 1024
    s_add_u32 s17, s17, 13824
    buffer_load_dwordx4 v9, s[64:67], s17 offen lds
    s_add_u32 m0, m0, 1024
    s_add_u32 s17, s17, 13824
    buffer_load_dwordx4 v9, s[64:67], s17 offen lds
    s_add_u32 m0, m0, 1024
    s_add_u32 s17, s17, 13824
    buffer_load_dwordx4 v9, s[64:67], s17 offen lds
    s_add_u32 m0, m0, 1024
    s_add_u32 s17, s17, 13824
    buffer_load_dwordx4 v9, s[64:67], s17 offen lds
    s_add_u32 m0, m0, 1024
    s_add_u32 s17, s17, 13824
    buffer_load_dwordx4 v9, s[64:67], s17 offen lds
    s_add_u32 m0, m0, 1024
    s_add_u32 s17, s17, 13824
    buffer_load_dwordx4 v9, s[64:67], s17 offen lds
    s_add_u32 m0, m0, 1024
    s_add_u32 s17, s17, 13824
    buffer_load_dwordx4 v9, s[64:67], s17 offen lds
    s_add_u32 m0, m0, 1024
    s_add_u32 s17, s17, 13824
    buffer_load_dwordx4 v9, s[64:67], s17 offen lds
    s_add_u32 m0, m0, 1024
    s_add_u32 s17, s17, 13824
    buffer_load_dwordx4 v9, s[64:67], s17 offen lds
    s_add_u32 m0, m0, 1024
    s_add_u32 s17, s17, 13824
    buffer_load_dwordx4 v9, s[64:67], s17 offen lds
    s_add_u32 m0, m0, 1024
    s_add_u32 s17, s17, 13824
    buffer_load_dwordx4 v9, s[64:67], s17 offen lds
    s_add_u32 m0, m0, 1024
    s_add_u32 s17, s17, 13824
    buffer_load_dwordx4 v9, s[64:67], s17 offen lds
    s_add_u32 m0, m0, 1024
    s_add_u32 s17, s17, 13824
    buffer_load_dwordx4 v9, s[64:67], s17 offen lds
    s_add_u32 m0, m0, 1024
    s_add_u32 s17, s17, 13824
    buffer_load_dwordx4 v9, s[64:67], s17 offen lds
    s_add_u32 m0, m0, 1024
    s_add_u32 s17, s17, 13824
    buffer_load_dwordx4 v9, s[64:67], s17 offen lds
    s_add_u32 m0, m0, 1024
    s_add_u32 s17, s17, 13824
    buffer_load_dwordx4 v9, s[64:67], s17 offen lds
    v_lshrrev_b32 v10, 5, v1
    v_bfe_u32 v11, v1, 2, 2
    v_lshl_add_u32 v10, v10, 3, v11
    v_lshlrev_b32 v10, 8, v10
    v_xor_b32 v11, s13, v11
    v_lshl_add_u32 v10, v11, 6, v10
    v_bfe_u32 v11, v1, 4, 1
    v_lshl_add_u32 v10, v11, 5, v10
    v_and_b32 v11, 3, v1
    v_lshl_add_u32 v10, v11, 3, v10
    v_add_u32 v11, 65536, v10
    v_add_u32 v12, 131072, v10
    s_waitcnt vmcnt(0)
    s_barrier
    s_cmp_eq_u32 s20, 16
    s_cbranch_scc1 L_ng_81
    s_load_dwordx2 s[64:65], s[0:1], 80
    s_waitcnt lgkmcnt(0)
    s_and_b32 s65, s65, 0xffff
    s_mov_b32 s66, 1152
    s_mov_b32 s67, 0x20000
    v_add_u32 v13, 0, v0
    v_lshlrev_b32 v14, 1, v13
    buffer_load_ushort v15, v14, s[64:67], 0 offen
    v_and_b32 v14, 3, v13
    v_xor_b32 v14, 2, v14
    v_lshlrev_b32 v14, 6, v14
    v_lshl_add_u32 v14, v13, 8, v14
    v_cmp_gt_u32 vcc, 576, v13
    s_waitcnt vmcnt(0)
    s_and_saveexec_b64 s[18:19], vcc
    ds_write_b16 v14, v15
    s_mov_b64 exec, s[18:19]
    v_add_u32 v13, 256, v0
    v_lshlrev_b32 v14, 1, v13
    buffer_load_ushort v15, v14, s[64:67], 0 offen
    v_and_b32 v14, 3, v13
    v_xor_b32 v14, 2, v14
    v_lshlrev_b32 v14, 6, v14
    v_lshl_add_u32 v14, v13, 8, v14
    v_cmp_gt_u32 vcc, 576, v13
    s_waitcnt vmcnt(0)
    s_and_saveexec_b64 s[18:19], vcc
    ds_write_b16 v14, v15
    s_mov_b64 exec, s[18:19]
    v_add_u32 v13, 512, v0
    v_lshlrev_b32 v14, 1, v13
    buffer_load_ushort v15, v14, s[64:67], 0 offen
    v_and_b32 v14, 3, v13
    v_xor_b32 v14, 2, v14
    v_lshlrev_b32 v14, 6, v14
    v_lshl_add_u32 v14, v13, 8, v14
    v_cmp_gt_u32 vcc, 576, v13
    s_waitcnt vmcnt(0)
    s_and_saveexec_b64 s[18:19], vcc
    ds_write_b16 v14, v15
    s_mov_b64 exec, s[18:19]
    s_waitcnt lgkmcnt(0)
L_ng_81:
    s_barrier
    ds_read_b64_tr_b16 a[0:1], v10 offset:0
    ds_read_b64_tr_b16 a[2:3], v10 offset:1024
    ds_read_b64_tr_b16 a[4:5], v10 offset:4096
    ds_read_b64_tr_b16 a[6:7], v10 offset:5120
    ds_read_b64_tr_b16 a[8:9], v10 offset:8192
    ds_read_b64_tr_b16 a[10:11], v10 offset:9216
    ds_read_b64_tr_b16 a[12:13], v10 offset:12288
    ds_read_b64_tr_b16 a[14:15], v10 offset:13312
    ds_read_b64_tr_b16 a[16:17], v10 offset:16384
    ds_read_b64_tr_b16 a[18:19], v10 offset:17408
    ds_read_b64_tr_b16 a[20:21], v10 offset:20480
    ds_read_b64_tr_b16 a[22:23], v10 offset:21504
    s_waitcnt lgkmcnt(0)
    ds_read_b64_tr_b16 a[24:25], v10 offset:24576
    ds_read_b64_tr_b16 a[26:27], v10 offset:25600
    ds_read_b64_tr_b16 a[28:29], v10 offset:28672
    ds_read_b64_tr_b16 a[30:31], v10 offset:29696
    ds_read_b64_tr_b16 a[32:33], v10 offset:32768
    ds_read_b64_tr_b16 a[34:35], v10 offset:33792
    ds_read_b64_tr_b16 a[36:37], v10 offset:36864
    ds_read_b64_tr_b16 a[38:39], v10 offset:37888
    ds_read_b64_tr_b16 a[40:41], v10 offset:40960
    ds_read_b64_tr_b16 a[42:43], v10 offset:41984
    ds_read_b64_tr_b16 a[44:45], v10 offset:45056
    ds_read_b64_tr_b16 a[46:47], v10 offset:46080
    s_waitcnt lgkmcnt(0)
    ds_read_b64_tr_b16 a[48:49], v10 offset:49152
    ds_read_b64_tr_b16 a[50:51], v10 offset:50176
    ds_read_b64_tr_b16 a[52:53], v10 offset:53248
    ds_read_b64_tr_b16 a[54:55], v10 offset:54272
    ds_read_b64_tr_b16 a[56:57], v10 offset:57344
    ds_read_b64_tr_b16 a[58:59], v10 offset:58368
    ds_read_b64_tr_b16 a[60:61], v10 offset:61440
    ds_read_b64_tr_b16 a[62:63], v10 offset:62464
    ds_read_b64_tr_b16 a[64:65], v11 offset:0
    ds_read_b64_tr_b16 a[66:67], v11 offset:1024
    ds_read_b64_tr_b16 a[68:69], v11 offset:4096
    ds_read_b64_tr_b16 a[70:71], v11 offset:5120
    s_waitcnt lgkmcnt(0)
    ds_read_b64_tr_b16 a[72:73], v11 offset:8192
    ds_read_b64_tr_b16 a[74:75], v11 offset:9216
    ds_read_b64_tr_b16 a[76:77], v11 offset:12288
    ds_read_b64_tr_b16 a[78:79], v11 offset:13312
    ds_read_b64_tr_b16 a[80:81], v11 offset:16384
    ds_read_b64_tr_b16 a[82:83], v11 offset:17408
    ds_read_b64_tr_b16 a[84:85], v11 offset:20480
    ds_read_b64_tr_b16 a[86:87], v11 offset:21504
    ds_read_b64_tr_b16 a[88:89], v11 offset:24576
    ds_read_b64_tr_b16 a[90:91], v11 offset:25600
    ds_read_b64_tr_b16 a[92:93], v11 offset:28672
    ds_read_b64_tr_b16 a[94:95], v11 offset:29696
    s_waitcnt lgkmcnt(0)
    ds_read_b64_tr_b16 a[96:97], v11 offset:32768
    ds_read_b64_tr_b16 a[98:99], v11 offset:33792
    ds_read_b64_tr_b16 a[100:101], v11 offset:36864
    ds_read_b64_tr_b16 a[102:103], v11 offset:37888
    ds_read_b64_tr_b16 a[104:105], v11 offset:40960
    ds_read_b64_tr_b16 a[106:107], v11 offset:41984
    ds_read_b64_tr_b16 a[108:109], v11 offset:45056
    ds_read_b64_tr_b16 a[110:111], v11 offset:46080
    ds_read_b64_tr_b16 a[112:113], v11 offset:49152
    ds_read_b64_tr_b16 a[114:115], v11 offset:50176
    ds_read_b64_tr_b16 a[116:117], v11 offset:53248
    ds_read_b64_tr_b16 a[118:119], v11 offset:54272
    s_waitcnt lgkmcnt(0)
    ds_read_b64_tr_b16 a[120:121], v11 offset:57344
    ds_read_b64_tr_b16 a[122:123], v11 offset:58368
    ds_read_b64_tr_b16 a[124:125], v11 offset:61440
    ds_read_b64_tr_b16 a[126:127], v11 offset:62464
    ds_read_b64_tr_b16 a[128:129], v12 offset:0
    ds_read_b64_tr_b16 a[130:131], v12 offset:1024
    ds_read_b64_tr_b16 a[132:133], v12 offset:4096
    ds_read_b64_tr_b16 a[134:135], v12 offset:5120
    ds_read_b64_tr_b16 a[136:137], v12 offset:8192
    ds_read_b64_tr_b16 a[138:139], v12 offset:9216
    ds_read_b64_tr_b16 a[140:141], v12 offset:12288
    ds_read_b64_tr_b16 a[142:143], v12 offset:13312
    s_waitcnt lgkmcnt(0)
    s_barrier
    s_load_dwordx2 s[68:69], s[0:1], 0
    s_waitcnt lgkmcnt(0)
    s_and_b32 s69, s69, 0xffff
    s_mov_b32 s70, 2359296
    s_mov_b32 s71, 0x20000
    v_and_b32 v1, 63, v0
    v_lshrrev_b32 v9, 3, v1
    v_lshrrev_b32 v10, 1, v9
    s_and_b32 s17, s13, 1
    s_lshl_b32 s17, s17, 2
    v_add_u32 v10, s17, v10
    v_and_b32 v11, 7, v1
    v_xor_b32 v10, v10, v11
    v_mul_u32_u24 v8, 1152, v9
    v_lshl_add_u32 v8, v10, 4, v8
    s_mul_i32 s17, s13, 9216
    v_add_u32 v8, s17, v8
    v_and_b32 v9, 31, v1
    v_lshrrev_b32 v10, 3, v9
    v_mul_u32_u24 v10, 9216, v10
    v_and_b32 v11, 7, v9
    v_lshl_add_u32 v10, v11, 7, v10
    v_bfe_u32 v11, v9, 1, 3
    v_lshrrev_b32 v12, 5, v1
    v_xor_b32 v11, v11, v12
    v_xor_b32 v12, 0, v11
    v_lshl_add_u32 v4, v12, 4, v10
    v_add_u32 v248, 65536, v4
    v_xor_b32 v12, 2, v11
    v_lshl_add_u32 v5, v12, 4, v10
    v_add_u32 v249, 65536, v5
    v_xor_b32 v12, 4, v11
    v_lshl_add_u32 v6, v12, 4, v10
    v_add_u32 v250, 65536, v6
    v_xor_b32 v12, 6, v11
    v_lshl_add_u32 v7, v12, 4, v10
    v_add_u32 v251, 65536, v7
    s_lshl_b32 s29, s27, 2
    s_add_u32 s29, s29, s13
    s_mov_b32 s30, 17408
    v_and_b32 v1, 63, v0
    v_lshrrev_b32 v13, 5, v1
    v_and_b32 v14, 31, v1
    s_mov_b32 s32, 238609295
    s_cmp_ge_u32 s29, 36
    s_cbranch_scc1 L_aq_v
    s_cmp_ge_u32 s29, 18
    s_cselect_b32 s31, 1.0, 0x3eae1a93
    s_cselect_b32 s33, 2097152, 0
    s_cselect_b32 s34, 262144, 0
    s_cselect_b32 s17, 18, 0
    s_add_u32 s33, s33, 7340032
    s_add_u32 s34, s34, 11534336
    s_sub_u32 s17, s29, s17
    s_lshl_b32 s17, s17, 5
    s_sub_u32 s34, s34, s33
    v_lshl_add_u32 v9, v13, 2, s17
    v_add_u32 v9, 0, v9
    v_mul_hi_u32 v10, v9, s32
    v_mul_u32_u24 v11, 18, v10
    v_sub_u32 v9, v9, v11
    v_lshlrev_b32 v11, 16, v10
    v_bfe_u32 v15, v9, 3, 1
    v_lshl_add_u32 v11, v15, 9, v11
    v_lshl_add_u32 v11, v14, 4, v11
    v_and_b32 v15, 7, v9
    v_lshl_add_u32 v11, v15, 1, v11
    v_lshlrev_b32 v10, 13, v10
    v_lshl_add_u32 v10, v14, 2, v10
    v_add_u32 v10, s34, v10
    v_cmp_gt_u32 vcc, 16, v9
    v_mov_b32 v15, 1024
    v_mov_b32 v9, 128
    v_cndmask_b32 v72, v10, v11, vcc
    v_cndmask_b32 v80, v9, v15, vcc
    v_lshl_add_u32 v9, v13, 2, s17
    v_add_u32 v9, 2, v9
    v_mul_hi_u32 v10, v9, s32
    v_mul_u32_u24 v11, 18, v10
    v_sub_u32 v9, v9, v11
    v_lshlrev_b32 v11, 16, v10
    v_bfe_u32 v15, v9, 3, 1
    v_lshl_add_u32 v11, v15, 9, v11
    v_lshl_add_u32 v11, v14, 4, v11
    v_and_b32 v15, 7, v9
    v_lshl_add_u32 v11, v15, 1, v11
    v_lshlrev_b32 v10, 13, v10
    v_lshl_add_u32 v10, v14, 2, v10
    v_add_u32 v10, s34, v10
    v_cmp_gt_u32 vcc, 16, v9
    v_mov_b32 v15, 1024
    v_mov_b32 v9, 128
    v_cndmask_b32 v73, v10, v11, vcc
    v_cndmask_b32 v81, v9, v15, vcc
    v_lshl_add_u32 v9, v13, 2, s17
    v_add_u32 v9, 8, v9
    v_mul_hi_u32 v10, v9, s32
    v_mul_u32_u24 v11, 18, v10
    v_sub_u32 v9, v9, v11
    v_lshlrev_b32 v11, 16, v10
    v_bfe_u32 v15, v9, 3, 1
    v_lshl_add_u32 v11, v15, 9, v11
    v_lshl_add_u32 v11, v14, 4, v11
    v_and_b32 v15, 7, v9
    v_lshl_add_u32 v11, v15, 1, v11
    v_lshlrev_b32 v10, 13, v10
    v_lshl_add_u32 v10, v14, 2, v10
    v_add_u32 v10, s34, v10
    v_cmp_gt_u32 vcc, 16, v9
    v_mov_b32 v15, 1024
    v_mov_b32 v9, 128
    v_cndmask_b32 v74, v10, v11, vcc
    v_cndmask_b32 v82, v9, v15, vcc
    v_lshl_add_u32 v9, v13, 2, s17
    v_add_u32 v9, 10, v9
    v_mul_hi_u32 v10, v9, s32
    v_mul_u32_u24 v11, 18, v10
    v_sub_u32 v9, v9, v11
    v_lshlrev_b32 v11, 16, v10
    v_bfe_u32 v15, v9, 3, 1
    v_lshl_add_u32 v11, v15, 9, v11
    v_lshl_add_u32 v11, v14, 4, v11
    v_and_b32 v15, 7, v9
    v_lshl_add_u32 v11, v15, 1, v11
    v_lshlrev_b32 v10, 13, v10
    v_lshl_add_u32 v10, v14, 2, v10
    v_add_u32 v10, s34, v10
    v_cmp_gt_u32 vcc, 16, v9
    v_mov_b32 v15, 1024
    v_mov_b32 v9, 128
    v_cndmask_b32 v75, v10, v11, vcc
    v_cndmask_b32 v83, v9, v15, vcc
    v_lshl_add_u32 v9, v13, 2, s17
    v_add_u32 v9, 16, v9
    v_mul_hi_u32 v10, v9, s32
    v_mul_u32_u24 v11, 18, v10
    v_sub_u32 v9, v9, v11
    v_lshlrev_b32 v11, 16, v10
    v_bfe_u32 v15, v9, 3, 1
    v_lshl_add_u32 v11, v15, 9, v11
    v_lshl_add_u32 v11, v14, 4, v11
    v_and_b32 v15, 7, v9
    v_lshl_add_u32 v11, v15, 1, v11
    v_lshlrev_b32 v10, 13, v10
    v_lshl_add_u32 v10, v14, 2, v10
    v_add_u32 v10, s34, v10
    v_cmp_gt_u32 vcc, 16, v9
    v_mov_b32 v15, 1024
    v_mov_b32 v9, 128
    v_cndmask_b32 v76, v10, v11, vcc
    v_cndmask_b32 v84, v9, v15, vcc
    v_lshl_add_u32 v9, v13, 2, s17
    v_add_u32 v9, 18, v9
    v_mul_hi_u32 v10, v9, s32
    v_mul_u32_u24 v11, 18, v10
    v_sub_u32 v9, v9, v11
    v_lshlrev_b32 v11, 16, v10
    v_bfe_u32 v15, v9, 3, 1
    v_lshl_add_u32 v11, v15, 9, v11
    v_lshl_add_u32 v11, v14, 4, v11
    v_and_b32 v15, 7, v9
    v_lshl_add_u32 v11, v15, 1, v11
    v_lshlrev_b32 v10, 13, v10
    v_lshl_add_u32 v10, v14, 2, v10
    v_add_u32 v10, s34, v10
    v_cmp_gt_u32 vcc, 16, v9
    v_mov_b32 v15, 1024
    v_mov_b32 v9, 128
    v_cndmask_b32 v77, v10, v11, vcc
    v_cndmask_b32 v85, v9, v15, vcc
    v_lshl_add_u32 v9, v13, 2, s17
    v_add_u32 v9, 24, v9
    v_mul_hi_u32 v10, v9, s32
    v_mul_u32_u24 v11, 18, v10
    v_sub_u32 v9, v9, v11
    v_lshlrev_b32 v11, 16, v10
    v_bfe_u32 v15, v9, 3, 1
    v_lshl_add_u32 v11, v15, 9, v11
    v_lshl_add_u32 v11, v14, 4, v11
    v_and_b32 v15, 7, v9
    v_lshl_add_u32 v11, v15, 1, v11
    v_lshlrev_b32 v10, 13, v10
    v_lshl_add_u32 v10, v14, 2, v10
    v_add_u32 v10, s34, v10
    v_cmp_gt_u32 vcc, 16, v9
    v_mov_b32 v15, 1024
    v_mov_b32 v9, 128
    v_cndmask_b32 v78, v10, v11, vcc
    v_cndmask_b32 v86, v9, v15, vcc
    v_lshl_add_u32 v9, v13, 2, s17
    v_add_u32 v9, 26, v9
    v_mul_hi_u32 v10, v9, s32
    v_mul_u32_u24 v11, 18, v10
    v_sub_u32 v9, v9, v11
    v_lshlrev_b32 v11, 16, v10
    v_bfe_u32 v15, v9, 3, 1
    v_lshl_add_u32 v11, v15, 9, v11
    v_lshl_add_u32 v11, v14, 4, v11
    v_and_b32 v15, 7, v9
    v_lshl_add_u32 v11, v15, 1, v11
    v_lshlrev_b32 v10, 13, v10
    v_lshl_add_u32 v10, v14, 2, v10
    v_add_u32 v10, s34, v10
    v_cmp_gt_u32 vcc, 16, v9
    v_mov_b32 v15, 1024
    v_mov_b32 v9, 128
    v_cndmask_b32 v79, v10, v11, vcc
    v_cndmask_b32 v87, v9, v15, vcc
    s_mov_b32 s25, 0
    s_mul_i32 s17, s13, 9216
    s_add_u32 m0, s17, s25
    s_mul_i32 s23, s22, 36864
    buffer_load_dwordx4 v8, s[68:71], s23 offen lds
    s_add_u32 m0, m0, 1024
    s_add_u32 s23, s23, 128
    buffer_load_dwordx4 v8, s[68:71], s23 offen lds
    s_add_u32 m0, m0, 1024
    s_add_u32 s23, s23, 128
    buffer_load_dwordx4 v8, s[68:71], s23 offen lds
    s_add_u32 m0, m0, 1024
    s_add_u32 s23, s23, 128
    buffer_load_dwordx4 v8, s[68:71], s23 offen lds
    s_add_u32 m0, m0, 1024
    s_add_u32 s23, s23, 128
    buffer_load_dwordx4 v8, s[68:71], s23 offen lds
    s_add_u32 m0, m0, 1024
    s_add_u32 s23, s23, 128
    buffer_load_dwordx4 v8, s[68:71], s23 offen lds
    s_add_u32 m0, m0, 1024
    s_add_u32 s23, s23, 128
    buffer_load_dwordx4 v8, s[68:71], s23 offen lds
    s_add_u32 m0, m0, 1024
    s_add_u32 s23, s23, 128
    buffer_load_dwordx4 v8, s[68:71], s23 offen lds
    s_add_u32 m0, m0, 1024
    s_add_u32 s23, s23, 128
    buffer_load_dwordx4 v8, s[68:71], s23 offen lds
    s_add_u32 s28, s22, 6
    s_min_u32 s28, s28, 63
    s_mov_b32 s25, 36864
    s_mul_i32 s17, s13, 9216
    s_add_u32 m0, s17, s25
    s_mul_i32 s23, s28, 36864
    buffer_load_dwordx4 v8, s[68:71], s23 offen lds
    s_add_u32 m0, m0, 1024
    s_add_u32 s23, s23, 128
    buffer_load_dwordx4 v8, s[68:71], s23 offen lds
    s_add_u32 m0, m0, 1024
    s_add_u32 s23, s23, 128
    buffer_load_dwordx4 v8, s[68:71], s23 offen lds
    s_add_u32 m0, m0, 1024
    s_add_u32 s23, s23, 128
    buffer_load_dwordx4 v8, s[68:71], s23 offen lds
    s_add_u32 m0, m0, 1024
    s_add_u32 s23, s23, 128
    buffer_load_dwordx4 v8, s[68:71], s23 offen lds
    s_add_u32 m0, m0, 1024
    s_add_u32 s23, s23, 128
    buffer_load_dwordx4 v8, s[68:71], s23 offen lds
    s_add_u32 m0, m0, 1024
    s_add_u32 s23, s23, 128
    buffer_load_dwordx4 v8, s[68:71], s23 offen lds
    s_add_u32 m0, m0, 1024
    s_add_u32 s23, s23, 128
    buffer_load_dwordx4 v8, s[68:71], s23 offen lds
    s_add_u32 m0, m0, 1024
    s_add_u32 s23, s23, 128
    buffer_load_dwordx4 v8, s[68:71], s23 offen lds
    s_mov_b32 s26, 0
    s_waitcnt vmcnt(9)
    s_barrier
    s_add_u32 s28, s22, 12
    s_min_u32 s28, s28, 63
    s_mov_b32 s25, 73728
    ds_read_b128 v[16:19], v4 offset:0
    s_mul_i32 s17, s13, 9216
    s_add_u32 m0, s17, s25
    s_mul_i32 s23, s28, 36864
    ds_read_b128 v[20:23], v5 offset:0
    ds_read_b128 v[24:27], v6 offset:0
    ds_read_b128 v[28:31], v7 offset:0
    ds_read_b128 v[32:35], v4 offset:1024
    ds_read_b128 v[36:39], v5 offset:1024
    ds_read_b128 v[40:43], v6 offset:1024
    ds_read_b128 v[44:47], v7 offset:1024
    s_waitcnt lgkmcnt(7)
    v_mfma_f32_32x32x16_bf16 v[48:63], a[0:3], v[16:19], 0
    ds_read_b128 v[16:19], v4 offset:2048
    s_waitcnt lgkmcnt(7)
    v_mfma_f32_32x32x16_bf16 v[48:63], a[4:7], v[20:23], v[48:63]
    ds_read_b128 v[20:23], v5 offset:2048
    buffer_load_dwordx4 v8, s[68:71], s23 offen lds
    s_add_u32 m0, m0, 1024
    s_add_u32 s23, s23, 128
    s_waitcnt lgkmcnt(7)
    v_mfma_f32_32x32x16_bf16 v[48:63], a[8:11], v[24:27], v[48:63]
    ds_read_b128 v[24:27], v6 offset:2048
    s_waitcnt lgkmcnt(7)
    v_mfma_f32_32x32x16_bf16 v[48:63], a[12:15], v[28:31], v[48:63]
    ds_read_b128 v[28:31], v7 offset:2048
    s_waitcnt lgkmcnt(7)
    v_mfma_f32_32x32x16_bf16 v[48:63], a[16:19], v[32:35], v[48:63]
    ds_read_b128 v[32:35], v4 offset:3072
    buffer_load_dwordx4 v8, s[68:71], s23 offen lds
    s_add_u32 m0, m0, 1024
    s_add_u32 s23, s23, 128
    s_waitcnt lgkmcnt(7)
    v_mfma_f32_32x32x16_bf16 v[48:63], a[20:23], v[36:39], v[48:63]
    ds_read_b128 v[36:39], v5 offset:3072
    s_waitcnt lgkmcnt(7)
    v_mfma_f32_32x32x16_bf16 v[48:63], a[24:27], v[40:43], v[48:63]
    ds_read_b128 v[40:43], v6 offset:3072
    s_waitcnt lgkmcnt(7)
    v_mfma_f32_32x32x16_bf16 v[48:63], a[28:31], v[44:47], v[48:63]
    ds_read_b128 v[44:47], v7 offset:3072
    buffer_load_dwordx4 v8, s[68:71], s23 offen lds
    s_add_u32 m0, m0, 1024
    s_add_u32 s23, s23, 128
    s_waitcnt lgkmcnt(7)
    v_mfma_f32_32x32x16_bf16 v[48:63], a[32:35], v[16:19], v[48:63]
    ds_read_b128 v[16:19], v4 offset:4096
    s_waitcnt lgkmcnt(7)
    v_mfma_f32_32x32x16_bf16 v[48:63], a[36:39], v[20:23], v[48:63]
    ds_read_b128 v[20:23], v5 offset:4096
    s_waitcnt lgkmcnt(7)
    v_mfma_f32_32x32x16_bf16 v[48:63], a[40:43], v[24:27], v[48:63]
    ds_read_b128 v[24:27], v6 offset:4096
    buffer_load_dwordx4 v8, s[68:71], s23 offen lds
    s_add_u32 m0, m0, 1024
    s_add_u32 s23, s23, 128
    s_waitcnt lgkmcnt(7)
    v_mfma_f32_32x32x16_bf16 v[48:63], a[44:47], v[28:31], v[48:63]
    ds_read_b128 v[28:31], v7 offset:4096
    s_waitcnt lgkmcnt(7)
    v_mfma_f32_32x32x16_bf16 v[48:63], a[48:51], v[32:35], v[48:63]
    ds_read_b128 v[32:35], v4 offset:5120
    s_waitcnt lgkmcnt(7)
    v_mfma_f32_32x32x16_bf16 v[48:63], a[52:55], v[36:39], v[48:63]
    ds_read_b128 v[36:39], v5 offset:5120
    buffer_load_dwordx4 v8, s[68:71], s23 offen lds
    s_add_u32 m0, m0, 1024
    s_add_u32 s23, s23, 128
    s_waitcnt lgkmcnt(7)
    v_mfma_f32_32x32x16_bf16 v[48:63], a[56:59], v[40:43], v[48:63]
    ds_read_b128 v[40:43], v6 offset:5120
    s_waitcnt lgkmcnt(7)
    v_mfma_f32_32x32x16_bf16 v[48:63], a[60:63], v[44:47], v[48:63]
    ds_read_b128 v[44:47], v7 offset:5120
    s_waitcnt lgkmcnt(7)
    v_mfma_f32_32x32x16_bf16 v[48:63], a[64:67], v[16:19], v[48:63]
    ds_read_b128 v[16:19], v4 offset:6144
    buffer_load_dwordx4 v8, s[68:71], s23 offen lds
    s_add_u32 m0, m0, 1024
    s_add_u32 s23, s23, 128
    s_waitcnt lgkmcnt(7)
    v_mfma_f32_32x32x16_bf16 v[48:63], a[68:71], v[20:23], v[48:63]
    ds_read_b128 v[20:23], v5 offset:6144
    s_waitcnt lgkmcnt(7)
    v_mfma_f32_32x32x16_bf16 v[48:63], a[72:75], v[24:27], v[48:63]
    ds_read_b128 v[24:27], v6 offset:6144
    s_waitcnt lgkmcnt(7)
    v_mfma_f32_32x32x16_bf16 v[48:63], a[76:79], v[28:31], v[48:63]
    buffer_load_dwordx4 v8, s[68:71], s23 offen lds
    s_add_u32 m0, m0, 1024
    s_add_u32 s23, s23, 128
    ds_read_b128 v[28:31], v7 offset:6144
    s_waitcnt lgkmcnt(7)
    v_mfma_f32_32x32x16_bf16 v[48:63], a[80:83], v[32:35], v[48:63]
    ds_read_b128 v[32:35], v4 offset:7168
    s_waitcnt lgkmcnt(7)
    v_mfma_f32_32x32x16_bf16 v[48:63], a[84:87], v[36:39], v[48:63]
    ds_read_b128 v[36:39], v5 offset:7168
    s_waitcnt lgkmcnt(7)
    v_mfma_f32_32x32x16_bf16 v[48:63], a[88:91], v[40:43], v[48:63]
    buffer_load_dwordx4 v8, s[68:71], s23 offen lds
    s_add_u32 m0, m0, 1024
    s_add_u32 s23, s23, 128
    ds_read_b128 v[40:43], v6 offset:7168
    s_waitcnt lgkmcnt(7)
    v_mfma_f32_32x32x16_bf16 v[48:63], a[92:95], v[44:47], v[48:63]
    ds_read_b128 v[44:47], v7 offset:7168
    s_waitcnt lgkmcnt(7)
    v_mfma_f32_32x32x16_bf16 v[48:63], a[96:99], v[16:19], v[48:63]
    ds_read_b128 v[16:19], v4 offset:8192
    s_waitcnt lgkmcnt(7)
    v_mfma_f32_32x32x16_bf16 v[48:63], a[100:103], v[20:23], v[48:63]
    buffer_load_dwordx4 v8, s[68:71], s23 offen lds
    ds_read_b128 v[20:23], v5 offset:8192
    s_waitcnt lgkmcnt(7)
    v_mfma_f32_32x32x16_bf16 v[48:63], a[104:107], v[24:27], v[48:63]
    ds_read_b128 v[24:27], v6 offset:8192
    s_waitcnt lgkmcnt(7)
    v_mfma_f32_32x32x16_bf16 v[48:63], a[108:111], v[28:31], v[48:63]
    ds_read_b128 v[28:31], v7 offset:8192
    s_waitcnt lgkmcnt(7)
    v_mfma_f32_32x32x16_bf16 v[48:63], a[112:115], v[32:35], v[48:63]
    s_waitcnt lgkmcnt(6)
    v_mfma_f32_32x32x16_bf16 v[48:63], a[116:119], v[36:39], v[48:63]
    s_waitcnt lgkmcnt(5)
    v_mfma_f32_32x32x16_bf16 v[48:63], a[120:123], v[40:43], v[48:63]
    s_waitcnt lgkmcnt(4)
    v_mfma_f32_32x32x16_bf16 v[48:63], a[124:127], v[44:47], v[48:63]
    s_waitcnt lgkmcnt(3)
    v_mfma_f32_32x32x16_bf16 v[48:63], a[128:131], v[16:19], v[48:63]
    s_waitcnt lgkmcnt(2)
    v_mfma_f32_32x32x16_bf16 v[48:63], a[132:135], v[20:23], v[48:63]
    s_waitcnt lgkmcnt(1)
    v_mfma_f32_32x32x16_bf16 v[48:63], a[136:139], v[24:27], v[48:63]
    s_waitcnt lgkmcnt(0)
    v_mfma_f32_32x32x16_bf16 v[48:63], a[140:143], v[28:31], v[48:63]
    s_mov_b32 s48, s22
    s_add_u32 s22, s22, 6
    s_waitcnt vmcnt(9)
L_aqqk_lp:
    s_barrier
    s_add_u32 s28, s22, 12
    s_min_u32 s28, s28, 63
    s_mov_b32 s25, 0
    ds_read_b128 v[16:19], v4 offset:36864
    s_mul_i32 s17, s13, 9216
    s_add_u32 m0, s17, s25
    s_mul_i32 s23, s28, 36864
    ds_read_b128 v[20:23], v5 offset:36864
    v_mul_f32 v48, s31, v48
    v_mul_f32 v49, s31, v49
    v_mul_f32 v50, s31, v50
    ds_read_b128 v[24:27], v6 offset:36864
    v_mul_f32 v51, s31, v51
    v_mul_f32 v52, s31, v52
    v_mul_f32 v53, s31, v53
    ds_read_b128 v[28:31], v7 offset:36864
    v_mul_f32 v54, s31, v54
    v_mul_f32 v55, s31, v55
    v_mul_f32 v56, s31, v56
    ds_read_b128 v[32:35], v4 offset:37888
    v_mul_f32 v57, s31, v57
    v_mul_f32 v58, s31, v58
    v_mul_f32 v59, s31, v59
    ds_read_b128 v[36:39], v5 offset:37888
    v_mul_f32 v60, s31, v60
    v_mul_f32 v61, s31, v61
    v_mul_f32 v62, s31, v62
    ds_read_b128 v[40:43], v6 offset:37888
    v_mul_f32 v63, s31, v63
    v_cvt_pk_bf16_f32 v64, v48, v49
    v_mad_u32_u24 v88, v80, s48, v72
    ds_read_b128 v[44:47], v7 offset:37888
    v_cvt_pk_bf16_f32 v65, v50, v51
    v_mad_u32_u24 v89, v81, s48, v73
    v_cvt_pk_bf16_f32 v66, v52, v53
    v_mad_u32_u24 v90, v82, s48, v74
    v_cvt_pk_bf16_f32 v67, v54, v55
    v_mad_u32_u24 v91, v83, s48, v75
    v_cvt_pk_bf16_f32 v68, v56, v57
    v_mad_u32_u24 v92, v84, s48, v76
    v_cvt_pk_bf16_f32 v69, v58, v59
    v_mad_u32_u24 v93, v85, s48, v77
    v_cvt_pk_bf16_f32 v70, v60, v61
    v_mad_u32_u24 v94, v86, s48, v78
    v_cvt_pk_bf16_f32 v71, v62, v63
    v_mad_u32_u24 v95, v87, s48, v79
    s_waitcnt lgkmcnt(7)
    v_mfma_f32_32x32x16_bf16 v[96:111], a[0:3], v[16:19], 0
    ds_read_b128 v[16:19], v4 offset:38912
    s_waitcnt lgkmcnt(7)
    v_mfma_f32_32x32x16_bf16 v[96:111], a[4:7], v[20:23], v[96:111]
    ds_read_b128 v[20:23], v5 offset:38912
    buffer_load_dwordx4 v8, s[68:71], s23 offen lds
    s_add_u32 m0, m0, 1024
    s_add_u32 s23, s23, 128
    s_waitcnt lgkmcnt(7)
    v_mfma_f32_32x32x16_bf16 v[96:111], a[8:11], v[24:27], v[96:111]
    ds_read_b128 v[24:27], v6 offset:38912
    s_waitcnt lgkmcnt(7)
    v_mfma_f32_32x32x16_bf16 v[96:111], a[12:15], v[28:31], v[96:111]
    ds_read_b128 v[28:31], v7 offset:38912
    s_waitcnt lgkmcnt(7)
    v_mfma_f32_32x32x16_bf16 v[96:111], a[16:19], v[32:35], v[96:111]
    ds_read_b128 v[32:35], v4 offset:39936
    buffer_load_dwordx4 v8, s[68:71], s23 offen lds
    s_add_u32 m0, m0, 1024
    s_add_u32 s23, s23, 128
    s_waitcnt lgkmcnt(7)
    v_mfma_f32_32x32x16_bf16 v[96:111], a[20:23], v[36:39], v[96:111]
    ds_read_b128 v[36:39], v5 offset:39936
    s_waitcnt lgkmcnt(7)
    v_mfma_f32_32x32x16_bf16 v[96:111], a[24:27], v[40:43], v[96:111]
    ds_read_b128 v[40:43], v6 offset:39936
    s_waitcnt lgkmcnt(7)
    v_mfma_f32_32x32x16_bf16 v[96:111], a[28:31], v[44:47], v[96:111]
    ds_read_b128 v[44:47], v7 offset:39936
    buffer_load_dwordx4 v8, s[68:71], s23 offen lds
    s_add_u32 m0, m0, 1024
    s_add_u32 s23, s23, 128
    s_waitcnt lgkmcnt(7)
    v_mfma_f32_32x32x16_bf16 v[96:111], a[32:35], v[16:19], v[96:111]
    ds_read_b128 v[16:19], v4 offset:40960
    s_waitcnt lgkmcnt(7)
    v_mfma_f32_32x32x16_bf16 v[96:111], a[36:39], v[20:23], v[96:111]
    ds_read_b128 v[20:23], v5 offset:40960
    s_waitcnt lgkmcnt(7)
    v_mfma_f32_32x32x16_bf16 v[96:111], a[40:43], v[24:27], v[96:111]
    ds_read_b128 v[24:27], v6 offset:40960
    buffer_load_dwordx4 v8, s[68:71], s23 offen lds
    s_add_u32 m0, m0, 1024
    s_add_u32 s23, s23, 128
    s_waitcnt lgkmcnt(7)
    v_mfma_f32_32x32x16_bf16 v[96:111], a[44:47], v[28:31], v[96:111]
    ds_read_b128 v[28:31], v7 offset:40960
    s_waitcnt lgkmcnt(7)
    v_mfma_f32_32x32x16_bf16 v[96:111], a[48:51], v[32:35], v[96:111]
    ds_read_b128 v[32:35], v4 offset:41984
    s_waitcnt lgkmcnt(7)
    v_mfma_f32_32x32x16_bf16 v[96:111], a[52:55], v[36:39], v[96:111]
    ds_read_b128 v[36:39], v5 offset:41984
    buffer_load_dwordx4 v8, s[68:71], s23 offen lds
    s_add_u32 m0, m0, 1024
    s_add_u32 s23, s23, 128
    s_waitcnt lgkmcnt(7)
    v_mfma_f32_32x32x16_bf16 v[96:111], a[56:59], v[40:43], v[96:111]
    ds_read_b128 v[40:43], v6 offset:41984
    s_waitcnt lgkmcnt(7)
    v_mfma_f32_32x32x16_bf16 v[96:111], a[60:63], v[44:47], v[96:111]
    ds_read_b128 v[44:47], v7 offset:41984
    s_waitcnt lgkmcnt(7)
    v_mfma_f32_32x32x16_bf16 v[96:111], a[64:67], v[16:19], v[96:111]
    ds_read_b128 v[16:19], v4 offset:43008
    buffer_load_dwordx4 v8, s[68:71], s23 offen lds
    s_add_u32 m0, m0, 1024
    s_add_u32 s23, s23, 128
    s_waitcnt lgkmcnt(7)
    v_mfma_f32_32x32x16_bf16 v[96:111], a[68:71], v[20:23], v[96:111]
    ds_read_b128 v[20:23], v5 offset:43008
    s_waitcnt lgkmcnt(7)
    v_mfma_f32_32x32x16_bf16 v[96:111], a[72:75], v[24:27], v[96:111]
    ds_read_b128 v[24:27], v6 offset:43008
    s_waitcnt lgkmcnt(7)
    v_mfma_f32_32x32x16_bf16 v[96:111], a[76:79], v[28:31], v[96:111]
    buffer_load_dwordx4 v8, s[68:71], s23 offen lds
    s_add_u32 m0, m0, 1024
    s_add_u32 s23, s23, 128
    ds_read_b128 v[28:31], v7 offset:43008
    s_waitcnt lgkmcnt(7)
    v_mfma_f32_32x32x16_bf16 v[96:111], a[80:83], v[32:35], v[96:111]
    ds_read_b128 v[32:35], v4 offset:44032
    s_waitcnt lgkmcnt(7)
    v_mfma_f32_32x32x16_bf16 v[96:111], a[84:87], v[36:39], v[96:111]
    ds_read_b128 v[36:39], v5 offset:44032
    s_waitcnt lgkmcnt(7)
    v_mfma_f32_32x32x16_bf16 v[96:111], a[88:91], v[40:43], v[96:111]
    buffer_load_dwordx4 v8, s[68:71], s23 offen lds
    s_add_u32 m0, m0, 1024
    s_add_u32 s23, s23, 128
    ds_read_b128 v[40:43], v6 offset:44032
    s_waitcnt lgkmcnt(7)
    v_mfma_f32_32x32x16_bf16 v[96:111], a[92:95], v[44:47], v[96:111]
    ds_read_b128 v[44:47], v7 offset:44032
    s_waitcnt lgkmcnt(7)
    v_mfma_f32_32x32x16_bf16 v[96:111], a[96:99], v[16:19], v[96:111]
    ds_read_b128 v[16:19], v4 offset:45056
    s_waitcnt lgkmcnt(7)
    v_mfma_f32_32x32x16_bf16 v[96:111], a[100:103], v[20:23], v[96:111]
    buffer_load_dwordx4 v8, s[68:71], s23 offen lds
    ds_read_b128 v[20:23], v5 offset:45056
    s_waitcnt lgkmcnt(7)
    v_mfma_f32_32x32x16_bf16 v[96:111], a[104:107], v[24:27], v[96:111]
    ds_read_b128 v[24:27], v6 offset:45056
    buffer_store_dword v64, v88, s[4:7], s33 offen
    s_waitcnt lgkmcnt(7)
    v_mfma_f32_32x32x16_bf16 v[96:111], a[108:111], v[28:31], v[96:111]
    buffer_store_dword v65, v89, s[4:7], s33 offen
    ds_read_b128 v[28:31], v7 offset:45056
    buffer_store_dword v66, v90, s[4:7], s33 offen
    s_waitcnt lgkmcnt(7)
    v_mfma_f32_32x32x16_bf16 v[96:111], a[112:115], v[32:35], v[96:111]
    buffer_store_dword v67, v91, s[4:7], s33 offen
    s_waitcnt lgkmcnt(6)
    v_mfma_f32_32x32x16_bf16 v[96:111], a[116:119], v[36:39], v[96:111]
    buffer_store_dword v68, v92, s[4:7], s33 offen
    buffer_store_dword v69, v93, s[4:7], s33 offen
    s_waitcnt lgkmcnt(5)
    v_mfma_f32_32x32x16_bf16 v[96:111], a[120:123], v[40:43], v[96:111]
    buffer_store_dword v70, v94, s[4:7], s33 offen
    buffer_store_dword v71, v95, s[4:7], s33 offen
    s_waitcnt lgkmcnt(4)
    v_mfma_f32_32x32x16_bf16 v[96:111], a[124:127], v[44:47], v[96:111]
    s_waitcnt lgkmcnt(3)
    v_mfma_f32_32x32x16_bf16 v[96:111], a[128:131], v[16:19], v[96:111]
    s_waitcnt lgkmcnt(2)
    v_mfma_f32_32x32x16_bf16 v[96:111], a[132:135], v[20:23], v[96:111]
    s_waitcnt lgkmcnt(1)
    v_mfma_f32_32x32x16_bf16 v[96:111], a[136:139], v[24:27], v[96:111]
    s_waitcnt lgkmcnt(0)
    v_mfma_f32_32x32x16_bf16 v[96:111], a[140:143], v[28:31], v[96:111]
    s_add_u32 s26, s26, 1
    s_mov_b32 s48, s22
    s_add_u32 s22, s22, 6
    s_cmp_gt_u32 s22, 63
    s_cbranch_scc1 L_aqqk_end1
    s_waitcnt vmcnt(17)
    s_barrier
    s_add_u32 s28, s22, 12
    s_min_u32 s28, s28, 63
    s_mov_b32 s25, 36864
    ds_read_b128 v[16:19], v248 offset:8192
    s_mul_i32 s17, s13, 9216
    s_add_u32 m0, s17, s25
    s_mul_i32 s23, s28, 36864
    ds_read_b128 v[20:23], v249 offset:8192
    v_mul_f32 v96, s31, v96
    v_mul_f32 v97, s31, v97
    v_mul_f32 v98, s31, v98
    ds_read_b128 v[24:27], v250 offset:8192
    v_mul_f32 v99, s31, v99
    v_mul_f32 v100, s31, v100
    v_mul_f32 v101, s31, v101
    ds_read_b128 v[28:31], v251 offset:8192
    v_mul_f32 v102, s31, v102
    v_mul_f32 v103, s31, v103
    v_mul_f32 v104, s31, v104
    ds_read_b128 v[32:35], v248 offset:9216
    v_mul_f32 v105, s31, v105
    v_mul_f32 v106, s31, v106
    v_mul_f32 v107, s31, v107
    ds_read_b128 v[36:39], v249 offset:9216
    v_mul_f32 v108, s31, v108
    v_mul_f32 v109, s31, v109
    v_mul_f32 v110, s31, v110
    ds_read_b128 v[40:43], v250 offset:9216
    v_mul_f32 v111, s31, v111
    v_cvt_pk_bf16_f32 v64, v96, v97
    v_mad_u32_u24 v88, v80, s48, v72
    ds_read_b128 v[44:47], v251 offset:9216
    v_cvt_pk_bf16_f32 v65, v98, v99
    v_mad_u32_u24 v89, v81, s48, v73
    v_cvt_pk_bf16_f32 v66, v100, v101
    v_mad_u32_u24 v90, v82, s48, v74
    v_cvt_pk_bf16_f32 v67, v102, v103
    v_mad_u32_u24 v91, v83, s48, v75
    v_cvt_pk_bf16_f32 v68, v104, v105
    v_mad_u32_u24 v92, v84, s48, v76
    v_cvt_pk_bf16_f32 v69, v106, v107
    v_mad_u32_u24 v93, v85, s48, v77
    v_cvt_pk_bf16_f32 v70, v108, v109
    v_mad_u32_u24 v94, v86, s48, v78
    v_cvt_pk_bf16_f32 v71, v110, v111
    v_mad_u32_u24 v95, v87, s48, v79
    s_waitcnt lgkmcnt(7)
    v_mfma_f32_32x32x16_bf16 v[48:63], a[0:3], v[16:19], 0
    ds_read_b128 v[16:19], v248 offset:10240
    s_waitcnt lgkmcnt(7)
    v_mfma_f32_32x32x16_bf16 v[48:63], a[4:7], v[20:23], v[48:63]
    ds_read_b128 v[20:23], v249 offset:10240
    buffer_load_dwordx4 v8, s[68:71], s23 offen lds
    s_add_u32 m0, m0, 1024
    s_add_u32 s23, s23, 128
    s_waitcnt lgkmcnt(7)
    v_mfma_f32_32x32x16_bf16 v[48:63], a[8:11], v[24:27], v[48:63]
    ds_read_b128 v[24:27], v250 offset:10240
    s_waitcnt lgkmcnt(7)
    v_mfma_f32_32x32x16_bf16 v[48:63], a[12:15], v[28:31], v[48:63]
    ds_read_b128 v[28:31], v251 offset:10240
    s_waitcnt lgkmcnt(7)
    v_mfma_f32_32x32x16_bf16 v[48:63], a[16:19], v[32:35], v[48:63]
    ds_read_b128 v[32:35], v248 offset:11264
    buffer_load_dwordx4 v8, s[68:71], s23 offen lds
    s_add_u32 m0, m0, 1024
    s_add_u32 s23, s23, 128
    s_waitcnt lgkmcnt(7)
    v_mfma_f32_32x32x16_bf16 v[48:63], a[20:23], v[36:39], v[48:63]
    ds_read_b128 v[36:39], v249 offset:11264
    s_waitcnt lgkmcnt(7)
    v_mfma_f32_32x32x16_bf16 v[48:63], a[24:27], v[40:43], v[48:63]
    ds_read_b128 v[40:43], v250 offset:11264
    s_waitcnt lgkmcnt(7)
    v_mfma_f32_32x32x16_bf16 v[48:63], a[28:31], v[44:47], v[48:63]
    ds_read_b128 v[44:47], v251 offset:11264
    buffer_load_dwordx4 v8, s[68:71], s23 offen lds
    s_add_u32 m0, m0, 1024
    s_add_u32 s23, s23, 128
    s_waitcnt lgkmcnt(7)
    v_mfma_f32_32x32x16_bf16 v[48:63], a[32:35], v[16:19], v[48:63]
    ds_read_b128 v[16:19], v248 offset:12288
    s_waitcnt lgkmcnt(7)
    v_mfma_f32_32x32x16_bf16 v[48:63], a[36:39], v[20:23], v[48:63]
    ds_read_b128 v[20:23], v249 offset:12288
    s_waitcnt lgkmcnt(7)
    v_mfma_f32_32x32x16_bf16 v[48:63], a[40:43], v[24:27], v[48:63]
    ds_read_b128 v[24:27], v250 offset:12288
    buffer_load_dwordx4 v8, s[68:71], s23 offen lds
    s_add_u32 m0, m0, 1024
    s_add_u32 s23, s23, 128
    s_waitcnt lgkmcnt(7)
    v_mfma_f32_32x32x16_bf16 v[48:63], a[44:47], v[28:31], v[48:63]
    ds_read_b128 v[28:31], v251 offset:12288
    s_waitcnt lgkmcnt(7)
    v_mfma_f32_32x32x16_bf16 v[48:63], a[48:51], v[32:35], v[48:63]
    ds_read_b128 v[32:35], v248 offset:13312
    s_waitcnt lgkmcnt(7)
    v_mfma_f32_32x32x16_bf16 v[48:63], a[52:55], v[36:39], v[48:63]
    ds_read_b128 v[36:39], v249 offset:13312
    buffer_load_dwordx4 v8, s[68:71], s23 offen lds
    s_add_u32 m0, m0, 1024
    s_add_u32 s23, s23, 128
    s_waitcnt lgkmcnt(7)
    v_mfma_f32_32x32x16_bf16 v[48:63], a[56:59], v[40:43], v[48:63]
    ds_read_b128 v[40:43], v250 offset:13312
    s_waitcnt lgkmcnt(7)
    v_mfma_f32_32x32x16_bf16 v[48:63], a[60:63], v[44:47], v[48:63]
    ds_read_b128 v[44:47], v251 offset:13312
    s_waitcnt lgkmcnt(7)
    v_mfma_f32_32x32x16_bf16 v[48:63], a[64:67], v[16:19], v[48:63]
    ds_read_b128 v[16:19], v248 offset:14336
    buffer_load_dwordx4 v8, s[68:71], s23 offen lds
    s_add_u32 m0, m0, 1024
    s_add_u32 s23, s23, 128
    s_waitcnt lgkmcnt(7)
    v_mfma_f32_32x32x16_bf16 v[48:63], a[68:71], v[20:23], v[48:63]
    ds_read_b128 v[20:23], v249 offset:14336
    s_waitcnt lgkmcnt(7)
    v_mfma_f32_32x32x16_bf16 v[48:63], a[72:75], v[24:27], v[48:63]
    ds_read_b128 v[24:27], v250 offset:14336
    s_waitcnt lgkmcnt(7)
    v_mfma_f32_32x32x16_bf16 v[48:63], a[76:79], v[28:31], v[48:63]
    buffer_load_dwordx4 v8, s[68:71], s23 offen lds
    s_add_u32 m0, m0, 1024
    s_add_u32 s23, s23, 128
    ds_read_b128 v[28:31], v251 offset:14336
    s_waitcnt lgkmcnt(7)
    v_mfma_f32_32x32x16_bf16 v[48:63], a[80:83], v[32:35], v[48:63]
    ds_read_b128 v[32:35], v248 offset:15360
    s_waitcnt lgkmcnt(7)
    v_mfma_f32_32x32x16_bf16 v[48:63], a[84:87], v[36:39], v[48:63]
    ds_read_b128 v[36:39], v249 offset:15360
    s_waitcnt lgkmcnt(7)
    v_mfma_f32_32x32x16_bf16 v[48:63], a[88:91], v[40:43], v[48:63]
    buffer_load_dwordx4 v8, s[68:71], s23 offen lds
    s_add_u32 m0, m0, 1024
    s_add_u32 s23, s23, 128
    ds_read_b128 v[40:43], v250 offset:15360
    s_waitcnt lgkmcnt(7)
    v_mfma_f32_32x32x16_bf16 v[48:63], a[92:95], v[44:47], v[48:63]
    ds_read_b128 v[44:47], v251 offset:15360
    s_waitcnt lgkmcnt(7)
    v_mfma_f32_32x32x16_bf16 v[48:63], a[96:99], v[16:19], v[48:63]
    ds_read_b128 v[16:19], v248 offset:16384
    s_waitcnt lgkmcnt(7)
    v_mfma_f32_32x32x16_bf16 v[48:63], a[100:103], v[20:23], v[48:63]
    buffer_load_dwordx4 v8, s[68:71], s23 offen lds
    ds_read_b128 v[20:23], v249 offset:16384
    s_waitcnt lgkmcnt(7)
    v_mfma_f32_32x32x16_bf16 v[48:63], a[104:107], v[24:27], v[48:63]
    ds_read_b128 v[24:27], v250 offset:16384
    buffer_store_dword v64, v88, s[4:7], s33 offen
    s_waitcnt lgkmcnt(7)
    v_mfma_f32_32x32x16_bf16 v[48:63], a[108:111], v[28:31], v[48:63]
    buffer_store_dword v65, v89, s[4:7], s33 offen
    ds_read_b128 v[28:31], v251 offset:16384
    buffer_store_dword v66, v90, s[4:7], s33 offen
    s_waitcnt lgkmcnt(7)
    v_mfma_f32_32x32x16_bf16 v[48:63], a[112:115], v[32:35], v[48:63]
    buffer_store_dword v67, v91, s[4:7], s33 offen
    s_waitcnt lgkmcnt(6)
    v_mfma_f32_32x32x16_bf16 v[48:63], a[116:119], v[36:39], v[48:63]
    buffer_store_dword v68, v92, s[4:7], s33 offen
    buffer_store_dword v69, v93, s[4:7], s33 offen
    s_waitcnt lgkmcnt(5)
    v_mfma_f32_32x32x16_bf16 v[48:63], a[120:123], v[40:43], v[48:63]
    buffer_store_dword v70, v94, s[4:7], s33 offen
    buffer_store_dword v71, v95, s[4:7], s33 offen
    s_waitcnt lgkmcnt(4)
    v_mfma_f32_32x32x16_bf16 v[48:63], a[124:127], v[44:47], v[48:63]
    s_waitcnt lgkmcnt(3)
    v_mfma_f32_32x32x16_bf16 v[48:63], a[128:131], v[16:19], v[48:63]
    s_waitcnt lgkmcnt(2)
    v_mfma_f32_32x32x16_bf16 v[48:63], a[132:135], v[20:23], v[48:63]
    s_waitcnt lgkmcnt(1)
    v_mfma_f32_32x32x16_bf16 v[48:63], a[136:139], v[24:27], v[48:63]
    s_waitcnt lgkmcnt(0)
    v_mfma_f32_32x32x16_bf16 v[48:63], a[140:143], v[28:31], v[48:63]
    s_add_u32 s26, s26, 1
    s_mov_b32 s48, s22
    s_add_u32 s22, s22, 6
    s_cmp_gt_u32 s22, 63
    s_cbranch_scc1 L_aqqk_end0
    s_waitcnt vmcnt(17)
    s_barrier
    s_add_u32 s28, s22, 12
    s_min_u32 s28, s28, 63
    s_mov_b32 s25, 73728
    ds_read_b128 v[16:19], v4 offset:0
    s_mul_i32 s17, s13, 9216
    s_add_u32 m0, s17, s25
    s_mul_i32 s23, s28, 36864
    ds_read_b128 v[20:23], v5 offset:0
    v_mul_f32 v48, s31, v48
    v_mul_f32 v49, s31, v49
    v_mul_f32 v50, s31, v50
    ds_read_b128 v[24:27], v6 offset:0
    v_mul_f32 v51, s31, v51
    v_mul_f32 v52, s31, v52
    v_mul_f32 v53, s31, v53
    ds_read_b128 v[28:31], v7 offset:0
    v_mul_f32 v54, s31, v54
    v_mul_f32 v55, s31, v55
    v_mul_f32 v56, s31, v56
    ds_read_b128 v[32:35], v4 offset:1024
    v_mul_f32 v57, s31, v57
    v_mul_f32 v58, s31, v58
    v_mul_f32 v59, s31, v59
    ds_read_b128 v[36:39], v5 offset:1024
    v_mul_f32 v60, s31, v60
    v_mul_f32 v61, s31, v61
    v_mul_f32 v62, s31, v62
    ds_read_b128 v[40:43], v6 offset:1024
    v_mul_f32 v63, s31, v63
    v_cvt_pk_bf16_f32 v64, v48, v49
    v_mad_u32_u24 v88, v80, s48, v72
    ds_read_b128 v[44:47], v7 offset:1024
    v_cvt_pk_bf16_f32 v65, v50, v51
    v_mad_u32_u24 v89, v81, s48, v73
    v_cvt_pk_bf16_f32 v66, v52, v53
    v_mad_u32_u24 v90, v82, s48, v74
    v_cvt_pk_bf16_f32 v67, v54, v55
    v_mad_u32_u24 v91, v83, s48, v75
    v_cvt_pk_bf16_f32 v68, v56, v57
    v_mad_u32_u24 v92, v84, s48, v76
    v_cvt_pk_bf16_f32 v69, v58, v59
    v_mad_u32_u24 v93, v85, s48, v77
    v_cvt_pk_bf16_f32 v70, v60, v61
    v_mad_u32_u24 v94, v86, s48, v78
    v_cvt_pk_bf16_f32 v71, v62, v63
    v_mad_u32_u24 v95, v87, s48, v79
    s_waitcnt lgkmcnt(7)
    v_mfma_f32_32x32x16_bf16 v[96:111], a[0:3], v[16:19], 0
    ds_read_b128 v[16:19], v4 offset:2048
    s_waitcnt lgkmcnt(7)
    v_mfma_f32_32x32x16_bf16 v[96:111], a[4:7], v[20:23], v[96:111]
    ds_read_b128 v[20:23], v5 offset:2048
    buffer_load_dwordx4 v8, s[68:71], s23 offen lds
    s_add_u32 m0, m0, 1024
    s_add_u32 s23, s23, 128
    s_waitcnt lgkmcnt(7)
    v_mfma_f32_32x32x16_bf16 v[96:111], a[8:11], v[24:27], v[96:111]
    ds_read_b128 v[24:27], v6 offset:2048
    s_waitcnt lgkmcnt(7)
    v_mfma_f32_32x32x16_bf16 v[96:111], a[12:15], v[28:31], v[96:111]
    ds_read_b128 v[28:31], v7 offset:2048
    s_waitcnt lgkmcnt(7)
    v_mfma_f32_32x32x16_bf16 v[96:111], a[16:19], v[32:35], v[96:111]
    ds_read_b128 v[32:35], v4 offset:3072
    buffer_load_dwordx4 v8, s[68:71], s23 offen lds
    s_add_u32 m0, m0, 1024
    s_add_u32 s23, s23, 128
    s_waitcnt lgkmcnt(7)
    v_mfma_f32_32x32x16_bf16 v[96:111], a[20:23], v[36:39], v[96:111]
    ds_read_b128 v[36:39], v5 offset:3072
    s_waitcnt lgkmcnt(7)
    v_mfma_f32_32x32x16_bf16 v[96:111], a[24:27], v[40:43], v[96:111]
    ds_read_b128 v[40:43], v6 offset:3072
    s_waitcnt lgkmcnt(7)
    v_mfma_f32_32x32x16_bf16 v[96:111], a[28:31], v[44:47], v[96:111]
    ds_read_b128 v[44:47], v7 offset:3072
    buffer_load_dwordx4 v8, s[68:71], s23 offen lds
    s_add_u32 m0, m0, 1024
    s_add_u32 s23, s23, 128
    s_waitcnt lgkmcnt(7)
    v_mfma_f32_32x32x16_bf16 v[96:111], a[32:35], v[16:19], v[96:111]
    ds_read_b128 v[16:19], v4 offset:4096
    s_waitcnt lgkmcnt(7)
    v_mfma_f32_32x32x16_bf16 v[96:111], a[36:39], v[20:23], v[96:111]
    ds_read_b128 v[20:23], v5 offset:4096
    s_waitcnt lgkmcnt(7)
    v_mfma_f32_32x32x16_bf16 v[96:111], a[40:43], v[24:27], v[96:111]
    ds_read_b128 v[24:27], v6 offset:4096
    buffer_load_dwordx4 v8, s[68:71], s23 offen lds
    s_add_u32 m0, m0, 1024
    s_add_u32 s23, s23, 128
    s_waitcnt lgkmcnt(7)
    v_mfma_f32_32x32x16_bf16 v[96:111], a[44:47], v[28:31], v[96:111]
    ds_read_b128 v[28:31], v7 offset:4096
    s_waitcnt lgkmcnt(7)
    v_mfma_f32_32x32x16_bf16 v[96:111], a[48:51], v[32:35], v[96:111]
    ds_read_b128 v[32:35], v4 offset:5120
    s_waitcnt lgkmcnt(7)
    v_mfma_f32_32x32x16_bf16 v[96:111], a[52:55], v[36:39], v[96:111]
    ds_read_b128 v[36:39], v5 offset:5120
    buffer_load_dwordx4 v8, s[68:71], s23 offen lds
    s_add_u32 m0, m0, 1024
    s_add_u32 s23, s23, 128
    s_waitcnt lgkmcnt(7)
    v_mfma_f32_32x32x16_bf16 v[96:111], a[56:59], v[40:43], v[96:111]
    ds_read_b128 v[40:43], v6 offset:5120
    s_waitcnt lgkmcnt(7)
    v_mfma_f32_32x32x16_bf16 v[96:111], a[60:63], v[44:47], v[96:111]
    ds_read_b128 v[44:47], v7 offset:5120
    s_waitcnt lgkmcnt(7)
    v_mfma_f32_32x32x16_bf16 v[96:111], a[64:67], v[16:19], v[96:111]
    ds_read_b128 v[16:19], v4 offset:6144
    buffer_load_dwordx4 v8, s[68:71], s23 offen lds
    s_add_u32 m0, m0, 1024
    s_add_u32 s23, s23, 128
    s_waitcnt lgkmcnt(7)
    v_mfma_f32_32x32x16_bf16 v[96:111], a[68:71], v[20:23], v[96:111]
    ds_read_b128 v[20:23], v5 offset:6144
    s_waitcnt lgkmcnt(7)
    v_mfma_f32_32x32x16_bf16 v[96:111], a[72:75], v[24:27], v[96:111]
    ds_read_b128 v[24:27], v6 offset:6144
    s_waitcnt lgkmcnt(7)
    v_mfma_f32_32x32x16_bf16 v[96:111], a[76:79], v[28:31], v[96:111]
    buffer_load_dwordx4 v8, s[68:71], s23 offen lds
    s_add_u32 m0, m0, 1024
    s_add_u32 s23, s23, 128
    ds_read_b128 v[28:31], v7 offset:6144
    s_waitcnt lgkmcnt(7)
    v_mfma_f32_32x32x16_bf16 v[96:111], a[80:83], v[32:35], v[96:111]
    ds_read_b128 v[32:35], v4 offset:7168
    s_waitcnt lgkmcnt(7)
    v_mfma_f32_32x32x16_bf16 v[96:111], a[84:87], v[36:39], v[96:111]
    ds_read_b128 v[36:39], v5 offset:7168
    s_waitcnt lgkmcnt(7)
    v_mfma_f32_32x32x16_bf16 v[96:111], a[88:91], v[40:43], v[96:111]
    buffer_load_dwordx4 v8, s[68:71], s23 offen lds
    s_add_u32 m0, m0, 1024
    s_add_u32 s23, s23, 128
    ds_read_b128 v[40:43], v6 offset:7168
    s_waitcnt lgkmcnt(7)
    v_mfma_f32_32x32x16_bf16 v[96:111], a[92:95], v[44:47], v[96:111]
    ds_read_b128 v[44:47], v7 offset:7168
    s_waitcnt lgkmcnt(7)
    v_mfma_f32_32x32x16_bf16 v[96:111], a[96:99], v[16:19], v[96:111]
    ds_read_b128 v[16:19], v4 offset:8192
    s_waitcnt lgkmcnt(7)
    v_mfma_f32_32x32x16_bf16 v[96:111], a[100:103], v[20:23], v[96:111]
    buffer_load_dwordx4 v8, s[68:71], s23 offen lds
    ds_read_b128 v[20:23], v5 offset:8192
    s_waitcnt lgkmcnt(7)
    v_mfma_f32_32x32x16_bf16 v[96:111], a[104:107], v[24:27], v[96:111]
    ds_read_b128 v[24:27], v6 offset:8192
    buffer_store_dword v64, v88, s[4:7], s33 offen
    s_waitcnt lgkmcnt(7)
    v_mfma_f32_32x32x16_bf16 v[96:111], a[108:111], v[28:31], v[96:111]
    buffer_store_dword v65, v89, s[4:7], s33 offen
    ds_read_b128 v[28:31], v7 offset:8192
    buffer_store_dword v66, v90, s[4:7], s33 offen
    s_waitcnt lgkmcnt(7)
    v_mfma_f32_32x32x16_bf16 v[96:111], a[112:115], v[32:35], v[96:111]
    buffer_store_dword v67, v91, s[4:7], s33 offen
    s_waitcnt lgkmcnt(6)
    v_mfma_f32_32x32x16_bf16 v[96:111], a[116:119], v[36:39], v[96:111]
    buffer_store_dword v68, v92, s[4:7], s33 offen
    buffer_store_dword v69, v93, s[4:7], s33 offen
    s_waitcnt lgkmcnt(5)
    v_mfma_f32_32x32x16_bf16 v[96:111], a[120:123], v[40:43], v[96:111]
    buffer_store_dword v70, v94, s[4:7], s33 offen
    buffer_store_dword v71, v95, s[4:7], s33 offen
    s_waitcnt lgkmcnt(4)
    v_mfma_f32_32x32x16_bf16 v[96:111], a[124:127], v[44:47], v[96:111]
    s_waitcnt lgkmcnt(3)
    v_mfma_f32_32x32x16_bf16 v[96:111], a[128:131], v[16:19], v[96:111]
    s_waitcnt lgkmcnt(2)
    v_mfma_f32_32x32x16_bf16 v[96:111], a[132:135], v[20:23], v[96:111]
    s_waitcnt lgkmcnt(1)
    v_mfma_f32_32x32x16_bf16 v[96:111], a[136:139], v[24:27], v[96:111]
    s_waitcnt lgkmcnt(0)
    v_mfma_f32_32x32x16_bf16 v[96:111], a[140:143], v[28:31], v[96:111]
    s_add_u32 s26, s26, 1
    s_mov_b32 s48, s22
    s_add_u32 s22, s22, 6
    s_cmp_gt_u32 s22, 63
    s_cbranch_scc1 L_aqqk_end1
    s_waitcnt vmcnt(17)
    s_barrier
    s_add_u32 s28, s22, 12
    s_min_u32 s28, s28, 63
    s_mov_b32 s25, 0
    ds_read_b128 v[16:19], v4 offset:36864
    s_mul_i32 s17, s13, 9216
    s_add_u32 m0, s17, s25
    s_mul_i32 s23, s28, 36864
    ds_read_b128 v[20:23], v5 offset:36864
    v_mul_f32 v96, s31, v96
    v_mul_f32 v97, s31, v97
    v_mul_f32 v98, s31, v98
    ds_read_b128 v[24:27], v6 offset:36864
    v_mul_f32 v99, s31, v99
    v_mul_f32 v100, s31, v100
    v_mul_f32 v101, s31, v101
    ds_read_b128 v[28:31], v7 offset:36864
    v_mul_f32 v102, s31, v102
    v_mul_f32 v103, s31, v103
    v_mul_f32 v104, s31, v104
    ds_read_b128 v[32:35], v4 offset:37888
    v_mul_f32 v105, s31, v105
    v_mul_f32 v106, s31, v106
    v_mul_f32 v107, s31, v107
    ds_read_b128 v[36:39], v5 offset:37888
    v_mul_f32 v108, s31, v108
    v_mul_f32 v109, s31, v109
    v_mul_f32 v110, s31, v110
    ds_read_b128 v[40:43], v6 offset:37888
    v_mul_f32 v111, s31, v111
    v_cvt_pk_bf16_f32 v64, v96, v97
    v_mad_u32_u24 v88, v80, s48, v72
    ds_read_b128 v[44:47], v7 offset:37888
    v_cvt_pk_bf16_f32 v65, v98, v99
    v_mad_u32_u24 v89, v81, s48, v73
    v_cvt_pk_bf16_f32 v66, v100, v101
    v_mad_u32_u24 v90, v82, s48, v74
    v_cvt_pk_bf16_f32 v67, v102, v103
    v_mad_u32_u24 v91, v83, s48, v75
    v_cvt_pk_bf16_f32 v68, v104, v105
    v_mad_u32_u24 v92, v84, s48, v76
    v_cvt_pk_bf16_f32 v69, v106, v107
    v_mad_u32_u24 v93, v85, s48, v77
    v_cvt_pk_bf16_f32 v70, v108, v109
    v_mad_u32_u24 v94, v86, s48, v78
    v_cvt_pk_bf16_f32 v71, v110, v111
    v_mad_u32_u24 v95, v87, s48, v79
    s_waitcnt lgkmcnt(7)
    v_mfma_f32_32x32x16_bf16 v[48:63], a[0:3], v[16:19], 0
    ds_read_b128 v[16:19], v4 offset:38912
    s_waitcnt lgkmcnt(7)
    v_mfma_f32_32x32x16_bf16 v[48:63], a[4:7], v[20:23], v[48:63]
    ds_read_b128 v[20:23], v5 offset:38912
    buffer_load_dwordx4 v8, s[68:71], s23 offen lds
    s_add_u32 m0, m0, 1024
    s_add_u32 s23, s23, 128
    s_waitcnt lgkmcnt(7)
    v_mfma_f32_32x32x16_bf16 v[48:63], a[8:11], v[24:27], v[48:63]
    ds_read_b128 v[24:27], v6 offset:38912
    s_waitcnt lgkmcnt(7)
    v_mfma_f32_32x32x16_bf16 v[48:63], a[12:15], v[28:31], v[48:63]
    ds_read_b128 v[28:31], v7 offset:38912
    s_waitcnt lgkmcnt(7)
    v_mfma_f32_32x32x16_bf16 v[48:63], a[16:19], v[32:35], v[48:63]
    ds_read_b128 v[32:35], v4 offset:39936
    buffer_load_dwordx4 v8, s[68:71], s23 offen lds
    s_add_u32 m0, m0, 1024
    s_add_u32 s23, s23, 128
    s_waitcnt lgkmcnt(7)
    v_mfma_f32_32x32x16_bf16 v[48:63], a[20:23], v[36:39], v[48:63]
    ds_read_b128 v[36:39], v5 offset:39936
    s_waitcnt lgkmcnt(7)
    v_mfma_f32_32x32x16_bf16 v[48:63], a[24:27], v[40:43], v[48:63]
    ds_read_b128 v[40:43], v6 offset:39936
    s_waitcnt lgkmcnt(7)
    v_mfma_f32_32x32x16_bf16 v[48:63], a[28:31], v[44:47], v[48:63]
    ds_read_b128 v[44:47], v7 offset:39936
    buffer_load_dwordx4 v8, s[68:71], s23 offen lds
    s_add_u32 m0, m0, 1024
    s_add_u32 s23, s23, 128
    s_waitcnt lgkmcnt(7)
    v_mfma_f32_32x32x16_bf16 v[48:63], a[32:35], v[16:19], v[48:63]
    ds_read_b128 v[16:19], v4 offset:40960
    s_waitcnt lgkmcnt(7)
    v_mfma_f32_32x32x16_bf16 v[48:63], a[36:39], v[20:23], v[48:63]
    ds_read_b128 v[20:23], v5 offset:40960
    s_waitcnt lgkmcnt(7)
    v_mfma_f32_32x32x16_bf16 v[48:63], a[40:43], v[24:27], v[48:63]
    ds_read_b128 v[24:27], v6 offset:40960
    buffer_load_dwordx4 v8, s[68:71], s23 offen lds
    s_add_u32 m0, m0, 1024
    s_add_u32 s23, s23, 128
    s_waitcnt lgkmcnt(7)
    v_mfma_f32_32x32x16_bf16 v[48:63], a[44:47], v[28:31], v[48:63]
    ds_read_b128 v[28:31], v7 offset:40960
    s_waitcnt lgkmcnt(7)
    v_mfma_f32_32x32x16_bf16 v[48:63], a[48:51], v[32:35], v[48:63]
    ds_read_b128 v[32:35], v4 offset:41984
    s_waitcnt lgkmcnt(7)
    v_mfma_f32_32x32x16_bf16 v[48:63], a[52:55], v[36:39], v[48:63]
    ds_read_b128 v[36:39], v5 offset:41984
    buffer_load_dwordx4 v8, s[68:71], s23 offen lds
    s_add_u32 m0, m0, 1024
    s_add_u32 s23, s23, 128
    s_waitcnt lgkmcnt(7)
    v_mfma_f32_32x32x16_bf16 v[48:63], a[56:59], v[40:43], v[48:63]
    ds_read_b128 v[40:43], v6 offset:41984
    s_waitcnt lgkmcnt(7)
    v_mfma_f32_32x32x16_bf16 v[48:63], a[60:63], v[44:47], v[48:63]
    ds_read_b128 v[44:47], v7 offset:41984
    s_waitcnt lgkmcnt(7)
    v_mfma_f32_32x32x16_bf16 v[48:63], a[64:67], v[16:19], v[48:63]
    ds_read_b128 v[16:19], v4 offset:43008
    buffer_load_dwordx4 v8, s[68:71], s23 offen lds
    s_add_u32 m0, m0, 1024
    s_add_u32 s23, s23, 128
    s_waitcnt lgkmcnt(7)
    v_mfma_f32_32x32x16_bf16 v[48:63], a[68:71], v[20:23], v[48:63]
    ds_read_b128 v[20:23], v5 offset:43008
    s_waitcnt lgkmcnt(7)
    v_mfma_f32_32x32x16_bf16 v[48:63], a[72:75], v[24:27], v[48:63]
    ds_read_b128 v[24:27], v6 offset:43008
    s_waitcnt lgkmcnt(7)
    v_mfma_f32_32x32x16_bf16 v[48:63], a[76:79], v[28:31], v[48:63]
    buffer_load_dwordx4 v8, s[68:71], s23 offen lds
    s_add_u32 m0, m0, 1024
    s_add_u32 s23, s23, 128
    ds_read_b128 v[28:31], v7 offset:43008
    s_waitcnt lgkmcnt(7)
    v_mfma_f32_32x32x16_bf16 v[48:63], a[80:83], v[32:35], v[48:63]
    ds_read_b128 v[32:35], v4 offset:44032
    s_waitcnt lgkmcnt(7)
    v_mfma_f32_32x32x16_bf16 v[48:63], a[84:87], v[36:39], v[48:63]
    ds_read_b128 v[36:39], v5 offset:44032
    s_waitcnt lgkmcnt(7)
    v_mfma_f32_32x32x16_bf16 v[48:63], a[88:91], v[40:43], v[48:63]
    buffer_load_dwordx4 v8, s[68:71], s23 offen lds
    s_add_u32 m0, m0, 1024
    s_add_u32 s23, s23, 128
    ds_read_b128 v[40:43], v6 offset:44032
    s_waitcnt lgkmcnt(7)
    v_mfma_f32_32x32x16_bf16 v[48:63], a[92:95], v[44:47], v[48:63]
    ds_read_b128 v[44:47], v7 offset:44032
    s_waitcnt lgkmcnt(7)
    v_mfma_f32_32x32x16_bf16 v[48:63], a[96:99], v[16:19], v[48:63]
    ds_read_b128 v[16:19], v4 offset:45056
    s_waitcnt lgkmcnt(7)
    v_mfma_f32_32x32x16_bf16 v[48:63], a[100:103], v[20:23], v[48:63]
    buffer_load_dwordx4 v8, s[68:71], s23 offen lds
    ds_read_b128 v[20:23], v5 offset:45056
    s_waitcnt lgkmcnt(7)
    v_mfma_f32_32x32x16_bf16 v[48:63], a[104:107], v[24:27], v[48:63]
    ds_read_b128 v[24:27], v6 offset:45056
    buffer_store_dword v64, v88, s[4:7], s33 offen
    s_waitcnt lgkmcnt(7)
    v_mfma_f32_32x32x16_bf16 v[48:63], a[108:111], v[28:31], v[48:63]
    buffer_store_dword v65, v89, s[4:7], s33 offen
    ds_read_b128 v[28:31], v7 offset:45056
    buffer_store_dword v66, v90, s[4:7], s33 offen
    s_waitcnt lgkmcnt(7)
    v_mfma_f32_32x32x16_bf16 v[48:63], a[112:115], v[32:35], v[48:63]
    buffer_store_dword v67, v91, s[4:7], s33 offen
    s_waitcnt lgkmcnt(6)
    v_mfma_f32_32x32x16_bf16 v[48:63], a[116:119], v[36:39], v[48:63]
    buffer_store_dword v68, v92, s[4:7], s33 offen
    buffer_store_dword v69, v93, s[4:7], s33 offen
    s_waitcnt lgkmcnt(5)
    v_mfma_f32_32x32x16_bf16 v[48:63], a[120:123], v[40:43], v[48:63]
    buffer_store_dword v70, v94, s[4:7], s33 offen
    buffer_store_dword v71, v95, s[4:7], s33 offen
    s_waitcnt lgkmcnt(4)
    v_mfma_f32_32x32x16_bf16 v[48:63], a[124:127], v[44:47], v[48:63]
    s_waitcnt lgkmcnt(3)
    v_mfma_f32_32x32x16_bf16 v[48:63], a[128:131], v[16:19], v[48:63]
    s_waitcnt lgkmcnt(2)
    v_mfma_f32_32x32x16_bf16 v[48:63], a[132:135], v[20:23], v[48:63]
    s_waitcnt lgkmcnt(1)
    v_mfma_f32_32x32x16_bf16 v[48:63], a[136:139], v[24:27], v[48:63]
    s_waitcnt lgkmcnt(0)
    v_mfma_f32_32x32x16_bf16 v[48:63], a[140:143], v[28:31], v[48:63]
    s_add_u32 s26, s26, 1
    s_mov_b32 s48, s22
    s_add_u32 s22, s22, 6
    s_cmp_gt_u32 s22, 63
    s_cbranch_scc1 L_aqqk_end0
    s_waitcnt vmcnt(17)
    s_barrier
    s_add_u32 s28, s22, 12
    s_min_u32 s28, s28, 63
    s_mov_b32 s25, 36864
    ds_read_b128 v[16:19], v248 offset:8192
    s_mul_i32 s17, s13, 9216
    s_add_u32 m0, s17, s25
    s_mul_i32 s23, s28, 36864
    ds_read_b128 v[20:23], v249 offset:8192
    v_mul_f32 v48, s31, v48
    v_mul_f32 v49, s31, v49
    v_mul_f32 v50, s31, v50
    ds_read_b128 v[24:27], v250 offset:8192
    v_mul_f32 v51, s31, v51
    v_mul_f32 v52, s31, v52
    v_mul_f32 v53, s31, v53
    ds_read_b128 v[28:31], v251 offset:8192
    v_mul_f32 v54, s31, v54
    v_mul_f32 v55, s31, v55
    v_mul_f32 v56, s31, v56
    ds_read_b128 v[32:35], v248 offset:9216
    v_mul_f32 v57, s31, v57
    v_mul_f32 v58, s31, v58
    v_mul_f32 v59, s31, v59
    ds_read_b128 v[36:39], v249 offset:9216
    v_mul_f32 v60, s31, v60
    v_mul_f32 v61, s31, v61
    v_mul_f32 v62, s31, v62
    ds_read_b128 v[40:43], v250 offset:9216
    v_mul_f32 v63, s31, v63
    v_cvt_pk_bf16_f32 v64, v48, v49
    v_mad_u32_u24 v88, v80, s48, v72
    ds_read_b128 v[44:47], v251 offset:9216
    v_cvt_pk_bf16_f32 v65, v50, v51
    v_mad_u32_u24 v89, v81, s48, v73
    v_cvt_pk_bf16_f32 v66, v52, v53
    v_mad_u32_u24 v90, v82, s48, v74
    v_cvt_pk_bf16_f32 v67, v54, v55
    v_mad_u32_u24 v91, v83, s48, v75
    v_cvt_pk_bf16_f32 v68, v56, v57
    v_mad_u32_u24 v92, v84, s48, v76
    v_cvt_pk_bf16_f32 v69, v58, v59
    v_mad_u32_u24 v93, v85, s48, v77
    v_cvt_pk_bf16_f32 v70, v60, v61
    v_mad_u32_u24 v94, v86, s48, v78
    v_cvt_pk_bf16_f32 v71, v62, v63
    v_mad_u32_u24 v95, v87, s48, v79
    s_waitcnt lgkmcnt(7)
    v_mfma_f32_32x32x16_bf16 v[96:111], a[0:3], v[16:19], 0
    ds_read_b128 v[16:19], v248 offset:10240
    s_waitcnt lgkmcnt(7)
    v_mfma_f32_32x32x16_bf16 v[96:111], a[4:7], v[20:23], v[96:111]
    ds_read_b128 v[20:23], v249 offset:10240
    buffer_load_dwordx4 v8, s[68:71], s23 offen lds
    s_add_u32 m0, m0, 1024
    s_add_u32 s23, s23, 128
    s_waitcnt lgkmcnt(7)
    v_mfma_f32_32x32x16_bf16 v[96:111], a[8:11], v[24:27], v[96:111]
    ds_read_b128 v[24:27], v250 offset:10240
    s_waitcnt lgkmcnt(7)
    v_mfma_f32_32x32x16_bf16 v[96:111], a[12:15], v[28:31], v[96:111]
    ds_read_b128 v[28:31], v251 offset:10240
    s_waitcnt lgkmcnt(7)
    v_mfma_f32_32x32x16_bf16 v[96:111], a[16:19], v[32:35], v[96:111]
    ds_read_b128 v[32:35], v248 offset:11264
    buffer_load_dwordx4 v8, s[68:71], s23 offen lds
    s_add_u32 m0, m0, 1024
    s_add_u32 s23, s23, 128
    s_waitcnt lgkmcnt(7)
    v_mfma_f32_32x32x16_bf16 v[96:111], a[20:23], v[36:39], v[96:111]
    ds_read_b128 v[36:39], v249 offset:11264
    s_waitcnt lgkmcnt(7)
    v_mfma_f32_32x32x16_bf16 v[96:111], a[24:27], v[40:43], v[96:111]
    ds_read_b128 v[40:43], v250 offset:11264
    s_waitcnt lgkmcnt(7)
    v_mfma_f32_32x32x16_bf16 v[96:111], a[28:31], v[44:47], v[96:111]
    ds_read_b128 v[44:47], v251 offset:11264
    buffer_load_dwordx4 v8, s[68:71], s23 offen lds
    s_add_u32 m0, m0, 1024
    s_add_u32 s23, s23, 128
    s_waitcnt lgkmcnt(7)
    v_mfma_f32_32x32x16_bf16 v[96:111], a[32:35], v[16:19], v[96:111]
    ds_read_b128 v[16:19], v248 offset:12288
    s_waitcnt lgkmcnt(7)
    v_mfma_f32_32x32x16_bf16 v[96:111], a[36:39], v[20:23], v[96:111]
    ds_read_b128 v[20:23], v249 offset:12288
    s_waitcnt lgkmcnt(7)
    v_mfma_f32_32x32x16_bf16 v[96:111], a[40:43], v[24:27], v[96:111]
    ds_read_b128 v[24:27], v250 offset:12288
    buffer_load_dwordx4 v8, s[68:71], s23 offen lds
    s_add_u32 m0, m0, 1024
    s_add_u32 s23, s23, 128
    s_waitcnt lgkmcnt(7)
    v_mfma_f32_32x32x16_bf16 v[96:111], a[44:47], v[28:31], v[96:111]
    ds_read_b128 v[28:31], v251 offset:12288
    s_waitcnt lgkmcnt(7)
    v_mfma_f32_32x32x16_bf16 v[96:111], a[48:51], v[32:35], v[96:111]
    ds_read_b128 v[32:35], v248 offset:13312
    s_waitcnt lgkmcnt(7)
    v_mfma_f32_32x32x16_bf16 v[96:111], a[52:55], v[36:39], v[96:111]
    ds_read_b128 v[36:39], v249 offset:13312
    buffer_load_dwordx4 v8, s[68:71], s23 offen lds
    s_add_u32 m0, m0, 1024
    s_add_u32 s23, s23, 128
    s_waitcnt lgkmcnt(7)
    v_mfma_f32_32x32x16_bf16 v[96:111], a[56:59], v[40:43], v[96:111]
    ds_read_b128 v[40:43], v250 offset:13312
    s_waitcnt lgkmcnt(7)
    v_mfma_f32_32x32x16_bf16 v[96:111], a[60:63], v[44:47], v[96:111]
    ds_read_b128 v[44:47], v251 offset:13312
    s_waitcnt lgkmcnt(7)
    v_mfma_f32_32x32x16_bf16 v[96:111], a[64:67], v[16:19], v[96:111]
    ds_read_b128 v[16:19], v248 offset:14336
    buffer_load_dwordx4 v8, s[68:71], s23 offen lds
    s_add_u32 m0, m0, 1024
    s_add_u32 s23, s23, 128
    s_waitcnt lgkmcnt(7)
    v_mfma_f32_32x32x16_bf16 v[96:111], a[68:71], v[20:23], v[96:111]
    ds_read_b128 v[20:23], v249 offset:14336
    s_waitcnt lgkmcnt(7)
    v_mfma_f32_32x32x16_bf16 v[96:111], a[72:75], v[24:27], v[96:111]
    ds_read_b128 v[24:27], v250 offset:14336
    s_waitcnt lgkmcnt(7)
    v_mfma_f32_32x32x16_bf16 v[96:111], a[76:79], v[28:31], v[96:111]
    buffer_load_dwordx4 v8, s[68:71], s23 offen lds
    s_add_u32 m0, m0, 1024
    s_add_u32 s23, s23, 128
    ds_read_b128 v[28:31], v251 offset:14336
    s_waitcnt lgkmcnt(7)
    v_mfma_f32_32x32x16_bf16 v[96:111], a[80:83], v[32:35], v[96:111]
    ds_read_b128 v[32:35], v248 offset:15360
    s_waitcnt lgkmcnt(7)
    v_mfma_f32_32x32x16_bf16 v[96:111], a[84:87], v[36:39], v[96:111]
    ds_read_b128 v[36:39], v249 offset:15360
    s_waitcnt lgkmcnt(7)
    v_mfma_f32_32x32x16_bf16 v[96:111], a[88:91], v[40:43], v[96:111]
    buffer_load_dwordx4 v8, s[68:71], s23 offen lds
    s_add_u32 m0, m0, 1024
    s_add_u32 s23, s23, 128
    ds_read_b128 v[40:43], v250 offset:15360
    s_waitcnt lgkmcnt(7)
    v_mfma_f32_32x32x16_bf16 v[96:111], a[92:95], v[44:47], v[96:111]
    ds_read_b128 v[44:47], v251 offset:15360
    s_waitcnt lgkmcnt(7)
    v_mfma_f32_32x32x16_bf16 v[96:111], a[96:99], v[16:19], v[96:111]
    ds_read_b128 v[16:19], v248 offset:16384
    s_waitcnt lgkmcnt(7)
    v_mfma_f32_32x32x16_bf16 v[96:111], a[100:103], v[20:23], v[96:111]
    buffer_load_dwordx4 v8, s[68:71], s23 offen lds
    ds_read_b128 v[20:23], v249 offset:16384
    s_waitcnt lgkmcnt(7)
    v_mfma_f32_32x32x16_bf16 v[96:111], a[104:107], v[24:27], v[96:111]
    ds_read_b128 v[24:27], v250 offset:16384
    buffer_store_dword v64, v88, s[4:7], s33 offen
    s_waitcnt lgkmcnt(7)
    v_mfma_f32_32x32x16_bf16 v[96:111], a[108:111], v[28:31], v[96:111]
    buffer_store_dword v65, v89, s[4:7], s33 offen
    ds_read_b128 v[28:31], v251 offset:16384
    buffer_store_dword v66, v90, s[4:7], s33 offen
    s_waitcnt lgkmcnt(7)
    v_mfma_f32_32x32x16_bf16 v[96:111], a[112:115], v[32:35], v[96:111]
    buffer_store_dword v67, v91, s[4:7], s33 offen
    s_waitcnt lgkmcnt(6)
    v_mfma_f32_32x32x16_bf16 v[96:111], a[116:119], v[36:39], v[96:111]
    buffer_store_dword v68, v92, s[4:7], s33 offen
    buffer_store_dword v69, v93, s[4:7], s33 offen
    s_waitcnt lgkmcnt(5)
    v_mfma_f32_32x32x16_bf16 v[96:111], a[120:123], v[40:43], v[96:111]
    buffer_store_dword v70, v94, s[4:7], s33 offen
    buffer_store_dword v71, v95, s[4:7], s33 offen
    s_waitcnt lgkmcnt(4)
    v_mfma_f32_32x32x16_bf16 v[96:111], a[124:127], v[44:47], v[96:111]
    s_waitcnt lgkmcnt(3)
    v_mfma_f32_32x32x16_bf16 v[96:111], a[128:131], v[16:19], v[96:111]
    s_waitcnt lgkmcnt(2)
    v_mfma_f32_32x32x16_bf16 v[96:111], a[132:135], v[20:23], v[96:111]
    s_waitcnt lgkmcnt(1)
    v_mfma_f32_32x32x16_bf16 v[96:111], a[136:139], v[24:27], v[96:111]
    s_waitcnt lgkmcnt(0)
    v_mfma_f32_32x32x16_bf16 v[96:111], a[140:143], v[28:31], v[96:111]
    s_add_u32 s26, s26, 1
    s_mov_b32 s48, s22
    s_add_u32 s22, s22, 6
    s_cmp_gt_u32 s22, 63
    s_cbranch_scc1 L_aqqk_end1
    s_waitcnt vmcnt(17)
    s_barrier
    s_add_u32 s28, s22, 12
    s_min_u32 s28, s28, 63
    s_mov_b32 s25, 73728
    ds_read_b128 v[16:19], v4 offset:0
    s_mul_i32 s17, s13, 9216
    s_add_u32 m0, s17, s25
    s_mul_i32 s23, s28, 36864
    ds_read_b128 v[20:23], v5 offset:0
    v_mul_f32 v96, s31, v96
    v_mul_f32 v97, s31, v97
    v_mul_f32 v98, s31, v98
    ds_read_b128 v[24:27], v6 offset:0
    v_mul_f32 v99, s31, v99
    v_mul_f32 v100, s31, v100
    v_mul_f32 v101, s31, v101
    ds_read_b128 v[28:31], v7 offset:0
    v_mul_f32 v102, s31, v102
    v_mul_f32 v103, s31, v103
    v_mul_f32 v104, s31, v104
    ds_read_b128 v[32:35], v4 offset:1024
    v_mul_f32 v105, s31, v105
    v_mul_f32 v106, s31, v106
    v_mul_f32 v107, s31, v107
    ds_read_b128 v[36:39], v5 offset:1024
    v_mul_f32 v108, s31, v108
    v_mul_f32 v109, s31, v109
    v_mul_f32 v110, s31, v110
    ds_read_b128 v[40:43], v6 offset:1024
    v_mul_f32 v111, s31, v111
    v_cvt_pk_bf16_f32 v64, v96, v97
    v_mad_u32_u24 v88, v80, s48, v72
    ds_read_b128 v[44:47], v7 offset:1024
    v_cvt_pk_bf16_f32 v65, v98, v99
    v_mad_u32_u24 v89, v81, s48, v73
    v_cvt_pk_bf16_f32 v66, v100, v101
    v_mad_u32_u24 v90, v82, s48, v74
    v_cvt_pk_bf16_f32 v67, v102, v103
    v_mad_u32_u24 v91, v83, s48, v75
    v_cvt_pk_bf16_f32 v68, v104, v105
    v_mad_u32_u24 v92, v84, s48, v76
    v_cvt_pk_bf16_f32 v69, v106, v107
    v_mad_u32_u24 v93, v85, s48, v77
    v_cvt_pk_bf16_f32 v70, v108, v109
    v_mad_u32_u24 v94, v86, s48, v78
    v_cvt_pk_bf16_f32 v71, v110, v111
    v_mad_u32_u24 v95, v87, s48, v79
    s_waitcnt lgkmcnt(7)
    v_mfma_f32_32x32x16_bf16 v[48:63], a[0:3], v[16:19], 0
    ds_read_b128 v[16:19], v4 offset:2048
    s_waitcnt lgkmcnt(7)
    v_mfma_f32_32x32x16_bf16 v[48:63], a[4:7], v[20:23], v[48:63]
    ds_read_b128 v[20:23], v5 offset:2048
    buffer_load_dwordx4 v8, s[68:71], s23 offen lds
    s_add_u32 m0, m0, 1024
    s_add_u32 s23, s23, 128
    s_waitcnt lgkmcnt(7)
    v_mfma_f32_32x32x16_bf16 v[48:63], a[8:11], v[24:27], v[48:63]
    ds_read_b128 v[24:27], v6 offset:2048
    s_waitcnt lgkmcnt(7)
    v_mfma_f32_32x32x16_bf16 v[48:63], a[12:15], v[28:31], v[48:63]
    ds_read_b128 v[28:31], v7 offset:2048
    s_waitcnt lgkmcnt(7)
    v_mfma_f32_32x32x16_bf16 v[48:63], a[16:19], v[32:35], v[48:63]
    ds_read_b128 v[32:35], v4 offset:3072
    buffer_load_dwordx4 v8, s[68:71], s23 offen lds
    s_add_u32 m0, m0, 1024
    s_add_u32 s23, s23, 128
    s_waitcnt lgkmcnt(7)
    v_mfma_f32_32x32x16_bf16 v[48:63], a[20:23], v[36:39], v[48:63]
    ds_read_b128 v[36:39], v5 offset:3072
    s_waitcnt lgkmcnt(7)
    v_mfma_f32_32x32x16_bf16 v[48:63], a[24:27], v[40:43], v[48:63]
    ds_read_b128 v[40:43], v6 offset:3072
    s_waitcnt lgkmcnt(7)
    v_mfma_f32_32x32x16_bf16 v[48:63], a[28:31], v[44:47], v[48:63]
    ds_read_b128 v[44:47], v7 offset:3072
    buffer_load_dwordx4 v8, s[68:71], s23 offen lds
    s_add_u32 m0, m0, 1024
    s_add_u32 s23, s23, 128
    s_waitcnt lgkmcnt(7)
    v_mfma_f32_32x32x16_bf16 v[48:63], a[32:35], v[16:19], v[48:63]
    ds_read_b128 v[16:19], v4 offset:4096
    s_waitcnt lgkmcnt(7)
    v_mfma_f32_32x32x16_bf16 v[48:63], a[36:39], v[20:23], v[48:63]
    ds_read_b128 v[20:23], v5 offset:4096
    s_waitcnt lgkmcnt(7)
    v_mfma_f32_32x32x16_bf16 v[48:63], a[40:43], v[24:27], v[48:63]
    ds_read_b128 v[24:27], v6 offset:4096
    buffer_load_dwordx4 v8, s[68:71], s23 offen lds
    s_add_u32 m0, m0, 1024
    s_add_u32 s23, s23, 128
    s_waitcnt lgkmcnt(7)
    v_mfma_f32_32x32x16_bf16 v[48:63], a[44:47], v[28:31], v[48:63]
    ds_read_b128 v[28:31], v7 offset:4096
    s_waitcnt lgkmcnt(7)
    v_mfma_f32_32x32x16_bf16 v[48:63], a[48:51], v[32:35], v[48:63]
    ds_read_b128 v[32:35], v4 offset:5120
    s_waitcnt lgkmcnt(7)
    v_mfma_f32_32x32x16_bf16 v[48:63], a[52:55], v[36:39], v[48:63]
    ds_read_b128 v[36:39], v5 offset:5120
    buffer_load_dwordx4 v8, s[68:71], s23 offen lds
    s_add_u32 m0, m0, 1024
    s_add_u32 s23, s23, 128
    s_waitcnt lgkmcnt(7)
    v_mfma_f32_32x32x16_bf16 v[48:63], a[56:59], v[40:43], v[48:63]
    ds_read_b128 v[40:43], v6 offset:5120
    s_waitcnt lgkmcnt(7)
    v_mfma_f32_32x32x16_bf16 v[48:63], a[60:63], v[44:47], v[48:63]
    ds_read_b128 v[44:47], v7 offset:5120
    s_waitcnt lgkmcnt(7)
    v_mfma_f32_32x32x16_bf16 v[48:63], a[64:67], v[16:19], v[48:63]
    ds_read_b128 v[16:19], v4 offset:6144
    buffer_load_dwordx4 v8, s[68:71], s23 offen lds
    s_add_u32 m0, m0, 1024
    s_add_u32 s23, s23, 128
    s_waitcnt lgkmcnt(7)
    v_mfma_f32_32x32x16_bf16 v[48:63], a[68:71], v[20:23], v[48:63]
    ds_read_b128 v[20:23], v5 offset:6144
    s_waitcnt lgkmcnt(7)
    v_mfma_f32_32x32x16_bf16 v[48:63], a[72:75], v[24:27], v[48:63]
    ds_read_b128 v[24:27], v6 offset:6144
    s_waitcnt lgkmcnt(7)
    v_mfma_f32_32x32x16_bf16 v[48:63], a[76:79], v[28:31], v[48:63]
    buffer_load_dwordx4 v8, s[68:71], s23 offen lds
    s_add_u32 m0, m0, 1024
    s_add_u32 s23, s23, 128
    ds_read_b128 v[28:31], v7 offset:6144
    s_waitcnt lgkmcnt(7)
    v_mfma_f32_32x32x16_bf16 v[48:63], a[80:83], v[32:35], v[48:63]
    ds_read_b128 v[32:35], v4 offset:7168
    s_waitcnt lgkmcnt(7)
    v_mfma_f32_32x32x16_bf16 v[48:63], a[84:87], v[36:39], v[48:63]
    ds_read_b128 v[36:39], v5 offset:7168
    s_waitcnt lgkmcnt(7)
    v_mfma_f32_32x32x16_bf16 v[48:63], a[88:91], v[40:43], v[48:63]
    buffer_load_dwordx4 v8, s[68:71], s23 offen lds
    s_add_u32 m0, m0, 1024
    s_add_u32 s23, s23, 128
    ds_read_b128 v[40:43], v6 offset:7168
    s_waitcnt lgkmcnt(7)
    v_mfma_f32_32x32x16_bf16 v[48:63], a[92:95], v[44:47], v[48:63]
    ds_read_b128 v[44:47], v7 offset:7168
    s_waitcnt lgkmcnt(7)
    v_mfma_f32_32x32x16_bf16 v[48:63], a[96:99], v[16:19], v[48:63]
    ds_read_b128 v[16:19], v4 offset:8192
    s_waitcnt lgkmcnt(7)
    v_mfma_f32_32x32x16_bf16 v[48:63], a[100:103], v[20:23], v[48:63]
    buffer_load_dwordx4 v8, s[68:71], s23 offen lds
    ds_read_b128 v[20:23], v5 offset:8192
    s_waitcnt lgkmcnt(7)
    v_mfma_f32_32x32x16_bf16 v[48:63], a[104:107], v[24:27], v[48:63]
    ds_read_b128 v[24:27], v6 offset:8192
    buffer_store_dword v64, v88, s[4:7], s33 offen
    s_waitcnt lgkmcnt(7)
    v_mfma_f32_32x32x16_bf16 v[48:63], a[108:111], v[28:31], v[48:63]
    buffer_store_dword v65, v89, s[4:7], s33 offen
    ds_read_b128 v[28:31], v7 offset:8192
    buffer_store_dword v66, v90, s[4:7], s33 offen
    s_waitcnt lgkmcnt(7)
    v_mfma_f32_32x32x16_bf16 v[48:63], a[112:115], v[32:35], v[48:63]
    buffer_store_dword v67, v91, s[4:7], s33 offen
    s_waitcnt lgkmcnt(6)
    v_mfma_f32_32x32x16_bf16 v[48:63], a[116:119], v[36:39], v[48:63]
    buffer_store_dword v68, v92, s[4:7], s33 offen
    buffer_store_dword v69, v93, s[4:7], s33 offen
    s_waitcnt lgkmcnt(5)
    v_mfma_f32_32x32x16_bf16 v[48:63], a[120:123], v[40:43], v[48:63]
    buffer_store_dword v70, v94, s[4:7], s33 offen
    buffer_store_dword v71, v95, s[4:7], s33 offen
    s_waitcnt lgkmcnt(4)
    v_mfma_f32_32x32x16_bf16 v[48:63], a[124:127], v[44:47], v[48:63]
    s_waitcnt lgkmcnt(3)
    v_mfma_f32_32x32x16_bf16 v[48:63], a[128:131], v[16:19], v[48:63]
    s_waitcnt lgkmcnt(2)
    v_mfma_f32_32x32x16_bf16 v[48:63], a[132:135], v[20:23], v[48:63]
    s_waitcnt lgkmcnt(1)
    v_mfma_f32_32x32x16_bf16 v[48:63], a[136:139], v[24:27], v[48:63]
    s_waitcnt lgkmcnt(0)
    v_mfma_f32_32x32x16_bf16 v[48:63], a[140:143], v[28:31], v[48:63]
    s_add_u32 s26, s26, 1
    s_mov_b32 s48, s22
    s_add_u32 s22, s22, 6
    s_cmp_gt_u32 s22, 63
    s_cbranch_scc1 L_aqqk_end0
    s_waitcnt vmcnt(17)
    s_branch L_aqqk_lp
L_aqqk_end0:
    s_nop 7
    s_nop 3
    v_mul_f32 v48, s31, v48
    v_mul_f32 v49, s31, v49
    v_mul_f32 v50, s31, v50
    v_mul_f32 v51, s31, v51
    v_mul_f32 v52, s31, v52
    v_mul_f32 v53, s31, v53
    v_mul_f32 v54, s31, v54
    v_mul_f32 v55, s31, v55
    v_mul_f32 v56, s31, v56
    v_mul_f32 v57, s31, v57
    v_mul_f32 v58, s31, v58
    v_mul_f32 v59, s31, v59
    v_mul_f32 v60, s31, v60
    v_mul_f32 v61, s31, v61
    v_mul_f32 v62, s31, v62
    v_mul_f32 v63, s31, v63
    v_cvt_pk_bf16_f32 v64, v48, v49
    v_mad_u32_u24 v88, v80, s48, v72
    v_cvt_pk_bf16_f32 v65, v50, v51
    v_mad_u32_u24 v89, v81, s48, v73
    v_cvt_pk_bf16_f32 v66, v52, v53
    v_mad_u32_u24 v90, v82, s48, v74
    v_cvt_pk_bf16_f32 v67, v54, v55
    v_mad_u32_u24 v91, v83, s48, v75
    v_cvt_pk_bf16_f32 v68, v56, v57
    v_mad_u32_u24 v92, v84, s48, v76
    v_cvt_pk_bf16_f32 v69, v58, v59
    v_mad_u32_u24 v93, v85, s48, v77
    v_cvt_pk_bf16_f32 v70, v60, v61
    v_mad_u32_u24 v94, v86, s48, v78
    v_cvt_pk_bf16_f32 v71, v62, v63
    v_mad_u32_u24 v95, v87, s48, v79
    buffer_store_dword v64, v88, s[4:7], s33 offen
    buffer_store_dword v65, v89, s[4:7], s33 offen
    buffer_store_dword v66, v90, s[4:7], s33 offen
    buffer_store_dword v67, v91, s[4:7], s33 offen
    buffer_store_dword v68, v92, s[4:7], s33 offen
    buffer_store_dword v69, v93, s[4:7], s33 offen
    buffer_store_dword v70, v94, s[4:7], s33 offen
    buffer_store_dword v71, v95, s[4:7], s33 offen
    s_branch L_aqqk_end
L_aqqk_end1:
    s_nop 7
    s_nop 3
    v_mul_f32 v96, s31, v96
    v_mul_f32 v97, s31, v97
    v_mul_f32 v98, s31, v98
    v_mul_f32 v99, s31, v99
    v_mul_f32 v100, s31, v100
    v_mul_f32 v101, s31, v101
    v_mul_f32 v102, s31, v102
    v_mul_f32 v103, s31, v103
    v_mul_f32 v104, s31, v104
    v_mul_f32 v105, s31, v105
    v_mul_f32 v106, s31, v106
    v_mul_f32 v107, s31, v107
    v_mul_f32 v108, s31, v108
    v_mul_f32 v109, s31, v109
    v_mul_f32 v110, s31, v110
    v_mul_f32 v111, s31, v111
    v_cvt_pk_bf16_f32 v64, v96, v97
    v_mad_u32_u24 v88, v80, s48, v72
    v_cvt_pk_bf16_f32 v65, v98, v99
    v_mad_u32_u24 v89, v81, s48, v73
    v_cvt_pk_bf16_f32 v66, v100, v101
    v_mad_u32_u24 v90, v82, s48, v74
    v_cvt_pk_bf16_f32 v67, v102, v103
    v_mad_u32_u24 v91, v83, s48, v75
    v_cvt_pk_bf16_f32 v68, v104, v105
    v_mad_u32_u24 v92, v84, s48, v76
    v_cvt_pk_bf16_f32 v69, v106, v107
    v_mad_u32_u24 v93, v85, s48, v77
    v_cvt_pk_bf16_f32 v70, v108, v109
    v_mad_u32_u24 v94, v86, s48, v78
    v_cvt_pk_bf16_f32 v71, v110, v111
    v_mad_u32_u24 v95, v87, s48, v79
    buffer_store_dword v64, v88, s[4:7], s33 offen
    buffer_store_dword v65, v89, s[4:7], s33 offen
    buffer_store_dword v66, v90, s[4:7], s33 offen
    buffer_store_dword v67, v91, s[4:7], s33 offen
    buffer_store_dword v68, v92, s[4:7], s33 offen
    buffer_store_dword v69, v93, s[4:7], s33 offen
    buffer_store_dword v70, v94, s[4:7], s33 offen
    buffer_store_dword v71, v95, s[4:7], s33 offen
L_aqqk_end:
    s_branch L_aq_done
        L_aq_v:
    s_cmp_ge_u32 s29, 54
    s_cbranch_scc1 L_aq_g
    s_sub_u32 s17, s29, 36
    s_lshl_b32 s17, s17, 5
    v_add_u32 v9, s17, v14
    v_mul_hi_u32 v10, v9, s32
    v_mul_u32_u24 v11, 18, v10
    v_sub_u32 v9, v9, v11
    v_mul_u32_u24 v11, 18, v13
    v_add_u32 v9, v9, v11
    v_lshlrev_b32 v9, 4, v9
    s_mov_b32 s17, 73728
    v_mul_lo_u32 v10, v10, s17
    v_add_u32 v72, v9, v10
    s_mov_b32 s25, 0
    s_mul_i32 s17, s13, 9216
    s_add_u32 m0, s17, s25
    s_mul_i32 s23, s22, 36864
    buffer_load_dwordx4 v8, s[68:71], s23 offen lds
    s_add_u32 m0, m0, 1024
    s_add_u32 s23, s23, 128
    buffer_load_dwordx4 v8, s[68:71], s23 offen lds
    s_add_u32 m0, m0, 1024
    s_add_u32 s23, s23, 128
    buffer_load_dwordx4 v8, s[68:71], s23 offen lds
    s_add_u32 m0, m0, 1024
    s_add_u32 s23, s23, 128
    buffer_load_dwordx4 v8, s[68:71], s23 offen lds
    s_add_u32 m0, m0, 1024
    s_add_u32 s23, s23, 128
    buffer_load_dwordx4 v8, s[68:71], s23 offen lds
    s_add_u32 m0, m0, 1024
    s_add_u32 s23, s23, 128
    buffer_load_dwordx4 v8, s[68:71], s23 offen lds
    s_add_u32 m0, m0, 1024
    s_add_u32 s23, s23, 128
    buffer_load_dwordx4 v8, s[68:71], s23 offen lds
    s_add_u32 m0, m0, 1024
    s_add_u32 s23, s23, 128
    buffer_load_dwordx4 v8, s[68:71], s23 offen lds
    s_add_u32 m0, m0, 1024
    s_add_u32 s23, s23, 128
    buffer_load_dwordx4 v8, s[68:71], s23 offen lds
    s_add_u32 s28, s22, 6
    s_min_u32 s28, s28, 63
    s_mov_b32 s25, 36864
    s_mul_i32 s17, s13, 9216
    s_add_u32 m0, s17, s25
    s_mul_i32 s23, s28, 36864
    buffer_load_dwordx4 v8, s[68:71], s23 offen lds
    s_add_u32 m0, m0, 1024
    s_add_u32 s23, s23, 128
    buffer_load_dwordx4 v8, s[68:71], s23 offen lds
    s_add_u32 m0, m0, 1024
    s_add_u32 s23, s23, 128
    buffer_load_dwordx4 v8, s[68:71], s23 offen lds
    s_add_u32 m0, m0, 1024
    s_add_u32 s23, s23, 128
    buffer_load_dwordx4 v8, s[68:71], s23 offen lds
    s_add_u32 m0, m0, 1024
    s_add_u32 s23, s23, 128
    buffer_load_dwordx4 v8, s[68:71], s23 offen lds
    s_add_u32 m0, m0, 1024
    s_add_u32 s23, s23, 128
    buffer_load_dwordx4 v8, s[68:71], s23 offen lds
    s_add_u32 m0, m0, 1024
    s_add_u32 s23, s23, 128
    buffer_load_dwordx4 v8, s[68:71], s23 offen lds
    s_add_u32 m0, m0, 1024
    s_add_u32 s23, s23, 128
    buffer_load_dwordx4 v8, s[68:71], s23 offen lds
    s_add_u32 m0, m0, 1024
    s_add_u32 s23, s23, 128
    buffer_load_dwordx4 v8, s[68:71], s23 offen lds
    s_mov_b32 s26, 0
    s_waitcnt vmcnt(9)
    s_barrier
    s_add_u32 s28, s22, 12
    s_min_u32 s28, s28, 63
    s_mov_b32 s25, 73728
    ds_read_b128 v[16:19], v4 offset:0
    s_mul_i32 s17, s13, 9216
    s_add_u32 m0, s17, s25
    s_mul_i32 s23, s28, 36864
    ds_read_b128 v[20:23], v5 offset:0
    ds_read_b128 v[24:27], v6 offset:0
    ds_read_b128 v[28:31], v7 offset:0
    ds_read_b128 v[32:35], v4 offset:1024
    ds_read_b128 v[36:39], v5 offset:1024
    ds_read_b128 v[40:43], v6 offset:1024
    ds_read_b128 v[44:47], v7 offset:1024
    s_waitcnt lgkmcnt(7)
    v_mfma_f32_32x32x16_bf16 v[48:63], v[16:19], a[0:3], 0
    ds_read_b128 v[16:19], v4 offset:2048
    s_waitcnt lgkmcnt(7)
    v_mfma_f32_32x32x16_bf16 v[48:63], v[20:23], a[4:7], v[48:63]
    ds_read_b128 v[20:23], v5 offset:2048
    buffer_load_dwordx4 v8, s[68:71], s23 offen lds
    s_add_u32 m0, m0, 1024
    s_add_u32 s23, s23, 128
    s_waitcnt lgkmcnt(7)
    v_mfma_f32_32x32x16_bf16 v[48:63], v[24:27], a[8:11], v[48:63]
    ds_read_b128 v[24:27], v6 offset:2048
    s_waitcnt lgkmcnt(7)
    v_mfma_f32_32x32x16_bf16 v[48:63], v[28:31], a[12:15], v[48:63]
    ds_read_b128 v[28:31], v7 offset:2048
    s_waitcnt lgkmcnt(7)
    v_mfma_f32_32x32x16_bf16 v[48:63], v[32:35], a[16:19], v[48:63]
    ds_read_b128 v[32:35], v4 offset:3072
    buffer_load_dwordx4 v8, s[68:71], s23 offen lds
    s_add_u32 m0, m0, 1024
    s_add_u32 s23, s23, 128
    s_waitcnt lgkmcnt(7)
    v_mfma_f32_32x32x16_bf16 v[48:63], v[36:39], a[20:23], v[48:63]
    ds_read_b128 v[36:39], v5 offset:3072
    s_waitcnt lgkmcnt(7)
    v_mfma_f32_32x32x16_bf16 v[48:63], v[40:43], a[24:27], v[48:63]
    ds_read_b128 v[40:43], v6 offset:3072
    s_waitcnt lgkmcnt(7)
    v_mfma_f32_32x32x16_bf16 v[48:63], v[44:47], a[28:31], v[48:63]
    ds_read_b128 v[44:47], v7 offset:3072
    buffer_load_dwordx4 v8, s[68:71], s23 offen lds
    s_add_u32 m0, m0, 1024
    s_add_u32 s23, s23, 128
    s_waitcnt lgkmcnt(7)
    v_mfma_f32_32x32x16_bf16 v[48:63], v[16:19], a[32:35], v[48:63]
    ds_read_b128 v[16:19], v4 offset:4096
    s_waitcnt lgkmcnt(7)
    v_mfma_f32_32x32x16_bf16 v[48:63], v[20:23], a[36:39], v[48:63]
    ds_read_b128 v[20:23], v5 offset:4096
    s_waitcnt lgkmcnt(7)
    v_mfma_f32_32x32x16_bf16 v[48:63], v[24:27], a[40:43], v[48:63]
    ds_read_b128 v[24:27], v6 offset:4096
    buffer_load_dwordx4 v8, s[68:71], s23 offen lds
    s_add_u32 m0, m0, 1024
    s_add_u32 s23, s23, 128
    s_waitcnt lgkmcnt(7)
    v_mfma_f32_32x32x16_bf16 v[48:63], v[28:31], a[44:47], v[48:63]
    ds_read_b128 v[28:31], v7 offset:4096
    s_waitcnt lgkmcnt(7)
    v_mfma_f32_32x32x16_bf16 v[48:63], v[32:35], a[48:51], v[48:63]
    ds_read_b128 v[32:35], v4 offset:5120
    s_waitcnt lgkmcnt(7)
    v_mfma_f32_32x32x16_bf16 v[48:63], v[36:39], a[52:55], v[48:63]
    ds_read_b128 v[36:39], v5 offset:5120
    buffer_load_dwordx4 v8, s[68:71], s23 offen lds
    s_add_u32 m0, m0, 1024
    s_add_u32 s23, s23, 128
    s_waitcnt lgkmcnt(7)
    v_mfma_f32_32x32x16_bf16 v[48:63], v[40:43], a[56:59], v[48:63]
    ds_read_b128 v[40:43], v6 offset:5120
    s_waitcnt lgkmcnt(7)
    v_mfma_f32_32x32x16_bf16 v[48:63], v[44:47], a[60:63], v[48:63]
    ds_read_b128 v[44:47], v7 offset:5120
    s_waitcnt lgkmcnt(7)
    v_mfma_f32_32x32x16_bf16 v[48:63], v[16:19], a[64:67], v[48:63]
    ds_read_b128 v[16:19], v4 offset:6144
    buffer_load_dwordx4 v8, s[68:71], s23 offen lds
    s_add_u32 m0, m0, 1024
    s_add_u32 s23, s23, 128
    s_waitcnt lgkmcnt(7)
    v_mfma_f32_32x32x16_bf16 v[48:63], v[20:23], a[68:71], v[48:63]
    ds_read_b128 v[20:23], v5 offset:6144
    s_waitcnt lgkmcnt(7)
    v_mfma_f32_32x32x16_bf16 v[48:63], v[24:27], a[72:75], v[48:63]
    ds_read_b128 v[24:27], v6 offset:6144
    s_waitcnt lgkmcnt(7)
    v_mfma_f32_32x32x16_bf16 v[48:63], v[28:31], a[76:79], v[48:63]
    buffer_load_dwordx4 v8, s[68:71], s23 offen lds
    s_add_u32 m0, m0, 1024
    s_add_u32 s23, s23, 128
    ds_read_b128 v[28:31], v7 offset:6144
    s_waitcnt lgkmcnt(7)
    v_mfma_f32_32x32x16_bf16 v[48:63], v[32:35], a[80:83], v[48:63]
    ds_read_b128 v[32:35], v4 offset:7168
    s_waitcnt lgkmcnt(7)
    v_mfma_f32_32x32x16_bf16 v[48:63], v[36:39], a[84:87], v[48:63]
    ds_read_b128 v[36:39], v5 offset:7168
    s_waitcnt lgkmcnt(7)
    v_mfma_f32_32x32x16_bf16 v[48:63], v[40:43], a[88:91], v[48:63]
    buffer_load_dwordx4 v8, s[68:71], s23 offen lds
    s_add_u32 m0, m0, 1024
    s_add_u32 s23, s23, 128
    ds_read_b128 v[40:43], v6 offset:7168
    s_waitcnt lgkmcnt(7)
    v_mfma_f32_32x32x16_bf16 v[48:63], v[44:47], a[92:95], v[48:63]
    ds_read_b128 v[44:47], v7 offset:7168
    s_waitcnt lgkmcnt(7)
    v_mfma_f32_32x32x16_bf16 v[48:63], v[16:19], a[96:99], v[48:63]
    ds_read_b128 v[16:19], v4 offset:8192
    s_waitcnt lgkmcnt(7)
    v_mfma_f32_32x32x16_bf16 v[48:63], v[20:23], a[100:103], v[48:63]
    buffer_load_dwordx4 v8, s[68:71], s23 offen lds
    ds_read_b128 v[20:23], v5 offset:8192
    s_waitcnt lgkmcnt(7)
    v_mfma_f32_32x32x16_bf16 v[48:63], v[24:27], a[104:107], v[48:63]
    ds_read_b128 v[24:27], v6 offset:8192
    s_waitcnt lgkmcnt(7)
    v_mfma_f32_32x32x16_bf16 v[48:63], v[28:31], a[108:111], v[48:63]
    ds_read_b128 v[28:31], v7 offset:8192
    s_waitcnt lgkmcnt(7)
    v_mfma_f32_32x32x16_bf16 v[48:63], v[32:35], a[112:115], v[48:63]
    s_waitcnt lgkmcnt(6)
    v_mfma_f32_32x32x16_bf16 v[48:63], v[36:39], a[116:119], v[48:63]
    s_waitcnt lgkmcnt(5)
    v_mfma_f32_32x32x16_bf16 v[48:63], v[40:43], a[120:123], v[48:63]
    s_waitcnt lgkmcnt(4)
    v_mfma_f32_32x32x16_bf16 v[48:63], v[44:47], a[124:127], v[48:63]
    s_waitcnt lgkmcnt(3)
    v_mfma_f32_32x32x16_bf16 v[48:63], v[16:19], a[128:131], v[48:63]
    s_waitcnt lgkmcnt(2)
    v_mfma_f32_32x32x16_bf16 v[48:63], v[20:23], a[132:135], v[48:63]
    s_waitcnt lgkmcnt(1)
    v_mfma_f32_32x32x16_bf16 v[48:63], v[24:27], a[136:139], v[48:63]
    s_waitcnt lgkmcnt(0)
    v_mfma_f32_32x32x16_bf16 v[48:63], v[28:31], a[140:143], v[48:63]
    s_mov_b32 s48, s22
    s_add_u32 s22, s22, 6
    s_waitcnt vmcnt(9)
L_aqv_lp:
    s_barrier
    s_add_u32 s28, s22, 12
    s_min_u32 s28, s28, 63
    s_mov_b32 s25, 0
    ds_read_b128 v[16:19], v4 offset:36864
    s_mul_i32 s17, s13, 9216
    s_add_u32 m0, s17, s25
    s_mul_i32 s23, s28, 36864
    ds_read_b128 v[20:23], v5 offset:36864
    s_mul_i32 s24, s48, 1152
    v_cvt_pk_bf16_f32 v64, v48, v49
    v_cvt_pk_bf16_f32 v65, v50, v51
    ds_read_b128 v[24:27], v6 offset:36864
    v_cvt_pk_bf16_f32 v66, v52, v53
    v_cvt_pk_bf16_f32 v67, v54, v55
    v_cvt_pk_bf16_f32 v68, v56, v57
    ds_read_b128 v[28:31], v7 offset:36864
    v_cvt_pk_bf16_f32 v69, v58, v59
    v_cvt_pk_bf16_f32 v70, v60, v61
    v_cvt_pk_bf16_f32 v71, v62, v63
    ds_read_b128 v[32:35], v4 offset:37888
    ds_read_b128 v[36:39], v5 offset:37888
    ds_read_b128 v[40:43], v6 offset:37888
    ds_read_b128 v[44:47], v7 offset:37888
    s_waitcnt lgkmcnt(7)
    v_mfma_f32_32x32x16_bf16 v[96:111], v[16:19], a[0:3], 0
    ds_read_b128 v[16:19], v4 offset:38912
    s_waitcnt lgkmcnt(7)
    v_mfma_f32_32x32x16_bf16 v[96:111], v[20:23], a[4:7], v[96:111]
    ds_read_b128 v[20:23], v5 offset:38912
    buffer_load_dwordx4 v8, s[68:71], s23 offen lds
    s_add_u32 m0, m0, 1024
    s_add_u32 s23, s23, 128
    s_waitcnt lgkmcnt(7)
    v_mfma_f32_32x32x16_bf16 v[96:111], v[24:27], a[8:11], v[96:111]
    ds_read_b128 v[24:27], v6 offset:38912
    s_waitcnt lgkmcnt(7)
    v_mfma_f32_32x32x16_bf16 v[96:111], v[28:31], a[12:15], v[96:111]
    ds_read_b128 v[28:31], v7 offset:38912
    s_waitcnt lgkmcnt(7)
    v_mfma_f32_32x32x16_bf16 v[96:111], v[32:35], a[16:19], v[96:111]
    ds_read_b128 v[32:35], v4 offset:39936
    buffer_load_dwordx4 v8, s[68:71], s23 offen lds
    s_add_u32 m0, m0, 1024
    s_add_u32 s23, s23, 128
    s_waitcnt lgkmcnt(7)
    v_mfma_f32_32x32x16_bf16 v[96:111], v[36:39], a[20:23], v[96:111]
    ds_read_b128 v[36:39], v5 offset:39936
    s_waitcnt lgkmcnt(7)
    v_mfma_f32_32x32x16_bf16 v[96:111], v[40:43], a[24:27], v[96:111]
    ds_read_b128 v[40:43], v6 offset:39936
    s_waitcnt lgkmcnt(7)
    v_mfma_f32_32x32x16_bf16 v[96:111], v[44:47], a[28:31], v[96:111]
    ds_read_b128 v[44:47], v7 offset:39936
    buffer_load_dwordx4 v8, s[68:71], s23 offen lds
    s_add_u32 m0, m0, 1024
    s_add_u32 s23, s23, 128
    s_waitcnt lgkmcnt(7)
    v_mfma_f32_32x32x16_bf16 v[96:111], v[16:19], a[32:35], v[96:111]
    ds_read_b128 v[16:19], v4 offset:40960
    s_waitcnt lgkmcnt(7)
    v_mfma_f32_32x32x16_bf16 v[96:111], v[20:23], a[36:39], v[96:111]
    ds_read_b128 v[20:23], v5 offset:40960
    s_waitcnt lgkmcnt(7)
    v_mfma_f32_32x32x16_bf16 v[96:111], v[24:27], a[40:43], v[96:111]
    ds_read_b128 v[24:27], v6 offset:40960
    buffer_load_dwordx4 v8, s[68:71], s23 offen lds
    s_add_u32 m0, m0, 1024
    s_add_u32 s23, s23, 128
    s_waitcnt lgkmcnt(7)
    v_mfma_f32_32x32x16_bf16 v[96:111], v[28:31], a[44:47], v[96:111]
    ds_read_b128 v[28:31], v7 offset:40960
    s_waitcnt lgkmcnt(7)
    v_mfma_f32_32x32x16_bf16 v[96:111], v[32:35], a[48:51], v[96:111]
    ds_read_b128 v[32:35], v4 offset:41984
    s_waitcnt lgkmcnt(7)
    v_mfma_f32_32x32x16_bf16 v[96:111], v[36:39], a[52:55], v[96:111]
    ds_read_b128 v[36:39], v5 offset:41984
    buffer_load_dwordx4 v8, s[68:71], s23 offen lds
    s_add_u32 m0, m0, 1024
    s_add_u32 s23, s23, 128
    s_waitcnt lgkmcnt(7)
    v_mfma_f32_32x32x16_bf16 v[96:111], v[40:43], a[56:59], v[96:111]
    ds_read_b128 v[40:43], v6 offset:41984
    s_waitcnt lgkmcnt(7)
    v_mfma_f32_32x32x16_bf16 v[96:111], v[44:47], a[60:63], v[96:111]
    ds_read_b128 v[44:47], v7 offset:41984
    s_waitcnt lgkmcnt(7)
    v_mfma_f32_32x32x16_bf16 v[96:111], v[16:19], a[64:67], v[96:111]
    ds_read_b128 v[16:19], v4 offset:43008
    buffer_load_dwordx4 v8, s[68:71], s23 offen lds
    s_add_u32 m0, m0, 1024
    s_add_u32 s23, s23, 128
    s_waitcnt lgkmcnt(7)
    v_mfma_f32_32x32x16_bf16 v[96:111], v[20:23], a[68:71], v[96:111]
    ds_read_b128 v[20:23], v5 offset:43008
    s_waitcnt lgkmcnt(7)
    v_mfma_f32_32x32x16_bf16 v[96:111], v[24:27], a[72:75], v[96:111]
    ds_read_b128 v[24:27], v6 offset:43008
    s_waitcnt lgkmcnt(7)
    v_mfma_f32_32x32x16_bf16 v[96:111], v[28:31], a[76:79], v[96:111]
    buffer_load_dwordx4 v8, s[68:71], s23 offen lds
    s_add_u32 m0, m0, 1024
    s_add_u32 s23, s23, 128
    ds_read_b128 v[28:31], v7 offset:43008
    s_waitcnt lgkmcnt(7)
    v_mfma_f32_32x32x16_bf16 v[96:111], v[32:35], a[80:83], v[96:111]
    ds_read_b128 v[32:35], v4 offset:44032
    s_waitcnt lgkmcnt(7)
    v_mfma_f32_32x32x16_bf16 v[96:111], v[36:39], a[84:87], v[96:111]
    ds_read_b128 v[36:39], v5 offset:44032
    s_waitcnt lgkmcnt(7)
    v_mfma_f32_32x32x16_bf16 v[96:111], v[40:43], a[88:91], v[96:111]
    buffer_load_dwordx4 v8, s[68:71], s23 offen lds
    s_add_u32 m0, m0, 1024
    s_add_u32 s23, s23, 128
    ds_read_b128 v[40:43], v6 offset:44032
    s_add_u32 s24, s24, 12582912
    s_waitcnt lgkmcnt(7)
    v_mfma_f32_32x32x16_bf16 v[96:111], v[44:47], a[92:95], v[96:111]
    ds_read_b128 v[44:47], v7 offset:44032
    s_waitcnt lgkmcnt(7)
    v_mfma_f32_32x32x16_bf16 v[96:111], v[16:19], a[96:99], v[96:111]
    ds_read_b128 v[16:19], v4 offset:45056
    s_waitcnt lgkmcnt(7)
    v_mfma_f32_32x32x16_bf16 v[96:111], v[20:23], a[100:103], v[96:111]
    buffer_load_dwordx4 v8, s[68:71], s23 offen lds
    ds_read_b128 v[20:23], v5 offset:45056
    s_waitcnt lgkmcnt(7)
    v_mfma_f32_32x32x16_bf16 v[96:111], v[24:27], a[104:107], v[96:111]
    ds_read_b128 v[24:27], v6 offset:45056
    buffer_store_dwordx4 v[64:67], v72, s[4:7], s24 offen offset:0 sc1
    s_waitcnt lgkmcnt(7)
    v_mfma_f32_32x32x16_bf16 v[96:111], v[28:31], a[108:111], v[96:111]
    ds_read_b128 v[28:31], v7 offset:45056
    buffer_store_dwordx4 v[68:71], v72, s[4:7], s24 offen offset:576 sc1
    s_waitcnt lgkmcnt(7)
    v_mfma_f32_32x32x16_bf16 v[96:111], v[32:35], a[112:115], v[96:111]
    s_waitcnt lgkmcnt(6)
    v_mfma_f32_32x32x16_bf16 v[96:111], v[36:39], a[116:119], v[96:111]
    s_waitcnt lgkmcnt(5)
    v_mfma_f32_32x32x16_bf16 v[96:111], v[40:43], a[120:123], v[96:111]
    s_waitcnt lgkmcnt(4)
    v_mfma_f32_32x32x16_bf16 v[96:111], v[44:47], a[124:127], v[96:111]
    s_waitcnt lgkmcnt(3)
    v_mfma_f32_32x32x16_bf16 v[96:111], v[16:19], a[128:131], v[96:111]
    s_waitcnt lgkmcnt(2)
    v_mfma_f32_32x32x16_bf16 v[96:111], v[20:23], a[132:135], v[96:111]
    s_waitcnt lgkmcnt(1)
    v_mfma_f32_32x32x16_bf16 v[96:111], v[24:27], a[136:139], v[96:111]
    s_waitcnt lgkmcnt(0)
    v_mfma_f32_32x32x16_bf16 v[96:111], v[28:31], a[140:143], v[96:111]
    s_add_u32 s26, s26, 1
    s_mov_b32 s48, s22
    s_add_u32 s22, s22, 6
    s_cmp_gt_u32 s22, 63
    s_cbranch_scc1 L_aqv_end1
    s_waitcnt vmcnt(11)
    s_barrier
    s_add_u32 s28, s22, 12
    s_min_u32 s28, s28, 63
    s_mov_b32 s25, 36864
    ds_read_b128 v[16:19], v248 offset:8192
    s_mul_i32 s17, s13, 9216
    s_add_u32 m0, s17, s25
    s_mul_i32 s23, s28, 36864
    ds_read_b128 v[20:23], v249 offset:8192
    s_mul_i32 s24, s48, 1152
    v_cvt_pk_bf16_f32 v64, v96, v97
    v_cvt_pk_bf16_f32 v65, v98, v99
    ds_read_b128 v[24:27], v250 offset:8192
    v_cvt_pk_bf16_f32 v66, v100, v101
    v_cvt_pk_bf16_f32 v67, v102, v103
    v_cvt_pk_bf16_f32 v68, v104, v105
    ds_read_b128 v[28:31], v251 offset:8192
    v_cvt_pk_bf16_f32 v69, v106, v107
    v_cvt_pk_bf16_f32 v70, v108, v109
    v_cvt_pk_bf16_f32 v71, v110, v111
    ds_read_b128 v[32:35], v248 offset:9216
    ds_read_b128 v[36:39], v249 offset:9216
    ds_read_b128 v[40:43], v250 offset:9216
    ds_read_b128 v[44:47], v251 offset:9216
    s_waitcnt lgkmcnt(7)
    v_mfma_f32_32x32x16_bf16 v[48:63], v[16:19], a[0:3], 0
    ds_read_b128 v[16:19], v248 offset:10240
    s_waitcnt lgkmcnt(7)
    v_mfma_f32_32x32x16_bf16 v[48:63], v[20:23], a[4:7], v[48:63]
    ds_read_b128 v[20:23], v249 offset:10240
    buffer_load_dwordx4 v8, s[68:71], s23 offen lds
    s_add_u32 m0, m0, 1024
    s_add_u32 s23, s23, 128
    s_waitcnt lgkmcnt(7)
    v_mfma_f32_32x32x16_bf16 v[48:63], v[24:27], a[8:11], v[48:63]
    ds_read_b128 v[24:27], v250 offset:10240
    s_waitcnt lgkmcnt(7)
    v_mfma_f32_32x32x16_bf16 v[48:63], v[28:31], a[12:15], v[48:63]
    ds_read_b128 v[28:31], v251 offset:10240
    s_waitcnt lgkmcnt(7)
    v_mfma_f32_32x32x16_bf16 v[48:63], v[32:35], a[16:19], v[48:63]
    ds_read_b128 v[32:35], v248 offset:11264
    buffer_load_dwordx4 v8, s[68:71], s23 offen lds
    s_add_u32 m0, m0, 1024
    s_add_u32 s23, s23, 128
    s_waitcnt lgkmcnt(7)
    v_mfma_f32_32x32x16_bf16 v[48:63], v[36:39], a[20:23], v[48:63]
    ds_read_b128 v[36:39], v249 offset:11264
    s_waitcnt lgkmcnt(7)
    v_mfma_f32_32x32x16_bf16 v[48:63], v[40:43], a[24:27], v[48:63]
    ds_read_b128 v[40:43], v250 offset:11264
    s_waitcnt lgkmcnt(7)
    v_mfma_f32_32x32x16_bf16 v[48:63], v[44:47], a[28:31], v[48:63]
    ds_read_b128 v[44:47], v251 offset:11264
    buffer_load_dwordx4 v8, s[68:71], s23 offen lds
    s_add_u32 m0, m0, 1024
    s_add_u32 s23, s23, 128
    s_waitcnt lgkmcnt(7)
    v_mfma_f32_32x32x16_bf16 v[48:63], v[16:19], a[32:35], v[48:63]
    ds_read_b128 v[16:19], v248 offset:12288
    s_waitcnt lgkmcnt(7)
    v_mfma_f32_32x32x16_bf16 v[48:63], v[20:23], a[36:39], v[48:63]
    ds_read_b128 v[20:23], v249 offset:12288
    s_waitcnt lgkmcnt(7)
    v_mfma_f32_32x32x16_bf16 v[48:63], v[24:27], a[40:43], v[48:63]
    ds_read_b128 v[24:27], v250 offset:12288
    buffer_load_dwordx4 v8, s[68:71], s23 offen lds
    s_add_u32 m0, m0, 1024
    s_add_u32 s23, s23, 128
    s_waitcnt lgkmcnt(7)
    v_mfma_f32_32x32x16_bf16 v[48:63], v[28:31], a[44:47], v[48:63]
    ds_read_b128 v[28:31], v251 offset:12288
    s_waitcnt lgkmcnt(7)
    v_mfma_f32_32x32x16_bf16 v[48:63], v[32:35], a[48:51], v[48:63]
    ds_read_b128 v[32:35], v248 offset:13312
    s_waitcnt lgkmcnt(7)
    v_mfma_f32_32x32x16_bf16 v[48:63], v[36:39], a[52:55], v[48:63]
    ds_read_b128 v[36:39], v249 offset:13312
    buffer_load_dwordx4 v8, s[68:71], s23 offen lds
    s_add_u32 m0, m0, 1024
    s_add_u32 s23, s23, 128
    s_waitcnt lgkmcnt(7)
    v_mfma_f32_32x32x16_bf16 v[48:63], v[40:43], a[56:59], v[48:63]
    ds_read_b128 v[40:43], v250 offset:13312
    s_waitcnt lgkmcnt(7)
    v_mfma_f32_32x32x16_bf16 v[48:63], v[44:47], a[60:63], v[48:63]
    ds_read_b128 v[44:47], v251 offset:13312
    s_waitcnt lgkmcnt(7)
    v_mfma_f32_32x32x16_bf16 v[48:63], v[16:19], a[64:67], v[48:63]
    ds_read_b128 v[16:19], v248 offset:14336
    buffer_load_dwordx4 v8, s[68:71], s23 offen lds
    s_add_u32 m0, m0, 1024
    s_add_u32 s23, s23, 128
    s_waitcnt lgkmcnt(7)
    v_mfma_f32_32x32x16_bf16 v[48:63], v[20:23], a[68:71], v[48:63]
    ds_read_b128 v[20:23], v249 offset:14336
    s_waitcnt lgkmcnt(7)
    v_mfma_f32_32x32x16_bf16 v[48:63], v[24:27], a[72:75], v[48:63]
    ds_read_b128 v[24:27], v250 offset:14336
    s_waitcnt lgkmcnt(7)
    v_mfma_f32_32x32x16_bf16 v[48:63], v[28:31], a[76:79], v[48:63]
    buffer_load_dwordx4 v8, s[68:71], s23 offen lds
    s_add_u32 m0, m0, 1024
    s_add_u32 s23, s23, 128
    ds_read_b128 v[28:31], v251 offset:14336
    s_waitcnt lgkmcnt(7)
    v_mfma_f32_32x32x16_bf16 v[48:63], v[32:35], a[80:83], v[48:63]
    ds_read_b128 v[32:35], v248 offset:15360
    s_waitcnt lgkmcnt(7)
    v_mfma_f32_32x32x16_bf16 v[48:63], v[36:39], a[84:87], v[48:63]
    ds_read_b128 v[36:39], v249 offset:15360
    s_waitcnt lgkmcnt(7)
    v_mfma_f32_32x32x16_bf16 v[48:63], v[40:43], a[88:91], v[48:63]
    buffer_load_dwordx4 v8, s[68:71], s23 offen lds
    s_add_u32 m0, m0, 1024
    s_add_u32 s23, s23, 128
    ds_read_b128 v[40:43], v250 offset:15360
    s_add_u32 s24, s24, 12582912
    s_waitcnt lgkmcnt(7)
    v_mfma_f32_32x32x16_bf16 v[48:63], v[44:47], a[92:95], v[48:63]
    ds_read_b128 v[44:47], v251 offset:15360
    s_waitcnt lgkmcnt(7)
    v_mfma_f32_32x32x16_bf16 v[48:63], v[16:19], a[96:99], v[48:63]
    ds_read_b128 v[16:19], v248 offset:16384
    s_waitcnt lgkmcnt(7)
    v_mfma_f32_32x32x16_bf16 v[48:63], v[20:23], a[100:103], v[48:63]
    buffer_load_dwordx4 v8, s[68:71], s23 offen lds
    ds_read_b128 v[20:23], v249 offset:16384
    s_waitcnt lgkmcnt(7)
    v_mfma_f32_32x32x16_bf16 v[48:63], v[24:27], a[104:107], v[48:63]
    ds_read_b128 v[24:27], v250 offset:16384
    buffer_store_dwordx4 v[64:67], v72, s[4:7], s24 offen offset:0 sc1
    s_waitcnt lgkmcnt(7)
    v_mfma_f32_32x32x16_bf16 v[48:63], v[28:31], a[108:111], v[48:63]
    ds_read_b128 v[28:31], v251 offset:16384
    buffer_store_dwordx4 v[68:71], v72, s[4:7], s24 offen offset:576 sc1
    s_waitcnt lgkmcnt(7)
    v_mfma_f32_32x32x16_bf16 v[48:63], v[32:35], a[112:115], v[48:63]
    s_waitcnt lgkmcnt(6)
    v_mfma_f32_32x32x16_bf16 v[48:63], v[36:39], a[116:119], v[48:63]
    s_waitcnt lgkmcnt(5)
    v_mfma_f32_32x32x16_bf16 v[48:63], v[40:43], a[120:123], v[48:63]
    s_waitcnt lgkmcnt(4)
    v_mfma_f32_32x32x16_bf16 v[48:63], v[44:47], a[124:127], v[48:63]
    s_waitcnt lgkmcnt(3)
    v_mfma_f32_32x32x16_bf16 v[48:63], v[16:19], a[128:131], v[48:63]
    s_waitcnt lgkmcnt(2)
    v_mfma_f32_32x32x16_bf16 v[48:63], v[20:23], a[132:135], v[48:63]
    s_waitcnt lgkmcnt(1)
    v_mfma_f32_32x32x16_bf16 v[48:63], v[24:27], a[136:139], v[48:63]
    s_waitcnt lgkmcnt(0)
    v_mfma_f32_32x32x16_bf16 v[48:63], v[28:31], a[140:143], v[48:63]
    s_add_u32 s26, s26, 1
    s_mov_b32 s48, s22
    s_add_u32 s22, s22, 6
    s_cmp_gt_u32 s22, 63
    s_cbranch_scc1 L_aqv_end0
    s_waitcnt vmcnt(11)
    s_barrier
    s_add_u32 s28, s22, 12
    s_min_u32 s28, s28, 63
    s_mov_b32 s25, 73728
    ds_read_b128 v[16:19], v4 offset:0
    s_mul_i32 s17, s13, 9216
    s_add_u32 m0, s17, s25
    s_mul_i32 s23, s28, 36864
    ds_read_b128 v[20:23], v5 offset:0
    s_mul_i32 s24, s48, 1152
    v_cvt_pk_bf16_f32 v64, v48, v49
    v_cvt_pk_bf16_f32 v65, v50, v51
    ds_read_b128 v[24:27], v6 offset:0
    v_cvt_pk_bf16_f32 v66, v52, v53
    v_cvt_pk_bf16_f32 v67, v54, v55
    v_cvt_pk_bf16_f32 v68, v56, v57
    ds_read_b128 v[28:31], v7 offset:0
    v_cvt_pk_bf16_f32 v69, v58, v59
    v_cvt_pk_bf16_f32 v70, v60, v61
    v_cvt_pk_bf16_f32 v71, v62, v63
    ds_read_b128 v[32:35], v4 offset:1024
    ds_read_b128 v[36:39], v5 offset:1024
    ds_read_b128 v[40:43], v6 offset:1024
    ds_read_b128 v[44:47], v7 offset:1024
    s_waitcnt lgkmcnt(7)
    v_mfma_f32_32x32x16_bf16 v[96:111], v[16:19], a[0:3], 0
    ds_read_b128 v[16:19], v4 offset:2048
    s_waitcnt lgkmcnt(7)
    v_mfma_f32_32x32x16_bf16 v[96:111], v[20:23], a[4:7], v[96:111]
    ds_read_b128 v[20:23], v5 offset:2048
    buffer_load_dwordx4 v8, s[68:71], s23 offen lds
    s_add_u32 m0, m0, 1024
    s_add_u32 s23, s23, 128
    s_waitcnt lgkmcnt(7)
    v_mfma_f32_32x32x16_bf16 v[96:111], v[24:27], a[8:11], v[96:111]
    ds_read_b128 v[24:27], v6 offset:2048
    s_waitcnt lgkmcnt(7)
    v_mfma_f32_32x32x16_bf16 v[96:111], v[28:31], a[12:15], v[96:111]
    ds_read_b128 v[28:31], v7 offset:2048
    s_waitcnt lgkmcnt(7)
    v_mfma_f32_32x32x16_bf16 v[96:111], v[32:35], a[16:19], v[96:111]
    ds_read_b128 v[32:35], v4 offset:3072
    buffer_load_dwordx4 v8, s[68:71], s23 offen lds
    s_add_u32 m0, m0, 1024
    s_add_u32 s23, s23, 128
    s_waitcnt lgkmcnt(7)
    v_mfma_f32_32x32x16_bf16 v[96:111], v[36:39], a[20:23], v[96:111]
    ds_read_b128 v[36:39], v5 offset:3072
    s_waitcnt lgkmcnt(7)
    v_mfma_f32_32x32x16_bf16 v[96:111], v[40:43], a[24:27], v[96:111]
    ds_read_b128 v[40:43], v6 offset:3072
    s_waitcnt lgkmcnt(7)
    v_mfma_f32_32x32x16_bf16 v[96:111], v[44:47], a[28:31], v[96:111]
    ds_read_b128 v[44:47], v7 offset:3072
    buffer_load_dwordx4 v8, s[68:71], s23 offen lds
    s_add_u32 m0, m0, 1024
    s_add_u32 s23, s23, 128
    s_waitcnt lgkmcnt(7)
    v_mfma_f32_32x32x16_bf16 v[96:111], v[16:19], a[32:35], v[96:111]
    ds_read_b128 v[16:19], v4 offset:4096
    s_waitcnt lgkmcnt(7)
    v_mfma_f32_32x32x16_bf16 v[96:111], v[20:23], a[36:39], v[96:111]
    ds_read_b128 v[20:23], v5 offset:4096
    s_waitcnt lgkmcnt(7)
    v_mfma_f32_32x32x16_bf16 v[96:111], v[24:27], a[40:43], v[96:111]
    ds_read_b128 v[24:27], v6 offset:4096
    buffer_load_dwordx4 v8, s[68:71], s23 offen lds
    s_add_u32 m0, m0, 1024
    s_add_u32 s23, s23, 128
    s_waitcnt lgkmcnt(7)
    v_mfma_f32_32x32x16_bf16 v[96:111], v[28:31], a[44:47], v[96:111]
    ds_read_b128 v[28:31], v7 offset:4096
    s_waitcnt lgkmcnt(7)
    v_mfma_f32_32x32x16_bf16 v[96:111], v[32:35], a[48:51], v[96:111]
    ds_read_b128 v[32:35], v4 offset:5120
    s_waitcnt lgkmcnt(7)
    v_mfma_f32_32x32x16_bf16 v[96:111], v[36:39], a[52:55], v[96:111]
    ds_read_b128 v[36:39], v5 offset:5120
    buffer_load_dwordx4 v8, s[68:71], s23 offen lds
    s_add_u32 m0, m0, 1024
    s_add_u32 s23, s23, 128
    s_waitcnt lgkmcnt(7)
    v_mfma_f32_32x32x16_bf16 v[96:111], v[40:43], a[56:59], v[96:111]
    ds_read_b128 v[40:43], v6 offset:5120
    s_waitcnt lgkmcnt(7)
    v_mfma_f32_32x32x16_bf16 v[96:111], v[44:47], a[60:63], v[96:111]
    ds_read_b128 v[44:47], v7 offset:5120
    s_waitcnt lgkmcnt(7)
    v_mfma_f32_32x32x16_bf16 v[96:111], v[16:19], a[64:67], v[96:111]
    ds_read_b128 v[16:19], v4 offset:6144
    buffer_load_dwordx4 v8, s[68:71], s23 offen lds
    s_add_u32 m0, m0, 1024
    s_add_u32 s23, s23, 128
    s_waitcnt lgkmcnt(7)
    v_mfma_f32_32x32x16_bf16 v[96:111], v[20:23], a[68:71], v[96:111]
    ds_read_b128 v[20:23], v5 offset:6144
    s_waitcnt lgkmcnt(7)
    v_mfma_f32_32x32x16_bf16 v[96:111], v[24:27], a[72:75], v[96:111]
    ds_read_b128 v[24:27], v6 offset:6144
    s_waitcnt lgkmcnt(7)
    v_mfma_f32_32x32x16_bf16 v[96:111], v[28:31], a[76:79], v[96:111]
    buffer_load_dwordx4 v8, s[68:71], s23 offen lds
    s_add_u32 m0, m0, 1024
    s_add_u32 s23, s23, 128
    ds_read_b128 v[28:31], v7 offset:6144
    s_waitcnt lgkmcnt(7)
    v_mfma_f32_32x32x16_bf16 v[96:111], v[32:35], a[80:83], v[96:111]
    ds_read_b128 v[32:35], v4 offset:7168
    s_waitcnt lgkmcnt(7)
    v_mfma_f32_32x32x16_bf16 v[96:111], v[36:39], a[84:87], v[96:111]
    ds_read_b128 v[36:39], v5 offset:7168
    s_waitcnt lgkmcnt(7)
    v_mfma_f32_32x32x16_bf16 v[96:111], v[40:43], a[88:91], v[96:111]
    buffer_load_dwordx4 v8, s[68:71], s23 offen lds
    s_add_u32 m0, m0, 1024
    s_add_u32 s23, s23, 128
    ds_read_b128 v[40:43], v6 offset:7168
    s_add_u32 s24, s24, 12582912
    s_waitcnt lgkmcnt(7)
    v_mfma_f32_32x32x16_bf16 v[96:111], v[44:47], a[92:95], v[96:111]
    ds_read_b128 v[44:47], v7 offset:7168
    s_waitcnt lgkmcnt(7)
    v_mfma_f32_32x32x16_bf16 v[96:111], v[16:19], a[96:99], v[96:111]
    ds_read_b128 v[16:19], v4 offset:8192
    s_waitcnt lgkmcnt(7)
    v_mfma_f32_32x32x16_bf16 v[96:111], v[20:23], a[100:103], v[96:111]
    buffer_load_dwordx4 v8, s[68:71], s23 offen lds
    ds_read_b128 v[20:23], v5 offset:8192
    s_waitcnt lgkmcnt(7)
    v_mfma_f32_32x32x16_bf16 v[96:111], v[24:27], a[104:107], v[96:111]
    ds_read_b128 v[24:27], v6 offset:8192
    buffer_store_dwordx4 v[64:67], v72, s[4:7], s24 offen offset:0 sc1
    s_waitcnt lgkmcnt(7)
    v_mfma_f32_32x32x16_bf16 v[96:111], v[28:31], a[108:111], v[96:111]
    ds_read_b128 v[28:31], v7 offset:8192
    buffer_store_dwordx4 v[68:71], v72, s[4:7], s24 offen offset:576 sc1
    s_waitcnt lgkmcnt(7)
    v_mfma_f32_32x32x16_bf16 v[96:111], v[32:35], a[112:115], v[96:111]
    s_waitcnt lgkmcnt(6)
    v_mfma_f32_32x32x16_bf16 v[96:111], v[36:39], a[116:119], v[96:111]
    s_waitcnt lgkmcnt(5)
    v_mfma_f32_32x32x16_bf16 v[96:111], v[40:43], a[120:123], v[96:111]
    s_waitcnt lgkmcnt(4)
    v_mfma_f32_32x32x16_bf16 v[96:111], v[44:47], a[124:127], v[96:111]
    s_waitcnt lgkmcnt(3)
    v_mfma_f32_32x32x16_bf16 v[96:111], v[16:19], a[128:131], v[96:111]
    s_waitcnt lgkmcnt(2)
    v_mfma_f32_32x32x16_bf16 v[96:111], v[20:23], a[132:135], v[96:111]
    s_waitcnt lgkmcnt(1)
    v_mfma_f32_32x32x16_bf16 v[96:111], v[24:27], a[136:139], v[96:111]
    s_waitcnt lgkmcnt(0)
    v_mfma_f32_32x32x16_bf16 v[96:111], v[28:31], a[140:143], v[96:111]
    s_add_u32 s26, s26, 1
    s_mov_b32 s48, s22
    s_add_u32 s22, s22, 6
    s_cmp_gt_u32 s22, 63
    s_cbranch_scc1 L_aqv_end1
    s_waitcnt vmcnt(11)
    s_barrier
    s_add_u32 s28, s22, 12
    s_min_u32 s28, s28, 63
    s_mov_b32 s25, 0
    ds_read_b128 v[16:19], v4 offset:36864
    s_mul_i32 s17, s13, 9216
    s_add_u32 m0, s17, s25
    s_mul_i32 s23, s28, 36864
    ds_read_b128 v[20:23], v5 offset:36864
    s_mul_i32 s24, s48, 1152
    v_cvt_pk_bf16_f32 v64, v96, v97
    v_cvt_pk_bf16_f32 v65, v98, v99
    ds_read_b128 v[24:27], v6 offset:36864
    v_cvt_pk_bf16_f32 v66, v100, v101
    v_cvt_pk_bf16_f32 v67, v102, v103
    v_cvt_pk_bf16_f32 v68, v104, v105
    ds_read_b128 v[28:31], v7 offset:36864
    v_cvt_pk_bf16_f32 v69, v106, v107
    v_cvt_pk_bf16_f32 v70, v108, v109
    v_cvt_pk_bf16_f32 v71, v110, v111
    ds_read_b128 v[32:35], v4 offset:37888
    ds_read_b128 v[36:39], v5 offset:37888
    ds_read_b128 v[40:43], v6 offset:37888
    ds_read_b128 v[44:47], v7 offset:37888
    s_waitcnt lgkmcnt(7)
    v_mfma_f32_32x32x16_bf16 v[48:63], v[16:19], a[0:3], 0
    ds_read_b128 v[16:19], v4 offset:38912
    s_waitcnt lgkmcnt(7)
    v_mfma_f32_32x32x16_bf16 v[48:63], v[20:23], a[4:7], v[48:63]
    ds_read_b128 v[20:23], v5 offset:38912
    buffer_load_dwordx4 v8, s[68:71], s23 offen lds
    s_add_u32 m0, m0, 1024
    s_add_u32 s23, s23, 128
    s_waitcnt lgkmcnt(7)
    v_mfma_f32_32x32x16_bf16 v[48:63], v[24:27], a[8:11], v[48:63]
    ds_read_b128 v[24:27], v6 offset:38912
    s_waitcnt lgkmcnt(7)
    v_mfma_f32_32x32x16_bf16 v[48:63], v[28:31], a[12:15], v[48:63]
    ds_read_b128 v[28:31], v7 offset:38912
    s_waitcnt lgkmcnt(7)
    v_mfma_f32_32x32x16_bf16 v[48:63], v[32:35], a[16:19], v[48:63]
    ds_read_b128 v[32:35], v4 offset:39936
    buffer_load_dwordx4 v8, s[68:71], s23 offen lds
    s_add_u32 m0, m0, 1024
    s_add_u32 s23, s23, 128
    s_waitcnt lgkmcnt(7)
    v_mfma_f32_32x32x16_bf16 v[48:63], v[36:39], a[20:23], v[48:63]
    ds_read_b128 v[36:39], v5 offset:39936
    s_waitcnt lgkmcnt(7)
    v_mfma_f32_32x32x16_bf16 v[48:63], v[40:43], a[24:27], v[48:63]
    ds_read_b128 v[40:43], v6 offset:39936
    s_waitcnt lgkmcnt(7)
    v_mfma_f32_32x32x16_bf16 v[48:63], v[44:47], a[28:31], v[48:63]
    ds_read_b128 v[44:47], v7 offset:39936
    buffer_load_dwordx4 v8, s[68:71], s23 offen lds
    s_add_u32 m0, m0, 1024
    s_add_u32 s23, s23, 128
    s_waitcnt lgkmcnt(7)
    v_mfma_f32_32x32x16_bf16 v[48:63], v[16:19], a[32:35], v[48:63]
    ds_read_b128 v[16:19], v4 offset:40960
    s_waitcnt lgkmcnt(7)
    v_mfma_f32_32x32x16_bf16 v[48:63], v[20:23], a[36:39], v[48:63]
    ds_read_b128 v[20:23], v5 offset:40960
    s_waitcnt lgkmcnt(7)
    v_mfma_f32_32x32x16_bf16 v[48:63], v[24:27], a[40:43], v[48:63]
    ds_read_b128 v[24:27], v6 offset:40960
    buffer_load_dwordx4 v8, s[68:71], s23 offen lds
    s_add_u32 m0, m0, 1024
    s_add_u32 s23, s23, 128
    s_waitcnt lgkmcnt(7)
    v_mfma_f32_32x32x16_bf16 v[48:63], v[28:31], a[44:47], v[48:63]
    ds_read_b128 v[28:31], v7 offset:40960
    s_waitcnt lgkmcnt(7)
    v_mfma_f32_32x32x16_bf16 v[48:63], v[32:35], a[48:51], v[48:63]
    ds_read_b128 v[32:35], v4 offset:41984
    s_waitcnt lgkmcnt(7)
    v_mfma_f32_32x32x16_bf16 v[48:63], v[36:39], a[52:55], v[48:63]
    ds_read_b128 v[36:39], v5 offset:41984
    buffer_load_dwordx4 v8, s[68:71], s23 offen lds
    s_add_u32 m0, m0, 1024
    s_add_u32 s23, s23, 128
    s_waitcnt lgkmcnt(7)
    v_mfma_f32_32x32x16_bf16 v[48:63], v[40:43], a[56:59], v[48:63]
    ds_read_b128 v[40:43], v6 offset:41984
    s_waitcnt lgkmcnt(7)
    v_mfma_f32_32x32x16_bf16 v[48:63], v[44:47], a[60:63], v[48:63]
    ds_read_b128 v[44:47], v7 offset:41984
    s_waitcnt lgkmcnt(7)
    v_mfma_f32_32x32x16_bf16 v[48:63], v[16:19], a[64:67], v[48:63]
    ds_read_b128 v[16:19], v4 offset:43008
    buffer_load_dwordx4 v8, s[68:71], s23 offen lds
    s_add_u32 m0, m0, 1024
    s_add_u32 s23, s23, 128
    s_waitcnt lgkmcnt(7)
    v_mfma_f32_32x32x16_bf16 v[48:63], v[20:23], a[68:71], v[48:63]
    ds_read_b128 v[20:23], v5 offset:43008
    s_waitcnt lgkmcnt(7)
    v_mfma_f32_32x32x16_bf16 v[48:63], v[24:27], a[72:75], v[48:63]
    ds_read_b128 v[24:27], v6 offset:43008
    s_waitcnt lgkmcnt(7)
    v_mfma_f32_32x32x16_bf16 v[48:63], v[28:31], a[76:79], v[48:63]
    buffer_load_dwordx4 v8, s[68:71], s23 offen lds
    s_add_u32 m0, m0, 1024
    s_add_u32 s23, s23, 128
    ds_read_b128 v[28:31], v7 offset:43008
    s_waitcnt lgkmcnt(7)
    v_mfma_f32_32x32x16_bf16 v[48:63], v[32:35], a[80:83], v[48:63]
    ds_read_b128 v[32:35], v4 offset:44032
    s_waitcnt lgkmcnt(7)
    v_mfma_f32_32x32x16_bf16 v[48:63], v[36:39], a[84:87], v[48:63]
    ds_read_b128 v[36:39], v5 offset:44032
    s_waitcnt lgkmcnt(7)
    v_mfma_f32_32x32x16_bf16 v[48:63], v[40:43], a[88:91], v[48:63]
    buffer_load_dwordx4 v8, s[68:71], s23 offen lds
    s_add_u32 m0, m0, 1024
    s_add_u32 s23, s23, 128
    ds_read_b128 v[40:43], v6 offset:44032
    s_add_u32 s24, s24, 12582912
    s_waitcnt lgkmcnt(7)
    v_mfma_f32_32x32x16_bf16 v[48:63], v[44:47], a[92:95], v[48:63]
    ds_read_b128 v[44:47], v7 offset:44032
    s_waitcnt lgkmcnt(7)
    v_mfma_f32_32x32x16_bf16 v[48:63], v[16:19], a[96:99], v[48:63]
    ds_read_b128 v[16:19], v4 offset:45056
    s_waitcnt lgkmcnt(7)
    v_mfma_f32_32x32x16_bf16 v[48:63], v[20:23], a[100:103], v[48:63]
    buffer_load_dwordx4 v8, s[68:71], s23 offen lds
    ds_read_b128 v[20:23], v5 offset:45056
    s_waitcnt lgkmcnt(7)
    v_mfma_f32_32x32x16_bf16 v[48:63], v[24:27], a[104:107], v[48:63]
    ds_read_b128 v[24:27], v6 offset:45056
    buffer_store_dwordx4 v[64:67], v72, s[4:7], s24 offen offset:0 sc1
    s_waitcnt lgkmcnt(7)
    v_mfma_f32_32x32x16_bf16 v[48:63], v[28:31], a[108:111], v[48:63]
    ds_read_b128 v[28:31], v7 offset:45056
    buffer_store_dwordx4 v[68:71], v72, s[4:7], s24 offen offset:576 sc1
    s_waitcnt lgkmcnt(7)
    v_mfma_f32_32x32x16_bf16 v[48:63], v[32:35], a[112:115], v[48:63]
    s_waitcnt lgkmcnt(6)
    v_mfma_f32_32x32x16_bf16 v[48:63], v[36:39], a[116:119], v[48:63]
    s_waitcnt lgkmcnt(5)
    v_mfma_f32_32x32x16_bf16 v[48:63], v[40:43], a[120:123], v[48:63]
    s_waitcnt lgkmcnt(4)
    v_mfma_f32_32x32x16_bf16 v[48:63], v[44:47], a[124:127], v[48:63]
    s_waitcnt lgkmcnt(3)
    v_mfma_f32_32x32x16_bf16 v[48:63], v[16:19], a[128:131], v[48:63]
    s_waitcnt lgkmcnt(2)
    v_mfma_f32_32x32x16_bf16 v[48:63], v[20:23], a[132:135], v[48:63]
    s_waitcnt lgkmcnt(1)
    v_mfma_f32_32x32x16_bf16 v[48:63], v[24:27], a[136:139], v[48:63]
    s_waitcnt lgkmcnt(0)
    v_mfma_f32_32x32x16_bf16 v[48:63], v[28:31], a[140:143], v[48:63]
    s_add_u32 s26, s26, 1
    s_mov_b32 s48, s22
    s_add_u32 s22, s22, 6
    s_cmp_gt_u32 s22, 63
    s_cbranch_scc1 L_aqv_end0
    s_waitcnt vmcnt(11)
    s_barrier
    s_add_u32 s28, s22, 12
    s_min_u32 s28, s28, 63
    s_mov_b32 s25, 36864
    ds_read_b128 v[16:19], v248 offset:8192
    s_mul_i32 s17, s13, 9216
    s_add_u32 m0, s17, s25
    s_mul_i32 s23, s28, 36864
    ds_read_b128 v[20:23], v249 offset:8192
    s_mul_i32 s24, s48, 1152
    v_cvt_pk_bf16_f32 v64, v48, v49
    v_cvt_pk_bf16_f32 v65, v50, v51
    ds_read_b128 v[24:27], v250 offset:8192
    v_cvt_pk_bf16_f32 v66, v52, v53
    v_cvt_pk_bf16_f32 v67, v54, v55
    v_cvt_pk_bf16_f32 v68, v56, v57
    ds_read_b128 v[28:31], v251 offset:8192
    v_cvt_pk_bf16_f32 v69, v58, v59
    v_cvt_pk_bf16_f32 v70, v60, v61
    v_cvt_pk_bf16_f32 v71, v62, v63
    ds_read_b128 v[32:35], v248 offset:9216
    ds_read_b128 v[36:39], v249 offset:9216
    ds_read_b128 v[40:43], v250 offset:9216
    ds_read_b128 v[44:47], v251 offset:9216
    s_waitcnt lgkmcnt(7)
    v_mfma_f32_32x32x16_bf16 v[96:111], v[16:19], a[0:3], 0
    ds_read_b128 v[16:19], v248 offset:10240
    s_waitcnt lgkmcnt(7)
    v_mfma_f32_32x32x16_bf16 v[96:111], v[20:23], a[4:7], v[96:111]
    ds_read_b128 v[20:23], v249 offset:10240
    buffer_load_dwordx4 v8, s[68:71], s23 offen lds
    s_add_u32 m0, m0, 1024
    s_add_u32 s23, s23, 128
    s_waitcnt lgkmcnt(7)
    v_mfma_f32_32x32x16_bf16 v[96:111], v[24:27], a[8:11], v[96:111]
    ds_read_b128 v[24:27], v250 offset:10240
    s_waitcnt lgkmcnt(7)
    v_mfma_f32_32x32x16_bf16 v[96:111], v[28:31], a[12:15], v[96:111]
    ds_read_b128 v[28:31], v251 offset:10240
    s_waitcnt lgkmcnt(7)
    v_mfma_f32_32x32x16_bf16 v[96:111], v[32:35], a[16:19], v[96:111]
    ds_read_b128 v[32:35], v248 offset:11264
    buffer_load_dwordx4 v8, s[68:71], s23 offen lds
    s_add_u32 m0, m0, 1024
    s_add_u32 s23, s23, 128
    s_waitcnt lgkmcnt(7)
    v_mfma_f32_32x32x16_bf16 v[96:111], v[36:39], a[20:23], v[96:111]
    ds_read_b128 v[36:39], v249 offset:11264
    s_waitcnt lgkmcnt(7)
    v_mfma_f32_32x32x16_bf16 v[96:111], v[40:43], a[24:27], v[96:111]
    ds_read_b128 v[40:43], v250 offset:11264
    s_waitcnt lgkmcnt(7)
    v_mfma_f32_32x32x16_bf16 v[96:111], v[44:47], a[28:31], v[96:111]
    ds_read_b128 v[44:47], v251 offset:11264
    buffer_load_dwordx4 v8, s[68:71], s23 offen lds
    s_add_u32 m0, m0, 1024
    s_add_u32 s23, s23, 128
    s_waitcnt lgkmcnt(7)
    v_mfma_f32_32x32x16_bf16 v[96:111], v[16:19], a[32:35], v[96:111]
    ds_read_b128 v[16:19], v248 offset:12288
    s_waitcnt lgkmcnt(7)
    v_mfma_f32_32x32x16_bf16 v[96:111], v[20:23], a[36:39], v[96:111]
    ds_read_b128 v[20:23], v249 offset:12288
    s_waitcnt lgkmcnt(7)
    v_mfma_f32_32x32x16_bf16 v[96:111], v[24:27], a[40:43], v[96:111]
    ds_read_b128 v[24:27], v250 offset:12288
    buffer_load_dwordx4 v8, s[68:71], s23 offen lds
    s_add_u32 m0, m0, 1024
    s_add_u32 s23, s23, 128
    s_waitcnt lgkmcnt(7)
    v_mfma_f32_32x32x16_bf16 v[96:111], v[28:31], a[44:47], v[96:111]
    ds_read_b128 v[28:31], v251 offset:12288
    s_waitcnt lgkmcnt(7)
    v_mfma_f32_32x32x16_bf16 v[96:111], v[32:35], a[48:51], v[96:111]
    ds_read_b128 v[32:35], v248 offset:13312
    s_waitcnt lgkmcnt(7)
    v_mfma_f32_32x32x16_bf16 v[96:111], v[36:39], a[52:55], v[96:111]
    ds_read_b128 v[36:39], v249 offset:13312
    buffer_load_dwordx4 v8, s[68:71], s23 offen lds
    s_add_u32 m0, m0, 1024
    s_add_u32 s23, s23, 128
    s_waitcnt lgkmcnt(7)
    v_mfma_f32_32x32x16_bf16 v[96:111], v[40:43], a[56:59], v[96:111]
    ds_read_b128 v[40:43], v250 offset:13312
    s_waitcnt lgkmcnt(7)
    v_mfma_f32_32x32x16_bf16 v[96:111], v[44:47], a[60:63], v[96:111]
    ds_read_b128 v[44:47], v251 offset:13312
    s_waitcnt lgkmcnt(7)
    v_mfma_f32_32x32x16_bf16 v[96:111], v[16:19], a[64:67], v[96:111]
    ds_read_b128 v[16:19], v248 offset:14336
    buffer_load_dwordx4 v8, s[68:71], s23 offen lds
    s_add_u32 m0, m0, 1024
    s_add_u32 s23, s23, 128
    s_waitcnt lgkmcnt(7)
    v_mfma_f32_32x32x16_bf16 v[96:111], v[20:23], a[68:71], v[96:111]
    ds_read_b128 v[20:23], v249 offset:14336
    s_waitcnt lgkmcnt(7)
    v_mfma_f32_32x32x16_bf16 v[96:111], v[24:27], a[72:75], v[96:111]
    ds_read_b128 v[24:27], v250 offset:14336
    s_waitcnt lgkmcnt(7)
    v_mfma_f32_32x32x16_bf16 v[96:111], v[28:31], a[76:79], v[96:111]
    buffer_load_dwordx4 v8, s[68:71], s23 offen lds
    s_add_u32 m0, m0, 1024
    s_add_u32 s23, s23, 128
    ds_read_b128 v[28:31], v251 offset:14336
    s_waitcnt lgkmcnt(7)
    v_mfma_f32_32x32x16_bf16 v[96:111], v[32:35], a[80:83], v[96:111]
    ds_read_b128 v[32:35], v248 offset:15360
    s_waitcnt lgkmcnt(7)
    v_mfma_f32_32x32x16_bf16 v[96:111], v[36:39], a[84:87], v[96:111]
    ds_read_b128 v[36:39], v249 offset:15360
    s_waitcnt lgkmcnt(7)
    v_mfma_f32_32x32x16_bf16 v[96:111], v[40:43], a[88:91], v[96:111]
    buffer_load_dwordx4 v8, s[68:71], s23 offen lds
    s_add_u32 m0, m0, 1024
    s_add_u32 s23, s23, 128
    ds_read_b128 v[40:43], v250 offset:15360
    s_add_u32 s24, s24, 12582912
    s_waitcnt lgkmcnt(7)
    v_mfma_f32_32x32x16_bf16 v[96:111], v[44:47], a[92:95], v[96:111]
    ds_read_b128 v[44:47], v251 offset:15360
    s_waitcnt lgkmcnt(7)
    v_mfma_f32_32x32x16_bf16 v[96:111], v[16:19], a[96:99], v[96:111]
    ds_read_b128 v[16:19], v248 offset:16384
    s_waitcnt lgkmcnt(7)
    v_mfma_f32_32x32x16_bf16 v[96:111], v[20:23], a[100:103], v[96:111]
    buffer_load_dwordx4 v8, s[68:71], s23 offen lds
    ds_read_b128 v[20:23], v249 offset:16384
    s_waitcnt lgkmcnt(7)
    v_mfma_f32_32x32x16_bf16 v[96:111], v[24:27], a[104:107], v[96:111]
    ds_read_b128 v[24:27], v250 offset:16384
    buffer_store_dwordx4 v[64:67], v72, s[4:7], s24 offen offset:0 sc1
    s_waitcnt lgkmcnt(7)
    v_mfma_f32_32x32x16_bf16 v[96:111], v[28:31], a[108:111], v[96:111]
    ds_read_b128 v[28:31], v251 offset:16384
    buffer_store_dwordx4 v[68:71], v72, s[4:7], s24 offen offset:576 sc1
    s_waitcnt lgkmcnt(7)
    v_mfma_f32_32x32x16_bf16 v[96:111], v[32:35], a[112:115], v[96:111]
    s_waitcnt lgkmcnt(6)
    v_mfma_f32_32x32x16_bf16 v[96:111], v[36:39], a[116:119], v[96:111]
    s_waitcnt lgkmcnt(5)
    v_mfma_f32_32x32x16_bf16 v[96:111], v[40:43], a[120:123], v[96:111]
    s_waitcnt lgkmcnt(4)
    v_mfma_f32_32x32x16_bf16 v[96:111], v[44:47], a[124:127], v[96:111]
    s_waitcnt lgkmcnt(3)
    v_mfma_f32_32x32x16_bf16 v[96:111], v[16:19], a[128:131], v[96:111]
    s_waitcnt lgkmcnt(2)
    v_mfma_f32_32x32x16_bf16 v[96:111], v[20:23], a[132:135], v[96:111]
    s_waitcnt lgkmcnt(1)
    v_mfma_f32_32x32x16_bf16 v[96:111], v[24:27], a[136:139], v[96:111]
    s_waitcnt lgkmcnt(0)
    v_mfma_f32_32x32x16_bf16 v[96:111], v[28:31], a[140:143], v[96:111]
    s_add_u32 s26, s26, 1
    s_mov_b32 s48, s22
    s_add_u32 s22, s22, 6
    s_cmp_gt_u32 s22, 63
    s_cbranch_scc1 L_aqv_end1
    s_waitcnt vmcnt(11)
    s_barrier
    s_add_u32 s28, s22, 12
    s_min_u32 s28, s28, 63
    s_mov_b32 s25, 73728
    ds_read_b128 v[16:19], v4 offset:0
    s_mul_i32 s17, s13, 9216
    s_add_u32 m0, s17, s25
    s_mul_i32 s23, s28, 36864
    ds_read_b128 v[20:23], v5 offset:0
    s_mul_i32 s24, s48, 1152
    v_cvt_pk_bf16_f32 v64, v96, v97
    v_cvt_pk_bf16_f32 v65, v98, v99
    ds_read_b128 v[24:27], v6 offset:0
    v_cvt_pk_bf16_f32 v66, v100, v101
    v_cvt_pk_bf16_f32 v67, v102, v103
    v_cvt_pk_bf16_f32 v68, v104, v105
    ds_read_b128 v[28:31], v7 offset:0
    v_cvt_pk_bf16_f32 v69, v106, v107
    v_cvt_pk_bf16_f32 v70, v108, v109
    v_cvt_pk_bf16_f32 v71, v110, v111
    ds_read_b128 v[32:35], v4 offset:1024
    ds_read_b128 v[36:39], v5 offset:1024
    ds_read_b128 v[40:43], v6 offset:1024
    ds_read_b128 v[44:47], v7 offset:1024
    s_waitcnt lgkmcnt(7)
    v_mfma_f32_32x32x16_bf16 v[48:63], v[16:19], a[0:3], 0
    ds_read_b128 v[16:19], v4 offset:2048
    s_waitcnt lgkmcnt(7)
    v_mfma_f32_32x32x16_bf16 v[48:63], v[20:23], a[4:7], v[48:63]
    ds_read_b128 v[20:23], v5 offset:2048
    buffer_load_dwordx4 v8, s[68:71], s23 offen lds
    s_add_u32 m0, m0, 1024
    s_add_u32 s23, s23, 128
    s_waitcnt lgkmcnt(7)
    v_mfma_f32_32x32x16_bf16 v[48:63], v[24:27], a[8:11], v[48:63]
    ds_read_b128 v[24:27], v6 offset:2048
    s_waitcnt lgkmcnt(7)
    v_mfma_f32_32x32x16_bf16 v[48:63], v[28:31], a[12:15], v[48:63]
    ds_read_b128 v[28:31], v7 offset:2048
    s_waitcnt lgkmcnt(7)
    v_mfma_f32_32x32x16_bf16 v[48:63], v[32:35], a[16:19], v[48:63]
    ds_read_b128 v[32:35], v4 offset:3072
    buffer_load_dwordx4 v8, s[68:71], s23 offen lds
    s_add_u32 m0, m0, 1024
    s_add_u32 s23, s23, 128
    s_waitcnt lgkmcnt(7)
    v_mfma_f32_32x32x16_bf16 v[48:63], v[36:39], a[20:23], v[48:63]
    ds_read_b128 v[36:39], v5 offset:3072
    s_waitcnt lgkmcnt(7)
    v_mfma_f32_32x32x16_bf16 v[48:63], v[40:43], a[24:27], v[48:63]
    ds_read_b128 v[40:43], v6 offset:3072
    s_waitcnt lgkmcnt(7)
    v_mfma_f32_32x32x16_bf16 v[48:63], v[44:47], a[28:31], v[48:63]
    ds_read_b128 v[44:47], v7 offset:3072
    buffer_load_dwordx4 v8, s[68:71], s23 offen lds
    s_add_u32 m0, m0, 1024
    s_add_u32 s23, s23, 128
    s_waitcnt lgkmcnt(7)
    v_mfma_f32_32x32x16_bf16 v[48:63], v[16:19], a[32:35], v[48:63]
    ds_read_b128 v[16:19], v4 offset:4096
    s_waitcnt lgkmcnt(7)
    v_mfma_f32_32x32x16_bf16 v[48:63], v[20:23], a[36:39], v[48:63]
    ds_read_b128 v[20:23], v5 offset:4096
    s_waitcnt lgkmcnt(7)
    v_mfma_f32_32x32x16_bf16 v[48:63], v[24:27], a[40:43], v[48:63]
    ds_read_b128 v[24:27], v6 offset:4096
    buffer_load_dwordx4 v8, s[68:71], s23 offen lds
    s_add_u32 m0, m0, 1024
    s_add_u32 s23, s23, 128
    s_waitcnt lgkmcnt(7)
    v_mfma_f32_32x32x16_bf16 v[48:63], v[28:31], a[44:47], v[48:63]
    ds_read_b128 v[28:31], v7 offset:4096
    s_waitcnt lgkmcnt(7)
    v_mfma_f32_32x32x16_bf16 v[48:63], v[32:35], a[48:51], v[48:63]
    ds_read_b128 v[32:35], v4 offset:5120
    s_waitcnt lgkmcnt(7)
    v_mfma_f32_32x32x16_bf16 v[48:63], v[36:39], a[52:55], v[48:63]
    ds_read_b128 v[36:39], v5 offset:5120
    buffer_load_dwordx4 v8, s[68:71], s23 offen lds
    s_add_u32 m0, m0, 1024
    s_add_u32 s23, s23, 128
    s_waitcnt lgkmcnt(7)
    v_mfma_f32_32x32x16_bf16 v[48:63], v[40:43], a[56:59], v[48:63]
    ds_read_b128 v[40:43], v6 offset:5120
    s_waitcnt lgkmcnt(7)
    v_mfma_f32_32x32x16_bf16 v[48:63], v[44:47], a[60:63], v[48:63]
    ds_read_b128 v[44:47], v7 offset:5120
    s_waitcnt lgkmcnt(7)
    v_mfma_f32_32x32x16_bf16 v[48:63], v[16:19], a[64:67], v[48:63]
    ds_read_b128 v[16:19], v4 offset:6144
    buffer_load_dwordx4 v8, s[68:71], s23 offen lds
    s_add_u32 m0, m0, 1024
    s_add_u32 s23, s23, 128
    s_waitcnt lgkmcnt(7)
    v_mfma_f32_32x32x16_bf16 v[48:63], v[20:23], a[68:71], v[48:63]
    ds_read_b128 v[20:23], v5 offset:6144
    s_waitcnt lgkmcnt(7)
    v_mfma_f32_32x32x16_bf16 v[48:63], v[24:27], a[72:75], v[48:63]
    ds_read_b128 v[24:27], v6 offset:6144
    s_waitcnt lgkmcnt(7)
    v_mfma_f32_32x32x16_bf16 v[48:63], v[28:31], a[76:79], v[48:63]
    buffer_load_dwordx4 v8, s[68:71], s23 offen lds
    s_add_u32 m0, m0, 1024
    s_add_u32 s23, s23, 128
    ds_read_b128 v[28:31], v7 offset:6144
    s_waitcnt lgkmcnt(7)
    v_mfma_f32_32x32x16_bf16 v[48:63], v[32:35], a[80:83], v[48:63]
    ds_read_b128 v[32:35], v4 offset:7168
    s_waitcnt lgkmcnt(7)
    v_mfma_f32_32x32x16_bf16 v[48:63], v[36:39], a[84:87], v[48:63]
    ds_read_b128 v[36:39], v5 offset:7168
    s_waitcnt lgkmcnt(7)
    v_mfma_f32_32x32x16_bf16 v[48:63], v[40:43], a[88:91], v[48:63]
    buffer_load_dwordx4 v8, s[68:71], s23 offen lds
    s_add_u32 m0, m0, 1024
    s_add_u32 s23, s23, 128
    ds_read_b128 v[40:43], v6 offset:7168
    s_add_u32 s24, s24, 12582912
    s_waitcnt lgkmcnt(7)
    v_mfma_f32_32x32x16_bf16 v[48:63], v[44:47], a[92:95], v[48:63]
    ds_read_b128 v[44:47], v7 offset:7168
    s_waitcnt lgkmcnt(7)
    v_mfma_f32_32x32x16_bf16 v[48:63], v[16:19], a[96:99], v[48:63]
    ds_read_b128 v[16:19], v4 offset:8192
    s_waitcnt lgkmcnt(7)
    v_mfma_f32_32x32x16_bf16 v[48:63], v[20:23], a[100:103], v[48:63]
    buffer_load_dwordx4 v8, s[68:71], s23 offen lds
    ds_read_b128 v[20:23], v5 offset:8192
    s_waitcnt lgkmcnt(7)
    v_mfma_f32_32x32x16_bf16 v[48:63], v[24:27], a[104:107], v[48:63]
    ds_read_b128 v[24:27], v6 offset:8192
    buffer_store_dwordx4 v[64:67], v72, s[4:7], s24 offen offset:0 sc1
    s_waitcnt lgkmcnt(7)
    v_mfma_f32_32x32x16_bf16 v[48:63], v[28:31], a[108:111], v[48:63]
    ds_read_b128 v[28:31], v7 offset:8192
    buffer_store_dwordx4 v[68:71], v72, s[4:7], s24 offen offset:576 sc1
    s_waitcnt lgkmcnt(7)
    v_mfma_f32_32x32x16_bf16 v[48:63], v[32:35], a[112:115], v[48:63]
    s_waitcnt lgkmcnt(6)
    v_mfma_f32_32x32x16_bf16 v[48:63], v[36:39], a[116:119], v[48:63]
    s_waitcnt lgkmcnt(5)
    v_mfma_f32_32x32x16_bf16 v[48:63], v[40:43], a[120:123], v[48:63]
    s_waitcnt lgkmcnt(4)
    v_mfma_f32_32x32x16_bf16 v[48:63], v[44:47], a[124:127], v[48:63]
    s_waitcnt lgkmcnt(3)
    v_mfma_f32_32x32x16_bf16 v[48:63], v[16:19], a[128:131], v[48:63]
    s_waitcnt lgkmcnt(2)
    v_mfma_f32_32x32x16_bf16 v[48:63], v[20:23], a[132:135], v[48:63]
    s_waitcnt lgkmcnt(1)
    v_mfma_f32_32x32x16_bf16 v[48:63], v[24:27], a[136:139], v[48:63]
    s_waitcnt lgkmcnt(0)
    v_mfma_f32_32x32x16_bf16 v[48:63], v[28:31], a[140:143], v[48:63]
    s_add_u32 s26, s26, 1
    s_mov_b32 s48, s22
    s_add_u32 s22, s22, 6
    s_cmp_gt_u32 s22, 63
    s_cbranch_scc1 L_aqv_end0
    s_waitcnt vmcnt(11)
    s_branch L_aqv_lp
L_aqv_end0:
    s_nop 7
    s_nop 3
    s_mul_i32 s24, s48, 1152
    v_cvt_pk_bf16_f32 v64, v48, v49
    v_cvt_pk_bf16_f32 v65, v50, v51
    v_cvt_pk_bf16_f32 v66, v52, v53
    v_cvt_pk_bf16_f32 v67, v54, v55
    v_cvt_pk_bf16_f32 v68, v56, v57
    v_cvt_pk_bf16_f32 v69, v58, v59
    v_cvt_pk_bf16_f32 v70, v60, v61
    v_cvt_pk_bf16_f32 v71, v62, v63
    s_add_u32 s24, s24, 12582912
    buffer_store_dwordx4 v[64:67], v72, s[4:7], s24 offen offset:0 sc1
    buffer_store_dwordx4 v[68:71], v72, s[4:7], s24 offen offset:576 sc1
    s_branch L_aqv_end
L_aqv_end1:
    s_nop 7
    s_nop 3
    s_mul_i32 s24, s48, 1152
    v_cvt_pk_bf16_f32 v64, v96, v97
    v_cvt_pk_bf16_f32 v65, v98, v99
    v_cvt_pk_bf16_f32 v66, v100, v101
    v_cvt_pk_bf16_f32 v67, v102, v103
    v_cvt_pk_bf16_f32 v68, v104, v105
    v_cvt_pk_bf16_f32 v69, v106, v107
    v_cvt_pk_bf16_f32 v70, v108, v109
    v_cvt_pk_bf16_f32 v71, v110, v111
    s_add_u32 s24, s24, 12582912
    buffer_store_dwordx4 v[64:67], v72, s[4:7], s24 offen offset:0 sc1
    buffer_store_dwordx4 v[68:71], v72, s[4:7], s24 offen offset:576 sc1
L_aqv_end:
    s_branch L_aq_done
        L_aq_g:
    v_lshlrev_b32 v72, 3, v14
    v_mov_b32 v9, 1073741824
    s_cmp_eq_u32 s29, 54
    s_cselect_b32 s17, 32, 0
    v_cmp_gt_u32 vcc, s17, v1
    s_mov_b32 s31, 0xbfb8aa3b
    s_mov_b32 s33, 0xffff0000
    v_cndmask_b32 v72, v9, v72, vcc
    s_mov_b32 s25, 0
    s_mul_i32 s17, s13, 9216
    s_add_u32 m0, s17, s25
    s_mul_i32 s23, s22, 36864
    buffer_load_dwordx4 v8, s[68:71], s23 offen lds
    s_add_u32 m0, m0, 1024
    s_add_u32 s23, s23, 128
    buffer_load_dwordx4 v8, s[68:71], s23 offen lds
    s_add_u32 m0, m0, 1024
    s_add_u32 s23, s23, 128
    buffer_load_dwordx4 v8, s[68:71], s23 offen lds
    s_add_u32 m0, m0, 1024
    s_add_u32 s23, s23, 128
    buffer_load_dwordx4 v8, s[68:71], s23 offen lds
    s_add_u32 m0, m0, 1024
    s_add_u32 s23, s23, 128
    buffer_load_dwordx4 v8, s[68:71], s23 offen lds
    s_add_u32 m0, m0, 1024
    s_add_u32 s23, s23, 128
    buffer_load_dwordx4 v8, s[68:71], s23 offen lds
    s_add_u32 m0, m0, 1024
    s_add_u32 s23, s23, 128
    buffer_load_dwordx4 v8, s[68:71], s23 offen lds
    s_add_u32 m0, m0, 1024
    s_add_u32 s23, s23, 128
    buffer_load_dwordx4 v8, s[68:71], s23 offen lds
    s_add_u32 m0, m0, 1024
    s_add_u32 s23, s23, 128
    buffer_load_dwordx4 v8, s[68:71], s23 offen lds
    s_add_u32 s28, s22, 6
    s_min_u32 s28, s28, 63
    s_mov_b32 s25, 36864
    s_mul_i32 s17, s13, 9216
    s_add_u32 m0, s17, s25
    s_mul_i32 s23, s28, 36864
    buffer_load_dwordx4 v8, s[68:71], s23 offen lds
    s_add_u32 m0, m0, 1024
    s_add_u32 s23, s23, 128
    buffer_load_dwordx4 v8, s[68:71], s23 offen lds
    s_add_u32 m0, m0, 1024
    s_add_u32 s23, s23, 128
    buffer_load_dwordx4 v8, s[68:71], s23 offen lds
    s_add_u32 m0, m0, 1024
    s_add_u32 s23, s23, 128
    buffer_load_dwordx4 v8, s[68:71], s23 offen lds
    s_add_u32 m0, m0, 1024
    s_add_u32 s23, s23, 128
    buffer_load_dwordx4 v8, s[68:71], s23 offen lds
    s_add_u32 m0, m0, 1024
    s_add_u32 s23, s23, 128
    buffer_load_dwordx4 v8, s[68:71], s23 offen lds
    s_add_u32 m0, m0, 1024
    s_add_u32 s23, s23, 128
    buffer_load_dwordx4 v8, s[68:71], s23 offen lds
    s_add_u32 m0, m0, 1024
    s_add_u32 s23, s23, 128
    buffer_load_dwordx4 v8, s[68:71], s23 offen lds
    s_add_u32 m0, m0, 1024
    s_add_u32 s23, s23, 128
    buffer_load_dwordx4 v8, s[68:71], s23 offen lds
    s_mov_b32 s26, 0
    s_waitcnt vmcnt(9)
    s_barrier
    s_add_u32 s28, s22, 12
    s_min_u32 s28, s28, 63
    s_mov_b32 s25, 73728
    ds_read_b128 v[16:19], v4 offset:0
    s_mul_i32 s17, s13, 9216
    s_add_u32 m0, s17, s25
    s_mul_i32 s23, s28, 36864
    ds_read_b128 v[20:23], v5 offset:0
    ds_read_b128 v[24:27], v6 offset:0
    ds_read_b128 v[28:31], v7 offset:0
    ds_read_b128 v[32:35], v4 offset:1024
    ds_read_b128 v[36:39], v5 offset:1024
    ds_read_b128 v[40:43], v6 offset:1024
    ds_read_b128 v[44:47], v7 offset:1024
    s_waitcnt lgkmcnt(7)
    v_mfma_f32_32x32x16_bf16 v[48:63], a[0:3], v[16:19], 0
    ds_read_b128 v[16:19], v4 offset:2048
    s_waitcnt lgkmcnt(7)
    v_mfma_f32_32x32x16_bf16 v[48:63], a[4:7], v[20:23], v[48:63]
    ds_read_b128 v[20:23], v5 offset:2048
    buffer_load_dwordx4 v8, s[68:71], s23 offen lds
    s_add_u32 m0, m0, 1024
    s_add_u32 s23, s23, 128
    s_waitcnt lgkmcnt(7)
    v_mfma_f32_32x32x16_bf16 v[48:63], a[8:11], v[24:27], v[48:63]
    ds_read_b128 v[24:27], v6 offset:2048
    s_waitcnt lgkmcnt(7)
    v_mfma_f32_32x32x16_bf16 v[48:63], a[12:15], v[28:31], v[48:63]
    ds_read_b128 v[28:31], v7 offset:2048
    s_waitcnt lgkmcnt(7)
    v_mfma_f32_32x32x16_bf16 v[48:63], a[16:19], v[32:35], v[48:63]
    ds_read_b128 v[32:35], v4 offset:3072
    buffer_load_dwordx4 v8, s[68:71], s23 offen lds
    s_add_u32 m0, m0, 1024
    s_add_u32 s23, s23, 128
    s_waitcnt lgkmcnt(7)
    v_mfma_f32_32x32x16_bf16 v[48:63], a[20:23], v[36:39], v[48:63]
    ds_read_b128 v[36:39], v5 offset:3072
    s_waitcnt lgkmcnt(7)
    v_mfma_f32_32x32x16_bf16 v[48:63], a[24:27], v[40:43], v[48:63]
    ds_read_b128 v[40:43], v6 offset:3072
    s_waitcnt lgkmcnt(7)
    v_mfma_f32_32x32x16_bf16 v[48:63], a[28:31], v[44:47], v[48:63]
    ds_read_b128 v[44:47], v7 offset:3072
    buffer_load_dwordx4 v8, s[68:71], s23 offen lds
    s_add_u32 m0, m0, 1024
    s_add_u32 s23, s23, 128
    s_waitcnt lgkmcnt(7)
    v_mfma_f32_32x32x16_bf16 v[48:63], a[32:35], v[16:19], v[48:63]
    ds_read_b128 v[16:19], v4 offset:4096
    s_waitcnt lgkmcnt(7)
    v_mfma_f32_32x32x16_bf16 v[48:63], a[36:39], v[20:23], v[48:63]
    ds_read_b128 v[20:23], v5 offset:4096
    s_waitcnt lgkmcnt(7)
    v_mfma_f32_32x32x16_bf16 v[48:63], a[40:43], v[24:27], v[48:63]
    ds_read_b128 v[24:27], v6 offset:4096
    buffer_load_dwordx4 v8, s[68:71], s23 offen lds
    s_add_u32 m0, m0, 1024
    s_add_u32 s23, s23, 128
    s_waitcnt lgkmcnt(7)
    v_mfma_f32_32x32x16_bf16 v[48:63], a[44:47], v[28:31], v[48:63]
    ds_read_b128 v[28:31], v7 offset:4096
    s_waitcnt lgkmcnt(7)
    v_mfma_f32_32x32x16_bf16 v[48:63], a[48:51], v[32:35], v[48:63]
    ds_read_b128 v[32:35], v4 offset:5120
    s_waitcnt lgkmcnt(7)
    v_mfma_f32_32x32x16_bf16 v[48:63], a[52:55], v[36:39], v[48:63]
    ds_read_b128 v[36:39], v5 offset:5120
    buffer_load_dwordx4 v8, s[68:71], s23 offen lds
    s_add_u32 m0, m0, 1024
    s_add_u32 s23, s23, 128
    s_waitcnt lgkmcnt(7)
    v_mfma_f32_32x32x16_bf16 v[48:63], a[56:59], v[40:43], v[48:63]
    ds_read_b128 v[40:43], v6 offset:5120
    s_waitcnt lgkmcnt(7)
    v_mfma_f32_32x32x16_bf16 v[48:63], a[60:63], v[44:47], v[48:63]
    ds_read_b128 v[44:47], v7 offset:5120
    s_waitcnt lgkmcnt(7)
    v_mfma_f32_32x32x16_bf16 v[48:63], a[64:67], v[16:19], v[48:63]
    ds_read_b128 v[16:19], v4 offset:6144
    buffer_load_dwordx4 v8, s[68:71], s23 offen lds
    s_add_u32 m0, m0, 1024
    s_add_u32 s23, s23, 128
    s_waitcnt lgkmcnt(7)
    v_mfma_f32_32x32x16_bf16 v[48:63], a[68:71], v[20:23], v[48:63]
    ds_read_b128 v[20:23], v5 offset:6144
    s_waitcnt lgkmcnt(7)
    v_mfma_f32_32x32x16_bf16 v[48:63], a[72:75], v[24:27], v[48:63]
    ds_read_b128 v[24:27], v6 offset:6144
    s_waitcnt lgkmcnt(7)
    v_mfma_f32_32x32x16_bf16 v[48:63], a[76:79], v[28:31], v[48:63]
    buffer_load_dwordx4 v8, s[68:71], s23 offen lds
    s_add_u32 m0, m0, 1024
    s_add_u32 s23, s23, 128
    ds_read_b128 v[28:31], v7 offset:6144
    s_waitcnt lgkmcnt(7)
    v_mfma_f32_32x32x16_bf16 v[48:63], a[80:83], v[32:35], v[48:63]
    ds_read_b128 v[32:35], v4 offset:7168
    s_waitcnt lgkmcnt(7)
    v_mfma_f32_32x32x16_bf16 v[48:63], a[84:87], v[36:39], v[48:63]
    ds_read_b128 v[36:39], v5 offset:7168
    s_waitcnt lgkmcnt(7)
    v_mfma_f32_32x32x16_bf16 v[48:63], a[88:91], v[40:43], v[48:63]
    buffer_load_dwordx4 v8, s[68:71], s23 offen lds
    s_add_u32 m0, m0, 1024
    s_add_u32 s23, s23, 128
    ds_read_b128 v[40:43], v6 offset:7168
    s_waitcnt lgkmcnt(7)
    v_mfma_f32_32x32x16_bf16 v[48:63], a[92:95], v[44:47], v[48:63]
    ds_read_b128 v[44:47], v7 offset:7168
    s_waitcnt lgkmcnt(7)
    v_mfma_f32_32x32x16_bf16 v[48:63], a[96:99], v[16:19], v[48:63]
    ds_read_b128 v[16:19], v4 offset:8192
    s_waitcnt lgkmcnt(7)
    v_mfma_f32_32x32x16_bf16 v[48:63], a[100:103], v[20:23], v[48:63]
    buffer_load_dwordx4 v8, s[68:71], s23 offen lds
    ds_read_b128 v[20:23], v5 offset:8192
    s_waitcnt lgkmcnt(7)
    v_mfma_f32_32x32x16_bf16 v[48:63], a[104:107], v[24:27], v[48:63]
    ds_read_b128 v[24:27], v6 offset:8192
    s_waitcnt lgkmcnt(7)
    v_mfma_f32_32x32x16_bf16 v[48:63], a[108:111], v[28:31], v[48:63]
    ds_read_b128 v[28:31], v7 offset:8192
    s_waitcnt lgkmcnt(7)
    v_mfma_f32_32x32x16_bf16 v[48:63], a[112:115], v[32:35], v[48:63]
    s_waitcnt lgkmcnt(6)
    v_mfma_f32_32x32x16_bf16 v[48:63], a[116:119], v[36:39], v[48:63]
    s_waitcnt lgkmcnt(5)
    v_mfma_f32_32x32x16_bf16 v[48:63], a[120:123], v[40:43], v[48:63]
    s_waitcnt lgkmcnt(4)
    v_mfma_f32_32x32x16_bf16 v[48:63], a[124:127], v[44:47], v[48:63]
    s_waitcnt lgkmcnt(3)
    v_mfma_f32_32x32x16_bf16 v[48:63], a[128:131], v[16:19], v[48:63]
    s_waitcnt lgkmcnt(2)
    v_mfma_f32_32x32x16_bf16 v[48:63], a[132:135], v[20:23], v[48:63]
    s_waitcnt lgkmcnt(1)
    v_mfma_f32_32x32x16_bf16 v[48:63], a[136:139], v[24:27], v[48:63]
    s_waitcnt lgkmcnt(0)
    v_mfma_f32_32x32x16_bf16 v[48:63], a[140:143], v[28:31], v[48:63]
    s_mov_b32 s48, s22
    s_add_u32 s22, s22, 6
    s_waitcnt vmcnt(9)
L_aqg_lp:
    s_barrier
    s_add_u32 s28, s22, 12
    s_min_u32 s28, s28, 63
    s_mov_b32 s25, 0
    ds_read_b128 v[16:19], v4 offset:36864
    s_mul_i32 s17, s13, 9216
    s_add_u32 m0, s17, s25
    s_mul_i32 s23, s28, 36864
    ds_read_b128 v[20:23], v5 offset:36864
    v_cvt_pk_bf16_f32 v64, v48, v48
    v_and_b32 v64, s33, v64
    ds_read_b128 v[24:27], v6 offset:36864
    v_mul_f32 v64, s31, v64
    v_exp_f32 v64, v64
    ds_read_b128 v[28:31], v7 offset:36864
    v_add_f32 v64, 1.0, v64
    ds_read_b128 v[32:35], v4 offset:37888
    v_rcp_f32 v64, v64
    ds_read_b128 v[36:39], v5 offset:37888
    v_cvt_pk_bf16_f32 v64, v64, v64
    v_and_b32 v64, s33, v64
    ds_read_b128 v[40:43], v6 offset:37888
    v_sub_f32 v65, 1.0, v64
    v_cvt_pk_bf16_f32 v65, v65, v65
    ds_read_b128 v[44:47], v7 offset:37888
    v_and_b32 v65, s33, v65
    s_waitcnt lgkmcnt(7)
    v_mfma_f32_32x32x16_bf16 v[96:111], a[0:3], v[16:19], 0
    ds_read_b128 v[16:19], v4 offset:38912
    s_waitcnt lgkmcnt(7)
    v_mfma_f32_32x32x16_bf16 v[96:111], a[4:7], v[20:23], v[96:111]
    ds_read_b128 v[20:23], v5 offset:38912
    buffer_load_dwordx4 v8, s[68:71], s23 offen lds
    s_add_u32 m0, m0, 1024
    s_add_u32 s23, s23, 128
    s_waitcnt lgkmcnt(7)
    v_mfma_f32_32x32x16_bf16 v[96:111], a[8:11], v[24:27], v[96:111]
    ds_read_b128 v[24:27], v6 offset:38912
    s_waitcnt lgkmcnt(7)
    v_mfma_f32_32x32x16_bf16 v[96:111], a[12:15], v[28:31], v[96:111]
    ds_read_b128 v[28:31], v7 offset:38912
    s_waitcnt lgkmcnt(7)
    v_mfma_f32_32x32x16_bf16 v[96:111], a[16:19], v[32:35], v[96:111]
    ds_read_b128 v[32:35], v4 offset:39936
    buffer_load_dwordx4 v8, s[68:71], s23 offen lds
    s_add_u32 m0, m0, 1024
    s_add_u32 s23, s23, 128
    s_waitcnt lgkmcnt(7)
    v_mfma_f32_32x32x16_bf16 v[96:111], a[20:23], v[36:39], v[96:111]
    ds_read_b128 v[36:39], v5 offset:39936
    s_waitcnt lgkmcnt(7)
    v_mfma_f32_32x32x16_bf16 v[96:111], a[24:27], v[40:43], v[96:111]
    ds_read_b128 v[40:43], v6 offset:39936
    s_waitcnt lgkmcnt(7)
    v_mfma_f32_32x32x16_bf16 v[96:111], a[28:31], v[44:47], v[96:111]
    ds_read_b128 v[44:47], v7 offset:39936
    buffer_load_dwordx4 v8, s[68:71], s23 offen lds
    s_add_u32 m0, m0, 1024
    s_add_u32 s23, s23, 128
    s_waitcnt lgkmcnt(7)
    v_mfma_f32_32x32x16_bf16 v[96:111], a[32:35], v[16:19], v[96:111]
    ds_read_b128 v[16:19], v4 offset:40960
    s_waitcnt lgkmcnt(7)
    v_mfma_f32_32x32x16_bf16 v[96:111], a[36:39], v[20:23], v[96:111]
    ds_read_b128 v[20:23], v5 offset:40960
    s_waitcnt lgkmcnt(7)
    v_mfma_f32_32x32x16_bf16 v[96:111], a[40:43], v[24:27], v[96:111]
    ds_read_b128 v[24:27], v6 offset:40960
    buffer_load_dwordx4 v8, s[68:71], s23 offen lds
    s_add_u32 m0, m0, 1024
    s_add_u32 s23, s23, 128
    s_waitcnt lgkmcnt(7)
    v_mfma_f32_32x32x16_bf16 v[96:111], a[44:47], v[28:31], v[96:111]
    ds_read_b128 v[28:31], v7 offset:40960
    s_waitcnt lgkmcnt(7)
    v_mfma_f32_32x32x16_bf16 v[96:111], a[48:51], v[32:35], v[96:111]
    ds_read_b128 v[32:35], v4 offset:41984
    s_waitcnt lgkmcnt(7)
    v_mfma_f32_32x32x16_bf16 v[96:111], a[52:55], v[36:39], v[96:111]
    ds_read_b128 v[36:39], v5 offset:41984
    buffer_load_dwordx4 v8, s[68:71], s23 offen lds
    s_add_u32 m0, m0, 1024
    s_add_u32 s23, s23, 128
    s_waitcnt lgkmcnt(7)
    v_mfma_f32_32x32x16_bf16 v[96:111], a[56:59], v[40:43], v[96:111]
    ds_read_b128 v[40:43], v6 offset:41984
    s_waitcnt lgkmcnt(7)
    v_mfma_f32_32x32x16_bf16 v[96:111], a[60:63], v[44:47], v[96:111]
    ds_read_b128 v[44:47], v7 offset:41984
    s_waitcnt lgkmcnt(7)
    v_mfma_f32_32x32x16_bf16 v[96:111], a[64:67], v[16:19], v[96:111]
    ds_read_b128 v[16:19], v4 offset:43008
    buffer_load_dwordx4 v8, s[68:71], s23 offen lds
    s_add_u32 m0, m0, 1024
    s_add_u32 s23, s23, 128
    s_waitcnt lgkmcnt(7)
    v_mfma_f32_32x32x16_bf16 v[96:111], a[68:71], v[20:23], v[96:111]
    ds_read_b128 v[20:23], v5 offset:43008
    s_waitcnt lgkmcnt(7)
    v_mfma_f32_32x32x16_bf16 v[96:111], a[72:75], v[24:27], v[96:111]
    ds_read_b128 v[24:27], v6 offset:43008
    s_waitcnt lgkmcnt(7)
    v_mfma_f32_32x32x16_bf16 v[96:111], a[76:79], v[28:31], v[96:111]
    buffer_load_dwordx4 v8, s[68:71], s23 offen lds
    s_add_u32 m0, m0, 1024
    s_add_u32 s23, s23, 128
    ds_read_b128 v[28:31], v7 offset:43008
    s_waitcnt lgkmcnt(7)
    v_mfma_f32_32x32x16_bf16 v[96:111], a[80:83], v[32:35], v[96:111]
    ds_read_b128 v[32:35], v4 offset:44032
    s_waitcnt lgkmcnt(7)
    v_mfma_f32_32x32x16_bf16 v[96:111], a[84:87], v[36:39], v[96:111]
    ds_read_b128 v[36:39], v5 offset:44032
    s_waitcnt lgkmcnt(7)
    v_mfma_f32_32x32x16_bf16 v[96:111], a[88:91], v[40:43], v[96:111]
    buffer_load_dwordx4 v8, s[68:71], s23 offen lds
    s_add_u32 m0, m0, 1024
    s_add_u32 s23, s23, 128
    ds_read_b128 v[40:43], v6 offset:44032
    s_lshl_b32 s24, s48, 8
    s_add_u32 s24, s24, 262144
    s_waitcnt lgkmcnt(7)
    v_mfma_f32_32x32x16_bf16 v[96:111], a[92:95], v[44:47], v[96:111]
    ds_read_b128 v[44:47], v7 offset:44032
    s_waitcnt lgkmcnt(7)
    v_mfma_f32_32x32x16_bf16 v[96:111], a[96:99], v[16:19], v[96:111]
    ds_read_b128 v[16:19], v4 offset:45056
    s_waitcnt lgkmcnt(7)
    v_mfma_f32_32x32x16_bf16 v[96:111], a[100:103], v[20:23], v[96:111]
    buffer_load_dwordx4 v8, s[68:71], s23 offen lds
    ds_read_b128 v[20:23], v5 offset:45056
    s_waitcnt lgkmcnt(7)
    v_mfma_f32_32x32x16_bf16 v[96:111], a[104:107], v[24:27], v[96:111]
    ds_read_b128 v[24:27], v6 offset:45056
    buffer_store_dwordx2 v[64:65], v72, s[4:7], s24 offen sc1
    s_waitcnt lgkmcnt(7)
    v_mfma_f32_32x32x16_bf16 v[96:111], a[108:111], v[28:31], v[96:111]
    ds_read_b128 v[28:31], v7 offset:45056
    s_waitcnt lgkmcnt(7)
    v_mfma_f32_32x32x16_bf16 v[96:111], a[112:115], v[32:35], v[96:111]
    s_waitcnt lgkmcnt(6)
    v_mfma_f32_32x32x16_bf16 v[96:111], a[116:119], v[36:39], v[96:111]
    s_waitcnt lgkmcnt(5)
    v_mfma_f32_32x32x16_bf16 v[96:111], a[120:123], v[40:43], v[96:111]
    s_waitcnt lgkmcnt(4)
    v_mfma_f32_32x32x16_bf16 v[96:111], a[124:127], v[44:47], v[96:111]
    s_waitcnt lgkmcnt(3)
    v_mfma_f32_32x32x16_bf16 v[96:111], a[128:131], v[16:19], v[96:111]
    s_waitcnt lgkmcnt(2)
    v_mfma_f32_32x32x16_bf16 v[96:111], a[132:135], v[20:23], v[96:111]
    s_waitcnt lgkmcnt(1)
    v_mfma_f32_32x32x16_bf16 v[96:111], a[136:139], v[24:27], v[96:111]
    s_waitcnt lgkmcnt(0)
    v_mfma_f32_32x32x16_bf16 v[96:111], a[140:143], v[28:31], v[96:111]
    s_add_u32 s26, s26, 1
    s_mov_b32 s48, s22
    s_add_u32 s22, s22, 6
    s_cmp_gt_u32 s22, 63
    s_cbranch_scc1 L_aqg_end1
    s_waitcnt vmcnt(10)
    s_barrier
    s_add_u32 s28, s22, 12
    s_min_u32 s28, s28, 63
    s_mov_b32 s25, 36864
    ds_read_b128 v[16:19], v248 offset:8192
    s_mul_i32 s17, s13, 9216
    s_add_u32 m0, s17, s25
    s_mul_i32 s23, s28, 36864
    ds_read_b128 v[20:23], v249 offset:8192
    v_cvt_pk_bf16_f32 v64, v96, v96
    v_and_b32 v64, s33, v64
    ds_read_b128 v[24:27], v250 offset:8192
    v_mul_f32 v64, s31, v64
    v_exp_f32 v64, v64
    ds_read_b128 v[28:31], v251 offset:8192
    v_add_f32 v64, 1.0, v64
    ds_read_b128 v[32:35], v248 offset:9216
    v_rcp_f32 v64, v64
    ds_read_b128 v[36:39], v249 offset:9216
    v_cvt_pk_bf16_f32 v64, v64, v64
    v_and_b32 v64, s33, v64
    ds_read_b128 v[40:43], v250 offset:9216
    v_sub_f32 v65, 1.0, v64
    v_cvt_pk_bf16_f32 v65, v65, v65
    ds_read_b128 v[44:47], v251 offset:9216
    v_and_b32 v65, s33, v65
    s_waitcnt lgkmcnt(7)
    v_mfma_f32_32x32x16_bf16 v[48:63], a[0:3], v[16:19], 0
    ds_read_b128 v[16:19], v248 offset:10240
    s_waitcnt lgkmcnt(7)
    v_mfma_f32_32x32x16_bf16 v[48:63], a[4:7], v[20:23], v[48:63]
    ds_read_b128 v[20:23], v249 offset:10240
    buffer_load_dwordx4 v8, s[68:71], s23 offen lds
    s_add_u32 m0, m0, 1024
    s_add_u32 s23, s23, 128
    s_waitcnt lgkmcnt(7)
    v_mfma_f32_32x32x16_bf16 v[48:63], a[8:11], v[24:27], v[48:63]
    ds_read_b128 v[24:27], v250 offset:10240
    s_waitcnt lgkmcnt(7)
    v_mfma_f32_32x32x16_bf16 v[48:63], a[12:15], v[28:31], v[48:63]
    ds_read_b128 v[28:31], v251 offset:10240
    s_waitcnt lgkmcnt(7)
    v_mfma_f32_32x32x16_bf16 v[48:63], a[16:19], v[32:35], v[48:63]
    ds_read_b128 v[32:35], v248 offset:11264
    buffer_load_dwordx4 v8, s[68:71], s23 offen lds
    s_add_u32 m0, m0, 1024
    s_add_u32 s23, s23, 128
    s_waitcnt lgkmcnt(7)
    v_mfma_f32_32x32x16_bf16 v[48:63], a[20:23], v[36:39], v[48:63]
    ds_read_b128 v[36:39], v249 offset:11264
    s_waitcnt lgkmcnt(7)
    v_mfma_f32_32x32x16_bf16 v[48:63], a[24:27], v[40:43], v[48:63]
    ds_read_b128 v[40:43], v250 offset:11264
    s_waitcnt lgkmcnt(7)
    v_mfma_f32_32x32x16_bf16 v[48:63], a[28:31], v[44:47], v[48:63]
    ds_read_b128 v[44:47], v251 offset:11264
    buffer_load_dwordx4 v8, s[68:71], s23 offen lds
    s_add_u32 m0, m0, 1024
    s_add_u32 s23, s23, 128
    s_waitcnt lgkmcnt(7)
    v_mfma_f32_32x32x16_bf16 v[48:63], a[32:35], v[16:19], v[48:63]
    ds_read_b128 v[16:19], v248 offset:12288
    s_waitcnt lgkmcnt(7)
    v_mfma_f32_32x32x16_bf16 v[48:63], a[36:39], v[20:23], v[48:63]
    ds_read_b128 v[20:23], v249 offset:12288
    s_waitcnt lgkmcnt(7)
    v_mfma_f32_32x32x16_bf16 v[48:63], a[40:43], v[24:27], v[48:63]
    ds_read_b128 v[24:27], v250 offset:12288
    buffer_load_dwordx4 v8, s[68:71], s23 offen lds
    s_add_u32 m0, m0, 1024
    s_add_u32 s23, s23, 128
    s_waitcnt lgkmcnt(7)
    v_mfma_f32_32x32x16_bf16 v[48:63], a[44:47], v[28:31], v[48:63]
    ds_read_b128 v[28:31], v251 offset:12288
    s_waitcnt lgkmcnt(7)
    v_mfma_f32_32x32x16_bf16 v[48:63], a[48:51], v[32:35], v[48:63]
    ds_read_b128 v[32:35], v248 offset:13312
    s_waitcnt lgkmcnt(7)
    v_mfma_f32_32x32x16_bf16 v[48:63], a[52:55], v[36:39], v[48:63]
    ds_read_b128 v[36:39], v249 offset:13312
    buffer_load_dwordx4 v8, s[68:71], s23 offen lds
    s_add_u32 m0, m0, 1024
    s_add_u32 s23, s23, 128
    s_waitcnt lgkmcnt(7)
    v_mfma_f32_32x32x16_bf16 v[48:63], a[56:59], v[40:43], v[48:63]
    ds_read_b128 v[40:43], v250 offset:13312
    s_waitcnt lgkmcnt(7)
    v_mfma_f32_32x32x16_bf16 v[48:63], a[60:63], v[44:47], v[48:63]
    ds_read_b128 v[44:47], v251 offset:13312
    s_waitcnt lgkmcnt(7)
    v_mfma_f32_32x32x16_bf16 v[48:63], a[64:67], v[16:19], v[48:63]
    ds_read_b128 v[16:19], v248 offset:14336
    buffer_load_dwordx4 v8, s[68:71], s23 offen lds
    s_add_u32 m0, m0, 1024
    s_add_u32 s23, s23, 128
    s_waitcnt lgkmcnt(7)
    v_mfma_f32_32x32x16_bf16 v[48:63], a[68:71], v[20:23], v[48:63]
    ds_read_b128 v[20:23], v249 offset:14336
    s_waitcnt lgkmcnt(7)
    v_mfma_f32_32x32x16_bf16 v[48:63], a[72:75], v[24:27], v[48:63]
    ds_read_b128 v[24:27], v250 offset:14336
    s_waitcnt lgkmcnt(7)
    v_mfma_f32_32x32x16_bf16 v[48:63], a[76:79], v[28:31], v[48:63]
    buffer_load_dwordx4 v8, s[68:71], s23 offen lds
    s_add_u32 m0, m0, 1024
    s_add_u32 s23, s23, 128
    ds_read_b128 v[28:31], v251 offset:14336
    s_waitcnt lgkmcnt(7)
    v_mfma_f32_32x32x16_bf16 v[48:63], a[80:83], v[32:35], v[48:63]
    ds_read_b128 v[32:35], v248 offset:15360
    s_waitcnt lgkmcnt(7)
    v_mfma_f32_32x32x16_bf16 v[48:63], a[84:87], v[36:39], v[48:63]
    ds_read_b128 v[36:39], v249 offset:15360
    s_waitcnt lgkmcnt(7)
    v_mfma_f32_32x32x16_bf16 v[48:63], a[88:91], v[40:43], v[48:63]
    buffer_load_dwordx4 v8, s[68:71], s23 offen lds
    s_add_u32 m0, m0, 1024
    s_add_u32 s23, s23, 128
    ds_read_b128 v[40:43], v250 offset:15360
    s_lshl_b32 s24, s48, 8
    s_add_u32 s24, s24, 262144
    s_waitcnt lgkmcnt(7)
    v_mfma_f32_32x32x16_bf16 v[48:63], a[92:95], v[44:47], v[48:63]
    ds_read_b128 v[44:47], v251 offset:15360
    s_waitcnt lgkmcnt(7)
    v_mfma_f32_32x32x16_bf16 v[48:63], a[96:99], v[16:19], v[48:63]
    ds_read_b128 v[16:19], v248 offset:16384
    s_waitcnt lgkmcnt(7)
    v_mfma_f32_32x32x16_bf16 v[48:63], a[100:103], v[20:23], v[48:63]
    buffer_load_dwordx4 v8, s[68:71], s23 offen lds
    ds_read_b128 v[20:23], v249 offset:16384
    s_waitcnt lgkmcnt(7)
    v_mfma_f32_32x32x16_bf16 v[48:63], a[104:107], v[24:27], v[48:63]
    ds_read_b128 v[24:27], v250 offset:16384
    buffer_store_dwordx2 v[64:65], v72, s[4:7], s24 offen sc1
    s_waitcnt lgkmcnt(7)
    v_mfma_f32_32x32x16_bf16 v[48:63], a[108:111], v[28:31], v[48:63]
    ds_read_b128 v[28:31], v251 offset:16384
    s_waitcnt lgkmcnt(7)
    v_mfma_f32_32x32x16_bf16 v[48:63], a[112:115], v[32:35], v[48:63]
    s_waitcnt lgkmcnt(6)
    v_mfma_f32_32x32x16_bf16 v[48:63], a[116:119], v[36:39], v[48:63]
    s_waitcnt lgkmcnt(5)
    v_mfma_f32_32x32x16_bf16 v[48:63], a[120:123], v[40:43], v[48:63]
    s_waitcnt lgkmcnt(4)
    v_mfma_f32_32x32x16_bf16 v[48:63], a[124:127], v[44:47], v[48:63]
    s_waitcnt lgkmcnt(3)
    v_mfma_f32_32x32x16_bf16 v[48:63], a[128:131], v[16:19], v[48:63]
    s_waitcnt lgkmcnt(2)
    v_mfma_f32_32x32x16_bf16 v[48:63], a[132:135], v[20:23], v[48:63]
    s_waitcnt lgkmcnt(1)
    v_mfma_f32_32x32x16_bf16 v[48:63], a[136:139], v[24:27], v[48:63]
    s_waitcnt lgkmcnt(0)
    v_mfma_f32_32x32x16_bf16 v[48:63], a[140:143], v[28:31], v[48:63]
    s_add_u32 s26, s26, 1
    s_mov_b32 s48, s22
    s_add_u32 s22, s22, 6
    s_cmp_gt_u32 s22, 63
    s_cbranch_scc1 L_aqg_end0
    s_waitcnt vmcnt(10)
    s_barrier
    s_add_u32 s28, s22, 12
    s_min_u32 s28, s28, 63
    s_mov_b32 s25, 73728
    ds_read_b128 v[16:19], v4 offset:0
    s_mul_i32 s17, s13, 9216
    s_add_u32 m0, s17, s25
    s_mul_i32 s23, s28, 36864
    ds_read_b128 v[20:23], v5 offset:0
    v_cvt_pk_bf16_f32 v64, v48, v48
    v_and_b32 v64, s33, v64
    ds_read_b128 v[24:27], v6 offset:0
    v_mul_f32 v64, s31, v64
    v_exp_f32 v64, v64
    ds_read_b128 v[28:31], v7 offset:0
    v_add_f32 v64, 1.0, v64
    ds_read_b128 v[32:35], v4 offset:1024
    v_rcp_f32 v64, v64
    ds_read_b128 v[36:39], v5 offset:1024
    v_cvt_pk_bf16_f32 v64, v64, v64
    v_and_b32 v64, s33, v64
    ds_read_b128 v[40:43], v6 offset:1024
    v_sub_f32 v65, 1.0, v64
    v_cvt_pk_bf16_f32 v65, v65, v65
    ds_read_b128 v[44:47], v7 offset:1024
    v_and_b32 v65, s33, v65
    s_waitcnt lgkmcnt(7)
    v_mfma_f32_32x32x16_bf16 v[96:111], a[0:3], v[16:19], 0
    ds_read_b128 v[16:19], v4 offset:2048
    s_waitcnt lgkmcnt(7)
    v_mfma_f32_32x32x16_bf16 v[96:111], a[4:7], v[20:23], v[96:111]
    ds_read_b128 v[20:23], v5 offset:2048
    buffer_load_dwordx4 v8, s[68:71], s23 offen lds
    s_add_u32 m0, m0, 1024
    s_add_u32 s23, s23, 128
    s_waitcnt lgkmcnt(7)
    v_mfma_f32_32x32x16_bf16 v[96:111], a[8:11], v[24:27], v[96:111]
    ds_read_b128 v[24:27], v6 offset:2048
    s_waitcnt lgkmcnt(7)
    v_mfma_f32_32x32x16_bf16 v[96:111], a[12:15], v[28:31], v[96:111]
    ds_read_b128 v[28:31], v7 offset:2048
    s_waitcnt lgkmcnt(7)
    v_mfma_f32_32x32x16_bf16 v[96:111], a[16:19], v[32:35], v[96:111]
    ds_read_b128 v[32:35], v4 offset:3072
    buffer_load_dwordx4 v8, s[68:71], s23 offen lds
    s_add_u32 m0, m0, 1024
    s_add_u32 s23, s23, 128
    s_waitcnt lgkmcnt(7)
    v_mfma_f32_32x32x16_bf16 v[96:111], a[20:23], v[36:39], v[96:111]
    ds_read_b128 v[36:39], v5 offset:3072
    s_waitcnt lgkmcnt(7)
    v_mfma_f32_32x32x16_bf16 v[96:111], a[24:27], v[40:43], v[96:111]
    ds_read_b128 v[40:43], v6 offset:3072
    s_waitcnt lgkmcnt(7)
    v_mfma_f32_32x32x16_bf16 v[96:111], a[28:31], v[44:47], v[96:111]
    ds_read_b128 v[44:47], v7 offset:3072
    buffer_load_dwordx4 v8, s[68:71], s23 offen lds
    s_add_u32 m0, m0, 1024
    s_add_u32 s23, s23, 128
    s_waitcnt lgkmcnt(7)
    v_mfma_f32_32x32x16_bf16 v[96:111], a[32:35], v[16:19], v[96:111]
    ds_read_b128 v[16:19], v4 offset:4096
    s_waitcnt lgkmcnt(7)
    v_mfma_f32_32x32x16_bf16 v[96:111], a[36:39], v[20:23], v[96:111]
    ds_read_b128 v[20:23], v5 offset:4096
    s_waitcnt lgkmcnt(7)
    v_mfma_f32_32x32x16_bf16 v[96:111], a[40:43], v[24:27], v[96:111]
    ds_read_b128 v[24:27], v6 offset:4096
    buffer_load_dwordx4 v8, s[68:71], s23 offen lds
    s_add_u32 m0, m0, 1024
    s_add_u32 s23, s23, 128
    s_waitcnt lgkmcnt(7)
    v_mfma_f32_32x32x16_bf16 v[96:111], a[44:47], v[28:31], v[96:111]
    ds_read_b128 v[28:31], v7 offset:4096
    s_waitcnt lgkmcnt(7)
    v_mfma_f32_32x32x16_bf16 v[96:111], a[48:51], v[32:35], v[96:111]
    ds_read_b128 v[32:35], v4 offset:5120
    s_waitcnt lgkmcnt(7)
    v_mfma_f32_32x32x16_bf16 v[96:111], a[52:55], v[36:39], v[96:111]
    ds_read_b128 v[36:39], v5 offset:5120
    buffer_load_dwordx4 v8, s[68:71], s23 offen lds
    s_add_u32 m0, m0, 1024
    s_add_u32 s23, s23, 128
    s_waitcnt lgkmcnt(7)
    v_mfma_f32_32x32x16_bf16 v[96:111], a[56:59], v[40:43], v[96:111]
    ds_read_b128 v[40:43], v6 offset:5120
    s_waitcnt lgkmcnt(7)
    v_mfma_f32_32x32x16_bf16 v[96:111], a[60:63], v[44:47], v[96:111]
    ds_read_b128 v[44:47], v7 offset:5120
    s_waitcnt lgkmcnt(7)
    v_mfma_f32_32x32x16_bf16 v[96:111], a[64:67], v[16:19], v[96:111]
    ds_read_b128 v[16:19], v4 offset:6144
    buffer_load_dwordx4 v8, s[68:71], s23 offen lds
    s_add_u32 m0, m0, 1024
    s_add_u32 s23, s23, 128
    s_waitcnt lgkmcnt(7)
    v_mfma_f32_32x32x16_bf16 v[96:111], a[68:71], v[20:23], v[96:111]
    ds_read_b128 v[20:23], v5 offset:6144
    s_waitcnt lgkmcnt(7)
    v_mfma_f32_32x32x16_bf16 v[96:111], a[72:75], v[24:27], v[96:111]
    ds_read_b128 v[24:27], v6 offset:6144
    s_waitcnt lgkmcnt(7)
    v_mfma_f32_32x32x16_bf16 v[96:111], a[76:79], v[28:31], v[96:111]
    buffer_load_dwordx4 v8, s[68:71], s23 offen lds
    s_add_u32 m0, m0, 1024
    s_add_u32 s23, s23, 128
    ds_read_b128 v[28:31], v7 offset:6144
    s_waitcnt lgkmcnt(7)
    v_mfma_f32_32x32x16_bf16 v[96:111], a[80:83], v[32:35], v[96:111]
    ds_read_b128 v[32:35], v4 offset:7168
    s_waitcnt lgkmcnt(7)
    v_mfma_f32_32x32x16_bf16 v[96:111], a[84:87], v[36:39], v[96:111]
    ds_read_b128 v[36:39], v5 offset:7168
    s_waitcnt lgkmcnt(7)
    v_mfma_f32_32x32x16_bf16 v[96:111], a[88:91], v[40:43], v[96:111]
    buffer_load_dwordx4 v8, s[68:71], s23 offen lds
    s_add_u32 m0, m0, 1024
    s_add_u32 s23, s23, 128
    ds_read_b128 v[40:43], v6 offset:7168
    s_lshl_b32 s24, s48, 8
    s_add_u32 s24, s24, 262144
    s_waitcnt lgkmcnt(7)
    v_mfma_f32_32x32x16_bf16 v[96:111], a[92:95], v[44:47], v[96:111]
    ds_read_b128 v[44:47], v7 offset:7168
    s_waitcnt lgkmcnt(7)
    v_mfma_f32_32x32x16_bf16 v[96:111], a[96:99], v[16:19], v[96:111]
    ds_read_b128 v[16:19], v4 offset:8192
    s_waitcnt lgkmcnt(7)
    v_mfma_f32_32x32x16_bf16 v[96:111], a[100:103], v[20:23], v[96:111]
    buffer_load_dwordx4 v8, s[68:71], s23 offen lds
    ds_read_b128 v[20:23], v5 offset:8192
    s_waitcnt lgkmcnt(7)
    v_mfma_f32_32x32x16_bf16 v[96:111], a[104:107], v[24:27], v[96:111]
    ds_read_b128 v[24:27], v6 offset:8192
    buffer_store_dwordx2 v[64:65], v72, s[4:7], s24 offen sc1
    s_waitcnt lgkmcnt(7)
    v_mfma_f32_32x32x16_bf16 v[96:111], a[108:111], v[28:31], v[96:111]
    ds_read_b128 v[28:31], v7 offset:8192
    s_waitcnt lgkmcnt(7)
    v_mfma_f32_32x32x16_bf16 v[96:111], a[112:115], v[32:35], v[96:111]
    s_waitcnt lgkmcnt(6)
    v_mfma_f32_32x32x16_bf16 v[96:111], a[116:119], v[36:39], v[96:111]
    s_waitcnt lgkmcnt(5)
    v_mfma_f32_32x32x16_bf16 v[96:111], a[120:123], v[40:43], v[96:111]
    s_waitcnt lgkmcnt(4)
    v_mfma_f32_32x32x16_bf16 v[96:111], a[124:127], v[44:47], v[96:111]
    s_waitcnt lgkmcnt(3)
    v_mfma_f32_32x32x16_bf16 v[96:111], a[128:131], v[16:19], v[96:111]
    s_waitcnt lgkmcnt(2)
    v_mfma_f32_32x32x16_bf16 v[96:111], a[132:135], v[20:23], v[96:111]
    s_waitcnt lgkmcnt(1)
    v_mfma_f32_32x32x16_bf16 v[96:111], a[136:139], v[24:27], v[96:111]
    s_waitcnt lgkmcnt(0)
    v_mfma_f32_32x32x16_bf16 v[96:111], a[140:143], v[28:31], v[96:111]
    s_add_u32 s26, s26, 1
    s_mov_b32 s48, s22
    s_add_u32 s22, s22, 6
    s_cmp_gt_u32 s22, 63
    s_cbranch_scc1 L_aqg_end1
    s_waitcnt vmcnt(10)
    s_barrier
    s_add_u32 s28, s22, 12
    s_min_u32 s28, s28, 63
    s_mov_b32 s25, 0
    ds_read_b128 v[16:19], v4 offset:36864
    s_mul_i32 s17, s13, 9216
    s_add_u32 m0, s17, s25
    s_mul_i32 s23, s28, 36864
    ds_read_b128 v[20:23], v5 offset:36864
    v_cvt_pk_bf16_f32 v64, v96, v96
    v_and_b32 v64, s33, v64
    ds_read_b128 v[24:27], v6 offset:36864
    v_mul_f32 v64, s31, v64
    v_exp_f32 v64, v64
    ds_read_b128 v[28:31], v7 offset:36864
    v_add_f32 v64, 1.0, v64
    ds_read_b128 v[32:35], v4 offset:37888
    v_rcp_f32 v64, v64
    ds_read_b128 v[36:39], v5 offset:37888
    v_cvt_pk_bf16_f32 v64, v64, v64
    v_and_b32 v64, s33, v64
    ds_read_b128 v[40:43], v6 offset:37888
    v_sub_f32 v65, 1.0, v64
    v_cvt_pk_bf16_f32 v65, v65, v65
    ds_read_b128 v[44:47], v7 offset:37888
    v_and_b32 v65, s33, v65
    s_waitcnt lgkmcnt(7)
    v_mfma_f32_32x32x16_bf16 v[48:63], a[0:3], v[16:19], 0
    ds_read_b128 v[16:19], v4 offset:38912
    s_waitcnt lgkmcnt(7)
    v_mfma_f32_32x32x16_bf16 v[48:63], a[4:7], v[20:23], v[48:63]
    ds_read_b128 v[20:23], v5 offset:38912
    buffer_load_dwordx4 v8, s[68:71], s23 offen lds
    s_add_u32 m0, m0, 1024
    s_add_u32 s23, s23, 128
    s_waitcnt lgkmcnt(7)
    v_mfma_f32_32x32x16_bf16 v[48:63], a[8:11], v[24:27], v[48:63]
    ds_read_b128 v[24:27], v6 offset:38912
    s_waitcnt lgkmcnt(7)
    v_mfma_f32_32x32x16_bf16 v[48:63], a[12:15], v[28:31], v[48:63]
    ds_read_b128 v[28:31], v7 offset:38912
    s_waitcnt lgkmcnt(7)
    v_mfma_f32_32x32x16_bf16 v[48:63], a[16:19], v[32:35], v[48:63]
    ds_read_b128 v[32:35], v4 offset:39936
    buffer_load_dwordx4 v8, s[68:71], s23 offen lds
    s_add_u32 m0, m0, 1024
    s_add_u32 s23, s23, 128
    s_waitcnt lgkmcnt(7)
    v_mfma_f32_32x32x16_bf16 v[48:63], a[20:23], v[36:39], v[48:63]
    ds_read_b128 v[36:39], v5 offset:39936
    s_waitcnt lgkmcnt(7)
    v_mfma_f32_32x32x16_bf16 v[48:63], a[24:27], v[40:43], v[48:63]
    ds_read_b128 v[40:43], v6 offset:39936
    s_waitcnt lgkmcnt(7)
    v_mfma_f32_32x32x16_bf16 v[48:63], a[28:31], v[44:47], v[48:63]
    ds_read_b128 v[44:47], v7 offset:39936
    buffer_load_dwordx4 v8, s[68:71], s23 offen lds
    s_add_u32 m0, m0, 1024
    s_add_u32 s23, s23, 128
    s_waitcnt lgkmcnt(7)
    v_mfma_f32_32x32x16_bf16 v[48:63], a[32:35], v[16:19], v[48:63]
    ds_read_b128 v[16:19], v4 offset:40960
    s_waitcnt lgkmcnt(7)
    v_mfma_f32_32x32x16_bf16 v[48:63], a[36:39], v[20:23], v[48:63]
    ds_read_b128 v[20:23], v5 offset:40960
    s_waitcnt lgkmcnt(7)
    v_mfma_f32_32x32x16_bf16 v[48:63], a[40:43], v[24:27], v[48:63]
    ds_read_b128 v[24:27], v6 offset:40960
    buffer_load_dwordx4 v8, s[68:71], s23 offen lds
    s_add_u32 m0, m0, 1024
    s_add_u32 s23, s23, 128
    s_waitcnt lgkmcnt(7)
    v_mfma_f32_32x32x16_bf16 v[48:63], a[44:47], v[28:31], v[48:63]
    ds_read_b128 v[28:31], v7 offset:40960
    s_waitcnt lgkmcnt(7)
    v_mfma_f32_32x32x16_bf16 v[48:63], a[48:51], v[32:35], v[48:63]
    ds_read_b128 v[32:35], v4 offset:41984
    s_waitcnt lgkmcnt(7)
    v_mfma_f32_32x32x16_bf16 v[48:63], a[52:55], v[36:39], v[48:63]
    ds_read_b128 v[36:39], v5 offset:41984
    buffer_load_dwordx4 v8, s[68:71], s23 offen lds
    s_add_u32 m0, m0, 1024
    s_add_u32 s23, s23, 128
    s_waitcnt lgkmcnt(7)
    v_mfma_f32_32x32x16_bf16 v[48:63], a[56:59], v[40:43], v[48:63]
    ds_read_b128 v[40:43], v6 offset:41984
    s_waitcnt lgkmcnt(7)
    v_mfma_f32_32x32x16_bf16 v[48:63], a[60:63], v[44:47], v[48:63]
    ds_read_b128 v[44:47], v7 offset:41984
    s_waitcnt lgkmcnt(7)
    v_mfma_f32_32x32x16_bf16 v[48:63], a[64:67], v[16:19], v[48:63]
    ds_read_b128 v[16:19], v4 offset:43008
    buffer_load_dwordx4 v8, s[68:71], s23 offen lds
    s_add_u32 m0, m0, 1024
    s_add_u32 s23, s23, 128
    s_waitcnt lgkmcnt(7)
    v_mfma_f32_32x32x16_bf16 v[48:63], a[68:71], v[20:23], v[48:63]
    ds_read_b128 v[20:23], v5 offset:43008
    s_waitcnt lgkmcnt(7)
    v_mfma_f32_32x32x16_bf16 v[48:63], a[72:75], v[24:27], v[48:63]
    ds_read_b128 v[24:27], v6 offset:43008
    s_waitcnt lgkmcnt(7)
    v_mfma_f32_32x32x16_bf16 v[48:63], a[76:79], v[28:31], v[48:63]
    buffer_load_dwordx4 v8, s[68:71], s23 offen lds
    s_add_u32 m0, m0, 1024
    s_add_u32 s23, s23, 128
    ds_read_b128 v[28:31], v7 offset:43008
    s_waitcnt lgkmcnt(7)
    v_mfma_f32_32x32x16_bf16 v[48:63], a[80:83], v[32:35], v[48:63]
    ds_read_b128 v[32:35], v4 offset:44032
    s_waitcnt lgkmcnt(7)
    v_mfma_f32_32x32x16_bf16 v[48:63], a[84:87], v[36:39], v[48:63]
    ds_read_b128 v[36:39], v5 offset:44032
    s_waitcnt lgkmcnt(7)
    v_mfma_f32_32x32x16_bf16 v[48:63], a[88:91], v[40:43], v[48:63]
    buffer_load_dwordx4 v8, s[68:71], s23 offen lds
    s_add_u32 m0, m0, 1024
    s_add_u32 s23, s23, 128
    ds_read_b128 v[40:43], v6 offset:44032
    s_lshl_b32 s24, s48, 8
    s_add_u32 s24, s24, 262144
    s_waitcnt lgkmcnt(7)
    v_mfma_f32_32x32x16_bf16 v[48:63], a[92:95], v[44:47], v[48:63]
    ds_read_b128 v[44:47], v7 offset:44032
    s_waitcnt lgkmcnt(7)
    v_mfma_f32_32x32x16_bf16 v[48:63], a[96:99], v[16:19], v[48:63]
    ds_read_b128 v[16:19], v4 offset:45056
    s_waitcnt lgkmcnt(7)
    v_mfma_f32_32x32x16_bf16 v[48:63], a[100:103], v[20:23], v[48:63]
    buffer_load_dwordx4 v8, s[68:71], s23 offen lds
    ds_read_b128 v[20:23], v5 offset:45056
    s_waitcnt lgkmcnt(7)
    v_mfma_f32_32x32x16_bf16 v[48:63], a[104:107], v[24:27], v[48:63]
    ds_read_b128 v[24:27], v6 offset:45056
    buffer_store_dwordx2 v[64:65], v72, s[4:7], s24 offen sc1
    s_waitcnt lgkmcnt(7)
    v_mfma_f32_32x32x16_bf16 v[48:63], a[108:111], v[28:31], v[48:63]
    ds_read_b128 v[28:31], v7 offset:45056
    s_waitcnt lgkmcnt(7)
    v_mfma_f32_32x32x16_bf16 v[48:63], a[112:115], v[32:35], v[48:63]
    s_waitcnt lgkmcnt(6)
    v_mfma_f32_32x32x16_bf16 v[48:63], a[116:119], v[36:39], v[48:63]
    s_waitcnt lgkmcnt(5)
    v_mfma_f32_32x32x16_bf16 v[48:63], a[120:123], v[40:43], v[48:63]
    s_waitcnt lgkmcnt(4)
    v_mfma_f32_32x32x16_bf16 v[48:63], a[124:127], v[44:47], v[48:63]
    s_waitcnt lgkmcnt(3)
    v_mfma_f32_32x32x16_bf16 v[48:63], a[128:131], v[16:19], v[48:63]
    s_waitcnt lgkmcnt(2)
    v_mfma_f32_32x32x16_bf16 v[48:63], a[132:135], v[20:23], v[48:63]
    s_waitcnt lgkmcnt(1)
    v_mfma_f32_32x32x16_bf16 v[48:63], a[136:139], v[24:27], v[48:63]
    s_waitcnt lgkmcnt(0)
    v_mfma_f32_32x32x16_bf16 v[48:63], a[140:143], v[28:31], v[48:63]
    s_add_u32 s26, s26, 1
    s_mov_b32 s48, s22
    s_add_u32 s22, s22, 6
    s_cmp_gt_u32 s22, 63
    s_cbranch_scc1 L_aqg_end0
    s_waitcnt vmcnt(10)
    s_barrier
    s_add_u32 s28, s22, 12
    s_min_u32 s28, s28, 63
    s_mov_b32 s25, 36864
    ds_read_b128 v[16:19], v248 offset:8192
    s_mul_i32 s17, s13, 9216
    s_add_u32 m0, s17, s25
    s_mul_i32 s23, s28, 36864
    ds_read_b128 v[20:23], v249 offset:8192
    v_cvt_pk_bf16_f32 v64, v48, v48
    v_and_b32 v64, s33, v64
    ds_read_b128 v[24:27], v250 offset:8192
    v_mul_f32 v64, s31, v64
    v_exp_f32 v64, v64
    ds_read_b128 v[28:31], v251 offset:8192
    v_add_f32 v64, 1.0, v64
    ds_read_b128 v[32:35], v248 offset:9216
    v_rcp_f32 v64, v64
    ds_read_b128 v[36:39], v249 offset:9216
    v_cvt_pk_bf16_f32 v64, v64, v64
    v_and_b32 v64, s33, v64
    ds_read_b128 v[40:43], v250 offset:9216
    v_sub_f32 v65, 1.0, v64
    v_cvt_pk_bf16_f32 v65, v65, v65
    ds_read_b128 v[44:47], v251 offset:9216
    v_and_b32 v65, s33, v65
    s_waitcnt lgkmcnt(7)
    v_mfma_f32_32x32x16_bf16 v[96:111], a[0:3], v[16:19], 0
    ds_read_b128 v[16:19], v248 offset:10240
    s_waitcnt lgkmcnt(7)
    v_mfma_f32_32x32x16_bf16 v[96:111], a[4:7], v[20:23], v[96:111]
    ds_read_b128 v[20:23], v249 offset:10240
    buffer_load_dwordx4 v8, s[68:71], s23 offen lds
    s_add_u32 m0, m0, 1024
    s_add_u32 s23, s23, 128
    s_waitcnt lgkmcnt(7)
    v_mfma_f32_32x32x16_bf16 v[96:111], a[8:11], v[24:27], v[96:111]
    ds_read_b128 v[24:27], v250 offset:10240
    s_waitcnt lgkmcnt(7)
    v_mfma_f32_32x32x16_bf16 v[96:111], a[12:15], v[28:31], v[96:111]
    ds_read_b128 v[28:31], v251 offset:10240
    s_waitcnt lgkmcnt(7)
    v_mfma_f32_32x32x16_bf16 v[96:111], a[16:19], v[32:35], v[96:111]
    ds_read_b128 v[32:35], v248 offset:11264
    buffer_load_dwordx4 v8, s[68:71], s23 offen lds
    s_add_u32 m0, m0, 1024
    s_add_u32 s23, s23, 128
    s_waitcnt lgkmcnt(7)
    v_mfma_f32_32x32x16_bf16 v[96:111], a[20:23], v[36:39], v[96:111]
    ds_read_b128 v[36:39], v249 offset:11264
    s_waitcnt lgkmcnt(7)
    v_mfma_f32_32x32x16_bf16 v[96:111], a[24:27], v[40:43], v[96:111]
    ds_read_b128 v[40:43], v250 offset:11264
    s_waitcnt lgkmcnt(7)
    v_mfma_f32_32x32x16_bf16 v[96:111], a[28:31], v[44:47], v[96:111]
    ds_read_b128 v[44:47], v251 offset:11264
    buffer_load_dwordx4 v8, s[68:71], s23 offen lds
    s_add_u32 m0, m0, 1024
    s_add_u32 s23, s23, 128
    s_waitcnt lgkmcnt(7)
    v_mfma_f32_32x32x16_bf16 v[96:111], a[32:35], v[16:19], v[96:111]
    ds_read_b128 v[16:19], v248 offset:12288
    s_waitcnt lgkmcnt(7)
    v_mfma_f32_32x32x16_bf16 v[96:111], a[36:39], v[20:23], v[96:111]
    ds_read_b128 v[20:23], v249 offset:12288
    s_waitcnt lgkmcnt(7)
    v_mfma_f32_32x32x16_bf16 v[96:111], a[40:43], v[24:27], v[96:111]
    ds_read_b128 v[24:27], v250 offset:12288
    buffer_load_dwordx4 v8, s[68:71], s23 offen lds
    s_add_u32 m0, m0, 1024
    s_add_u32 s23, s23, 128
    s_waitcnt lgkmcnt(7)
    v_mfma_f32_32x32x16_bf16 v[96:111], a[44:47], v[28:31], v[96:111]
    ds_read_b128 v[28:31], v251 offset:12288
    s_waitcnt lgkmcnt(7)
    v_mfma_f32_32x32x16_bf16 v[96:111], a[48:51], v[32:35], v[96:111]
    ds_read_b128 v[32:35], v248 offset:13312
    s_waitcnt lgkmcnt(7)
    v_mfma_f32_32x32x16_bf16 v[96:111], a[52:55], v[36:39], v[96:111]
    ds_read_b128 v[36:39], v249 offset:13312
    buffer_load_dwordx4 v8, s[68:71], s23 offen lds
    s_add_u32 m0, m0, 1024
    s_add_u32 s23, s23, 128
    s_waitcnt lgkmcnt(7)
    v_mfma_f32_32x32x16_bf16 v[96:111], a[56:59], v[40:43], v[96:111]
    ds_read_b128 v[40:43], v250 offset:13312
    s_waitcnt lgkmcnt(7)
    v_mfma_f32_32x32x16_bf16 v[96:111], a[60:63], v[44:47], v[96:111]
    ds_read_b128 v[44:47], v251 offset:13312
    s_waitcnt lgkmcnt(7)
    v_mfma_f32_32x32x16_bf16 v[96:111], a[64:67], v[16:19], v[96:111]
    ds_read_b128 v[16:19], v248 offset:14336
    buffer_load_dwordx4 v8, s[68:71], s23 offen lds
    s_add_u32 m0, m0, 1024
    s_add_u32 s23, s23, 128
    s_waitcnt lgkmcnt(7)
    v_mfma_f32_32x32x16_bf16 v[96:111], a[68:71], v[20:23], v[96:111]
    ds_read_b128 v[20:23], v249 offset:14336
    s_waitcnt lgkmcnt(7)
    v_mfma_f32_32x32x16_bf16 v[96:111], a[72:75], v[24:27], v[96:111]
    ds_read_b128 v[24:27], v250 offset:14336
    s_waitcnt lgkmcnt(7)
    v_mfma_f32_32x32x16_bf16 v[96:111], a[76:79], v[28:31], v[96:111]
    buffer_load_dwordx4 v8, s[68:71], s23 offen lds
    s_add_u32 m0, m0, 1024
    s_add_u32 s23, s23, 128
    ds_read_b128 v[28:31], v251 offset:14336
    s_waitcnt lgkmcnt(7)
    v_mfma_f32_32x32x16_bf16 v[96:111], a[80:83], v[32:35], v[96:111]
    ds_read_b128 v[32:35], v248 offset:15360
    s_waitcnt lgkmcnt(7)
    v_mfma_f32_32x32x16_bf16 v[96:111], a[84:87], v[36:39], v[96:111]
    ds_read_b128 v[36:39], v249 offset:15360
    s_waitcnt lgkmcnt(7)
    v_mfma_f32_32x32x16_bf16 v[96:111], a[88:91], v[40:43], v[96:111]
    buffer_load_dwordx4 v8, s[68:71], s23 offen lds
    s_add_u32 m0, m0, 1024
    s_add_u32 s23, s23, 128
    ds_read_b128 v[40:43], v250 offset:15360
    s_lshl_b32 s24, s48, 8
    s_add_u32 s24, s24, 262144
    s_waitcnt lgkmcnt(7)
    v_mfma_f32_32x32x16_bf16 v[96:111], a[92:95], v[44:47], v[96:111]
    ds_read_b128 v[44:47], v251 offset:15360
    s_waitcnt lgkmcnt(7)
    v_mfma_f32_32x32x16_bf16 v[96:111], a[96:99], v[16:19], v[96:111]
    ds_read_b128 v[16:19], v248 offset:16384
    s_waitcnt lgkmcnt(7)
    v_mfma_f32_32x32x16_bf16 v[96:111], a[100:103], v[20:23], v[96:111]
    buffer_load_dwordx4 v8, s[68:71], s23 offen lds
    ds_read_b128 v[20:23], v249 offset:16384
    s_waitcnt lgkmcnt(7)
    v_mfma_f32_32x32x16_bf16 v[96:111], a[104:107], v[24:27], v[96:111]
    ds_read_b128 v[24:27], v250 offset:16384
    buffer_store_dwordx2 v[64:65], v72, s[4:7], s24 offen sc1
    s_waitcnt lgkmcnt(7)
    v_mfma_f32_32x32x16_bf16 v[96:111], a[108:111], v[28:31], v[96:111]
    ds_read_b128 v[28:31], v251 offset:16384
    s_waitcnt lgkmcnt(7)
    v_mfma_f32_32x32x16_bf16 v[96:111], a[112:115], v[32:35], v[96:111]
    s_waitcnt lgkmcnt(6)
    v_mfma_f32_32x32x16_bf16 v[96:111], a[116:119], v[36:39], v[96:111]
    s_waitcnt lgkmcnt(5)
    v_mfma_f32_32x32x16_bf16 v[96:111], a[120:123], v[40:43], v[96:111]
    s_waitcnt lgkmcnt(4)
    v_mfma_f32_32x32x16_bf16 v[96:111], a[124:127], v[44:47], v[96:111]
    s_waitcnt lgkmcnt(3)
    v_mfma_f32_32x32x16_bf16 v[96:111], a[128:131], v[16:19], v[96:111]
    s_waitcnt lgkmcnt(2)
    v_mfma_f32_32x32x16_bf16 v[96:111], a[132:135], v[20:23], v[96:111]
    s_waitcnt lgkmcnt(1)
    v_mfma_f32_32x32x16_bf16 v[96:111], a[136:139], v[24:27], v[96:111]
    s_waitcnt lgkmcnt(0)
    v_mfma_f32_32x32x16_bf16 v[96:111], a[140:143], v[28:31], v[96:111]
    s_add_u32 s26, s26, 1
    s_mov_b32 s48, s22
    s_add_u32 s22, s22, 6
    s_cmp_gt_u32 s22, 63
    s_cbranch_scc1 L_aqg_end1
    s_waitcnt vmcnt(10)
    s_barrier
    s_add_u32 s28, s22, 12
    s_min_u32 s28, s28, 63
    s_mov_b32 s25, 73728
    ds_read_b128 v[16:19], v4 offset:0
    s_mul_i32 s17, s13, 9216
    s_add_u32 m0, s17, s25
    s_mul_i32 s23, s28, 36864
    ds_read_b128 v[20:23], v5 offset:0
    v_cvt_pk_bf16_f32 v64, v96, v96
    v_and_b32 v64, s33, v64
    ds_read_b128 v[24:27], v6 offset:0
    v_mul_f32 v64, s31, v64
    v_exp_f32 v64, v64
    ds_read_b128 v[28:31], v7 offset:0
    v_add_f32 v64, 1.0, v64
    ds_read_b128 v[32:35], v4 offset:1024
    v_rcp_f32 v64, v64
    ds_read_b128 v[36:39], v5 offset:1024
    v_cvt_pk_bf16_f32 v64, v64, v64
    v_and_b32 v64, s33, v64
    ds_read_b128 v[40:43], v6 offset:1024
    v_sub_f32 v65, 1.0, v64
    v_cvt_pk_bf16_f32 v65, v65, v65
    ds_read_b128 v[44:47], v7 offset:1024
    v_and_b32 v65, s33, v65
    s_waitcnt lgkmcnt(7)
    v_mfma_f32_32x32x16_bf16 v[48:63], a[0:3], v[16:19], 0
    ds_read_b128 v[16:19], v4 offset:2048
    s_waitcnt lgkmcnt(7)
    v_mfma_f32_32x32x16_bf16 v[48:63], a[4:7], v[20:23], v[48:63]
    ds_read_b128 v[20:23], v5 offset:2048
    buffer_load_dwordx4 v8, s[68:71], s23 offen lds
    s_add_u32 m0, m0, 1024
    s_add_u32 s23, s23, 128
    s_waitcnt lgkmcnt(7)
    v_mfma_f32_32x32x16_bf16 v[48:63], a[8:11], v[24:27], v[48:63]
    ds_read_b128 v[24:27], v6 offset:2048
    s_waitcnt lgkmcnt(7)
    v_mfma_f32_32x32x16_bf16 v[48:63], a[12:15], v[28:31], v[48:63]
    ds_read_b128 v[28:31], v7 offset:2048
    s_waitcnt lgkmcnt(7)
    v_mfma_f32_32x32x16_bf16 v[48:63], a[16:19], v[32:35], v[48:63]
    ds_read_b128 v[32:35], v4 offset:3072
    buffer_load_dwordx4 v8, s[68:71], s23 offen lds
    s_add_u32 m0, m0, 1024
    s_add_u32 s23, s23, 128
    s_waitcnt lgkmcnt(7)
    v_mfma_f32_32x32x16_bf16 v[48:63], a[20:23], v[36:39], v[48:63]
    ds_read_b128 v[36:39], v5 offset:3072
    s_waitcnt lgkmcnt(7)
    v_mfma_f32_32x32x16_bf16 v[48:63], a[24:27], v[40:43], v[48:63]
    ds_read_b128 v[40:43], v6 offset:3072
    s_waitcnt lgkmcnt(7)
    v_mfma_f32_32x32x16_bf16 v[48:63], a[28:31], v[44:47], v[48:63]
    ds_read_b128 v[44:47], v7 offset:3072
    buffer_load_dwordx4 v8, s[68:71], s23 offen lds
    s_add_u32 m0, m0, 1024
    s_add_u32 s23, s23, 128
    s_waitcnt lgkmcnt(7)
    v_mfma_f32_32x32x16_bf16 v[48:63], a[32:35], v[16:19], v[48:63]
    ds_read_b128 v[16:19], v4 offset:4096
    s_waitcnt lgkmcnt(7)
    v_mfma_f32_32x32x16_bf16 v[48:63], a[36:39], v[20:23], v[48:63]
    ds_read_b128 v[20:23], v5 offset:4096
    s_waitcnt lgkmcnt(7)
    v_mfma_f32_32x32x16_bf16 v[48:63], a[40:43], v[24:27], v[48:63]
    ds_read_b128 v[24:27], v6 offset:4096
    buffer_load_dwordx4 v8, s[68:71], s23 offen lds
    s_add_u32 m0, m0, 1024
    s_add_u32 s23, s23, 128
    s_waitcnt lgkmcnt(7)
    v_mfma_f32_32x32x16_bf16 v[48:63], a[44:47], v[28:31], v[48:63]
    ds_read_b128 v[28:31], v7 offset:4096
    s_waitcnt lgkmcnt(7)
    v_mfma_f32_32x32x16_bf16 v[48:63], a[48:51], v[32:35], v[48:63]
    ds_read_b128 v[32:35], v4 offset:5120
    s_waitcnt lgkmcnt(7)
    v_mfma_f32_32x32x16_bf16 v[48:63], a[52:55], v[36:39], v[48:63]
    ds_read_b128 v[36:39], v5 offset:5120
    buffer_load_dwordx4 v8, s[68:71], s23 offen lds
    s_add_u32 m0, m0, 1024
    s_add_u32 s23, s23, 128
    s_waitcnt lgkmcnt(7)
    v_mfma_f32_32x32x16_bf16 v[48:63], a[56:59], v[40:43], v[48:63]
    ds_read_b128 v[40:43], v6 offset:5120
    s_waitcnt lgkmcnt(7)
    v_mfma_f32_32x32x16_bf16 v[48:63], a[60:63], v[44:47], v[48:63]
    ds_read_b128 v[44:47], v7 offset:5120
    s_waitcnt lgkmcnt(7)
    v_mfma_f32_32x32x16_bf16 v[48:63], a[64:67], v[16:19], v[48:63]
    ds_read_b128 v[16:19], v4 offset:6144
    buffer_load_dwordx4 v8, s[68:71], s23 offen lds
    s_add_u32 m0, m0, 1024
    s_add_u32 s23, s23, 128
    s_waitcnt lgkmcnt(7)
    v_mfma_f32_32x32x16_bf16 v[48:63], a[68:71], v[20:23], v[48:63]
    ds_read_b128 v[20:23], v5 offset:6144
    s_waitcnt lgkmcnt(7)
    v_mfma_f32_32x32x16_bf16 v[48:63], a[72:75], v[24:27], v[48:63]
    ds_read_b128 v[24:27], v6 offset:6144
    s_waitcnt lgkmcnt(7)
    v_mfma_f32_32x32x16_bf16 v[48:63], a[76:79], v[28:31], v[48:63]
    buffer_load_dwordx4 v8, s[68:71], s23 offen lds
    s_add_u32 m0, m0, 1024
    s_add_u32 s23, s23, 128
    ds_read_b128 v[28:31], v7 offset:6144
    s_waitcnt lgkmcnt(7)
    v_mfma_f32_32x32x16_bf16 v[48:63], a[80:83], v[32:35], v[48:63]
    ds_read_b128 v[32:35], v4 offset:7168
    s_waitcnt lgkmcnt(7)
    v_mfma_f32_32x32x16_bf16 v[48:63], a[84:87], v[36:39], v[48:63]
    ds_read_b128 v[36:39], v5 offset:7168
    s_waitcnt lgkmcnt(7)
    v_mfma_f32_32x32x16_bf16 v[48:63], a[88:91], v[40:43], v[48:63]
    buffer_load_dwordx4 v8, s[68:71], s23 offen lds
    s_add_u32 m0, m0, 1024
    s_add_u32 s23, s23, 128
    ds_read_b128 v[40:43], v6 offset:7168
    s_lshl_b32 s24, s48, 8
    s_add_u32 s24, s24, 262144
    s_waitcnt lgkmcnt(7)
    v_mfma_f32_32x32x16_bf16 v[48:63], a[92:95], v[44:47], v[48:63]
    ds_read_b128 v[44:47], v7 offset:7168
    s_waitcnt lgkmcnt(7)
    v_mfma_f32_32x32x16_bf16 v[48:63], a[96:99], v[16:19], v[48:63]
    ds_read_b128 v[16:19], v4 offset:8192
    s_waitcnt lgkmcnt(7)
    v_mfma_f32_32x32x16_bf16 v[48:63], a[100:103], v[20:23], v[48:63]
    buffer_load_dwordx4 v8, s[68:71], s23 offen lds
    ds_read_b128 v[20:23], v5 offset:8192
    s_waitcnt lgkmcnt(7)
    v_mfma_f32_32x32x16_bf16 v[48:63], a[104:107], v[24:27], v[48:63]
    ds_read_b128 v[24:27], v6 offset:8192
    buffer_store_dwordx2 v[64:65], v72, s[4:7], s24 offen sc1
    s_waitcnt lgkmcnt(7)
    v_mfma_f32_32x32x16_bf16 v[48:63], a[108:111], v[28:31], v[48:63]
    ds_read_b128 v[28:31], v7 offset:8192
    s_waitcnt lgkmcnt(7)
    v_mfma_f32_32x32x16_bf16 v[48:63], a[112:115], v[32:35], v[48:63]
    s_waitcnt lgkmcnt(6)
    v_mfma_f32_32x32x16_bf16 v[48:63], a[116:119], v[36:39], v[48:63]
    s_waitcnt lgkmcnt(5)
    v_mfma_f32_32x32x16_bf16 v[48:63], a[120:123], v[40:43], v[48:63]
    s_waitcnt lgkmcnt(4)
    v_mfma_f32_32x32x16_bf16 v[48:63], a[124:127], v[44:47], v[48:63]
    s_waitcnt lgkmcnt(3)
    v_mfma_f32_32x32x16_bf16 v[48:63], a[128:131], v[16:19], v[48:63]
    s_waitcnt lgkmcnt(2)
    v_mfma_f32_32x32x16_bf16 v[48:63], a[132:135], v[20:23], v[48:63]
    s_waitcnt lgkmcnt(1)
    v_mfma_f32_32x32x16_bf16 v[48:63], a[136:139], v[24:27], v[48:63]
    s_waitcnt lgkmcnt(0)
    v_mfma_f32_32x32x16_bf16 v[48:63], a[140:143], v[28:31], v[48:63]
    s_add_u32 s26, s26, 1
    s_mov_b32 s48, s22
    s_add_u32 s22, s22, 6
    s_cmp_gt_u32 s22, 63
    s_cbranch_scc1 L_aqg_end0
    s_waitcnt vmcnt(10)
    s_branch L_aqg_lp
L_aqg_end0:
    s_nop 7
    s_nop 3
    v_cvt_pk_bf16_f32 v64, v48, v48
    s_lshl_b32 s24, s48, 8
    v_and_b32 v64, s33, v64
    s_add_u32 s24, s24, 262144
    v_mul_f32 v64, s31, v64
    v_exp_f32 v64, v64
    s_nop 0
    v_add_f32 v64, 1.0, v64
    v_rcp_f32 v64, v64
    s_nop 0
    v_cvt_pk_bf16_f32 v64, v64, v64
    v_and_b32 v64, s33, v64
    v_sub_f32 v65, 1.0, v64
    v_cvt_pk_bf16_f32 v65, v65, v65
    v_and_b32 v65, s33, v65
    buffer_store_dwordx2 v[64:65], v72, s[4:7], s24 offen sc1
    s_branch L_aqg_end
L_aqg_end1:
    s_nop 7
    s_nop 3
    v_cvt_pk_bf16_f32 v64, v96, v96
    s_lshl_b32 s24, s48, 8
    v_and_b32 v64, s33, v64
    s_add_u32 s24, s24, 262144
    v_mul_f32 v64, s31, v64
    v_exp_f32 v64, v64
    s_nop 0
    v_add_f32 v64, 1.0, v64
    v_rcp_f32 v64, v64
    s_nop 0
    v_cvt_pk_bf16_f32 v64, v64, v64
    v_and_b32 v64, s33, v64
    v_sub_f32 v65, 1.0, v64
    v_cvt_pk_bf16_f32 v65, v65, v65
    v_and_b32 v65, s33, v65
    buffer_store_dwordx2 v[64:65], v72, s[4:7], s24 offen sc1
L_aqg_end:
L_aq_done:
    s_cmp_eq_u32 s13, 0
    s_cbranch_scc0 L_wfd_83
    s_mov_b32 s21, 0
        L_wf_82:
    buffer_load_dword v2, off, s[8:11], 0 offset:8 sc1
    s_add_u32 s21, s21, 1
    s_cmp_gt_u32 s21, 3000000
    s_cbranch_scc1 L_failA
    s_waitcnt vmcnt(0)
    v_cmp_gt_u32 vcc, 1, v2
    s_cbranch_vccz L_wfd_83
    s_sleep 2
    s_branch L_wf_82
        L_wfd_83:
    s_waitcnt vmcnt(0)
    s_barrier
    s_cmp_eq_u32 s13, 0
    s_cbranch_scc0 L_sig_84
    buffer_wbl2 sc1
    s_waitcnt vmcnt(0)
    s_mov_b64 exec, 1
    v_mov_b32 v2, 1
    buffer_atomic_add v2, off, s[4:7], s30 sc1
    s_mov_b64 exec, -1
        L_sig_84:
    s_branch L_next
L_do_g1:
    s_load_dwordx2 s[68:69], s[0:1], 0
    s_waitcnt lgkmcnt(0)
    s_and_b32 s69, s69, 0xffff
    s_mov_b32 s70, 2359296
    s_mov_b32 s71, 0x20000
    v_lshlrev_b32 v9, 7, v0
    s_mul_i32 s17, s12, 73728
    s_mov_b32 m0, 163264
    v_cmp_gt_u32 vcc, 64, v0
    buffer_load_dword v9, s[68:71], s17 offen lds
    s_add_u32 s17, s17, 32768
    v_mov_b32 v10, 1073741824
    buffer_load_dword v9, s[68:71], s17 offen lds
    s_add_u32 s17, s17, 32768
    v_cndmask_b32 v9, v10, v9, vcc
    buffer_load_dword v9, s[68:71], s17 offen lds
    s_and_b32 s19, s16, 1
    s_bfe_u32 s27, s16, 0x50001
    s_lshr_b32 s22, s16, 6
    s_lshl_b32 s19, s19, 3
    s_add_u32 s19, s19, 48
    s_load_dwordx2 s[64:65], s[0:1], s19
    s_waitcnt lgkmcnt(0)
    s_and_b32 s65, s65, 0xffff
    s_mov_b32 s66, 4718592
    s_mov_b32 s67, 0x20000
    s_lshl_b32 s17, s27, 8
    v_and_b32 v1, 63, v0
    v_lshrrev_b32 v9, 4, v1
    v_and_b32 v10, 15, v1
    v_lshlrev_b32 v11, 2, v9
    v_xor_b32 v10, v10, v11
    v_mul_u32_u24 v9, 8192, v9
    v_lshl_add_u32 v9, v10, 4, v9
    s_mul_i32 s18, s13, 1179648
    s_add_u32 s17, s17, s18
    s_mul_i32 s18, s13, 36864
    s_mov_b32 m0, s18
    s_nop 0
    buffer_load_dwordx4 v9, s[64:67], s17 offen lds
    s_add_u32 m0, m0, 1024
    s_add_u32 s17, s17, 32768
    buffer_load_dwordx4 v9, s[64:67], s17 offen lds
    s_add_u32 m0, m0, 1024
    s_add_u32 s17, s17, 32768
    buffer_load_dwordx4 v9, s[64:67], s17 offen lds
    s_add_u32 m0, m0, 1024
    s_add_u32 s17, s17, 32768
    buffer_load_dwordx4 v9, s[64:67], s17 offen lds
    s_add_u32 m0, m0, 1024
    s_add_u32 s17, s17, 32768
    buffer_load_dwordx4 v9, s[64:67], s17 offen lds
    s_add_u32 m0, m0, 1024
    s_add_u32 s17, s17, 32768
    buffer_load_dwordx4 v9, s[64:67], s17 offen lds
    s_add_u32 m0, m0, 1024
    s_add_u32 s17, s17, 32768
    buffer_load_dwordx4 v9, s[64:67], s17 offen lds
    s_add_u32 m0, m0, 1024
    s_add_u32 s17, s17, 32768
    buffer_load_dwordx4 v9, s[64:67], s17 offen lds
    s_add_u32 m0, m0, 1024
    s_add_u32 s17, s17, 32768
    buffer_load_dwordx4 v9, s[64:67], s17 offen lds
    s_add_u32 m0, m0, 1024
    s_add_u32 s17, s17, 32768
    buffer_load_dwordx4 v9, s[64:67], s17 offen lds
    s_add_u32 m0, m0, 1024
    s_add_u32 s17, s17, 32768
    buffer_load_dwordx4 v9, s[64:67], s17 offen lds
    s_add_u32 m0, m0, 1024
    s_add_u32 s17, s17, 32768
    buffer_load_dwordx4 v9, s[64:67], s17 offen lds
    s_add_u32 m0, m0, 1024
    s_add_u32 s17, s17, 32768
    buffer_load_dwordx4 v9, s[64:67], s17 offen lds
    s_add_u32 m0, m0, 1024
    s_add_u32 s17, s17, 32768
    buffer_load_dwordx4 v9, s[64:67], s17 offen lds
    s_add_u32 m0, m0, 1024
    s_add_u32 s17, s17, 32768
    buffer_load_dwordx4 v9, s[64:67], s17 offen lds
    s_add_u32 m0, m0, 1024
    s_add_u32 s17, s17, 32768
    buffer_load_dwordx4 v9, s[64:67], s17 offen lds
    s_add_u32 m0, m0, 1024
    s_add_u32 s17, s17, 32768
    buffer_load_dwordx4 v9, s[64:67], s17 offen lds
    s_add_u32 m0, m0, 1024
    s_add_u32 s17, s17, 32768
    buffer_load_dwordx4 v9, s[64:67], s17 offen lds
    s_add_u32 m0, m0, 1024
    s_add_u32 s17, s17, 32768
    buffer_load_dwordx4 v9, s[64:67], s17 offen lds
    s_add_u32 m0, m0, 1024
    s_add_u32 s17, s17, 32768
    buffer_load_dwordx4 v9, s[64:67], s17 offen lds
    s_add_u32 m0, m0, 1024
    s_add_u32 s17, s17, 32768
    buffer_load_dwordx4 v9, s[64:67], s17 offen lds
    s_add_u32 m0, m0, 1024
    s_add_u32 s17, s17, 32768
    buffer_load_dwordx4 v9, s[64:67], s17 offen lds
    s_add_u32 m0, m0, 1024
    s_add_u32 s17, s17, 32768
    buffer_load_dwordx4 v9, s[64:67], s17 offen lds
    s_add_u32 m0, m0, 1024
    s_add_u32 s17, s17, 32768
    buffer_load_dwordx4 v9, s[64:67], s17 offen lds
    s_add_u32 m0, m0, 1024
    s_add_u32 s17, s17, 32768
    buffer_load_dwordx4 v9, s[64:67], s17 offen lds
    s_add_u32 m0, m0, 1024
    s_add_u32 s17, s17, 32768
    buffer_load_dwordx4 v9, s[64:67], s17 offen lds
    s_add_u32 m0, m0, 1024
    s_add_u32 s17, s17, 32768
    buffer_load_dwordx4 v9, s[64:67], s17 offen lds
    s_add_u32 m0, m0, 1024
    s_add_u32 s17, s17, 32768
    buffer_load_dwordx4 v9, s[64:67], s17 offen lds
    s_add_u32 m0, m0, 1024
    s_add_u32 s17, s17, 32768
    buffer_load_dwordx4 v9, s[64:67], s17 offen lds
    s_add_u32 m0, m0, 1024
    s_add_u32 s17, s17, 32768
    buffer_load_dwordx4 v9, s[64:67], s17 offen lds
    s_add_u32 m0, m0, 1024
    s_add_u32 s17, s17, 32768
    buffer_load_dwordx4 v9, s[64:67], s17 offen lds
    s_add_u32 m0, m0, 1024
    s_add_u32 s17, s17, 32768
    buffer_load_dwordx4 v9, s[64:67], s17 offen lds
    s_add_u32 m0, m0, 1024
    s_add_u32 s17, s17, 32768
    buffer_load_dwordx4 v9, s[64:67], s17 offen lds
    s_add_u32 m0, m0, 1024
    s_add_u32 s17, s17, 32768
    buffer_load_dwordx4 v9, s[64:67], s17 offen lds
    s_add_u32 m0, m0, 1024
    s_add_u32 s17, s17, 32768
    buffer_load_dwordx4 v9, s[64:67], s17 offen lds
    s_add_u32 m0, m0, 1024
    s_add_u32 s17, s17, 32768
    buffer_load_dwordx4 v9, s[64:67], s17 offen lds
    v_lshrrev_b32 v10, 5, v1
    v_bfe_u32 v11, v1, 2, 2
    v_lshl_add_u32 v10, v10, 3, v11
    v_lshlrev_b32 v10, 8, v10
    v_xor_b32 v11, s13, v11
    v_lshl_add_u32 v10, v11, 6, v10
    v_bfe_u32 v11, v1, 4, 1
    v_lshl_add_u32 v10, v11, 5, v10
    v_and_b32 v11, 3, v1
    v_lshl_add_u32 v10, v11, 3, v10
    v_add_u32 v11, 65536, v10
    v_add_u32 v12, 131072, v10
    s_waitcnt vmcnt(0)
    s_barrier
    ds_read_b64_tr_b16 a[0:1], v10 offset:0
    ds_read_b64_tr_b16 a[2:3], v10 offset:1024
    ds_read_b64_tr_b16 a[4:5], v10 offset:4096
    ds_read_b64_tr_b16 a[6:7], v10 offset:5120
    ds_read_b64_tr_b16 a[8:9], v10 offset:8192
    ds_read_b64_tr_b16 a[10:11], v10 offset:9216
    ds_read_b64_tr_b16 a[12:13], v10 offset:12288
    ds_read_b64_tr_b16 a[14:15], v10 offset:13312
    ds_read_b64_tr_b16 a[16:17], v10 offset:16384
    ds_read_b64_tr_b16 a[18:19], v10 offset:17408
    ds_read_b64_tr_b16 a[20:21], v10 offset:20480
    ds_read_b64_tr_b16 a[22:23], v10 offset:21504
    s_waitcnt lgkmcnt(0)
    ds_read_b64_tr_b16 a[24:25], v10 offset:24576
    ds_read_b64_tr_b16 a[26:27], v10 offset:25600
    ds_read_b64_tr_b16 a[28:29], v10 offset:28672
    ds_read_b64_tr_b16 a[30:31], v10 offset:29696
    ds_read_b64_tr_b16 a[32:33], v10 offset:32768
    ds_read_b64_tr_b16 a[34:35], v10 offset:33792
    ds_read_b64_tr_b16 a[36:37], v10 offset:36864
    ds_read_b64_tr_b16 a[38:39], v10 offset:37888
    ds_read_b64_tr_b16 a[40:41], v10 offset:40960
    ds_read_b64_tr_b16 a[42:43], v10 offset:41984
    ds_read_b64_tr_b16 a[44:45], v10 offset:45056
    ds_read_b64_tr_b16 a[46:47], v10 offset:46080
    s_waitcnt lgkmcnt(0)
    ds_read_b64_tr_b16 a[48:49], v10 offset:49152
    ds_read_b64_tr_b16 a[50:51], v10 offset:50176
    ds_read_b64_tr_b16 a[52:53], v10 offset:53248
    ds_read_b64_tr_b16 a[54:55], v10 offset:54272
    ds_read_b64_tr_b16 a[56:57], v10 offset:57344
    ds_read_b64_tr_b16 a[58:59], v10 offset:58368
    ds_read_b64_tr_b16 a[60:61], v10 offset:61440
    ds_read_b64_tr_b16 a[62:63], v10 offset:62464
    ds_read_b64_tr_b16 a[64:65], v11 offset:0
    ds_read_b64_tr_b16 a[66:67], v11 offset:1024
    ds_read_b64_tr_b16 a[68:69], v11 offset:4096
    ds_read_b64_tr_b16 a[70:71], v11 offset:5120
    s_waitcnt lgkmcnt(0)
    ds_read_b64_tr_b16 a[72:73], v11 offset:8192
    ds_read_b64_tr_b16 a[74:75], v11 offset:9216
    ds_read_b64_tr_b16 a[76:77], v11 offset:12288
    ds_read_b64_tr_b16 a[78:79], v11 offset:13312
    ds_read_b64_tr_b16 a[80:81], v11 offset:16384
    ds_read_b64_tr_b16 a[82:83], v11 offset:17408
    ds_read_b64_tr_b16 a[84:85], v11 offset:20480
    ds_read_b64_tr_b16 a[86:87], v11 offset:21504
    ds_read_b64_tr_b16 a[88:89], v11 offset:24576
    ds_read_b64_tr_b16 a[90:91], v11 offset:25600
    ds_read_b64_tr_b16 a[92:93], v11 offset:28672
    ds_read_b64_tr_b16 a[94:95], v11 offset:29696
    s_waitcnt lgkmcnt(0)
    ds_read_b64_tr_b16 a[96:97], v11 offset:32768
    ds_read_b64_tr_b16 a[98:99], v11 offset:33792
    ds_read_b64_tr_b16 a[100:101], v11 offset:36864
    ds_read_b64_tr_b16 a[102:103], v11 offset:37888
    ds_read_b64_tr_b16 a[104:105], v11 offset:40960
    ds_read_b64_tr_b16 a[106:107], v11 offset:41984
    ds_read_b64_tr_b16 a[108:109], v11 offset:45056
    ds_read_b64_tr_b16 a[110:111], v11 offset:46080
    ds_read_b64_tr_b16 a[112:113], v11 offset:49152
    ds_read_b64_tr_b16 a[114:115], v11 offset:50176
    ds_read_b64_tr_b16 a[116:117], v11 offset:53248
    ds_read_b64_tr_b16 a[118:119], v11 offset:54272
    s_waitcnt lgkmcnt(0)
    ds_read_b64_tr_b16 a[120:121], v11 offset:57344
    ds_read_b64_tr_b16 a[122:123], v11 offset:58368
    ds_read_b64_tr_b16 a[124:125], v11 offset:61440
    ds_read_b64_tr_b16 a[126:127], v11 offset:62464
    ds_read_b64_tr_b16 a[128:129], v12 offset:0
    ds_read_b64_tr_b16 a[130:131], v12 offset:1024
    ds_read_b64_tr_b16 a[132:133], v12 offset:4096
    ds_read_b64_tr_b16 a[134:135], v12 offset:5120
    ds_read_b64_tr_b16 a[136:137], v12 offset:8192
    ds_read_b64_tr_b16 a[138:139], v12 offset:9216
    ds_read_b64_tr_b16 a[140:141], v12 offset:12288
    ds_read_b64_tr_b16 a[142:143], v12 offset:13312
    s_waitcnt lgkmcnt(0)
    s_barrier
    s_load_dwordx2 s[68:69], s[0:1], 0
    s_waitcnt lgkmcnt(0)
    s_and_b32 s69, s69, 0xffff
    s_mov_b32 s70, 2359296
    s_mov_b32 s71, 0x20000
    v_and_b32 v1, 63, v0
    v_lshrrev_b32 v9, 3, v1
    v_lshrrev_b32 v10, 1, v9
    s_and_b32 s17, s13, 1
    s_lshl_b32 s17, s17, 2
    v_add_u32 v10, s17, v10
    v_and_b32 v11, 7, v1
    v_xor_b32 v10, v10, v11
    v_mul_u32_u24 v8, 1152, v9
    v_lshl_add_u32 v8, v10, 4, v8
    s_mul_i32 s17, s13, 9216
    v_add_u32 v8, s17, v8
    v_and_b32 v9, 31, v1
    v_lshrrev_b32 v10, 3, v9
    v_mul_u32_u24 v10, 9216, v10
    v_and_b32 v11, 7, v9
    v_lshl_add_u32 v10, v11, 7, v10
    v_bfe_u32 v11, v9, 1, 3
    v_lshrrev_b32 v12, 5, v1
    v_xor_b32 v11, v11, v12
    v_xor_b32 v12, 0, v11
    v_lshl_add_u32 v4, v12, 4, v10
    v_add_u32 v248, 65536, v4
    v_xor_b32 v12, 2, v11
    v_lshl_add_u32 v5, v12, 4, v10
    v_add_u32 v249, 65536, v5
    v_xor_b32 v12, 4, v11
    v_lshl_add_u32 v6, v12, 4, v10
    v_add_u32 v250, 65536, v6
    v_xor_b32 v12, 6, v11
    v_lshl_add_u32 v7, v12, 4, v10
    v_add_u32 v251, 65536, v7
    v_and_b32 v1, 63, v0
    v_bfe_u32 v9, v1, 4, 1
    v_lshlrev_b32 v9, 10, v9
    v_lshrrev_b32 v10, 5, v1
    v_lshl_add_u32 v9, v10, 8, v9
    v_and_b32 v10, 15, v1
    v_lshl_add_u32 v12, v10, 4, v9
    s_lshl_b32 s29, s27, 14
    s_lshl_b32 s17, s13, 11
    s_add_u32 s29, s29, s17
    s_add_u32 s29, s29, 16777216
    s_lshl_b32 s30, s27, 7
    s_add_u32 s30, s30, 0
    s_lshl_b32 s17, s22, 3
    s_add_u32 s30, s30, s17
    s_and_b32 s17, s16, 1
    s_lshl_b32 s17, s17, 2
    s_add_u32 s30, s30, s17
    s_mov_b32 s31, 0x3e0293ee
    s_bitcmp1_b32 s16, 0
    s_cbranch_scc1 L_g1_v
    s_cmp_eq_u32 s13, 0
    s_cbranch_scc0 L_wfd_86
    s_mov_b32 s21, 0
        L_wf_85:
    buffer_load_dword v2, off, s[8:11], 0 offset:8 sc1
    s_add_u32 s21, s21, 1
    s_cmp_gt_u32 s21, 3000000
    s_cbranch_scc1 L_failA
    s_waitcnt vmcnt(0)
    v_cmp_gt_u32 vcc, 1, v2
    s_cbranch_vccz L_wfd_86
    s_sleep 2
    s_branch L_wf_85
        L_wfd_86:
    s_mov_b32 s25, 0
    s_mul_i32 s17, s13, 9216
    s_add_u32 m0, s17, s25
    s_mul_i32 s23, s22, 36864
    buffer_load_dwordx4 v8, s[68:71], s23 offen lds
    s_add_u32 m0, m0, 1024
    s_add_u32 s23, s23, 128
    buffer_load_dwordx4 v8, s[68:71], s23 offen lds
    s_add_u32 m0, m0, 1024
    s_add_u32 s23, s23, 128
    buffer_load_dwordx4 v8, s[68:71], s23 offen lds
    s_add_u32 m0, m0, 1024
    s_add_u32 s23, s23, 128
    buffer_load_dwordx4 v8, s[68:71], s23 offen lds
    s_add_u32 m0, m0, 1024
    s_add_u32 s23, s23, 128
    buffer_load_dwordx4 v8, s[68:71], s23 offen lds
    s_add_u32 m0, m0, 1024
    s_add_u32 s23, s23, 128
    buffer_load_dwordx4 v8, s[68:71], s23 offen lds
    s_add_u32 m0, m0, 1024
    s_add_u32 s23, s23, 128
    buffer_load_dwordx4 v8, s[68:71], s23 offen lds
    s_add_u32 m0, m0, 1024
    s_add_u32 s23, s23, 128
    buffer_load_dwordx4 v8, s[68:71], s23 offen lds
    s_add_u32 m0, m0, 1024
    s_add_u32 s23, s23, 128
    buffer_load_dwordx4 v8, s[68:71], s23 offen lds
    s_add_u32 s28, s22, 2
    s_min_u32 s28, s28, 63
    s_mov_b32 s25, 36864
    s_mul_i32 s17, s13, 9216
    s_add_u32 m0, s17, s25
    s_mul_i32 s23, s28, 36864
    buffer_load_dwordx4 v8, s[68:71], s23 offen lds
    s_add_u32 m0, m0, 1024
    s_add_u32 s23, s23, 128
    buffer_load_dwordx4 v8, s[68:71], s23 offen lds
    s_add_u32 m0, m0, 1024
    s_add_u32 s23, s23, 128
    buffer_load_dwordx4 v8, s[68:71], s23 offen lds
    s_add_u32 m0, m0, 1024
    s_add_u32 s23, s23, 128
    buffer_load_dwordx4 v8, s[68:71], s23 offen lds
    s_add_u32 m0, m0, 1024
    s_add_u32 s23, s23, 128
    buffer_load_dwordx4 v8, s[68:71], s23 offen lds
    s_add_u32 m0, m0, 1024
    s_add_u32 s23, s23, 128
    buffer_load_dwordx4 v8, s[68:71], s23 offen lds
    s_add_u32 m0, m0, 1024
    s_add_u32 s23, s23, 128
    buffer_load_dwordx4 v8, s[68:71], s23 offen lds
    s_add_u32 m0, m0, 1024
    s_add_u32 s23, s23, 128
    buffer_load_dwordx4 v8, s[68:71], s23 offen lds
    s_add_u32 m0, m0, 1024
    s_add_u32 s23, s23, 128
    buffer_load_dwordx4 v8, s[68:71], s23 offen lds
    s_mov_b32 s26, 0
    s_waitcnt vmcnt(9)
    s_barrier
    s_add_u32 s28, s22, 4
    s_min_u32 s28, s28, 63
    s_mov_b32 s25, 73728
    ds_read_b128 v[16:19], v4 offset:0
    s_mul_i32 s17, s13, 9216
    s_add_u32 m0, s17, s25
    s_mul_i32 s23, s28, 36864
    ds_read_b128 v[20:23], v5 offset:0
    ds_read_b128 v[24:27], v6 offset:0
    ds_read_b128 v[28:31], v7 offset:0
    ds_read_b128 v[32:35], v4 offset:1024
    ds_read_b128 v[36:39], v5 offset:1024
    ds_read_b128 v[40:43], v6 offset:1024
    ds_read_b128 v[44:47], v7 offset:1024
    s_waitcnt lgkmcnt(7)
    v_mfma_f32_32x32x16_bf16 v[48:63], a[0:3], v[16:19], 0
    ds_read_b128 v[16:19], v4 offset:2048
    s_waitcnt lgkmcnt(7)
    v_mfma_f32_32x32x16_bf16 v[48:63], a[4:7], v[20:23], v[48:63]
    ds_read_b128 v[20:23], v5 offset:2048
    buffer_load_dwordx4 v8, s[68:71], s23 offen lds
    s_add_u32 m0, m0, 1024
    s_add_u32 s23, s23, 128
    s_waitcnt lgkmcnt(7)
    v_mfma_f32_32x32x16_bf16 v[48:63], a[8:11], v[24:27], v[48:63]
    ds_read_b128 v[24:27], v6 offset:2048
    s_waitcnt lgkmcnt(7)
    v_mfma_f32_32x32x16_bf16 v[48:63], a[12:15], v[28:31], v[48:63]
    ds_read_b128 v[28:31], v7 offset:2048
    s_waitcnt lgkmcnt(7)
    v_mfma_f32_32x32x16_bf16 v[48:63], a[16:19], v[32:35], v[48:63]
    ds_read_b128 v[32:35], v4 offset:3072
    buffer_load_dwordx4 v8, s[68:71], s23 offen lds
    s_add_u32 m0, m0, 1024
    s_add_u32 s23, s23, 128
    s_waitcnt lgkmcnt(7)
    v_mfma_f32_32x32x16_bf16 v[48:63], a[20:23], v[36:39], v[48:63]
    ds_read_b128 v[36:39], v5 offset:3072
    s_waitcnt lgkmcnt(7)
    v_mfma_f32_32x32x16_bf16 v[48:63], a[24:27], v[40:43], v[48:63]
    ds_read_b128 v[40:43], v6 offset:3072
    s_waitcnt lgkmcnt(7)
    v_mfma_f32_32x32x16_bf16 v[48:63], a[28:31], v[44:47], v[48:63]
    ds_read_b128 v[44:47], v7 offset:3072
    buffer_load_dwordx4 v8, s[68:71], s23 offen lds
    s_add_u32 m0, m0, 1024
    s_add_u32 s23, s23, 128
    s_waitcnt lgkmcnt(7)
    v_mfma_f32_32x32x16_bf16 v[48:63], a[32:35], v[16:19], v[48:63]
    ds_read_b128 v[16:19], v4 offset:4096
    s_waitcnt lgkmcnt(7)
    v_mfma_f32_32x32x16_bf16 v[48:63], a[36:39], v[20:23], v[48:63]
    ds_read_b128 v[20:23], v5 offset:4096
    s_waitcnt lgkmcnt(7)
    v_mfma_f32_32x32x16_bf16 v[48:63], a[40:43], v[24:27], v[48:63]
    ds_read_b128 v[24:27], v6 offset:4096
    buffer_load_dwordx4 v8, s[68:71], s23 offen lds
    s_add_u32 m0, m0, 1024
    s_add_u32 s23, s23, 128
    s_waitcnt lgkmcnt(7)
    v_mfma_f32_32x32x16_bf16 v[48:63], a[44:47], v[28:31], v[48:63]
    ds_read_b128 v[28:31], v7 offset:4096
    s_waitcnt lgkmcnt(7)
    v_mfma_f32_32x32x16_bf16 v[48:63], a[48:51], v[32:35], v[48:63]
    ds_read_b128 v[32:35], v4 offset:5120
    s_waitcnt lgkmcnt(7)
    v_mfma_f32_32x32x16_bf16 v[48:63], a[52:55], v[36:39], v[48:63]
    ds_read_b128 v[36:39], v5 offset:5120
    buffer_load_dwordx4 v8, s[68:71], s23 offen lds
    s_add_u32 m0, m0, 1024
    s_add_u32 s23, s23, 128
    s_waitcnt lgkmcnt(7)
    v_mfma_f32_32x32x16_bf16 v[48:63], a[56:59], v[40:43], v[48:63]
    ds_read_b128 v[40:43], v6 offset:5120
    s_waitcnt lgkmcnt(7)
    v_mfma_f32_32x32x16_bf16 v[48:63], a[60:63], v[44:47], v[48:63]
    ds_read_b128 v[44:47], v7 offset:5120
    s_waitcnt lgkmcnt(7)
    v_mfma_f32_32x32x16_bf16 v[48:63], a[64:67], v[16:19], v[48:63]
    ds_read_b128 v[16:19], v4 offset:6144
    buffer_load_dwordx4 v8, s[68:71], s23 offen lds
    s_add_u32 m0, m0, 1024
    s_add_u32 s23, s23, 128
    s_waitcnt lgkmcnt(7)
    v_mfma_f32_32x32x16_bf16 v[48:63], a[68:71], v[20:23], v[48:63]
    ds_read_b128 v[20:23], v5 offset:6144
    s_waitcnt lgkmcnt(7)
    v_mfma_f32_32x32x16_bf16 v[48:63], a[72:75], v[24:27], v[48:63]
    ds_read_b128 v[24:27], v6 offset:6144
    s_waitcnt lgkmcnt(7)
    v_mfma_f32_32x32x16_bf16 v[48:63], a[76:79], v[28:31], v[48:63]
    buffer_load_dwordx4 v8, s[68:71], s23 offen lds
    s_add_u32 m0, m0, 1024
    s_add_u32 s23, s23, 128
    ds_read_b128 v[28:31], v7 offset:6144
    s_waitcnt lgkmcnt(7)
    v_mfma_f32_32x32x16_bf16 v[48:63], a[80:83], v[32:35], v[48:63]
    ds_read_b128 v[32:35], v4 offset:7168
    s_waitcnt lgkmcnt(7)
    v_mfma_f32_32x32x16_bf16 v[48:63], a[84:87], v[36:39], v[48:63]
    ds_read_b128 v[36:39], v5 offset:7168
    s_waitcnt lgkmcnt(7)
    v_mfma_f32_32x32x16_bf16 v[48:63], a[88:91], v[40:43], v[48:63]
    buffer_load_dwordx4 v8, s[68:71], s23 offen lds
    s_add_u32 m0, m0, 1024
    s_add_u32 s23, s23, 128
    ds_read_b128 v[40:43], v6 offset:7168
    s_waitcnt lgkmcnt(7)
    v_mfma_f32_32x32x16_bf16 v[48:63], a[92:95], v[44:47], v[48:63]
    ds_read_b128 v[44:47], v7 offset:7168
    s_waitcnt lgkmcnt(7)
    v_mfma_f32_32x32x16_bf16 v[48:63], a[96:99], v[16:19], v[48:63]
    ds_read_b128 v[16:19], v4 offset:8192
    s_waitcnt lgkmcnt(7)
    v_mfma_f32_32x32x16_bf16 v[48:63], a[100:103], v[20:23], v[48:63]
    buffer_load_dwordx4 v8, s[68:71], s23 offen lds
    ds_read_b128 v[20:23], v5 offset:8192
    s_waitcnt lgkmcnt(7)
    v_mfma_f32_32x32x16_bf16 v[48:63], a[104:107], v[24:27], v[48:63]
    ds_read_b128 v[24:27], v6 offset:8192
    s_waitcnt lgkmcnt(7)
    v_mfma_f32_32x32x16_bf16 v[48:63], a[108:111], v[28:31], v[48:63]
    ds_read_b128 v[28:31], v7 offset:8192
    s_waitcnt lgkmcnt(7)
    v_mfma_f32_32x32x16_bf16 v[48:63], a[112:115], v[32:35], v[48:63]
    s_waitcnt lgkmcnt(6)
    v_mfma_f32_32x32x16_bf16 v[48:63], a[116:119], v[36:39], v[48:63]
    s_waitcnt lgkmcnt(5)
    v_mfma_f32_32x32x16_bf16 v[48:63], a[120:123], v[40:43], v[48:63]
    s_waitcnt lgkmcnt(4)
    v_mfma_f32_32x32x16_bf16 v[48:63], a[124:127], v[44:47], v[48:63]
    s_waitcnt lgkmcnt(3)
    v_mfma_f32_32x32x16_bf16 v[48:63], a[128:131], v[16:19], v[48:63]
    s_waitcnt lgkmcnt(2)
    v_mfma_f32_32x32x16_bf16 v[48:63], a[132:135], v[20:23], v[48:63]
    s_waitcnt lgkmcnt(1)
    v_mfma_f32_32x32x16_bf16 v[48:63], a[136:139], v[24:27], v[48:63]
    s_waitcnt lgkmcnt(0)
    v_mfma_f32_32x32x16_bf16 v[48:63], a[140:143], v[28:31], v[48:63]
    s_mov_b32 s48, s22
    s_add_u32 s22, s22, 2
    s_waitcnt vmcnt(9)
L_g10_lp:
    s_barrier
    s_add_u32 s28, s22, 4
    s_min_u32 s28, s28, 63
    s_mov_b32 s25, 0
    ds_read_b128 v[16:19], v4 offset:36864
    s_mul_i32 s17, s13, 9216
    s_add_u32 m0, s17, s25
    s_mul_i32 s23, s28, 36864
    ds_read_b128 v[20:23], v5 offset:36864
    v_mul_f32 v48, s31, v48
    v_mul_f32 v49, s31, v49
    v_mul_f32 v50, s31, v50
    ds_read_b128 v[24:27], v6 offset:36864
    v_mul_f32 v51, s31, v51
    v_mul_f32 v52, s31, v52
    v_mul_f32 v53, s31, v53
    ds_read_b128 v[28:31], v7 offset:36864
    v_mul_f32 v54, s31, v54
    v_mul_f32 v55, s31, v55
    v_mul_f32 v56, s31, v56
    ds_read_b128 v[32:35], v4 offset:37888
    v_mul_f32 v57, s31, v57
    v_mul_f32 v58, s31, v58
    v_mul_f32 v59, s31, v59
    ds_read_b128 v[36:39], v5 offset:37888
    v_mul_f32 v60, s31, v60
    v_mul_f32 v61, s31, v61
    v_mul_f32 v62, s31, v62
    ds_read_b128 v[40:43], v6 offset:37888
    v_mul_f32 v63, s31, v63
    v_cvt_pk_bf16_f32 v64, v48, v49
    v_cvt_pk_bf16_f32 v65, v50, v51
    ds_read_b128 v[44:47], v7 offset:37888
    v_cvt_pk_bf16_f32 v66, v56, v57
    v_cvt_pk_bf16_f32 v67, v58, v59
    v_cvt_pk_bf16_f32 v68, v52, v53
    v_cvt_pk_bf16_f32 v69, v54, v55
    v_cvt_pk_bf16_f32 v70, v60, v61
    v_cvt_pk_bf16_f32 v71, v62, v63
    s_waitcnt lgkmcnt(7)
    v_mfma_f32_32x32x16_bf16 v[96:111], a[0:3], v[16:19], 0
    ds_read_b128 v[16:19], v4 offset:38912
    s_waitcnt lgkmcnt(7)
    v_mfma_f32_32x32x16_bf16 v[96:111], a[4:7], v[20:23], v[96:111]
    ds_read_b128 v[20:23], v5 offset:38912
    buffer_load_dwordx4 v8, s[68:71], s23 offen lds
    s_add_u32 m0, m0, 1024
    s_add_u32 s23, s23, 128
    s_waitcnt lgkmcnt(7)
    v_mfma_f32_32x32x16_bf16 v[96:111], a[8:11], v[24:27], v[96:111]
    ds_read_b128 v[24:27], v6 offset:38912
    s_waitcnt lgkmcnt(7)
    v_mfma_f32_32x32x16_bf16 v[96:111], a[12:15], v[28:31], v[96:111]
    ds_read_b128 v[28:31], v7 offset:38912
    s_waitcnt lgkmcnt(7)
    v_mfma_f32_32x32x16_bf16 v[96:111], a[16:19], v[32:35], v[96:111]
    ds_read_b128 v[32:35], v4 offset:39936
    buffer_load_dwordx4 v8, s[68:71], s23 offen lds
    s_add_u32 m0, m0, 1024
    s_add_u32 s23, s23, 128
    s_waitcnt lgkmcnt(7)
    v_mfma_f32_32x32x16_bf16 v[96:111], a[20:23], v[36:39], v[96:111]
    ds_read_b128 v[36:39], v5 offset:39936
    s_waitcnt lgkmcnt(7)
    v_mfma_f32_32x32x16_bf16 v[96:111], a[24:27], v[40:43], v[96:111]
    ds_read_b128 v[40:43], v6 offset:39936
    s_waitcnt lgkmcnt(7)
    v_mfma_f32_32x32x16_bf16 v[96:111], a[28:31], v[44:47], v[96:111]
    ds_read_b128 v[44:47], v7 offset:39936
    buffer_load_dwordx4 v8, s[68:71], s23 offen lds
    s_add_u32 m0, m0, 1024
    s_add_u32 s23, s23, 128
    s_waitcnt lgkmcnt(7)
    v_mfma_f32_32x32x16_bf16 v[96:111], a[32:35], v[16:19], v[96:111]
    ds_read_b128 v[16:19], v4 offset:40960
    s_waitcnt lgkmcnt(7)
    v_mfma_f32_32x32x16_bf16 v[96:111], a[36:39], v[20:23], v[96:111]
    ds_read_b128 v[20:23], v5 offset:40960
    s_waitcnt lgkmcnt(7)
    v_mfma_f32_32x32x16_bf16 v[96:111], a[40:43], v[24:27], v[96:111]
    ds_read_b128 v[24:27], v6 offset:40960
    buffer_load_dwordx4 v8, s[68:71], s23 offen lds
    s_add_u32 m0, m0, 1024
    s_add_u32 s23, s23, 128
    s_waitcnt lgkmcnt(7)
    v_mfma_f32_32x32x16_bf16 v[96:111], a[44:47], v[28:31], v[96:111]
    ds_read_b128 v[28:31], v7 offset:40960
    s_waitcnt lgkmcnt(7)
    v_mfma_f32_32x32x16_bf16 v[96:111], a[48:51], v[32:35], v[96:111]
    ds_read_b128 v[32:35], v4 offset:41984
    s_waitcnt lgkmcnt(7)
    v_mfma_f32_32x32x16_bf16 v[96:111], a[52:55], v[36:39], v[96:111]
    ds_read_b128 v[36:39], v5 offset:41984
    buffer_load_dwordx4 v8, s[68:71], s23 offen lds
    s_add_u32 m0, m0, 1024
    s_add_u32 s23, s23, 128
    s_waitcnt lgkmcnt(7)
    v_mfma_f32_32x32x16_bf16 v[96:111], a[56:59], v[40:43], v[96:111]
    ds_read_b128 v[40:43], v6 offset:41984
    s_waitcnt lgkmcnt(7)
    v_mfma_f32_32x32x16_bf16 v[96:111], a[60:63], v[44:47], v[96:111]
    ds_read_b128 v[44:47], v7 offset:41984
    s_waitcnt lgkmcnt(7)
    v_mfma_f32_32x32x16_bf16 v[96:111], a[64:67], v[16:19], v[96:111]
    ds_read_b128 v[16:19], v4 offset:43008
    buffer_load_dwordx4 v8, s[68:71], s23 offen lds
    s_add_u32 m0, m0, 1024
    s_add_u32 s23, s23, 128
    s_waitcnt lgkmcnt(7)
    v_mfma_f32_32x32x16_bf16 v[96:111], a[68:71], v[20:23], v[96:111]
    ds_read_b128 v[20:23], v5 offset:43008
    s_waitcnt lgkmcnt(7)
    v_mfma_f32_32x32x16_bf16 v[96:111], a[72:75], v[24:27], v[96:111]
    ds_read_b128 v[24:27], v6 offset:43008
    s_waitcnt lgkmcnt(7)
    v_mfma_f32_32x32x16_bf16 v[96:111], a[76:79], v[28:31], v[96:111]
    buffer_load_dwordx4 v8, s[68:71], s23 offen lds
    s_add_u32 m0, m0, 1024
    s_add_u32 s23, s23, 128
    ds_read_b128 v[28:31], v7 offset:43008
    s_waitcnt lgkmcnt(7)
    v_mfma_f32_32x32x16_bf16 v[96:111], a[80:83], v[32:35], v[96:111]
    ds_read_b128 v[32:35], v4 offset:44032
    s_waitcnt lgkmcnt(7)
    v_mfma_f32_32x32x16_bf16 v[96:111], a[84:87], v[36:39], v[96:111]
    ds_read_b128 v[36:39], v5 offset:44032
    s_waitcnt lgkmcnt(7)
    v_mfma_f32_32x32x16_bf16 v[96:111], a[88:91], v[40:43], v[96:111]
    buffer_load_dwordx4 v8, s[68:71], s23 offen lds
    s_add_u32 m0, m0, 1024
    s_add_u32 s23, s23, 128
    ds_read_b128 v[40:43], v6 offset:44032
    s_lshl_b32 s24, s48, 19
    s_add_u32 s24, s24, s29
    s_waitcnt lgkmcnt(7)
    v_mfma_f32_32x32x16_bf16 v[96:111], a[92:95], v[44:47], v[96:111]
    ds_read_b128 v[44:47], v7 offset:44032
    s_waitcnt lgkmcnt(7)
    v_mfma_f32_32x32x16_bf16 v[96:111], a[96:99], v[16:19], v[96:111]
    ds_read_b128 v[16:19], v4 offset:45056
    s_waitcnt lgkmcnt(7)
    v_mfma_f32_32x32x16_bf16 v[96:111], a[100:103], v[20:23], v[96:111]
    buffer_load_dwordx4 v8, s[68:71], s23 offen lds
    ds_read_b128 v[20:23], v5 offset:45056
    s_waitcnt lgkmcnt(7)
    v_mfma_f32_32x32x16_bf16 v[96:111], a[104:107], v[24:27], v[96:111]
    ds_read_b128 v[24:27], v6 offset:45056
    buffer_store_dwordx4 v[64:67], v12, s[4:7], s24 offen offset:0 sc1
    s_waitcnt lgkmcnt(7)
    v_mfma_f32_32x32x16_bf16 v[96:111], a[108:111], v[28:31], v[96:111]
    ds_read_b128 v[28:31], v7 offset:45056
    buffer_store_dwordx4 v[68:71], v12, s[4:7], s24 offen offset:512 sc1
    s_waitcnt lgkmcnt(7)
    v_mfma_f32_32x32x16_bf16 v[96:111], a[112:115], v[32:35], v[96:111]
    s_waitcnt lgkmcnt(6)
    v_mfma_f32_32x32x16_bf16 v[96:111], a[116:119], v[36:39], v[96:111]
    s_waitcnt lgkmcnt(5)
    v_mfma_f32_32x32x16_bf16 v[96:111], a[120:123], v[40:43], v[96:111]
    s_waitcnt lgkmcnt(4)
    v_mfma_f32_32x32x16_bf16 v[96:111], a[124:127], v[44:47], v[96:111]
    s_waitcnt lgkmcnt(3)
    v_mfma_f32_32x32x16_bf16 v[96:111], a[128:131], v[16:19], v[96:111]
    s_waitcnt lgkmcnt(2)
    v_mfma_f32_32x32x16_bf16 v[96:111], a[132:135], v[20:23], v[96:111]
    s_waitcnt lgkmcnt(1)
    v_mfma_f32_32x32x16_bf16 v[96:111], a[136:139], v[24:27], v[96:111]
    s_waitcnt lgkmcnt(0)
    v_mfma_f32_32x32x16_bf16 v[96:111], a[140:143], v[28:31], v[96:111]
    s_add_u32 s26, s26, 1
    s_cmp_eq_u32 s13, 0
    s_cbranch_scc0 L_np_87
    s_sub_u32 s17, s26, 2
    s_max_i32 s17, s17, 0
    v_mov_b32 v2, s17
    s_mov_b64 exec, 1
    buffer_store_dword v2, off, s[4:7], s30 sc1
    s_mov_b64 exec, -1
                L_np_87:
    s_mov_b32 s48, s22
    s_add_u32 s22, s22, 2
    s_cmp_gt_u32 s22, 63
    s_cbranch_scc1 L_g10_end1
    s_waitcnt vmcnt(11)
    s_barrier
    s_add_u32 s28, s22, 4
    s_min_u32 s28, s28, 63
    s_mov_b32 s25, 36864
    ds_read_b128 v[16:19], v248 offset:8192
    s_mul_i32 s17, s13, 9216
    s_add_u32 m0, s17, s25
    s_mul_i32 s23, s28, 36864
    ds_read_b128 v[20:23], v249 offset:8192
    v_mul_f32 v96, s31, v96
    v_mul_f32 v97, s31, v97
    v_mul_f32 v98, s31, v98
    ds_read_b128 v[24:27], v250 offset:8192
    v_mul_f32 v99, s31, v99
    v_mul_f32 v100, s31, v100
    v_mul_f32 v101, s31, v101
    ds_read_b128 v[28:31], v251 offset:8192
    v_mul_f32 v102, s31, v102
    v_mul_f32 v103, s31, v103
    v_mul_f32 v104, s31, v104
    ds_read_b128 v[32:35], v248 offset:9216
    v_mul_f32 v105, s31, v105
    v_mul_f32 v106, s31, v106
    v_mul_f32 v107, s31, v107
    ds_read_b128 v[36:39], v249 offset:9216
    v_mul_f32 v108, s31, v108
    v_mul_f32 v109, s31, v109
    v_mul_f32 v110, s31, v110
    ds_read_b128 v[40:43], v250 offset:9216
    v_mul_f32 v111, s31, v111
    v_cvt_pk_bf16_f32 v64, v96, v97
    v_cvt_pk_bf16_f32 v65, v98, v99
    ds_read_b128 v[44:47], v251 offset:9216
    v_cvt_pk_bf16_f32 v66, v104, v105
    v_cvt_pk_bf16_f32 v67, v106, v107
    v_cvt_pk_bf16_f32 v68, v100, v101
    v_cvt_pk_bf16_f32 v69, v102, v103
    v_cvt_pk_bf16_f32 v70, v108, v109
    v_cvt_pk_bf16_f32 v71, v110, v111
    s_waitcnt lgkmcnt(7)
    v_mfma_f32_32x32x16_bf16 v[48:63], a[0:3], v[16:19], 0
    ds_read_b128 v[16:19], v248 offset:10240
    s_waitcnt lgkmcnt(7)
    v_mfma_f32_32x32x16_bf16 v[48:63], a[4:7], v[20:23], v[48:63]
    ds_read_b128 v[20:23], v249 offset:10240
    buffer_load_dwordx4 v8, s[68:71], s23 offen lds
    s_add_u32 m0, m0, 1024
    s_add_u32 s23, s23, 128
    s_waitcnt lgkmcnt(7)
    v_mfma_f32_32x32x16_bf16 v[48:63], a[8:11], v[24:27], v[48:63]
    ds_read_b128 v[24:27], v250 offset:10240
    s_waitcnt lgkmcnt(7)
    v_mfma_f32_32x32x16_bf16 v[48:63], a[12:15], v[28:31], v[48:63]
    ds_read_b128 v[28:31], v251 offset:10240
    s_waitcnt lgkmcnt(7)
    v_mfma_f32_32x32x16_bf16 v[48:63], a[16:19], v[32:35], v[48:63]
    ds_read_b128 v[32:35], v248 offset:11264
    buffer_load_dwordx4 v8, s[68:71], s23 offen lds
    s_add_u32 m0, m0, 1024
    s_add_u32 s23, s23, 128
    s_waitcnt lgkmcnt(7)
    v_mfma_f32_32x32x16_bf16 v[48:63], a[20:23], v[36:39], v[48:63]
    ds_read_b128 v[36:39], v249 offset:11264
    s_waitcnt lgkmcnt(7)
    v_mfma_f32_32x32x16_bf16 v[48:63], a[24:27], v[40:43], v[48:63]
    ds_read_b128 v[40:43], v250 offset:11264
    s_waitcnt lgkmcnt(7)
    v_mfma_f32_32x32x16_bf16 v[48:63], a[28:31], v[44:47], v[48:63]
    ds_read_b128 v[44:47], v251 offset:11264
    buffer_load_dwordx4 v8, s[68:71], s23 offen lds
    s_add_u32 m0, m0, 1024
    s_add_u32 s23, s23, 128
    s_waitcnt lgkmcnt(7)
    v_mfma_f32_32x32x16_bf16 v[48:63], a[32:35], v[16:19], v[48:63]
    ds_read_b128 v[16:19], v248 offset:12288
    s_waitcnt lgkmcnt(7)
    v_mfma_f32_32x32x16_bf16 v[48:63], a[36:39], v[20:23], v[48:63]
    ds_read_b128 v[20:23], v249 offset:12288
    s_waitcnt lgkmcnt(7)
    v_mfma_f32_32x32x16_bf16 v[48:63], a[40:43], v[24:27], v[48:63]
    ds_read_b128 v[24:27], v250 offset:12288
    buffer_load_dwordx4 v8, s[68:71], s23 offen lds
    s_add_u32 m0, m0, 1024
    s_add_u32 s23, s23, 128
    s_waitcnt lgkmcnt(7)
    v_mfma_f32_32x32x16_bf16 v[48:63], a[44:47], v[28:31], v[48:63]
    ds_read_b128 v[28:31], v251 offset:12288
    s_waitcnt lgkmcnt(7)
    v_mfma_f32_32x32x16_bf16 v[48:63], a[48:51], v[32:35], v[48:63]
    ds_read_b128 v[32:35], v248 offset:13312
    s_waitcnt lgkmcnt(7)
    v_mfma_f32_32x32x16_bf16 v[48:63], a[52:55], v[36:39], v[48:63]
    ds_read_b128 v[36:39], v249 offset:13312
    buffer_load_dwordx4 v8, s[68:71], s23 offen lds
    s_add_u32 m0, m0, 1024
    s_add_u32 s23, s23, 128
    s_waitcnt lgkmcnt(7)
    v_mfma_f32_32x32x16_bf16 v[48:63], a[56:59], v[40:43], v[48:63]
    ds_read_b128 v[40:43], v250 offset:13312
    s_waitcnt lgkmcnt(7)
    v_mfma_f32_32x32x16_bf16 v[48:63], a[60:63], v[44:47], v[48:63]
    ds_read_b128 v[44:47], v251 offset:13312
    s_waitcnt lgkmcnt(7)
    v_mfma_f32_32x32x16_bf16 v[48:63], a[64:67], v[16:19], v[48:63]
    ds_read_b128 v[16:19], v248 offset:14336
    buffer_load_dwordx4 v8, s[68:71], s23 offen lds
    s_add_u32 m0, m0, 1024
    s_add_u32 s23, s23, 128
    s_waitcnt lgkmcnt(7)
    v_mfma_f32_32x32x16_bf16 v[48:63], a[68:71], v[20:23], v[48:63]
    ds_read_b128 v[20:23], v249 offset:14336
    s_waitcnt lgkmcnt(7)
    v_mfma_f32_32x32x16_bf16 v[48:63], a[72:75], v[24:27], v[48:63]
    ds_read_b128 v[24:27], v250 offset:14336
    s_waitcnt lgkmcnt(7)
    v_mfma_f32_32x32x16_bf16 v[48:63], a[76:79], v[28:31], v[48:63]
    buffer_load_dwordx4 v8, s[68:71], s23 offen lds
    s_add_u32 m0, m0, 1024
    s_add_u32 s23, s23, 128
    ds_read_b128 v[28:31], v251 offset:14336
    s_waitcnt lgkmcnt(7)
    v_mfma_f32_32x32x16_bf16 v[48:63], a[80:83], v[32:35], v[48:63]
    ds_read_b128 v[32:35], v248 offset:15360
    s_waitcnt lgkmcnt(7)
    v_mfma_f32_32x32x16_bf16 v[48:63], a[84:87], v[36:39], v[48:63]
    ds_read_b128 v[36:39], v249 offset:15360
    s_waitcnt lgkmcnt(7)
    v_mfma_f32_32x32x16_bf16 v[48:63], a[88:91], v[40:43], v[48:63]
    buffer_load_dwordx4 v8, s[68:71], s23 offen lds
    s_add_u32 m0, m0, 1024
    s_add_u32 s23, s23, 128
    ds_read_b128 v[40:43], v250 offset:15360
    s_lshl_b32 s24, s48, 19
    s_add_u32 s24, s24, s29
    s_waitcnt lgkmcnt(7)
    v_mfma_f32_32x32x16_bf16 v[48:63], a[92:95], v[44:47], v[48:63]
    ds_read_b128 v[44:47], v251 offset:15360
    s_waitcnt lgkmcnt(7)
    v_mfma_f32_32x32x16_bf16 v[48:63], a[96:99], v[16:19], v[48:63]
    ds_read_b128 v[16:19], v248 offset:16384
    s_waitcnt lgkmcnt(7)
    v_mfma_f32_32x32x16_bf16 v[48:63], a[100:103], v[20:23], v[48:63]
    buffer_load_dwordx4 v8, s[68:71], s23 offen lds
    ds_read_b128 v[20:23], v249 offset:16384
    s_waitcnt lgkmcnt(7)
    v_mfma_f32_32x32x16_bf16 v[48:63], a[104:107], v[24:27], v[48:63]
    ds_read_b128 v[24:27], v250 offset:16384
    buffer_store_dwordx4 v[64:67], v12, s[4:7], s24 offen offset:0 sc1
    s_waitcnt lgkmcnt(7)
    v_mfma_f32_32x32x16_bf16 v[48:63], a[108:111], v[28:31], v[48:63]
    ds_read_b128 v[28:31], v251 offset:16384
    buffer_store_dwordx4 v[68:71], v12, s[4:7], s24 offen offset:512 sc1
    s_waitcnt lgkmcnt(7)
    v_mfma_f32_32x32x16_bf16 v[48:63], a[112:115], v[32:35], v[48:63]
    s_waitcnt lgkmcnt(6)
    v_mfma_f32_32x32x16_bf16 v[48:63], a[116:119], v[36:39], v[48:63]
    s_waitcnt lgkmcnt(5)
    v_mfma_f32_32x32x16_bf16 v[48:63], a[120:123], v[40:43], v[48:63]
    s_waitcnt lgkmcnt(4)
    v_mfma_f32_32x32x16_bf16 v[48:63], a[124:127], v[44:47], v[48:63]
    s_waitcnt lgkmcnt(3)
    v_mfma_f32_32x32x16_bf16 v[48:63], a[128:131], v[16:19], v[48:63]
    s_waitcnt lgkmcnt(2)
    v_mfma_f32_32x32x16_bf16 v[48:63], a[132:135], v[20:23], v[48:63]
    s_waitcnt lgkmcnt(1)
    v_mfma_f32_32x32x16_bf16 v[48:63], a[136:139], v[24:27], v[48:63]
    s_waitcnt lgkmcnt(0)
    v_mfma_f32_32x32x16_bf16 v[48:63], a[140:143], v[28:31], v[48:63]
    s_add_u32 s26, s26, 1
    s_cmp_eq_u32 s13, 0
    s_cbranch_scc0 L_np_88
    s_sub_u32 s17, s26, 2
    s_max_i32 s17, s17, 0
    v_mov_b32 v2, s17
    s_mov_b64 exec, 1
    buffer_store_dword v2, off, s[4:7], s30 sc1
    s_mov_b64 exec, -1
                L_np_88:
    s_mov_b32 s48, s22
    s_add_u32 s22, s22, 2
    s_cmp_gt_u32 s22, 63
    s_cbranch_scc1 L_g10_end0
    s_waitcnt vmcnt(11)
    s_barrier
    s_add_u32 s28, s22, 4
    s_min_u32 s28, s28, 63
    s_mov_b32 s25, 73728
    ds_read_b128 v[16:19], v4 offset:0
    s_mul_i32 s17, s13, 9216
    s_add_u32 m0, s17, s25
    s_mul_i32 s23, s28, 36864
    ds_read_b128 v[20:23], v5 offset:0
    v_mul_f32 v48, s31, v48
    v_mul_f32 v49, s31, v49
    v_mul_f32 v50, s31, v50
    ds_read_b128 v[24:27], v6 offset:0
    v_mul_f32 v51, s31, v51
    v_mul_f32 v52, s31, v52
    v_mul_f32 v53, s31, v53
    ds_read_b128 v[28:31], v7 offset:0
    v_mul_f32 v54, s31, v54
    v_mul_f32 v55, s31, v55
    v_mul_f32 v56, s31, v56
    ds_read_b128 v[32:35], v4 offset:1024
    v_mul_f32 v57, s31, v57
    v_mul_f32 v58, s31, v58
    v_mul_f32 v59, s31, v59
    ds_read_b128 v[36:39], v5 offset:1024
    v_mul_f32 v60, s31, v60
    v_mul_f32 v61, s31, v61
    v_mul_f32 v62, s31, v62
    ds_read_b128 v[40:43], v6 offset:1024
    v_mul_f32 v63, s31, v63
    v_cvt_pk_bf16_f32 v64, v48, v49
    v_cvt_pk_bf16_f32 v65, v50, v51
    ds_read_b128 v[44:47], v7 offset:1024
    v_cvt_pk_bf16_f32 v66, v56, v57
    v_cvt_pk_bf16_f32 v67, v58, v59
    v_cvt_pk_bf16_f32 v68, v52, v53
    v_cvt_pk_bf16_f32 v69, v54, v55
    v_cvt_pk_bf16_f32 v70, v60, v61
    v_cvt_pk_bf16_f32 v71, v62, v63
    s_waitcnt lgkmcnt(7)
    v_mfma_f32_32x32x16_bf16 v[96:111], a[0:3], v[16:19], 0
    ds_read_b128 v[16:19], v4 offset:2048
    s_waitcnt lgkmcnt(7)
    v_mfma_f32_32x32x16_bf16 v[96:111], a[4:7], v[20:23], v[96:111]
    ds_read_b128 v[20:23], v5 offset:2048
    buffer_load_dwordx4 v8, s[68:71], s23 offen lds
    s_add_u32 m0, m0, 1024
    s_add_u32 s23, s23, 128
    s_waitcnt lgkmcnt(7)
    v_mfma_f32_32x32x16_bf16 v[96:111], a[8:11], v[24:27], v[96:111]
    ds_read_b128 v[24:27], v6 offset:2048
    s_waitcnt lgkmcnt(7)
    v_mfma_f32_32x32x16_bf16 v[96:111], a[12:15], v[28:31], v[96:111]
    ds_read_b128 v[28:31], v7 offset:2048
    s_waitcnt lgkmcnt(7)
    v_mfma_f32_32x32x16_bf16 v[96:111], a[16:19], v[32:35], v[96:111]
    ds_read_b128 v[32:35], v4 offset:3072
    buffer_load_dwordx4 v8, s[68:71], s23 offen lds
    s_add_u32 m0, m0, 1024
    s_add_u32 s23, s23, 128
    s_waitcnt lgkmcnt(7)
    v_mfma_f32_32x32x16_bf16 v[96:111], a[20:23], v[36:39], v[96:111]
    ds_read_b128 v[36:39], v5 offset:3072
    s_waitcnt lgkmcnt(7)
    v_mfma_f32_32x32x16_bf16 v[96:111], a[24:27], v[40:43], v[96:111]
    ds_read_b128 v[40:43], v6 offset:3072
    s_waitcnt lgkmcnt(7)
    v_mfma_f32_32x32x16_bf16 v[96:111], a[28:31], v[44:47], v[96:111]
    ds_read_b128 v[44:47], v7 offset:3072
    buffer_load_dwordx4 v8, s[68:71], s23 offen lds
    s_add_u32 m0, m0, 1024
    s_add_u32 s23, s23, 128
    s_waitcnt lgkmcnt(7)
    v_mfma_f32_32x32x16_bf16 v[96:111], a[32:35], v[16:19], v[96:111]
    ds_read_b128 v[16:19], v4 offset:4096
    s_waitcnt lgkmcnt(7)
    v_mfma_f32_32x32x16_bf16 v[96:111], a[36:39], v[20:23], v[96:111]
    ds_read_b128 v[20:23], v5 offset:4096
    s_waitcnt lgkmcnt(7)
    v_mfma_f32_32x32x16_bf16 v[96:111], a[40:43], v[24:27], v[96:111]
    ds_read_b128 v[24:27], v6 offset:4096
    buffer_load_dwordx4 v8, s[68:71], s23 offen lds
    s_add_u32 m0, m0, 1024
    s_add_u32 s23, s23, 128
    s_waitcnt lgkmcnt(7)
    v_mfma_f32_32x32x16_bf16 v[96:111], a[44:47], v[28:31], v[96:111]
    ds_read_b128 v[28:31], v7 offset:4096
    s_waitcnt lgkmcnt(7)
    v_mfma_f32_32x32x16_bf16 v[96:111], a[48:51], v[32:35], v[96:111]
    ds_read_b128 v[32:35], v4 offset:5120
    s_waitcnt lgkmcnt(7)
    v_mfma_f32_32x32x16_bf16 v[96:111], a[52:55], v[36:39], v[96:111]
    ds_read_b128 v[36:39], v5 offset:5120
    buffer_load_dwordx4 v8, s[68:71], s23 offen lds
    s_add_u32 m0, m0, 1024
    s_add_u32 s23, s23, 128
    s_waitcnt lgkmcnt(7)
    v_mfma_f32_32x32x16_bf16 v[96:111], a[56:59], v[40:43], v[96:111]
    ds_read_b128 v[40:43], v6 offset:5120
    s_waitcnt lgkmcnt(7)
    v_mfma_f32_32x32x16_bf16 v[96:111], a[60:63], v[44:47], v[96:111]
    ds_read_b128 v[44:47], v7 offset:5120
    s_waitcnt lgkmcnt(7)
    v_mfma_f32_32x32x16_bf16 v[96:111], a[64:67], v[16:19], v[96:111]
    ds_read_b128 v[16:19], v4 offset:6144
    buffer_load_dwordx4 v8, s[68:71], s23 offen lds
    s_add_u32 m0, m0, 1024
    s_add_u32 s23, s23, 128
    s_waitcnt lgkmcnt(7)
    v_mfma_f32_32x32x16_bf16 v[96:111], a[68:71], v[20:23], v[96:111]
    ds_read_b128 v[20:23], v5 offset:6144
    s_waitcnt lgkmcnt(7)
    v_mfma_f32_32x32x16_bf16 v[96:111], a[72:75], v[24:27], v[96:111]
    ds_read_b128 v[24:27], v6 offset:6144
    s_waitcnt lgkmcnt(7)
    v_mfma_f32_32x32x16_bf16 v[96:111], a[76:79], v[28:31], v[96:111]
    buffer_load_dwordx4 v8, s[68:71], s23 offen lds
    s_add_u32 m0, m0, 1024
    s_add_u32 s23, s23, 128
    ds_read_b128 v[28:31], v7 offset:6144
    s_waitcnt lgkmcnt(7)
    v_mfma_f32_32x32x16_bf16 v[96:111], a[80:83], v[32:35], v[96:111]
    ds_read_b128 v[32:35], v4 offset:7168
    s_waitcnt lgkmcnt(7)
    v_mfma_f32_32x32x16_bf16 v[96:111], a[84:87], v[36:39], v[96:111]
    ds_read_b128 v[36:39], v5 offset:7168
    s_waitcnt lgkmcnt(7)
    v_mfma_f32_32x32x16_bf16 v[96:111], a[88:91], v[40:43], v[96:111]
    buffer_load_dwordx4 v8, s[68:71], s23 offen lds
    s_add_u32 m0, m0, 1024
    s_add_u32 s23, s23, 128
    ds_read_b128 v[40:43], v6 offset:7168
    s_lshl_b32 s24, s48, 19
    s_add_u32 s24, s24, s29
    s_waitcnt lgkmcnt(7)
    v_mfma_f32_32x32x16_bf16 v[96:111], a[92:95], v[44:47], v[96:111]
    ds_read_b128 v[44:47], v7 offset:7168
    s_waitcnt lgkmcnt(7)
    v_mfma_f32_32x32x16_bf16 v[96:111], a[96:99], v[16:19], v[96:111]
    ds_read_b128 v[16:19], v4 offset:8192
    s_waitcnt lgkmcnt(7)
    v_mfma_f32_32x32x16_bf16 v[96:111], a[100:103], v[20:23], v[96:111]
    buffer_load_dwordx4 v8, s[68:71], s23 offen lds
    ds_read_b128 v[20:23], v5 offset:8192
    s_waitcnt lgkmcnt(7)
    v_mfma_f32_32x32x16_bf16 v[96:111], a[104:107], v[24:27], v[96:111]
    ds_read_b128 v[24:27], v6 offset:8192
    buffer_store_dwordx4 v[64:67], v12, s[4:7], s24 offen offset:0 sc1
    s_waitcnt lgkmcnt(7)
    v_mfma_f32_32x32x16_bf16 v[96:111], a[108:111], v[28:31], v[96:111]
    ds_read_b128 v[28:31], v7 offset:8192
    buffer_store_dwordx4 v[68:71], v12, s[4:7], s24 offen offset:512 sc1
    s_waitcnt lgkmcnt(7)
    v_mfma_f32_32x32x16_bf16 v[96:111], a[112:115], v[32:35], v[96:111]
    s_waitcnt lgkmcnt(6)
    v_mfma_f32_32x32x16_bf16 v[96:111], a[116:119], v[36:39], v[96:111]
    s_waitcnt lgkmcnt(5)
    v_mfma_f32_32x32x16_bf16 v[96:111], a[120:123], v[40:43], v[96:111]
    s_waitcnt lgkmcnt(4)
    v_mfma_f32_32x32x16_bf16 v[96:111], a[124:127], v[44:47], v[96:111]
    s_waitcnt lgkmcnt(3)
    v_mfma_f32_32x32x16_bf16 v[96:111], a[128:131], v[16:19], v[96:111]
    s_waitcnt lgkmcnt(2)
    v_mfma_f32_32x32x16_bf16 v[96:111], a[132:135], v[20:23], v[96:111]
    s_waitcnt lgkmcnt(1)
    v_mfma_f32_32x32x16_bf16 v[96:111], a[136:139], v[24:27], v[96:111]
    s_waitcnt lgkmcnt(0)
    v_mfma_f32_32x32x16_bf16 v[96:111], a[140:143], v[28:31], v[96:111]
    s_add_u32 s26, s26, 1
    s_cmp_eq_u32 s13, 0
    s_cbranch_scc0 L_np_89
    s_sub_u32 s17, s26, 2
    s_max_i32 s17, s17, 0
    v_mov_b32 v2, s17
    s_mov_b64 exec, 1
    buffer_store_dword v2, off, s[4:7], s30 sc1
    s_mov_b64 exec, -1
                L_np_89:
    s_mov_b32 s48, s22
    s_add_u32 s22, s22, 2
    s_cmp_gt_u32 s22, 63
    s_cbranch_scc1 L_g10_end1
    s_waitcnt vmcnt(11)
    s_barrier
    s_add_u32 s28, s22, 4
    s_min_u32 s28, s28, 63
    s_mov_b32 s25, 0
    ds_read_b128 v[16:19], v4 offset:36864
    s_mul_i32 s17, s13, 9216
    s_add_u32 m0, s17, s25
    s_mul_i32 s23, s28, 36864
    ds_read_b128 v[20:23], v5 offset:36864
    v_mul_f32 v96, s31, v96
    v_mul_f32 v97, s31, v97
    v_mul_f32 v98, s31, v98
    ds_read_b128 v[24:27], v6 offset:36864
    v_mul_f32 v99, s31, v99
    v_mul_f32 v100, s31, v100
    v_mul_f32 v101, s31, v101
    ds_read_b128 v[28:31], v7 offset:36864
    v_mul_f32 v102, s31, v102
    v_mul_f32 v103, s31, v103
    v_mul_f32 v104, s31, v104
    ds_read_b128 v[32:35], v4 offset:37888
    v_mul_f32 v105, s31, v105
    v_mul_f32 v106, s31, v106
    v_mul_f32 v107, s31, v107
    ds_read_b128 v[36:39], v5 offset:37888
    v_mul_f32 v108, s31, v108
    v_mul_f32 v109, s31, v109
    v_mul_f32 v110, s31, v110
    ds_read_b128 v[40:43], v6 offset:37888
    v_mul_f32 v111, s31, v111
    v_cvt_pk_bf16_f32 v64, v96, v97
    v_cvt_pk_bf16_f32 v65, v98, v99
    ds_read_b128 v[44:47], v7 offset:37888
    v_cvt_pk_bf16_f32 v66, v104, v105
    v_cvt_pk_bf16_f32 v67, v106, v107
    v_cvt_pk_bf16_f32 v68, v100, v101
    v_cvt_pk_bf16_f32 v69, v102, v103
    v_cvt_pk_bf16_f32 v70, v108, v109
    v_cvt_pk_bf16_f32 v71, v110, v111
    s_waitcnt lgkmcnt(7)
    v_mfma_f32_32x32x16_bf16 v[48:63], a[0:3], v[16:19], 0
    ds_read_b128 v[16:19], v4 offset:38912
    s_waitcnt lgkmcnt(7)
    v_mfma_f32_32x32x16_bf16 v[48:63], a[4:7], v[20:23], v[48:63]
    ds_read_b128 v[20:23], v5 offset:38912
    buffer_load_dwordx4 v8, s[68:71], s23 offen lds
    s_add_u32 m0, m0, 1024
    s_add_u32 s23, s23, 128
    s_waitcnt lgkmcnt(7)
    v_mfma_f32_32x32x16_bf16 v[48:63], a[8:11], v[24:27], v[48:63]
    ds_read_b128 v[24:27], v6 offset:38912
    s_waitcnt lgkmcnt(7)
    v_mfma_f32_32x32x16_bf16 v[48:63], a[12:15], v[28:31], v[48:63]
    ds_read_b128 v[28:31], v7 offset:38912
    s_waitcnt lgkmcnt(7)
    v_mfma_f32_32x32x16_bf16 v[48:63], a[16:19], v[32:35], v[48:63]
    ds_read_b128 v[32:35], v4 offset:39936
    buffer_load_dwordx4 v8, s[68:71], s23 offen lds
    s_add_u32 m0, m0, 1024
    s_add_u32 s23, s23, 128
    s_waitcnt lgkmcnt(7)
    v_mfma_f32_32x32x16_bf16 v[48:63], a[20:23], v[36:39], v[48:63]
    ds_read_b128 v[36:39], v5 offset:39936
    s_waitcnt lgkmcnt(7)
    v_mfma_f32_32x32x16_bf16 v[48:63], a[24:27], v[40:43], v[48:63]
    ds_read_b128 v[40:43], v6 offset:39936
    s_waitcnt lgkmcnt(7)
    v_mfma_f32_32x32x16_bf16 v[48:63], a[28:31], v[44:47], v[48:63]
    ds_read_b128 v[44:47], v7 offset:39936
    buffer_load_dwordx4 v8, s[68:71], s23 offen lds
    s_add_u32 m0, m0, 1024
    s_add_u32 s23, s23, 128
    s_waitcnt lgkmcnt(7)
    v_mfma_f32_32x32x16_bf16 v[48:63], a[32:35], v[16:19], v[48:63]
    ds_read_b128 v[16:19], v4 offset:40960
    s_waitcnt lgkmcnt(7)
    v_mfma_f32_32x32x16_bf16 v[48:63], a[36:39], v[20:23], v[48:63]
    ds_read_b128 v[20:23], v5 offset:40960
    s_waitcnt lgkmcnt(7)
    v_mfma_f32_32x32x16_bf16 v[48:63], a[40:43], v[24:27], v[48:63]
    ds_read_b128 v[24:27], v6 offset:40960
    buffer_load_dwordx4 v8, s[68:71], s23 offen lds
    s_add_u32 m0, m0, 1024
    s_add_u32 s23, s23, 128
    s_waitcnt lgkmcnt(7)
    v_mfma_f32_32x32x16_bf16 v[48:63], a[44:47], v[28:31], v[48:63]
    ds_read_b128 v[28:31], v7 offset:40960
    s_waitcnt lgkmcnt(7)
    v_mfma_f32_32x32x16_bf16 v[48:63], a[48:51], v[32:35], v[48:63]
    ds_read_b128 v[32:35], v4 offset:41984
    s_waitcnt lgkmcnt(7)
    v_mfma_f32_32x32x16_bf16 v[48:63], a[52:55], v[36:39], v[48:63]
    ds_read_b128 v[36:39], v5 offset:41984
    buffer_load_dwordx4 v8, s[68:71], s23 offen lds
    s_add_u32 m0, m0, 1024
    s_add_u32 s23, s23, 128
    s_waitcnt lgkmcnt(7)
    v_mfma_f32_32x32x16_bf16 v[48:63], a[56:59], v[40:43], v[48:63]
    ds_read_b128 v[40:43], v6 offset:41984
    s_waitcnt lgkmcnt(7)
    v_mfma_f32_32x32x16_bf16 v[48:63], a[60:63], v[44:47], v[48:63]
    ds_read_b128 v[44:47], v7 offset:41984
    s_waitcnt lgkmcnt(7)
    v_mfma_f32_32x32x16_bf16 v[48:63], a[64:67], v[16:19], v[48:63]
    ds_read_b128 v[16:19], v4 offset:43008
    buffer_load_dwordx4 v8, s[68:71], s23 offen lds
    s_add_u32 m0, m0, 1024
    s_add_u32 s23, s23, 128
    s_waitcnt lgkmcnt(7)
    v_mfma_f32_32x32x16_bf16 v[48:63], a[68:71], v[20:23], v[48:63]
    ds_read_b128 v[20:23], v5 offset:43008
    s_waitcnt lgkmcnt(7)
    v_mfma_f32_32x32x16_bf16 v[48:63], a[72:75], v[24:27], v[48:63]
    ds_read_b128 v[24:27], v6 offset:43008
    s_waitcnt lgkmcnt(7)
    v_mfma_f32_32x32x16_bf16 v[48:63], a[76:79], v[28:31], v[48:63]
    buffer_load_dwordx4 v8, s[68:71], s23 offen lds
    s_add_u32 m0, m0, 1024
    s_add_u32 s23, s23, 128
    ds_read_b128 v[28:31], v7 offset:43008
    s_waitcnt lgkmcnt(7)
    v_mfma_f32_32x32x16_bf16 v[48:63], a[80:83], v[32:35], v[48:63]
    ds_read_b128 v[32:35], v4 offset:44032
    s_waitcnt lgkmcnt(7)
    v_mfma_f32_32x32x16_bf16 v[48:63], a[84:87], v[36:39], v[48:63]
    ds_read_b128 v[36:39], v5 offset:44032
    s_waitcnt lgkmcnt(7)
    v_mfma_f32_32x32x16_bf16 v[48:63], a[88:91], v[40:43], v[48:63]
    buffer_load_dwordx4 v8, s[68:71], s23 offen lds
    s_add_u32 m0, m0, 1024
    s_add_u32 s23, s23, 128
    ds_read_b128 v[40:43], v6 offset:44032
    s_lshl_b32 s24, s48, 19
    s_add_u32 s24, s24, s29
    s_waitcnt lgkmcnt(7)
    v_mfma_f32_32x32x16_bf16 v[48:63], a[92:95], v[44:47], v[48:63]
    ds_read_b128 v[44:47], v7 offset:44032
    s_waitcnt lgkmcnt(7)
    v_mfma_f32_32x32x16_bf16 v[48:63], a[96:99], v[16:19], v[48:63]
    ds_read_b128 v[16:19], v4 offset:45056
    s_waitcnt lgkmcnt(7)
    v_mfma_f32_32x32x16_bf16 v[48:63], a[100:103], v[20:23], v[48:63]
    buffer_load_dwordx4 v8, s[68:71], s23 offen lds
    ds_read_b128 v[20:23], v5 offset:45056
    s_waitcnt lgkmcnt(7)
    v_mfma_f32_32x32x16_bf16 v[48:63], a[104:107], v[24:27], v[48:63]
    ds_read_b128 v[24:27], v6 offset:45056
    buffer_store_dwordx4 v[64:67], v12, s[4:7], s24 offen offset:0 sc1
    s_waitcnt lgkmcnt(7)
    v_mfma_f32_32x32x16_bf16 v[48:63], a[108:111], v[28:31], v[48:63]
    ds_read_b128 v[28:31], v7 offset:45056
    buffer_store_dwordx4 v[68:71], v12, s[4:7], s24 offen offset:512 sc1
    s_waitcnt lgkmcnt(7)
    v_mfma_f32_32x32x16_bf16 v[48:63], a[112:115], v[32:35], v[48:63]
    s_waitcnt lgkmcnt(6)
    v_mfma_f32_32x32x16_bf16 v[48:63], a[116:119], v[36:39], v[48:63]
    s_waitcnt lgkmcnt(5)
    v_mfma_f32_32x32x16_bf16 v[48:63], a[120:123], v[40:43], v[48:63]
    s_waitcnt lgkmcnt(4)
    v_mfma_f32_32x32x16_bf16 v[48:63], a[124:127], v[44:47], v[48:63]
    s_waitcnt lgkmcnt(3)
    v_mfma_f32_32x32x16_bf16 v[48:63], a[128:131], v[16:19], v[48:63]
    s_waitcnt lgkmcnt(2)
    v_mfma_f32_32x32x16_bf16 v[48:63], a[132:135], v[20:23], v[48:63]
    s_waitcnt lgkmcnt(1)
    v_mfma_f32_32x32x16_bf16 v[48:63], a[136:139], v[24:27], v[48:63]
    s_waitcnt lgkmcnt(0)
    v_mfma_f32_32x32x16_bf16 v[48:63], a[140:143], v[28:31], v[48:63]
    s_add_u32 s26, s26, 1
    s_cmp_eq_u32 s13, 0
    s_cbranch_scc0 L_np_90
    s_sub_u32 s17, s26, 2
    s_max_i32 s17, s17, 0
    v_mov_b32 v2, s17
    s_mov_b64 exec, 1
    buffer_store_dword v2, off, s[4:7], s30 sc1
    s_mov_b64 exec, -1
                L_np_90:
    s_mov_b32 s48, s22
    s_add_u32 s22, s22, 2
    s_cmp_gt_u32 s22, 63
    s_cbranch_scc1 L_g10_end0
    s_waitcnt vmcnt(11)
    s_barrier
    s_add_u32 s28, s22, 4
    s_min_u32 s28, s28, 63
    s_mov_b32 s25, 36864
    ds_read_b128 v[16:19], v248 offset:8192
    s_mul_i32 s17, s13, 9216
    s_add_u32 m0, s17, s25
    s_mul_i32 s23, s28, 36864
    ds_read_b128 v[20:23], v249 offset:8192
    v_mul_f32 v48, s31, v48
    v_mul_f32 v49, s31, v49
    v_mul_f32 v50, s31, v50
    ds_read_b128 v[24:27], v250 offset:8192
    v_mul_f32 v51, s31, v51
    v_mul_f32 v52, s31, v52
    v_mul_f32 v53, s31, v53
    ds_read_b128 v[28:31], v251 offset:8192
    v_mul_f32 v54, s31, v54
    v_mul_f32 v55, s31, v55
    v_mul_f32 v56, s31, v56
    ds_read_b128 v[32:35], v248 offset:9216
    v_mul_f32 v57, s31, v57
    v_mul_f32 v58, s31, v58
    v_mul_f32 v59, s31, v59
    ds_read_b128 v[36:39], v249 offset:9216
    v_mul_f32 v60, s31, v60
    v_mul_f32 v61, s31, v61
    v_mul_f32 v62, s31, v62
    ds_read_b128 v[40:43], v250 offset:9216
    v_mul_f32 v63, s31, v63
    v_cvt_pk_bf16_f32 v64, v48, v49
    v_cvt_pk_bf16_f32 v65, v50, v51
    ds_read_b128 v[44:47], v251 offset:9216
    v_cvt_pk_bf16_f32 v66, v56, v57
    v_cvt_pk_bf16_f32 v67, v58, v59
    v_cvt_pk_bf16_f32 v68, v52, v53
    v_cvt_pk_bf16_f32 v69, v54, v55
    v_cvt_pk_bf16_f32 v70, v60, v61
    v_cvt_pk_bf16_f32 v71, v62, v63
    s_waitcnt lgkmcnt(7)
    v_mfma_f32_32x32x16_bf16 v[96:111], a[0:3], v[16:19], 0
    ds_read_b128 v[16:19], v248 offset:10240
    s_waitcnt lgkmcnt(7)
    v_mfma_f32_32x32x16_bf16 v[96:111], a[4:7], v[20:23], v[96:111]
    ds_read_b128 v[20:23], v249 offset:10240
    buffer_load_dwordx4 v8, s[68:71], s23 offen lds
    s_add_u32 m0, m0, 1024
    s_add_u32 s23, s23, 128
    s_waitcnt lgkmcnt(7)
    v_mfma_f32_32x32x16_bf16 v[96:111], a[8:11], v[24:27], v[96:111]
    ds_read_b128 v[24:27], v250 offset:10240
    s_waitcnt lgkmcnt(7)
    v_mfma_f32_32x32x16_bf16 v[96:111], a[12:15], v[28:31], v[96:111]
    ds_read_b128 v[28:31], v251 offset:10240
    s_waitcnt lgkmcnt(7)
    v_mfma_f32_32x32x16_bf16 v[96:111], a[16:19], v[32:35], v[96:111]
    ds_read_b128 v[32:35], v248 offset:11264
    buffer_load_dwordx4 v8, s[68:71], s23 offen lds
    s_add_u32 m0, m0, 1024
    s_add_u32 s23, s23, 128
    s_waitcnt lgkmcnt(7)
    v_mfma_f32_32x32x16_bf16 v[96:111], a[20:23], v[36:39], v[96:111]
    ds_read_b128 v[36:39], v249 offset:11264
    s_waitcnt lgkmcnt(7)
    v_mfma_f32_32x32x16_bf16 v[96:111], a[24:27], v[40:43], v[96:111]
    ds_read_b128 v[40:43], v250 offset:11264
    s_waitcnt lgkmcnt(7)
    v_mfma_f32_32x32x16_bf16 v[96:111], a[28:31], v[44:47], v[96:111]
    ds_read_b128 v[44:47], v251 offset:11264
    buffer_load_dwordx4 v8, s[68:71], s23 offen lds
    s_add_u32 m0, m0, 1024
    s_add_u32 s23, s23, 128
    s_waitcnt lgkmcnt(7)
    v_mfma_f32_32x32x16_bf16 v[96:111], a[32:35], v[16:19], v[96:111]
    ds_read_b128 v[16:19], v248 offset:12288
    s_waitcnt lgkmcnt(7)
    v_mfma_f32_32x32x16_bf16 v[96:111], a[36:39], v[20:23], v[96:111]
    ds_read_b128 v[20:23], v249 offset:12288
    s_waitcnt lgkmcnt(7)
    v_mfma_f32_32x32x16_bf16 v[96:111], a[40:43], v[24:27], v[96:111]
    ds_read_b128 v[24:27], v250 offset:12288
    buffer_load_dwordx4 v8, s[68:71], s23 offen lds
    s_add_u32 m0, m0, 1024
    s_add_u32 s23, s23, 128
    s_waitcnt lgkmcnt(7)
    v_mfma_f32_32x32x16_bf16 v[96:111], a[44:47], v[28:31], v[96:111]
    ds_read_b128 v[28:31], v251 offset:12288
    s_waitcnt lgkmcnt(7)
    v_mfma_f32_32x32x16_bf16 v[96:111], a[48:51], v[32:35], v[96:111]
    ds_read_b128 v[32:35], v248 offset:13312
    s_waitcnt lgkmcnt(7)
    v_mfma_f32_32x32x16_bf16 v[96:111], a[52:55], v[36:39], v[96:111]
    ds_read_b128 v[36:39], v249 offset:13312
    buffer_load_dwordx4 v8, s[68:71], s23 offen lds
    s_add_u32 m0, m0, 1024
    s_add_u32 s23, s23, 128
    s_waitcnt lgkmcnt(7)
    v_mfma_f32_32x32x16_bf16 v[96:111], a[56:59], v[40:43], v[96:111]
    ds_read_b128 v[40:43], v250 offset:13312
    s_waitcnt lgkmcnt(7)
    v_mfma_f32_32x32x16_bf16 v[96:111], a[60:63], v[44:47], v[96:111]
    ds_read_b128 v[44:47], v251 offset:13312
    s_waitcnt lgkmcnt(7)
    v_mfma_f32_32x32x16_bf16 v[96:111], a[64:67], v[16:19], v[96:111]
    ds_read_b128 v[16:19], v248 offset:14336
    buffer_load_dwordx4 v8, s[68:71], s23 offen lds
    s_add_u32 m0, m0, 1024
    s_add_u32 s23, s23, 128
    s_waitcnt lgkmcnt(7)
    v_mfma_f32_32x32x16_bf16 v[96:111], a[68:71], v[20:23], v[96:111]
    ds_read_b128 v[20:23], v249 offset:14336
    s_waitcnt lgkmcnt(7)
    v_mfma_f32_32x32x16_bf16 v[96:111], a[72:75], v[24:27], v[96:111]
    ds_read_b128 v[24:27], v250 offset:14336
    s_waitcnt lgkmcnt(7)
    v_mfma_f32_32x32x16_bf16 v[96:111], a[76:79], v[28:31], v[96:111]
    buffer_load_dwordx4 v8, s[68:71], s23 offen lds
    s_add_u32 m0, m0, 1024
    s_add_u32 s23, s23, 128
    ds_read_b128 v[28:31], v251 offset:14336
    s_waitcnt lgkmcnt(7)
    v_mfma_f32_32x32x16_bf16 v[96:111], a[80:83], v[32:35], v[96:111]
    ds_read_b128 v[32:35], v248 offset:15360
    s_waitcnt lgkmcnt(7)
    v_mfma_f32_32x32x16_bf16 v[96:111], a[84:87], v[36:39], v[96:111]
    ds_read_b128 v[36:39], v249 offset:15360
    s_waitcnt lgkmcnt(7)
    v_mfma_f32_32x32x16_bf16 v[96:111], a[88:91], v[40:43], v[96:111]
    buffer_load_dwordx4 v8, s[68:71], s23 offen lds
    s_add_u32 m0, m0, 1024
    s_add_u32 s23, s23, 128
    ds_read_b128 v[40:43], v250 offset:15360
    s_lshl_b32 s24, s48, 19
    s_add_u32 s24, s24, s29
    s_waitcnt lgkmcnt(7)
    v_mfma_f32_32x32x16_bf16 v[96:111], a[92:95], v[44:47], v[96:111]
    ds_read_b128 v[44:47], v251 offset:15360
    s_waitcnt lgkmcnt(7)
    v_mfma_f32_32x32x16_bf16 v[96:111], a[96:99], v[16:19], v[96:111]
    ds_read_b128 v[16:19], v248 offset:16384
    s_waitcnt lgkmcnt(7)
    v_mfma_f32_32x32x16_bf16 v[96:111], a[100:103], v[20:23], v[96:111]
    buffer_load_dwordx4 v8, s[68:71], s23 offen lds
    ds_read_b128 v[20:23], v249 offset:16384
    s_waitcnt lgkmcnt(7)
    v_mfma_f32_32x32x16_bf16 v[96:111], a[104:107], v[24:27], v[96:111]
    ds_read_b128 v[24:27], v250 offset:16384
    buffer_store_dwordx4 v[64:67], v12, s[4:7], s24 offen offset:0 sc1
    s_waitcnt lgkmcnt(7)
    v_mfma_f32_32x32x16_bf16 v[96:111], a[108:111], v[28:31], v[96:111]
    ds_read_b128 v[28:31], v251 offset:16384
    buffer_store_dwordx4 v[68:71], v12, s[4:7], s24 offen offset:512 sc1
    s_waitcnt lgkmcnt(7)
    v_mfma_f32_32x32x16_bf16 v[96:111], a[112:115], v[32:35], v[96:111]
    s_waitcnt lgkmcnt(6)
    v_mfma_f32_32x32x16_bf16 v[96:111], a[116:119], v[36:39], v[96:111]
    s_waitcnt lgkmcnt(5)
    v_mfma_f32_32x32x16_bf16 v[96:111], a[120:123], v[40:43], v[96:111]
    s_waitcnt lgkmcnt(4)
    v_mfma_f32_32x32x16_bf16 v[96:111], a[124:127], v[44:47], v[96:111]
    s_waitcnt lgkmcnt(3)
    v_mfma_f32_32x32x16_bf16 v[96:111], a[128:131], v[16:19], v[96:111]
    s_waitcnt lgkmcnt(2)
    v_mfma_f32_32x32x16_bf16 v[96:111], a[132:135], v[20:23], v[96:111]
    s_waitcnt lgkmcnt(1)
    v_mfma_f32_32x32x16_bf16 v[96:111], a[136:139], v[24:27], v[96:111]
    s_waitcnt lgkmcnt(0)
    v_mfma_f32_32x32x16_bf16 v[96:111], a[140:143], v[28:31], v[96:111]
    s_add_u32 s26, s26, 1
    s_cmp_eq_u32 s13, 0
    s_cbranch_scc0 L_np_91
    s_sub_u32 s17, s26, 2
    s_max_i32 s17, s17, 0
    v_mov_b32 v2, s17
    s_mov_b64 exec, 1
    buffer_store_dword v2, off, s[4:7], s30 sc1
    s_mov_b64 exec, -1
                L_np_91:
    s_mov_b32 s48, s22
    s_add_u32 s22, s22, 2
    s_cmp_gt_u32 s22, 63
    s_cbranch_scc1 L_g10_end1
    s_waitcnt vmcnt(11)
    s_barrier
    s_add_u32 s28, s22, 4
    s_min_u32 s28, s28, 63
    s_mov_b32 s25, 73728
    ds_read_b128 v[16:19], v4 offset:0
    s_mul_i32 s17, s13, 9216
    s_add_u32 m0, s17, s25
    s_mul_i32 s23, s28, 36864
    ds_read_b128 v[20:23], v5 offset:0
    v_mul_f32 v96, s31, v96
    v_mul_f32 v97, s31, v97
    v_mul_f32 v98, s31, v98
    ds_read_b128 v[24:27], v6 offset:0
    v_mul_f32 v99, s31, v99
    v_mul_f32 v100, s31, v100
    v_mul_f32 v101, s31, v101
    ds_read_b128 v[28:31], v7 offset:0
    v_mul_f32 v102, s31, v102
    v_mul_f32 v103, s31, v103
    v_mul_f32 v104, s31, v104
    ds_read_b128 v[32:35], v4 offset:1024
    v_mul_f32 v105, s31, v105
    v_mul_f32 v106, s31, v106
    v_mul_f32 v107, s31, v107
    ds_read_b128 v[36:39], v5 offset:1024
    v_mul_f32 v108, s31, v108
    v_mul_f32 v109, s31, v109
    v_mul_f32 v110, s31, v110
    ds_read_b128 v[40:43], v6 offset:1024
    v_mul_f32 v111, s31, v111
    v_cvt_pk_bf16_f32 v64, v96, v97
    v_cvt_pk_bf16_f32 v65, v98, v99
    ds_read_b128 v[44:47], v7 offset:1024
    v_cvt_pk_bf16_f32 v66, v104, v105
    v_cvt_pk_bf16_f32 v67, v106, v107
    v_cvt_pk_bf16_f32 v68, v100, v101
    v_cvt_pk_bf16_f32 v69, v102, v103
    v_cvt_pk_bf16_f32 v70, v108, v109
    v_cvt_pk_bf16_f32 v71, v110, v111
    s_waitcnt lgkmcnt(7)
    v_mfma_f32_32x32x16_bf16 v[48:63], a[0:3], v[16:19], 0
    ds_read_b128 v[16:19], v4 offset:2048
    s_waitcnt lgkmcnt(7)
    v_mfma_f32_32x32x16_bf16 v[48:63], a[4:7], v[20:23], v[48:63]
    ds_read_b128 v[20:23], v5 offset:2048
    buffer_load_dwordx4 v8, s[68:71], s23 offen lds
    s_add_u32 m0, m0, 1024
    s_add_u32 s23, s23, 128
    s_waitcnt lgkmcnt(7)
    v_mfma_f32_32x32x16_bf16 v[48:63], a[8:11], v[24:27], v[48:63]
    ds_read_b128 v[24:27], v6 offset:2048
    s_waitcnt lgkmcnt(7)
    v_mfma_f32_32x32x16_bf16 v[48:63], a[12:15], v[28:31], v[48:63]
    ds_read_b128 v[28:31], v7 offset:2048
    s_waitcnt lgkmcnt(7)
    v_mfma_f32_32x32x16_bf16 v[48:63], a[16:19], v[32:35], v[48:63]
    ds_read_b128 v[32:35], v4 offset:3072
    buffer_load_dwordx4 v8, s[68:71], s23 offen lds
    s_add_u32 m0, m0, 1024
    s_add_u32 s23, s23, 128
    s_waitcnt lgkmcnt(7)
    v_mfma_f32_32x32x16_bf16 v[48:63], a[20:23], v[36:39], v[48:63]
    ds_read_b128 v[36:39], v5 offset:3072
    s_waitcnt lgkmcnt(7)
    v_mfma_f32_32x32x16_bf16 v[48:63], a[24:27], v[40:43], v[48:63]
    ds_read_b128 v[40:43], v6 offset:3072
    s_waitcnt lgkmcnt(7)
    v_mfma_f32_32x32x16_bf16 v[48:63], a[28:31], v[44:47], v[48:63]
    ds_read_b128 v[44:47], v7 offset:3072
    buffer_load_dwordx4 v8, s[68:71], s23 offen lds
    s_add_u32 m0, m0, 1024
    s_add_u32 s23, s23, 128
    s_waitcnt lgkmcnt(7)
    v_mfma_f32_32x32x16_bf16 v[48:63], a[32:35], v[16:19], v[48:63]
    ds_read_b128 v[16:19], v4 offset:4096
    s_waitcnt lgkmcnt(7)
    v_mfma_f32_32x32x16_bf16 v[48:63], a[36:39], v[20:23], v[48:63]
    ds_read_b128 v[20:23], v5 offset:4096
    s_waitcnt lgkmcnt(7)
    v_mfma_f32_32x32x16_bf16 v[48:63], a[40:43], v[24:27], v[48:63]
    ds_read_b128 v[24:27], v6 offset:4096
    buffer_load_dwordx4 v8, s[68:71], s23 offen lds
    s_add_u32 m0, m0, 1024
    s_add_u32 s23, s23, 128
    s_waitcnt lgkmcnt(7)
    v_mfma_f32_32x32x16_bf16 v[48:63], a[44:47], v[28:31], v[48:63]
    ds_read_b128 v[28:31], v7 offset:4096
    s_waitcnt lgkmcnt(7)
    v_mfma_f32_32x32x16_bf16 v[48:63], a[48:51], v[32:35], v[48:63]
    ds_read_b128 v[32:35], v4 offset:5120
    s_waitcnt lgkmcnt(7)
    v_mfma_f32_32x32x16_bf16 v[48:63], a[52:55], v[36:39], v[48:63]
    ds_read_b128 v[36:39], v5 offset:5120
    buffer_load_dwordx4 v8, s[68:71], s23 offen lds
    s_add_u32 m0, m0, 1024
    s_add_u32 s23, s23, 128
    s_waitcnt lgkmcnt(7)
    v_mfma_f32_32x32x16_bf16 v[48:63], a[56:59], v[40:43], v[48:63]
    ds_read_b128 v[40:43], v6 offset:5120
    s_waitcnt lgkmcnt(7)
    v_mfma_f32_32x32x16_bf16 v[48:63], a[60:63], v[44:47], v[48:63]
    ds_read_b128 v[44:47], v7 offset:5120
    s_waitcnt lgkmcnt(7)
    v_mfma_f32_32x32x16_bf16 v[48:63], a[64:67], v[16:19], v[48:63]
    ds_read_b128 v[16:19], v4 offset:6144
    buffer_load_dwordx4 v8, s[68:71], s23 offen lds
    s_add_u32 m0, m0, 1024
    s_add_u32 s23, s23, 128
    s_waitcnt lgkmcnt(7)
    v_mfma_f32_32x32x16_bf16 v[48:63], a[68:71], v[20:23], v[48:63]
    ds_read_b128 v[20:23], v5 offset:6144
    s_waitcnt lgkmcnt(7)
    v_mfma_f32_32x32x16_bf16 v[48:63], a[72:75], v[24:27], v[48:63]
    ds_read_b128 v[24:27], v6 offset:6144
    s_waitcnt lgkmcnt(7)
    v_mfma_f32_32x32x16_bf16 v[48:63], a[76:79], v[28:31], v[48:63]
    buffer_load_dwordx4 v8, s[68:71], s23 offen lds
    s_add_u32 m0, m0, 1024
    s_add_u32 s23, s23, 128
    ds_read_b128 v[28:31], v7 offset:6144
    s_waitcnt lgkmcnt(7)
    v_mfma_f32_32x32x16_bf16 v[48:63], a[80:83], v[32:35], v[48:63]
    ds_read_b128 v[32:35], v4 offset:7168
    s_waitcnt lgkmcnt(7)
    v_mfma_f32_32x32x16_bf16 v[48:63], a[84:87], v[36:39], v[48:63]
    ds_read_b128 v[36:39], v5 offset:7168
    s_waitcnt lgkmcnt(7)
    v_mfma_f32_32x32x16_bf16 v[48:63], a[88:91], v[40:43], v[48:63]
    buffer_load_dwordx4 v8, s[68:71], s23 offen lds
    s_add_u32 m0, m0, 1024
    s_add_u32 s23, s23, 128
    ds_read_b128 v[40:43], v6 offset:7168
    s_lshl_b32 s24, s48, 19
    s_add_u32 s24, s24, s29
    s_waitcnt lgkmcnt(7)
    v_mfma_f32_32x32x16_bf16 v[48:63], a[92:95], v[44:47], v[48:63]
    ds_read_b128 v[44:47], v7 offset:7168
    s_waitcnt lgkmcnt(7)
    v_mfma_f32_32x32x16_bf16 v[48:63], a[96:99], v[16:19], v[48:63]
    ds_read_b128 v[16:19], v4 offset:8192
    s_waitcnt lgkmcnt(7)
    v_mfma_f32_32x32x16_bf16 v[48:63], a[100:103], v[20:23], v[48:63]
    buffer_load_dwordx4 v8, s[68:71], s23 offen lds
    ds_read_b128 v[20:23], v5 offset:8192
    s_waitcnt lgkmcnt(7)
    v_mfma_f32_32x32x16_bf16 v[48:63], a[104:107], v[24:27], v[48:63]
    ds_read_b128 v[24:27], v6 offset:8192
    buffer_store_dwordx4 v[64:67], v12, s[4:7], s24 offen offset:0 sc1
    s_waitcnt lgkmcnt(7)
    v_mfma_f32_32x32x16_bf16 v[48:63], a[108:111], v[28:31], v[48:63]
    ds_read_b128 v[28:31], v7 offset:8192
    buffer_store_dwordx4 v[68:71], v12, s[4:7], s24 offen offset:512 sc1
    s_waitcnt lgkmcnt(7)
    v_mfma_f32_32x32x16_bf16 v[48:63], a[112:115], v[32:35], v[48:63]
    s_waitcnt lgkmcnt(6)
    v_mfma_f32_32x32x16_bf16 v[48:63], a[116:119], v[36:39], v[48:63]
    s_waitcnt lgkmcnt(5)
    v_mfma_f32_32x32x16_bf16 v[48:63], a[120:123], v[40:43], v[48:63]
    s_waitcnt lgkmcnt(4)
    v_mfma_f32_32x32x16_bf16 v[48:63], a[124:127], v[44:47], v[48:63]
    s_waitcnt lgkmcnt(3)
    v_mfma_f32_32x32x16_bf16 v[48:63], a[128:131], v[16:19], v[48:63]
    s_waitcnt lgkmcnt(2)
    v_mfma_f32_32x32x16_bf16 v[48:63], a[132:135], v[20:23], v[48:63]
    s_waitcnt lgkmcnt(1)
    v_mfma_f32_32x32x16_bf16 v[48:63], a[136:139], v[24:27], v[48:63]
    s_waitcnt lgkmcnt(0)
    v_mfma_f32_32x32x16_bf16 v[48:63], a[140:143], v[28:31], v[48:63]
    s_add_u32 s26, s26, 1
    s_cmp_eq_u32 s13, 0
    s_cbranch_scc0 L_np_92
    s_sub_u32 s17, s26, 2
    s_max_i32 s17, s17, 0
    v_mov_b32 v2, s17
    s_mov_b64 exec, 1
    buffer_store_dword v2, off, s[4:7], s30 sc1
    s_mov_b64 exec, -1
                L_np_92:
    s_mov_b32 s48, s22
    s_add_u32 s22, s22, 2
    s_cmp_gt_u32 s22, 63
    s_cbranch_scc1 L_g10_end0
    s_waitcnt vmcnt(11)
    s_branch L_g10_lp
L_g10_end0:
    s_nop 7
    s_nop 3
    v_mul_f32 v48, s31, v48
    v_mul_f32 v49, s31, v49
    v_mul_f32 v50, s31, v50
    v_mul_f32 v51, s31, v51
    v_mul_f32 v52, s31, v52
    v_mul_f32 v53, s31, v53
    v_mul_f32 v54, s31, v54
    v_mul_f32 v55, s31, v55
    v_mul_f32 v56, s31, v56
    v_mul_f32 v57, s31, v57
    v_mul_f32 v58, s31, v58
    v_mul_f32 v59, s31, v59
    v_mul_f32 v60, s31, v60
    v_mul_f32 v61, s31, v61
    v_mul_f32 v62, s31, v62
    v_mul_f32 v63, s31, v63
    s_lshl_b32 s24, s48, 19
    v_cvt_pk_bf16_f32 v64, v48, v49
    v_cvt_pk_bf16_f32 v65, v50, v51
    v_cvt_pk_bf16_f32 v66, v56, v57
    v_cvt_pk_bf16_f32 v67, v58, v59
    v_cvt_pk_bf16_f32 v68, v52, v53
    v_cvt_pk_bf16_f32 v69, v54, v55
    v_cvt_pk_bf16_f32 v70, v60, v61
    v_cvt_pk_bf16_f32 v71, v62, v63
    s_add_u32 s24, s24, s29
    buffer_store_dwordx4 v[64:67], v12, s[4:7], s24 offen offset:0 sc1
    buffer_store_dwordx4 v[68:71], v12, s[4:7], s24 offen offset:512 sc1
    s_branch L_g10_end
L_g10_end1:
    s_nop 7
    s_nop 3
    v_mul_f32 v96, s31, v96
    v_mul_f32 v97, s31, v97
    v_mul_f32 v98, s31, v98
    v_mul_f32 v99, s31, v99
    v_mul_f32 v100, s31, v100
    v_mul_f32 v101, s31, v101
    v_mul_f32 v102, s31, v102
    v_mul_f32 v103, s31, v103
    v_mul_f32 v104, s31, v104
    v_mul_f32 v105, s31, v105
    v_mul_f32 v106, s31, v106
    v_mul_f32 v107, s31, v107
    v_mul_f32 v108, s31, v108
    v_mul_f32 v109, s31, v109
    v_mul_f32 v110, s31, v110
    v_mul_f32 v111, s31, v111
    s_lshl_b32 s24, s48, 19
    v_cvt_pk_bf16_f32 v64, v96, v97
    v_cvt_pk_bf16_f32 v65, v98, v99
    v_cvt_pk_bf16_f32 v66, v104, v105
    v_cvt_pk_bf16_f32 v67, v106, v107
    v_cvt_pk_bf16_f32 v68, v100, v101
    v_cvt_pk_bf16_f32 v69, v102, v103
    v_cvt_pk_bf16_f32 v70, v108, v109
    v_cvt_pk_bf16_f32 v71, v110, v111
    s_add_u32 s24, s24, s29
    buffer_store_dwordx4 v[64:67], v12, s[4:7], s24 offen offset:0 sc1
    buffer_store_dwordx4 v[68:71], v12, s[4:7], s24 offen offset:512 sc1
L_g10_end:
    s_waitcnt vmcnt(0)
    s_barrier
    s_cmp_eq_u32 s13, 0
    s_cbranch_scc0 L_np_93
    v_mov_b32 v2, 255
    s_mov_b64 exec, 1
    buffer_store_dword v2, off, s[4:7], s30 sc1
    s_mov_b64 exec, -1
            L_np_93:
    s_branch L_g1_done
L_g1_v:
    s_cmp_eq_u32 s13, 0
    s_cbranch_scc0 L_wfd_95
    s_mov_b32 s21, 0
        L_wf_94:
    buffer_load_dword v2, off, s[8:11], 0 offset:8 sc1
    s_add_u32 s21, s21, 1
    s_cmp_gt_u32 s21, 3000000
    s_cbranch_scc1 L_failA
    s_waitcnt vmcnt(0)
    v_cmp_gt_u32 vcc, 1, v2
    s_cbranch_vccz L_wfd_95
    s_sleep 2
    s_branch L_wf_94
        L_wfd_95:
    s_mov_b32 s25, 0
    s_mul_i32 s17, s13, 9216
    s_add_u32 m0, s17, s25
    s_mul_i32 s23, s22, 36864
    buffer_load_dwordx4 v8, s[68:71], s23 offen lds
    s_add_u32 m0, m0, 1024
    s_add_u32 s23, s23, 128
    buffer_load_dwordx4 v8, s[68:71], s23 offen lds
    s_add_u32 m0, m0, 1024
    s_add_u32 s23, s23, 128
    buffer_load_dwordx4 v8, s[68:71], s23 offen lds
    s_add_u32 m0, m0, 1024
    s_add_u32 s23, s23, 128
    buffer_load_dwordx4 v8, s[68:71], s23 offen lds
    s_add_u32 m0, m0, 1024
    s_add_u32 s23, s23, 128
    buffer_load_dwordx4 v8, s[68:71], s23 offen lds
    s_add_u32 m0, m0, 1024
    s_add_u32 s23, s23, 128
    buffer_load_dwordx4 v8, s[68:71], s23 offen lds
    s_add_u32 m0, m0, 1024
    s_add_u32 s23, s23, 128
    buffer_load_dwordx4 v8, s[68:71], s23 offen lds
    s_add_u32 m0, m0, 1024
    s_add_u32 s23, s23, 128
    buffer_load_dwordx4 v8, s[68:71], s23 offen lds
    s_add_u32 m0, m0, 1024
    s_add_u32 s23, s23, 128
    buffer_load_dwordx4 v8, s[68:71], s23 offen lds
    s_add_u32 s28, s22, 2
    s_min_u32 s28, s28, 63
    s_mov_b32 s25, 36864
    s_mul_i32 s17, s13, 9216
    s_add_u32 m0, s17, s25
    s_mul_i32 s23, s28, 36864
    buffer_load_dwordx4 v8, s[68:71], s23 offen lds
    s_add_u32 m0, m0, 1024
    s_add_u32 s23, s23, 128
    buffer_load_dwordx4 v8, s[68:71], s23 offen lds
    s_add_u32 m0, m0, 1024
    s_add_u32 s23, s23, 128
    buffer_load_dwordx4 v8, s[68:71], s23 offen lds
    s_add_u32 m0, m0, 1024
    s_add_u32 s23, s23, 128
    buffer_load_dwordx4 v8, s[68:71], s23 offen lds
    s_add_u32 m0, m0, 1024
    s_add_u32 s23, s23, 128
    buffer_load_dwordx4 v8, s[68:71], s23 offen lds
    s_add_u32 m0, m0, 1024
    s_add_u32 s23, s23, 128
    buffer_load_dwordx4 v8, s[68:71], s23 offen lds
    s_add_u32 m0, m0, 1024
    s_add_u32 s23, s23, 128
    buffer_load_dwordx4 v8, s[68:71], s23 offen lds
    s_add_u32 m0, m0, 1024
    s_add_u32 s23, s23, 128
    buffer_load_dwordx4 v8, s[68:71], s23 offen lds
    s_add_u32 m0, m0, 1024
    s_add_u32 s23, s23, 128
    buffer_load_dwordx4 v8, s[68:71], s23 offen lds
    s_mov_b32 s26, 0
    s_waitcnt vmcnt(9)
    s_barrier
    s_add_u32 s28, s22, 4
    s_min_u32 s28, s28, 63
    s_mov_b32 s25, 73728
    ds_read_b128 v[16:19], v4 offset:0
    s_mul_i32 s17, s13, 9216
    s_add_u32 m0, s17, s25
    s_mul_i32 s23, s28, 36864
    ds_read_b128 v[20:23], v5 offset:0
    ds_read_b128 v[24:27], v6 offset:0
    ds_read_b128 v[28:31], v7 offset:0
    ds_read_b128 v[32:35], v4 offset:1024
    ds_read_b128 v[36:39], v5 offset:1024
    ds_read_b128 v[40:43], v6 offset:1024
    ds_read_b128 v[44:47], v7 offset:1024
    s_waitcnt lgkmcnt(7)
    v_mfma_f32_32x32x16_bf16 v[48:63], v[16:19], a[0:3], 0
    ds_read_b128 v[16:19], v4 offset:2048
    s_waitcnt lgkmcnt(7)
    v_mfma_f32_32x32x16_bf16 v[48:63], v[20:23], a[4:7], v[48:63]
    ds_read_b128 v[20:23], v5 offset:2048
    buffer_load_dwordx4 v8, s[68:71], s23 offen lds
    s_add_u32 m0, m0, 1024
    s_add_u32 s23, s23, 128
    s_waitcnt lgkmcnt(7)
    v_mfma_f32_32x32x16_bf16 v[48:63], v[24:27], a[8:11], v[48:63]
    ds_read_b128 v[24:27], v6 offset:2048
    s_waitcnt lgkmcnt(7)
    v_mfma_f32_32x32x16_bf16 v[48:63], v[28:31], a[12:15], v[48:63]
    ds_read_b128 v[28:31], v7 offset:2048
    s_waitcnt lgkmcnt(7)
    v_mfma_f32_32x32x16_bf16 v[48:63], v[32:35], a[16:19], v[48:63]
    ds_read_b128 v[32:35], v4 offset:3072
    buffer_load_dwordx4 v8, s[68:71], s23 offen lds
    s_add_u32 m0, m0, 1024
    s_add_u32 s23, s23, 128
    s_waitcnt lgkmcnt(7)
    v_mfma_f32_32x32x16_bf16 v[48:63], v[36:39], a[20:23], v[48:63]
    ds_read_b128 v[36:39], v5 offset:3072
    s_waitcnt lgkmcnt(7)
    v_mfma_f32_32x32x16_bf16 v[48:63], v[40:43], a[24:27], v[48:63]
    ds_read_b128 v[40:43], v6 offset:3072
    s_waitcnt lgkmcnt(7)
    v_mfma_f32_32x32x16_bf16 v[48:63], v[44:47], a[28:31], v[48:63]
    ds_read_b128 v[44:47], v7 offset:3072
    buffer_load_dwordx4 v8, s[68:71], s23 offen lds
    s_add_u32 m0, m0, 1024
    s_add_u32 s23, s23, 128
    s_waitcnt lgkmcnt(7)
    v_mfma_f32_32x32x16_bf16 v[48:63], v[16:19], a[32:35], v[48:63]
    ds_read_b128 v[16:19], v4 offset:4096
    s_waitcnt lgkmcnt(7)
    v_mfma_f32_32x32x16_bf16 v[48:63], v[20:23], a[36:39], v[48:63]
    ds_read_b128 v[20:23], v5 offset:4096
    s_waitcnt lgkmcnt(7)
    v_mfma_f32_32x32x16_bf16 v[48:63], v[24:27], a[40:43], v[48:63]
    ds_read_b128 v[24:27], v6 offset:4096
    buffer_load_dwordx4 v8, s[68:71], s23 offen lds
    s_add_u32 m0, m0, 1024
    s_add_u32 s23, s23, 128
    s_waitcnt lgkmcnt(7)
    v_mfma_f32_32x32x16_bf16 v[48:63], v[28:31], a[44:47], v[48:63]
    ds_read_b128 v[28:31], v7 offset:4096
    s_waitcnt lgkmcnt(7)
    v_mfma_f32_32x32x16_bf16 v[48:63], v[32:35], a[48:51], v[48:63]
    ds_read_b128 v[32:35], v4 offset:5120
    s_waitcnt lgkmcnt(7)
    v_mfma_f32_32x32x16_bf16 v[48:63], v[36:39], a[52:55], v[48:63]
    ds_read_b128 v[36:39], v5 offset:5120
    buffer_load_dwordx4 v8, s[68:71], s23 offen lds
    s_add_u32 m0, m0, 1024
    s_add_u32 s23, s23, 128
    s_waitcnt lgkmcnt(7)
    v_mfma_f32_32x32x16_bf16 v[48:63], v[40:43], a[56:59], v[48:63]
    ds_read_b128 v[40:43], v6 offset:5120
    s_waitcnt lgkmcnt(7)
    v_mfma_f32_32x32x16_bf16 v[48:63], v[44:47], a[60:63], v[48:63]
    ds_read_b128 v[44:47], v7 offset:5120
    s_waitcnt lgkmcnt(7)
    v_mfma_f32_32x32x16_bf16 v[48:63], v[16:19], a[64:67], v[48:63]
    ds_read_b128 v[16:19], v4 offset:6144
    buffer_load_dwordx4 v8, s[68:71], s23 offen lds
    s_add_u32 m0, m0, 1024
    s_add_u32 s23, s23, 128
    s_waitcnt lgkmcnt(7)
    v_mfma_f32_32x32x16_bf16 v[48:63], v[20:23], a[68:71], v[48:63]
    ds_read_b128 v[20:23], v5 offset:6144
    s_waitcnt lgkmcnt(7)
    v_mfma_f32_32x32x16_bf16 v[48:63], v[24:27], a[72:75], v[48:63]
    ds_read_b128 v[24:27], v6 offset:6144
    s_waitcnt lgkmcnt(7)
    v_mfma_f32_32x32x16_bf16 v[48:63], v[28:31], a[76:79], v[48:63]
    buffer_load_dwordx4 v8, s[68:71], s23 offen lds
    s_add_u32 m0, m0, 1024
    s_add_u32 s23, s23, 128
    ds_read_b128 v[28:31], v7 offset:6144
    s_waitcnt lgkmcnt(7)
    v_mfma_f32_32x32x16_bf16 v[48:63], v[32:35], a[80:83], v[48:63]
    ds_read_b128 v[32:35], v4 offset:7168
    s_waitcnt lgkmcnt(7)
    v_mfma_f32_32x32x16_bf16 v[48:63], v[36:39], a[84:87], v[48:63]
    ds_read_b128 v[36:39], v5 offset:7168
    s_waitcnt lgkmcnt(7)
    v_mfma_f32_32x32x16_bf16 v[48:63], v[40:43], a[88:91], v[48:63]
    buffer_load_dwordx4 v8, s[68:71], s23 offen lds
    s_add_u32 m0, m0, 1024
    s_add_u32 s23, s23, 128
    ds_read_b128 v[40:43], v6 offset:7168
    s_waitcnt lgkmcnt(7)
    v_mfma_f32_32x32x16_bf16 v[48:63], v[44:47], a[92:95], v[48:63]
    ds_read_b128 v[44:47], v7 offset:7168
    s_waitcnt lgkmcnt(7)
    v_mfma_f32_32x32x16_bf16 v[48:63], v[16:19], a[96:99], v[48:63]
    ds_read_b128 v[16:19], v4 offset:8192
    s_waitcnt lgkmcnt(7)
    v_mfma_f32_32x32x16_bf16 v[48:63], v[20:23], a[100:103], v[48:63]
    buffer_load_dwordx4 v8, s[68:71], s23 offen lds
    ds_read_b128 v[20:23], v5 offset:8192
    s_waitcnt lgkmcnt(7)
    v_mfma_f32_32x32x16_bf16 v[48:63], v[24:27], a[104:107], v[48:63]
    ds_read_b128 v[24:27], v6 offset:8192
    s_waitcnt lgkmcnt(7)
    v_mfma_f32_32x32x16_bf16 v[48:63], v[28:31], a[108:111], v[48:63]
    ds_read_b128 v[28:31], v7 offset:8192
    s_waitcnt lgkmcnt(7)
    v_mfma_f32_32x32x16_bf16 v[48:63], v[32:35], a[112:115], v[48:63]
    s_waitcnt lgkmcnt(6)
    v_mfma_f32_32x32x16_bf16 v[48:63], v[36:39], a[116:119], v[48:63]
    s_waitcnt lgkmcnt(5)
    v_mfma_f32_32x32x16_bf16 v[48:63], v[40:43], a[120:123], v[48:63]
    s_waitcnt lgkmcnt(4)
    v_mfma_f32_32x32x16_bf16 v[48:63], v[44:47], a[124:127], v[48:63]
    s_waitcnt lgkmcnt(3)
    v_mfma_f32_32x32x16_bf16 v[48:63], v[16:19], a[128:131], v[48:63]
    s_waitcnt lgkmcnt(2)
    v_mfma_f32_32x32x16_bf16 v[48:63], v[20:23], a[132:135], v[48:63]
    s_waitcnt lgkmcnt(1)
    v_mfma_f32_32x32x16_bf16 v[48:63], v[24:27], a[136:139], v[48:63]
    s_waitcnt lgkmcnt(0)
    v_mfma_f32_32x32x16_bf16 v[48:63], v[28:31], a[140:143], v[48:63]
    s_mov_b32 s48, s22
    s_add_u32 s22, s22, 2
    s_waitcnt vmcnt(9)
L_g11_lp:
    s_barrier
    s_add_u32 s28, s22, 4
    s_min_u32 s28, s28, 63
    s_mov_b32 s25, 0
    ds_read_b128 v[16:19], v4 offset:36864
    s_mul_i32 s17, s13, 9216
    s_add_u32 m0, s17, s25
    s_mul_i32 s23, s28, 36864
    ds_read_b128 v[20:23], v5 offset:36864
    v_cvt_pk_bf16_f32 v64, v48, v49
    v_cvt_pk_bf16_f32 v65, v50, v51
    v_cvt_pk_bf16_f32 v66, v56, v57
    ds_read_b128 v[24:27], v6 offset:36864
    v_cvt_pk_bf16_f32 v67, v58, v59
    v_cvt_pk_bf16_f32 v68, v52, v53
    v_cvt_pk_bf16_f32 v69, v54, v55
    ds_read_b128 v[28:31], v7 offset:36864
    v_cvt_pk_bf16_f32 v70, v60, v61
    v_cvt_pk_bf16_f32 v71, v62, v63
    ds_read_b128 v[32:35], v4 offset:37888
    ds_read_b128 v[36:39], v5 offset:37888
    ds_read_b128 v[40:43], v6 offset:37888
    ds_read_b128 v[44:47], v7 offset:37888
    s_waitcnt lgkmcnt(7)
    v_mfma_f32_32x32x16_bf16 v[96:111], v[16:19], a[0:3], 0
    ds_read_b128 v[16:19], v4 offset:38912
    s_waitcnt lgkmcnt(7)
    v_mfma_f32_32x32x16_bf16 v[96:111], v[20:23], a[4:7], v[96:111]
    ds_read_b128 v[20:23], v5 offset:38912
    buffer_load_dwordx4 v8, s[68:71], s23 offen lds
    s_add_u32 m0, m0, 1024
    s_add_u32 s23, s23, 128
    s_waitcnt lgkmcnt(7)
    v_mfma_f32_32x32x16_bf16 v[96:111], v[24:27], a[8:11], v[96:111]
    ds_read_b128 v[24:27], v6 offset:38912
    s_waitcnt lgkmcnt(7)
    v_mfma_f32_32x32x16_bf16 v[96:111], v[28:31], a[12:15], v[96:111]
    ds_read_b128 v[28:31], v7 offset:38912
    s_waitcnt lgkmcnt(7)
    v_mfma_f32_32x32x16_bf16 v[96:111], v[32:35], a[16:19], v[96:111]
    ds_read_b128 v[32:35], v4 offset:39936
    buffer_load_dwordx4 v8, s[68:71], s23 offen lds
    s_add_u32 m0, m0, 1024
    s_add_u32 s23, s23, 128
    s_waitcnt lgkmcnt(7)
    v_mfma_f32_32x32x16_bf16 v[96:111], v[36:39], a[20:23], v[96:111]
    ds_read_b128 v[36:39], v5 offset:39936
    s_waitcnt lgkmcnt(7)
    v_mfma_f32_32x32x16_bf16 v[96:111], v[40:43], a[24:27], v[96:111]
    ds_read_b128 v[40:43], v6 offset:39936
    s_waitcnt lgkmcnt(7)
    v_mfma_f32_32x32x16_bf16 v[96:111], v[44:47], a[28:31], v[96:111]
    ds_read_b128 v[44:47], v7 offset:39936
    buffer_load_dwordx4 v8, s[68:71], s23 offen lds
    s_add_u32 m0, m0, 1024
    s_add_u32 s23, s23, 128
    s_waitcnt lgkmcnt(7)
    v_mfma_f32_32x32x16_bf16 v[96:111], v[16:19], a[32:35], v[96:111]
    ds_read_b128 v[16:19], v4 offset:40960
    s_waitcnt lgkmcnt(7)
    v_mfma_f32_32x32x16_bf16 v[96:111], v[20:23], a[36:39], v[96:111]
    ds_read_b128 v[20:23], v5 offset:40960
    s_waitcnt lgkmcnt(7)
    v_mfma_f32_32x32x16_bf16 v[96:111], v[24:27], a[40:43], v[96:111]
    ds_read_b128 v[24:27], v6 offset:40960
    buffer_load_dwordx4 v8, s[68:71], s23 offen lds
    s_add_u32 m0, m0, 1024
    s_add_u32 s23, s23, 128
    s_waitcnt lgkmcnt(7)
    v_mfma_f32_32x32x16_bf16 v[96:111], v[28:31], a[44:47], v[96:111]
    ds_read_b128 v[28:31], v7 offset:40960
    s_waitcnt lgkmcnt(7)
    v_mfma_f32_32x32x16_bf16 v[96:111], v[32:35], a[48:51], v[96:111]
    ds_read_b128 v[32:35], v4 offset:41984
    s_waitcnt lgkmcnt(7)
    v_mfma_f32_32x32x16_bf16 v[96:111], v[36:39], a[52:55], v[96:111]
    ds_read_b128 v[36:39], v5 offset:41984
    buffer_load_dwordx4 v8, s[68:71], s23 offen lds
    s_add_u32 m0, m0, 1024
    s_add_u32 s23, s23, 128
    s_waitcnt lgkmcnt(7)
    v_mfma_f32_32x32x16_bf16 v[96:111], v[40:43], a[56:59], v[96:111]
    ds_read_b128 v[40:43], v6 offset:41984
    s_waitcnt lgkmcnt(7)
    v_mfma_f32_32x32x16_bf16 v[96:111], v[44:47], a[60:63], v[96:111]
    ds_read_b128 v[44:47], v7 offset:41984
    s_waitcnt lgkmcnt(7)
    v_mfma_f32_32x32x16_bf16 v[96:111], v[16:19], a[64:67], v[96:111]
    ds_read_b128 v[16:19], v4 offset:43008
    buffer_load_dwordx4 v8, s[68:71], s23 offen lds
    s_add_u32 m0, m0, 1024
    s_add_u32 s23, s23, 128
    s_waitcnt lgkmcnt(7)
    v_mfma_f32_32x32x16_bf16 v[96:111], v[20:23], a[68:71], v[96:111]
    ds_read_b128 v[20:23], v5 offset:43008
    s_waitcnt lgkmcnt(7)
    v_mfma_f32_32x32x16_bf16 v[96:111], v[24:27], a[72:75], v[96:111]
    ds_read_b128 v[24:27], v6 offset:43008
    s_waitcnt lgkmcnt(7)
    v_mfma_f32_32x32x16_bf16 v[96:111], v[28:31], a[76:79], v[96:111]
    buffer_load_dwordx4 v8, s[68:71], s23 offen lds
    s_add_u32 m0, m0, 1024
    s_add_u32 s23, s23, 128
    ds_read_b128 v[28:31], v7 offset:43008
    s_waitcnt lgkmcnt(7)
    v_mfma_f32_32x32x16_bf16 v[96:111], v[32:35], a[80:83], v[96:111]
    ds_read_b128 v[32:35], v4 offset:44032
    s_waitcnt lgkmcnt(7)
    v_mfma_f32_32x32x16_bf16 v[96:111], v[36:39], a[84:87], v[96:111]
    ds_read_b128 v[36:39], v5 offset:44032
    s_waitcnt lgkmcnt(7)
    v_mfma_f32_32x32x16_bf16 v[96:111], v[40:43], a[88:91], v[96:111]
    buffer_load_dwordx4 v8, s[68:71], s23 offen lds
    s_add_u32 m0, m0, 1024
    s_add_u32 s23, s23, 128
    ds_read_b128 v[40:43], v6 offset:44032
    s_lshl_b32 s24, s48, 19
    s_add_u32 s24, s24, s29
    s_add_u32 s24, s24, 8192
    s_waitcnt lgkmcnt(7)
    v_mfma_f32_32x32x16_bf16 v[96:111], v[44:47], a[92:95], v[96:111]
    ds_read_b128 v[44:47], v7 offset:44032
    s_waitcnt lgkmcnt(7)
    v_mfma_f32_32x32x16_bf16 v[96:111], v[16:19], a[96:99], v[96:111]
    ds_read_b128 v[16:19], v4 offset:45056
    s_waitcnt lgkmcnt(7)
    v_mfma_f32_32x32x16_bf16 v[96:111], v[20:23], a[100:103], v[96:111]
    buffer_load_dwordx4 v8, s[68:71], s23 offen lds
    ds_read_b128 v[20:23], v5 offset:45056
    s_waitcnt lgkmcnt(7)
    v_mfma_f32_32x32x16_bf16 v[96:111], v[24:27], a[104:107], v[96:111]
    ds_read_b128 v[24:27], v6 offset:45056
    buffer_store_dwordx4 v[64:67], v12, s[4:7], s24 offen offset:0 sc1
    s_waitcnt lgkmcnt(7)
    v_mfma_f32_32x32x16_bf16 v[96:111], v[28:31], a[108:111], v[96:111]
    ds_read_b128 v[28:31], v7 offset:45056
    buffer_store_dwordx4 v[68:71], v12, s[4:7], s24 offen offset:512 sc1
    s_waitcnt lgkmcnt(7)
    v_mfma_f32_32x32x16_bf16 v[96:111], v[32:35], a[112:115], v[96:111]
    s_waitcnt lgkmcnt(6)
    v_mfma_f32_32x32x16_bf16 v[96:111], v[36:39], a[116:119], v[96:111]
    s_waitcnt lgkmcnt(5)
    v_mfma_f32_32x32x16_bf16 v[96:111], v[40:43], a[120:123], v[96:111]
    s_waitcnt lgkmcnt(4)
    v_mfma_f32_32x32x16_bf16 v[96:111], v[44:47], a[124:127], v[96:111]
    s_waitcnt lgkmcnt(3)
    v_mfma_f32_32x32x16_bf16 v[96:111], v[16:19], a[128:131], v[96:111]
    s_waitcnt lgkmcnt(2)
    v_mfma_f32_32x32x16_bf16 v[96:111], v[20:23], a[132:135], v[96:111]
    s_waitcnt lgkmcnt(1)
    v_mfma_f32_32x32x16_bf16 v[96:111], v[24:27], a[136:139], v[96:111]
    s_waitcnt lgkmcnt(0)
    v_mfma_f32_32x32x16_bf16 v[96:111], v[28:31], a[140:143], v[96:111]
    s_add_u32 s26, s26, 1
    s_cmp_eq_u32 s13, 0
    s_cbranch_scc0 L_np_96
    s_sub_u32 s17, s26, 2
    s_max_i32 s17, s17, 0
    v_mov_b32 v2, s17
    s_mov_b64 exec, 1
    buffer_store_dword v2, off, s[4:7], s30 sc1
    s_mov_b64 exec, -1
                L_np_96:
    s_mov_b32 s48, s22
    s_add_u32 s22, s22, 2
    s_cmp_gt_u32 s22, 63
    s_cbranch_scc1 L_g11_end1
    s_waitcnt vmcnt(11)
    s_barrier
    s_add_u32 s28, s22, 4
    s_min_u32 s28, s28, 63
    s_mov_b32 s25, 36864
    ds_read_b128 v[16:19], v248 offset:8192
    s_mul_i32 s17, s13, 9216
    s_add_u32 m0, s17, s25
    s_mul_i32 s23, s28, 36864
    ds_read_b128 v[20:23], v249 offset:8192
    v_cvt_pk_bf16_f32 v64, v96, v97
    v_cvt_pk_bf16_f32 v65, v98, v99
    v_cvt_pk_bf16_f32 v66, v104, v105
    ds_read_b128 v[24:27], v250 offset:8192
    v_cvt_pk_bf16_f32 v67, v106, v107
    v_cvt_pk_bf16_f32 v68, v100, v101
    v_cvt_pk_bf16_f32 v69, v102, v103
    ds_read_b128 v[28:31], v251 offset:8192
    v_cvt_pk_bf16_f32 v70, v108, v109
    v_cvt_pk_bf16_f32 v71, v110, v111
    ds_read_b128 v[32:35], v248 offset:9216
    ds_read_b128 v[36:39], v249 offset:9216
    ds_read_b128 v[40:43], v250 offset:9216
    ds_read_b128 v[44:47], v251 offset:9216
    s_waitcnt lgkmcnt(7)
    v_mfma_f32_32x32x16_bf16 v[48:63], v[16:19], a[0:3], 0
    ds_read_b128 v[16:19], v248 offset:10240
    s_waitcnt lgkmcnt(7)
    v_mfma_f32_32x32x16_bf16 v[48:63], v[20:23], a[4:7], v[48:63]
    ds_read_b128 v[20:23], v249 offset:10240
    buffer_load_dwordx4 v8, s[68:71], s23 offen lds
    s_add_u32 m0, m0, 1024
    s_add_u32 s23, s23, 128
    s_waitcnt lgkmcnt(7)
    v_mfma_f32_32x32x16_bf16 v[48:63], v[24:27], a[8:11], v[48:63]
    ds_read_b128 v[24:27], v250 offset:10240
    s_waitcnt lgkmcnt(7)
    v_mfma_f32_32x32x16_bf16 v[48:63], v[28:31], a[12:15], v[48:63]
    ds_read_b128 v[28:31], v251 offset:10240
    s_waitcnt lgkmcnt(7)
    v_mfma_f32_32x32x16_bf16 v[48:63], v[32:35], a[16:19], v[48:63]
    ds_read_b128 v[32:35], v248 offset:11264
    buffer_load_dwordx4 v8, s[68:71], s23 offen lds
    s_add_u32 m0, m0, 1024
    s_add_u32 s23, s23, 128
    s_waitcnt lgkmcnt(7)
    v_mfma_f32_32x32x16_bf16 v[48:63], v[36:39], a[20:23], v[48:63]
    ds_read_b128 v[36:39], v249 offset:11264
    s_waitcnt lgkmcnt(7)
    v_mfma_f32_32x32x16_bf16 v[48:63], v[40:43], a[24:27], v[48:63]
    ds_read_b128 v[40:43], v250 offset:11264
    s_waitcnt lgkmcnt(7)
    v_mfma_f32_32x32x16_bf16 v[48:63], v[44:47], a[28:31], v[48:63]
    ds_read_b128 v[44:47], v251 offset:11264
    buffer_load_dwordx4 v8, s[68:71], s23 offen lds
    s_add_u32 m0, m0, 1024
    s_add_u32 s23, s23, 128
    s_waitcnt lgkmcnt(7)
    v_mfma_f32_32x32x16_bf16 v[48:63], v[16:19], a[32:35], v[48:63]
    ds_read_b128 v[16:19], v248 offset:12288
    s_waitcnt lgkmcnt(7)
    v_mfma_f32_32x32x16_bf16 v[48:63], v[20:23], a[36:39], v[48:63]
    ds_read_b128 v[20:23], v249 offset:12288
    s_waitcnt lgkmcnt(7)
    v_mfma_f32_32x32x16_bf16 v[48:63], v[24:27], a[40:43], v[48:63]
    ds_read_b128 v[24:27], v250 offset:12288
    buffer_load_dwordx4 v8, s[68:71], s23 offen lds
    s_add_u32 m0, m0, 1024
    s_add_u32 s23, s23, 128
    s_waitcnt lgkmcnt(7)
    v_mfma_f32_32x32x16_bf16 v[48:63], v[28:31], a[44:47], v[48:63]
    ds_read_b128 v[28:31], v251 offset:12288
    s_waitcnt lgkmcnt(7)
    v_mfma_f32_32x32x16_bf16 v[48:63], v[32:35], a[48:51], v[48:63]
    ds_read_b128 v[32:35], v248 offset:13312
    s_waitcnt lgkmcnt(7)
    v_mfma_f32_32x32x16_bf16 v[48:63], v[36:39], a[52:55], v[48:63]
    ds_read_b128 v[36:39], v249 offset:13312
    buffer_load_dwordx4 v8, s[68:71], s23 offen lds
    s_add_u32 m0, m0, 1024
    s_add_u32 s23, s23, 128
    s_waitcnt lgkmcnt(7)
    v_mfma_f32_32x32x16_bf16 v[48:63], v[40:43], a[56:59], v[48:63]
    ds_read_b128 v[40:43], v250 offset:13312
    s_waitcnt lgkmcnt(7)
    v_mfma_f32_32x32x16_bf16 v[48:63], v[44:47], a[60:63], v[48:63]
    ds_read_b128 v[44:47], v251 offset:13312
    s_waitcnt lgkmcnt(7)
    v_mfma_f32_32x32x16_bf16 v[48:63], v[16:19], a[64:67], v[48:63]
    ds_read_b128 v[16:19], v248 offset:14336
    buffer_load_dwordx4 v8, s[68:71], s23 offen lds
    s_add_u32 m0, m0, 1024
    s_add_u32 s23, s23, 128
    s_waitcnt lgkmcnt(7)
    v_mfma_f32_32x32x16_bf16 v[48:63], v[20:23], a[68:71], v[48:63]
    ds_read_b128 v[20:23], v249 offset:14336
    s_waitcnt lgkmcnt(7)
    v_mfma_f32_32x32x16_bf16 v[48:63], v[24:27], a[72:75], v[48:63]
    ds_read_b128 v[24:27], v250 offset:14336
    s_waitcnt lgkmcnt(7)
    v_mfma_f32_32x32x16_bf16 v[48:63], v[28:31], a[76:79], v[48:63]
    buffer_load_dwordx4 v8, s[68:71], s23 offen lds
    s_add_u32 m0, m0, 1024
    s_add_u32 s23, s23, 128
    ds_read_b128 v[28:31], v251 offset:14336
    s_waitcnt lgkmcnt(7)
    v_mfma_f32_32x32x16_bf16 v[48:63], v[32:35], a[80:83], v[48:63]
    ds_read_b128 v[32:35], v248 offset:15360
    s_waitcnt lgkmcnt(7)
    v_mfma_f32_32x32x16_bf16 v[48:63], v[36:39], a[84:87], v[48:63]
    ds_read_b128 v[36:39], v249 offset:15360
    s_waitcnt lgkmcnt(7)
    v_mfma_f32_32x32x16_bf16 v[48:63], v[40:43], a[88:91], v[48:63]
    buffer_load_dwordx4 v8, s[68:71], s23 offen lds
    s_add_u32 m0, m0, 1024
    s_add_u32 s23, s23, 128
    ds_read_b128 v[40:43], v250 offset:15360
    s_lshl_b32 s24, s48, 19
    s_add_u32 s24, s24, s29
    s_add_u32 s24, s24, 8192
    s_waitcnt lgkmcnt(7)
    v_mfma_f32_32x32x16_bf16 v[48:63], v[44:47], a[92:95], v[48:63]
    ds_read_b128 v[44:47], v251 offset:15360
    s_waitcnt lgkmcnt(7)
    v_mfma_f32_32x32x16_bf16 v[48:63], v[16:19], a[96:99], v[48:63]
    ds_read_b128 v[16:19], v248 offset:16384
    s_waitcnt lgkmcnt(7)
    v_mfma_f32_32x32x16_bf16 v[48:63], v[20:23], a[100:103], v[48:63]
    buffer_load_dwordx4 v8, s[68:71], s23 offen lds
    ds_read_b128 v[20:23], v249 offset:16384
    s_waitcnt lgkmcnt(7)
    v_mfma_f32_32x32x16_bf16 v[48:63], v[24:27], a[104:107], v[48:63]
    ds_read_b128 v[24:27], v250 offset:16384
    buffer_store_dwordx4 v[64:67], v12, s[4:7], s24 offen offset:0 sc1
    s_waitcnt lgkmcnt(7)
    v_mfma_f32_32x32x16_bf16 v[48:63], v[28:31], a[108:111], v[48:63]
    ds_read_b128 v[28:31], v251 offset:16384
    buffer_store_dwordx4 v[68:71], v12, s[4:7], s24 offen offset:512 sc1
    s_waitcnt lgkmcnt(7)
    v_mfma_f32_32x32x16_bf16 v[48:63], v[32:35], a[112:115], v[48:63]
    s_waitcnt lgkmcnt(6)
    v_mfma_f32_32x32x16_bf16 v[48:63], v[36:39], a[116:119], v[48:63]
    s_waitcnt lgkmcnt(5)
    v_mfma_f32_32x32x16_bf16 v[48:63], v[40:43], a[120:123], v[48:63]
    s_waitcnt lgkmcnt(4)
    v_mfma_f32_32x32x16_bf16 v[48:63], v[44:47], a[124:127], v[48:63]
    s_waitcnt lgkmcnt(3)
    v_mfma_f32_32x32x16_bf16 v[48:63], v[16:19], a[128:131], v[48:63]
    s_waitcnt lgkmcnt(2)
    v_mfma_f32_32x32x16_bf16 v[48:63], v[20:23], a[132:135], v[48:63]
    s_waitcnt lgkmcnt(1)
    v_mfma_f32_32x32x16_bf16 v[48:63], v[24:27], a[136:139], v[48:63]
    s_waitcnt lgkmcnt(0)
    v_mfma_f32_32x32x16_bf16 v[48:63], v[28:31], a[140:143], v[48:63]
    s_add_u32 s26, s26, 1
    s_cmp_eq_u32 s13, 0
    s_cbranch_scc0 L_np_97
    s_sub_u32 s17, s26, 2
    s_max_i32 s17, s17, 0
    v_mov_b32 v2, s17
    s_mov_b64 exec, 1
    buffer_store_dword v2, off, s[4:7], s30 sc1
    s_mov_b64 exec, -1
                L_np_97:
    s_mov_b32 s48, s22
    s_add_u32 s22, s22, 2
    s_cmp_gt_u32 s22, 63
    s_cbranch_scc1 L_g11_end0
    s_waitcnt vmcnt(11)
    s_barrier
    s_add_u32 s28, s22, 4
    s_min_u32 s28, s28, 63
    s_mov_b32 s25, 73728
    ds_read_b128 v[16:19], v4 offset:0
    s_mul_i32 s17, s13, 9216
    s_add_u32 m0, s17, s25
    s_mul_i32 s23, s28, 36864
    ds_read_b128 v[20:23], v5 offset:0
    v_cvt_pk_bf16_f32 v64, v48, v49
    v_cvt_pk_bf16_f32 v65, v50, v51
    v_cvt_pk_bf16_f32 v66, v56, v57
    ds_read_b128 v[24:27], v6 offset:0
    v_cvt_pk_bf16_f32 v67, v58, v59
    v_cvt_pk_bf16_f32 v68, v52, v53
    v_cvt_pk_bf16_f32 v69, v54, v55
    ds_read_b128 v[28:31], v7 offset:0
    v_cvt_pk_bf16_f32 v70, v60, v61
    v_cvt_pk_bf16_f32 v71, v62, v63
    ds_read_b128 v[32:35], v4 offset:1024
    ds_read_b128 v[36:39], v5 offset:1024
    ds_read_b128 v[40:43], v6 offset:1024
    ds_read_b128 v[44:47], v7 offset:1024
    s_waitcnt lgkmcnt(7)
    v_mfma_f32_32x32x16_bf16 v[96:111], v[16:19], a[0:3], 0
    ds_read_b128 v[16:19], v4 offset:2048
    s_waitcnt lgkmcnt(7)
    v_mfma_f32_32x32x16_bf16 v[96:111], v[20:23], a[4:7], v[96:111]
    ds_read_b128 v[20:23], v5 offset:2048
    buffer_load_dwordx4 v8, s[68:71], s23 offen lds
    s_add_u32 m0, m0, 1024
    s_add_u32 s23, s23, 128
    s_waitcnt lgkmcnt(7)
    v_mfma_f32_32x32x16_bf16 v[96:111], v[24:27], a[8:11], v[96:111]
    ds_read_b128 v[24:27], v6 offset:2048
    s_waitcnt lgkmcnt(7)
    v_mfma_f32_32x32x16_bf16 v[96:111], v[28:31], a[12:15], v[96:111]
    ds_read_b128 v[28:31], v7 offset:2048
    s_waitcnt lgkmcnt(7)
    v_mfma_f32_32x32x16_bf16 v[96:111], v[32:35], a[16:19], v[96:111]
    ds_read_b128 v[32:35], v4 offset:3072
    buffer_load_dwordx4 v8, s[68:71], s23 offen lds
    s_add_u32 m0, m0, 1024
    s_add_u32 s23, s23, 128
    s_waitcnt lgkmcnt(7)
    v_mfma_f32_32x32x16_bf16 v[96:111], v[36:39], a[20:23], v[96:111]
    ds_read_b128 v[36:39], v5 offset:3072
    s_waitcnt lgkmcnt(7)
    v_mfma_f32_32x32x16_bf16 v[96:111], v[40:43], a[24:27], v[96:111]
    ds_read_b128 v[40:43], v6 offset:3072
    s_waitcnt lgkmcnt(7)
    v_mfma_f32_32x32x16_bf16 v[96:111], v[44:47], a[28:31], v[96:111]
    ds_read_b128 v[44:47], v7 offset:3072
    buffer_load_dwordx4 v8, s[68:71], s23 offen lds
    s_add_u32 m0, m0, 1024
    s_add_u32 s23, s23, 128
    s_waitcnt lgkmcnt(7)
    v_mfma_f32_32x32x16_bf16 v[96:111], v[16:19], a[32:35], v[96:111]
    ds_read_b128 v[16:19], v4 offset:4096
    s_waitcnt lgkmcnt(7)
    v_mfma_f32_32x32x16_bf16 v[96:111], v[20:23], a[36:39], v[96:111]
    ds_read_b128 v[20:23], v5 offset:4096
    s_waitcnt lgkmcnt(7)
    v_mfma_f32_32x32x16_bf16 v[96:111], v[24:27], a[40:43], v[96:111]
    ds_read_b128 v[24:27], v6 offset:4096
    buffer_load_dwordx4 v8, s[68:71], s23 offen lds
    s_add_u32 m0, m0, 1024
    s_add_u32 s23, s23, 128
    s_waitcnt lgkmcnt(7)
    v_mfma_f32_32x32x16_bf16 v[96:111], v[28:31], a[44:47], v[96:111]
    ds_read_b128 v[28:31], v7 offset:4096
    s_waitcnt lgkmcnt(7)
    v_mfma_f32_32x32x16_bf16 v[96:111], v[32:35], a[48:51], v[96:111]
    ds_read_b128 v[32:35], v4 offset:5120
    s_waitcnt lgkmcnt(7)
    v_mfma_f32_32x32x16_bf16 v[96:111], v[36:39], a[52:55], v[96:111]
    ds_read_b128 v[36:39], v5 offset:5120
    buffer_load_dwordx4 v8, s[68:71], s23 offen lds
    s_add_u32 m0, m0, 1024
    s_add_u32 s23, s23, 128
    s_waitcnt lgkmcnt(7)
    v_mfma_f32_32x32x16_bf16 v[96:111], v[40:43], a[56:59], v[96:111]
    ds_read_b128 v[40:43], v6 offset:5120
    s_waitcnt lgkmcnt(7)
    v_mfma_f32_32x32x16_bf16 v[96:111], v[44:47], a[60:63], v[96:111]
    ds_read_b128 v[44:47], v7 offset:5120
    s_waitcnt lgkmcnt(7)
    v_mfma_f32_32x32x16_bf16 v[96:111], v[16:19], a[64:67], v[96:111]
    ds_read_b128 v[16:19], v4 offset:6144
    buffer_load_dwordx4 v8, s[68:71], s23 offen lds
    s_add_u32 m0, m0, 1024
    s_add_u32 s23, s23, 128
    s_waitcnt lgkmcnt(7)
    v_mfma_f32_32x32x16_bf16 v[96:111], v[20:23], a[68:71], v[96:111]
    ds_read_b128 v[20:23], v5 offset:6144
    s_waitcnt lgkmcnt(7)
    v_mfma_f32_32x32x16_bf16 v[96:111], v[24:27], a[72:75], v[96:111]
    ds_read_b128 v[24:27], v6 offset:6144
    s_waitcnt lgkmcnt(7)
    v_mfma_f32_32x32x16_bf16 v[96:111], v[28:31], a[76:79], v[96:111]
    buffer_load_dwordx4 v8, s[68:71], s23 offen lds
    s_add_u32 m0, m0, 1024
    s_add_u32 s23, s23, 128
    ds_read_b128 v[28:31], v7 offset:6144
    s_waitcnt lgkmcnt(7)
    v_mfma_f32_32x32x16_bf16 v[96:111], v[32:35], a[80:83], v[96:111]
    ds_read_b128 v[32:35], v4 offset:7168
    s_waitcnt lgkmcnt(7)
    v_mfma_f32_32x32x16_bf16 v[96:111], v[36:39], a[84:87], v[96:111]
    ds_read_b128 v[36:39], v5 offset:7168
    s_waitcnt lgkmcnt(7)
    v_mfma_f32_32x32x16_bf16 v[96:111], v[40:43], a[88:91], v[96:111]
    buffer_load_dwordx4 v8, s[68:71], s23 offen lds
    s_add_u32 m0, m0, 1024
    s_add_u32 s23, s23, 128
    ds_read_b128 v[40:43], v6 offset:7168
    s_lshl_b32 s24, s48, 19
    s_add_u32 s24, s24, s29
    s_add_u32 s24, s24, 8192
    s_waitcnt lgkmcnt(7)
    v_mfma_f32_32x32x16_bf16 v[96:111], v[44:47], a[92:95], v[96:111]
    ds_read_b128 v[44:47], v7 offset:7168
    s_waitcnt lgkmcnt(7)
    v_mfma_f32_32x32x16_bf16 v[96:111], v[16:19], a[96:99], v[96:111]
    ds_read_b128 v[16:19], v4 offset:8192
    s_waitcnt lgkmcnt(7)
    v_mfma_f32_32x32x16_bf16 v[96:111], v[20:23], a[100:103], v[96:111]
    buffer_load_dwordx4 v8, s[68:71], s23 offen lds
    ds_read_b128 v[20:23], v5 offset:8192
    s_waitcnt lgkmcnt(7)
    v_mfma_f32_32x32x16_bf16 v[96:111], v[24:27], a[104:107], v[96:111]
    ds_read_b128 v[24:27], v6 offset:8192
    buffer_store_dwordx4 v[64:67], v12, s[4:7], s24 offen offset:0 sc1
    s_waitcnt lgkmcnt(7)
    v_mfma_f32_32x32x16_bf16 v[96:111], v[28:31], a[108:111], v[96:111]
    ds_read_b128 v[28:31], v7 offset:8192
    buffer_store_dwordx4 v[68:71], v12, s[4:7], s24 offen offset:512 sc1
    s_waitcnt lgkmcnt(7)
    v_mfma_f32_32x32x16_bf16 v[96:111], v[32:35], a[112:115], v[96:111]
    s_waitcnt lgkmcnt(6)
    v_mfma_f32_32x32x16_bf16 v[96:111], v[36:39], a[116:119], v[96:111]
    s_waitcnt lgkmcnt(5)
    v_mfma_f32_32x32x16_bf16 v[96:111], v[40:43], a[120:123], v[96:111]
    s_waitcnt lgkmcnt(4)
    v_mfma_f32_32x32x16_bf16 v[96:111], v[44:47], a[124:127], v[96:111]
    s_waitcnt lgkmcnt(3)
    v_mfma_f32_32x32x16_bf16 v[96:111], v[16:19], a[128:131], v[96:111]
    s_waitcnt lgkmcnt(2)
    v_mfma_f32_32x32x16_bf16 v[96:111], v[20:23], a[132:135], v[96:111]
    s_waitcnt lgkmcnt(1)
    v_mfma_f32_32x32x16_bf16 v[96:111], v[24:27], a[136:139], v[96:111]
    s_waitcnt lgkmcnt(0)
    v_mfma_f32_32x32x16_bf16 v[96:111], v[28:31], a[140:143], v[96:111]
    s_add_u32 s26, s26, 1
    s_cmp_eq_u32 s13, 0
    s_cbranch_scc0 L_np_98
    s_sub_u32 s17, s26, 2
    s_max_i32 s17, s17, 0
    v_mov_b32 v2, s17
    s_mov_b64 exec, 1
    buffer_store_dword v2, off, s[4:7], s30 sc1
    s_mov_b64 exec, -1
                L_np_98:
    s_mov_b32 s48, s22
    s_add_u32 s22, s22, 2
    s_cmp_gt_u32 s22, 63
    s_cbranch_scc1 L_g11_end1
    s_waitcnt vmcnt(11)
    s_barrier
    s_add_u32 s28, s22, 4
    s_min_u32 s28, s28, 63
    s_mov_b32 s25, 0
    ds_read_b128 v[16:19], v4 offset:36864
    s_mul_i32 s17, s13, 9216
    s_add_u32 m0, s17, s25
    s_mul_i32 s23, s28, 36864
    ds_read_b128 v[20:23], v5 offset:36864
    v_cvt_pk_bf16_f32 v64, v96, v97
    v_cvt_pk_bf16_f32 v65, v98, v99
    v_cvt_pk_bf16_f32 v66, v104, v105
    ds_read_b128 v[24:27], v6 offset:36864
    v_cvt_pk_bf16_f32 v67, v106, v107
    v_cvt_pk_bf16_f32 v68, v100, v101
    v_cvt_pk_bf16_f32 v69, v102, v103
    ds_read_b128 v[28:31], v7 offset:36864
    v_cvt_pk_bf16_f32 v70, v108, v109
    v_cvt_pk_bf16_f32 v71, v110, v111
    ds_read_b128 v[32:35], v4 offset:37888
    ds_read_b128 v[36:39], v5 offset:37888
    ds_read_b128 v[40:43], v6 offset:37888
    ds_read_b128 v[44:47], v7 offset:37888
    s_waitcnt lgkmcnt(7)
    v_mfma_f32_32x32x16_bf16 v[48:63], v[16:19], a[0:3], 0
    ds_read_b128 v[16:19], v4 offset:38912
    s_waitcnt lgkmcnt(7)
    v_mfma_f32_32x32x16_bf16 v[48:63], v[20:23], a[4:7], v[48:63]
    ds_read_b128 v[20:23], v5 offset:38912
    buffer_load_dwordx4 v8, s[68:71], s23 offen lds
    s_add_u32 m0, m0, 1024
    s_add_u32 s23, s23, 128
    s_waitcnt lgkmcnt(7)
    v_mfma_f32_32x32x16_bf16 v[48:63], v[24:27], a[8:11], v[48:63]
    ds_read_b128 v[24:27], v6 offset:38912
    s_waitcnt lgkmcnt(7)
    v_mfma_f32_32x32x16_bf16 v[48:63], v[28:31], a[12:15], v[48:63]
    ds_read_b128 v[28:31], v7 offset:38912
    s_waitcnt lgkmcnt(7)
    v_mfma_f32_32x32x16_bf16 v[48:63], v[32:35], a[16:19], v[48:63]
    ds_read_b128 v[32:35], v4 offset:39936
    buffer_load_dwordx4 v8, s[68:71], s23 offen lds
    s_add_u32 m0, m0, 1024
    s_add_u32 s23, s23, 128
    s_waitcnt lgkmcnt(7)
    v_mfma_f32_32x32x16_bf16 v[48:63], v[36:39], a[20:23], v[48:63]
    ds_read_b128 v[36:39], v5 offset:39936
    s_waitcnt lgkmcnt(7)
    v_mfma_f32_32x32x16_bf16 v[48:63], v[40:43], a[24:27], v[48:63]
    ds_read_b128 v[40:43], v6 offset:39936
    s_waitcnt lgkmcnt(7)
    v_mfma_f32_32x32x16_bf16 v[48:63], v[44:47], a[28:31], v[48:63]
    ds_read_b128 v[44:47], v7 offset:39936
    buffer_load_dwordx4 v8, s[68:71], s23 offen lds
    s_add_u32 m0, m0, 1024
    s_add_u32 s23, s23, 128
    s_waitcnt lgkmcnt(7)
    v_mfma_f32_32x32x16_bf16 v[48:63], v[16:19], a[32:35], v[48:63]
    ds_read_b128 v[16:19], v4 offset:40960
    s_waitcnt lgkmcnt(7)
    v_mfma_f32_32x32x16_bf16 v[48:63], v[20:23], a[36:39], v[48:63]
    ds_read_b128 v[20:23], v5 offset:40960
    s_waitcnt lgkmcnt(7)
    v_mfma_f32_32x32x16_bf16 v[48:63], v[24:27], a[40:43], v[48:63]
    ds_read_b128 v[24:27], v6 offset:40960
    buffer_load_dwordx4 v8, s[68:71], s23 offen lds
    s_add_u32 m0, m0, 1024
    s_add_u32 s23, s23, 128
    s_waitcnt lgkmcnt(7)
    v_mfma_f32_32x32x16_bf16 v[48:63], v[28:31], a[44:47], v[48:63]
    ds_read_b128 v[28:31], v7 offset:40960
    s_waitcnt lgkmcnt(7)
    v_mfma_f32_32x32x16_bf16 v[48:63], v[32:35], a[48:51], v[48:63]
    ds_read_b128 v[32:35], v4 offset:41984
    s_waitcnt lgkmcnt(7)
    v_mfma_f32_32x32x16_bf16 v[48:63], v[36:39], a[52:55], v[48:63]
    ds_read_b128 v[36:39], v5 offset:41984
    buffer_load_dwordx4 v8, s[68:71], s23 offen lds
    s_add_u32 m0, m0, 1024
    s_add_u32 s23, s23, 128
    s_waitcnt lgkmcnt(7)
    v_mfma_f32_32x32x16_bf16 v[48:63], v[40:43], a[56:59], v[48:63]
    ds_read_b128 v[40:43], v6 offset:41984
    s_waitcnt lgkmcnt(7)
    v_mfma_f32_32x32x16_bf16 v[48:63], v[44:47], a[60:63], v[48:63]
    ds_read_b128 v[44:47], v7 offset:41984
    s_waitcnt lgkmcnt(7)
    v_mfma_f32_32x32x16_bf16 v[48:63], v[16:19], a[64:67], v[48:63]
    ds_read_b128 v[16:19], v4 offset:43008
    buffer_load_dwordx4 v8, s[68:71], s23 offen lds
    s_add_u32 m0, m0, 1024
    s_add_u32 s23, s23, 128
    s_waitcnt lgkmcnt(7)
    v_mfma_f32_32x32x16_bf16 v[48:63], v[20:23], a[68:71], v[48:63]
    ds_read_b128 v[20:23], v5 offset:43008
    s_waitcnt lgkmcnt(7)
    v_mfma_f32_32x32x16_bf16 v[48:63], v[24:27], a[72:75], v[48:63]
    ds_read_b128 v[24:27], v6 offset:43008
    s_waitcnt lgkmcnt(7)
    v_mfma_f32_32x32x16_bf16 v[48:63], v[28:31], a[76:79], v[48:63]
    buffer_load_dwordx4 v8, s[68:71], s23 offen lds
    s_add_u32 m0, m0, 1024
    s_add_u32 s23, s23, 128
    ds_read_b128 v[28:31], v7 offset:43008
    s_waitcnt lgkmcnt(7)
    v_mfma_f32_32x32x16_bf16 v[48:63], v[32:35], a[80:83], v[48:63]
    ds_read_b128 v[32:35], v4 offset:44032
    s_waitcnt lgkmcnt(7)
    v_mfma_f32_32x32x16_bf16 v[48:63], v[36:39], a[84:87], v[48:63]
    ds_read_b128 v[36:39], v5 offset:44032
    s_waitcnt lgkmcnt(7)
    v_mfma_f32_32x32x16_bf16 v[48:63], v[40:43], a[88:91], v[48:63]
    buffer_load_dwordx4 v8, s[68:71], s23 offen lds
    s_add_u32 m0, m0, 1024
    s_add_u32 s23, s23, 128
    ds_read_b128 v[40:43], v6 offset:44032
    s_lshl_b32 s24, s48, 19
    s_add_u32 s24, s24, s29
    s_add_u32 s24, s24, 8192
    s_waitcnt lgkmcnt(7)
    v_mfma_f32_32x32x16_bf16 v[48:63], v[44:47], a[92:95], v[48:63]
    ds_read_b128 v[44:47], v7 offset:44032
    s_waitcnt lgkmcnt(7)
    v_mfma_f32_32x32x16_bf16 v[48:63], v[16:19], a[96:99], v[48:63]
    ds_read_b128 v[16:19], v4 offset:45056
    s_waitcnt lgkmcnt(7)
    v_mfma_f32_32x32x16_bf16 v[48:63], v[20:23], a[100:103], v[48:63]
    buffer_load_dwordx4 v8, s[68:71], s23 offen lds
    ds_read_b128 v[20:23], v5 offset:45056
    s_waitcnt lgkmcnt(7)
    v_mfma_f32_32x32x16_bf16 v[48:63], v[24:27], a[104:107], v[48:63]
    ds_read_b128 v[24:27], v6 offset:45056
    buffer_store_dwordx4 v[64:67], v12, s[4:7], s24 offen offset:0 sc1
    s_waitcnt lgkmcnt(7)
    v_mfma_f32_32x32x16_bf16 v[48:63], v[28:31], a[108:111], v[48:63]
    ds_read_b128 v[28:31], v7 offset:45056
    buffer_store_dwordx4 v[68:71], v12, s[4:7], s24 offen offset:512 sc1
    s_waitcnt lgkmcnt(7)
    v_mfma_f32_32x32x16_bf16 v[48:63], v[32:35], a[112:115], v[48:63]
    s_waitcnt lgkmcnt(6)
    v_mfma_f32_32x32x16_bf16 v[48:63], v[36:39], a[116:119], v[48:63]
    s_waitcnt lgkmcnt(5)
    v_mfma_f32_32x32x16_bf16 v[48:63], v[40:43], a[120:123], v[48:63]
    s_waitcnt lgkmcnt(4)
    v_mfma_f32_32x32x16_bf16 v[48:63], v[44:47], a[124:127], v[48:63]
    s_waitcnt lgkmcnt(3)
    v_mfma_f32_32x32x16_bf16 v[48:63], v[16:19], a[128:131], v[48:63]
    s_waitcnt lgkmcnt(2)
    v_mfma_f32_32x32x16_bf16 v[48:63], v[20:23], a[132:135], v[48:63]
    s_waitcnt lgkmcnt(1)
    v_mfma_f32_32x32x16_bf16 v[48:63], v[24:27], a[136:139], v[48:63]
    s_waitcnt lgkmcnt(0)
    v_mfma_f32_32x32x16_bf16 v[48:63], v[28:31], a[140:143], v[48:63]
    s_add_u32 s26, s26, 1
    s_cmp_eq_u32 s13, 0
    s_cbranch_scc0 L_np_99
    s_sub_u32 s17, s26, 2
    s_max_i32 s17, s17, 0
    v_mov_b32 v2, s17
    s_mov_b64 exec, 1
    buffer_store_dword v2, off, s[4:7], s30 sc1
    s_mov_b64 exec, -1
                L_np_99:
    s_mov_b32 s48, s22
    s_add_u32 s22, s22, 2
    s_cmp_gt_u32 s22, 63
    s_cbranch_scc1 L_g11_end0
    s_waitcnt vmcnt(11)
    s_barrier
    s_add_u32 s28, s22, 4
    s_min_u32 s28, s28, 63
    s_mov_b32 s25, 36864
    ds_read_b128 v[16:19], v248 offset:8192
    s_mul_i32 s17, s13, 9216
    s_add_u32 m0, s17, s25
    s_mul_i32 s23, s28, 36864
    ds_read_b128 v[20:23], v249 offset:8192
    v_cvt_pk_bf16_f32 v64, v48, v49
    v_cvt_pk_bf16_f32 v65, v50, v51
    v_cvt_pk_bf16_f32 v66, v56, v57
    ds_read_b128 v[24:27], v250 offset:8192
    v_cvt_pk_bf16_f32 v67, v58, v59
    v_cvt_pk_bf16_f32 v68, v52, v53
    v_cvt_pk_bf16_f32 v69, v54, v55
    ds_read_b128 v[28:31], v251 offset:8192
    v_cvt_pk_bf16_f32 v70, v60, v61
    v_cvt_pk_bf16_f32 v71, v62, v63
    ds_read_b128 v[32:35], v248 offset:9216
    ds_read_b128 v[36:39], v249 offset:9216
    ds_read_b128 v[40:43], v250 offset:9216
    ds_read_b128 v[44:47], v251 offset:9216
    s_waitcnt lgkmcnt(7)
    v_mfma_f32_32x32x16_bf16 v[96:111], v[16:19], a[0:3], 0
    ds_read_b128 v[16:19], v248 offset:10240
    s_waitcnt lgkmcnt(7)
    v_mfma_f32_32x32x16_bf16 v[96:111], v[20:23], a[4:7], v[96:111]
    ds_read_b128 v[20:23], v249 offset:10240
    buffer_load_dwordx4 v8, s[68:71], s23 offen lds
    s_add_u32 m0, m0, 1024
    s_add_u32 s23, s23, 128
    s_waitcnt lgkmcnt(7)
    v_mfma_f32_32x32x16_bf16 v[96:111], v[24:27], a[8:11], v[96:111]
    ds_read_b128 v[24:27], v250 offset:10240
    s_waitcnt lgkmcnt(7)
    v_mfma_f32_32x32x16_bf16 v[96:111], v[28:31], a[12:15], v[96:111]
    ds_read_b128 v[28:31], v251 offset:10240
    s_waitcnt lgkmcnt(7)
    v_mfma_f32_32x32x16_bf16 v[96:111], v[32:35], a[16:19], v[96:111]
    ds_read_b128 v[32:35], v248 offset:11264
    buffer_load_dwordx4 v8, s[68:71], s23 offen lds
    s_add_u32 m0, m0, 1024
    s_add_u32 s23, s23, 128
    s_waitcnt lgkmcnt(7)
    v_mfma_f32_32x32x16_bf16 v[96:111], v[36:39], a[20:23], v[96:111]
    ds_read_b128 v[36:39], v249 offset:11264
    s_waitcnt lgkmcnt(7)
    v_mfma_f32_32x32x16_bf16 v[96:111], v[40:43], a[24:27], v[96:111]
    ds_read_b128 v[40:43], v250 offset:11264
    s_waitcnt lgkmcnt(7)
    v_mfma_f32_32x32x16_bf16 v[96:111], v[44:47], a[28:31], v[96:111]
    ds_read_b128 v[44:47], v251 offset:11264
    buffer_load_dwordx4 v8, s[68:71], s23 offen lds
    s_add_u32 m0, m0, 1024
    s_add_u32 s23, s23, 128
    s_waitcnt lgkmcnt(7)
    v_mfma_f32_32x32x16_bf16 v[96:111], v[16:19], a[32:35], v[96:111]
    ds_read_b128 v[16:19], v248 offset:12288
    s_waitcnt lgkmcnt(7)
    v_mfma_f32_32x32x16_bf16 v[96:111], v[20:23], a[36:39], v[96:111]
    ds_read_b128 v[20:23], v249 offset:12288
    s_waitcnt lgkmcnt(7)
    v_mfma_f32_32x32x16_bf16 v[96:111], v[24:27], a[40:43], v[96:111]
    ds_read_b128 v[24:27], v250 offset:12288
    buffer_load_dwordx4 v8, s[68:71], s23 offen lds
    s_add_u32 m0, m0, 1024
    s_add_u32 s23, s23, 128
    s_waitcnt lgkmcnt(7)
    v_mfma_f32_32x32x16_bf16 v[96:111], v[28:31], a[44:47], v[96:111]
    ds_read_b128 v[28:31], v251 offset:12288
    s_waitcnt lgkmcnt(7)
    v_mfma_f32_32x32x16_bf16 v[96:111], v[32:35], a[48:51], v[96:111]
    ds_read_b128 v[32:35], v248 offset:13312
    s_waitcnt lgkmcnt(7)
    v_mfma_f32_32x32x16_bf16 v[96:111], v[36:39], a[52:55], v[96:111]
    ds_read_b128 v[36:39], v249 offset:13312
    buffer_load_dwordx4 v8, s[68:71], s23 offen lds
    s_add_u32 m0, m0, 1024
    s_add_u32 s23, s23, 128
    s_waitcnt lgkmcnt(7)
    v_mfma_f32_32x32x16_bf16 v[96:111], v[40:43], a[56:59], v[96:111]
    ds_read_b128 v[40:43], v250 offset:13312
    s_waitcnt lgkmcnt(7)
    v_mfma_f32_32x32x16_bf16 v[96:111], v[44:47], a[60:63], v[96:111]
    ds_read_b128 v[44:47], v251 offset:13312
    s_waitcnt lgkmcnt(7)
    v_mfma_f32_32x32x16_bf16 v[96:111], v[16:19], a[64:67], v[96:111]
    ds_read_b128 v[16:19], v248 offset:14336
    buffer_load_dwordx4 v8, s[68:71], s23 offen lds
    s_add_u32 m0, m0, 1024
    s_add_u32 s23, s23, 128
    s_waitcnt lgkmcnt(7)
    v_mfma_f32_32x32x16_bf16 v[96:111], v[20:23], a[68:71], v[96:111]
    ds_read_b128 v[20:23], v249 offset:14336
    s_waitcnt lgkmcnt(7)
    v_mfma_f32_32x32x16_bf16 v[96:111], v[24:27], a[72:75], v[96:111]
    ds_read_b128 v[24:27], v250 offset:14336
    s_waitcnt lgkmcnt(7)
    v_mfma_f32_32x32x16_bf16 v[96:111], v[28:31], a[76:79], v[96:111]
    buffer_load_dwordx4 v8, s[68:71], s23 offen lds
    s_add_u32 m0, m0, 1024
    s_add_u32 s23, s23, 128
    ds_read_b128 v[28:31], v251 offset:14336
    s_waitcnt lgkmcnt(7)
    v_mfma_f32_32x32x16_bf16 v[96:111], v[32:35], a[80:83], v[96:111]
    ds_read_b128 v[32:35], v248 offset:15360
    s_waitcnt lgkmcnt(7)
    v_mfma_f32_32x32x16_bf16 v[96:111], v[36:39], a[84:87], v[96:111]
    ds_read_b128 v[36:39], v249 offset:15360
    s_waitcnt lgkmcnt(7)
    v_mfma_f32_32x32x16_bf16 v[96:111], v[40:43], a[88:91], v[96:111]
    buffer_load_dwordx4 v8, s[68:71], s23 offen lds
    s_add_u32 m0, m0, 1024
    s_add_u32 s23, s23, 128
    ds_read_b128 v[40:43], v250 offset:15360
    s_lshl_b32 s24, s48, 19
    s_add_u32 s24, s24, s29
    s_add_u32 s24, s24, 8192
    s_waitcnt lgkmcnt(7)
    v_mfma_f32_32x32x16_bf16 v[96:111], v[44:47], a[92:95], v[96:111]
    ds_read_b128 v[44:47], v251 offset:15360
    s_waitcnt lgkmcnt(7)
    v_mfma_f32_32x32x16_bf16 v[96:111], v[16:19], a[96:99], v[96:111]
    ds_read_b128 v[16:19], v248 offset:16384
    s_waitcnt lgkmcnt(7)
    v_mfma_f32_32x32x16_bf16 v[96:111], v[20:23], a[100:103], v[96:111]
    buffer_load_dwordx4 v8, s[68:71], s23 offen lds
    ds_read_b128 v[20:23], v249 offset:16384
    s_waitcnt lgkmcnt(7)
    v_mfma_f32_32x32x16_bf16 v[96:111], v[24:27], a[104:107], v[96:111]
    ds_read_b128 v[24:27], v250 offset:16384
    buffer_store_dwordx4 v[64:67], v12, s[4:7], s24 offen offset:0 sc1
    s_waitcnt lgkmcnt(7)
    v_mfma_f32_32x32x16_bf16 v[96:111], v[28:31], a[108:111], v[96:111]
    ds_read_b128 v[28:31], v251 offset:16384
    buffer_store_dwordx4 v[68:71], v12, s[4:7], s24 offen offset:512 sc1
    s_waitcnt lgkmcnt(7)
    v_mfma_f32_32x32x16_bf16 v[96:111], v[32:35], a[112:115], v[96:111]
    s_waitcnt lgkmcnt(6)
    v_mfma_f32_32x32x16_bf16 v[96:111], v[36:39], a[116:119], v[96:111]
    s_waitcnt lgkmcnt(5)
    v_mfma_f32_32x32x16_bf16 v[96:111], v[40:43], a[120:123], v[96:111]
    s_waitcnt lgkmcnt(4)
    v_mfma_f32_32x32x16_bf16 v[96:111], v[44:47], a[124:127], v[96:111]
    s_waitcnt lgkmcnt(3)
    v_mfma_f32_32x32x16_bf16 v[96:111], v[16:19], a[128:131], v[96:111]
    s_waitcnt lgkmcnt(2)
    v_mfma_f32_32x32x16_bf16 v[96:111], v[20:23], a[132:135], v[96:111]
    s_waitcnt lgkmcnt(1)
    v_mfma_f32_32x32x16_bf16 v[96:111], v[24:27], a[136:139], v[96:111]
    s_waitcnt lgkmcnt(0)
    v_mfma_f32_32x32x16_bf16 v[96:111], v[28:31], a[140:143], v[96:111]
    s_add_u32 s26, s26, 1
    s_cmp_eq_u32 s13, 0
    s_cbranch_scc0 L_np_100
    s_sub_u32 s17, s26, 2
    s_max_i32 s17, s17, 0
    v_mov_b32 v2, s17
    s_mov_b64 exec, 1
    buffer_store_dword v2, off, s[4:7], s30 sc1
    s_mov_b64 exec, -1
                L_np_100:
    s_mov_b32 s48, s22
    s_add_u32 s22, s22, 2
    s_cmp_gt_u32 s22, 63
    s_cbranch_scc1 L_g11_end1
    s_waitcnt vmcnt(11)
    s_barrier
    s_add_u32 s28, s22, 4
    s_min_u32 s28, s28, 63
    s_mov_b32 s25, 73728
    ds_read_b128 v[16:19], v4 offset:0
    s_mul_i32 s17, s13, 9216
    s_add_u32 m0, s17, s25
    s_mul_i32 s23, s28, 36864
    ds_read_b128 v[20:23], v5 offset:0
    v_cvt_pk_bf16_f32 v64, v96, v97
    v_cvt_pk_bf16_f32 v65, v98, v99
    v_cvt_pk_bf16_f32 v66, v104, v105
    ds_read_b128 v[24:27], v6 offset:0
    v_cvt_pk_bf16_f32 v67, v106, v107
    v_cvt_pk_bf16_f32 v68, v100, v101
    v_cvt_pk_bf16_f32 v69, v102, v103
    ds_read_b128 v[28:31], v7 offset:0
    v_cvt_pk_bf16_f32 v70, v108, v109
    v_cvt_pk_bf16_f32 v71, v110, v111
    ds_read_b128 v[32:35], v4 offset:1024
    ds_read_b128 v[36:39], v5 offset:1024
    ds_read_b128 v[40:43], v6 offset:1024
    ds_read_b128 v[44:47], v7 offset:1024
    s_waitcnt lgkmcnt(7)
    v_mfma_f32_32x32x16_bf16 v[48:63], v[16:19], a[0:3], 0
    ds_read_b128 v[16:19], v4 offset:2048
    s_waitcnt lgkmcnt(7)
    v_mfma_f32_32x32x16_bf16 v[48:63], v[20:23], a[4:7], v[48:63]
    ds_read_b128 v[20:23], v5 offset:2048
    buffer_load_dwordx4 v8, s[68:71], s23 offen lds
    s_add_u32 m0, m0, 1024
    s_add_u32 s23, s23, 128
    s_waitcnt lgkmcnt(7)
    v_mfma_f32_32x32x16_bf16 v[48:63], v[24:27], a[8:11], v[48:63]
    ds_read_b128 v[24:27], v6 offset:2048
    s_waitcnt lgkmcnt(7)
    v_mfma_f32_32x32x16_bf16 v[48:63], v[28:31], a[12:15], v[48:63]
    ds_read_b128 v[28:31], v7 offset:2048
    s_waitcnt lgkmcnt(7)
    v_mfma_f32_32x32x16_bf16 v[48:63], v[32:35], a[16:19], v[48:63]
    ds_read_b128 v[32:35], v4 offset:3072
    buffer_load_dwordx4 v8, s[68:71], s23 offen lds
    s_add_u32 m0, m0, 1024
    s_add_u32 s23, s23, 128
    s_waitcnt lgkmcnt(7)
    v_mfma_f32_32x32x16_bf16 v[48:63], v[36:39], a[20:23], v[48:63]
    ds_read_b128 v[36:39], v5 offset:3072
    s_waitcnt lgkmcnt(7)
    v_mfma_f32_32x32x16_bf16 v[48:63], v[40:43], a[24:27], v[48:63]
    ds_read_b128 v[40:43], v6 offset:3072
    s_waitcnt lgkmcnt(7)
    v_mfma_f32_32x32x16_bf16 v[48:63], v[44:47], a[28:31], v[48:63]
    ds_read_b128 v[44:47], v7 offset:3072
    buffer_load_dwordx4 v8, s[68:71], s23 offen lds
    s_add_u32 m0, m0, 1024
    s_add_u32 s23, s23, 128
    s_waitcnt lgkmcnt(7)
    v_mfma_f32_32x32x16_bf16 v[48:63], v[16:19], a[32:35], v[48:63]
    ds_read_b128 v[16:19], v4 offset:4096
    s_waitcnt lgkmcnt(7)
    v_mfma_f32_32x32x16_bf16 v[48:63], v[20:23], a[36:39], v[48:63]
    ds_read_b128 v[20:23], v5 offset:4096
    s_waitcnt lgkmcnt(7)
    v_mfma_f32_32x32x16_bf16 v[48:63], v[24:27], a[40:43], v[48:63]
    ds_read_b128 v[24:27], v6 offset:4096
    buffer_load_dwordx4 v8, s[68:71], s23 offen lds
    s_add_u32 m0, m0, 1024
    s_add_u32 s23, s23, 128
    s_waitcnt lgkmcnt(7)
    v_mfma_f32_32x32x16_bf16 v[48:63], v[28:31], a[44:47], v[48:63]
    ds_read_b128 v[28:31], v7 offset:4096
    s_waitcnt lgkmcnt(7)
    v_mfma_f32_32x32x16_bf16 v[48:63], v[32:35], a[48:51], v[48:63]
    ds_read_b128 v[32:35], v4 offset:5120
    s_waitcnt lgkmcnt(7)
    v_mfma_f32_32x32x16_bf16 v[48:63], v[36:39], a[52:55], v[48:63]
    ds_read_b128 v[36:39], v5 offset:5120
    buffer_load_dwordx4 v8, s[68:71], s23 offen lds
    s_add_u32 m0, m0, 1024
    s_add_u32 s23, s23, 128
    s_waitcnt lgkmcnt(7)
    v_mfma_f32_32x32x16_bf16 v[48:63], v[40:43], a[56:59], v[48:63]
    ds_read_b128 v[40:43], v6 offset:5120
    s_waitcnt lgkmcnt(7)
    v_mfma_f32_32x32x16_bf16 v[48:63], v[44:47], a[60:63], v[48:63]
    ds_read_b128 v[44:47], v7 offset:5120
    s_waitcnt lgkmcnt(7)
    v_mfma_f32_32x32x16_bf16 v[48:63], v[16:19], a[64:67], v[48:63]
    ds_read_b128 v[16:19], v4 offset:6144
    buffer_load_dwordx4 v8, s[68:71], s23 offen lds
    s_add_u32 m0, m0, 1024
    s_add_u32 s23, s23, 128
    s_waitcnt lgkmcnt(7)
    v_mfma_f32_32x32x16_bf16 v[48:63], v[20:23], a[68:71], v[48:63]
    ds_read_b128 v[20:23], v5 offset:6144
    s_waitcnt lgkmcnt(7)
    v_mfma_f32_32x32x16_bf16 v[48:63], v[24:27], a[72:75], v[48:63]
    ds_read_b128 v[24:27], v6 offset:6144
    s_waitcnt lgkmcnt(7)
    v_mfma_f32_32x32x16_bf16 v[48:63], v[28:31], a[76:79], v[48:63]
    buffer_load_dwordx4 v8, s[68:71], s23 offen lds
    s_add_u32 m0, m0, 1024
    s_add_u32 s23, s23, 128
    ds_read_b128 v[28:31], v7 offset:6144
    s_waitcnt lgkmcnt(7)
    v_mfma_f32_32x32x16_bf16 v[48:63], v[32:35], a[80:83], v[48:63]
    ds_read_b128 v[32:35], v4 offset:7168
    s_waitcnt lgkmcnt(7)
    v_mfma_f32_32x32x16_bf16 v[48:63], v[36:39], a[84:87], v[48:63]
    ds_read_b128 v[36:39], v5 offset:7168
    s_waitcnt lgkmcnt(7)
    v_mfma_f32_32x32x16_bf16 v[48:63], v[40:43], a[88:91], v[48:63]
    buffer_load_dwordx4 v8, s[68:71], s23 offen lds
    s_add_u32 m0, m0, 1024
    s_add_u32 s23, s23, 128
    ds_read_b128 v[40:43], v6 offset:7168
    s_lshl_b32 s24, s48, 19
    s_add_u32 s24, s24, s29
    s_add_u32 s24, s24, 8192
    s_waitcnt lgkmcnt(7)
    v_mfma_f32_32x32x16_bf16 v[48:63], v[44:47], a[92:95], v[48:63]
    ds_read_b128 v[44:47], v7 offset:7168
    s_waitcnt lgkmcnt(7)
    v_mfma_f32_32x32x16_bf16 v[48:63], v[16:19], a[96:99], v[48:63]
    ds_read_b128 v[16:19], v4 offset:8192
    s_waitcnt lgkmcnt(7)
    v_mfma_f32_32x32x16_bf16 v[48:63], v[20:23], a[100:103], v[48:63]
    buffer_load_dwordx4 v8, s[68:71], s23 offen lds
    ds_read_b128 v[20:23], v5 offset:8192
    s_waitcnt lgkmcnt(7)
    v_mfma_f32_32x32x16_bf16 v[48:63], v[24:27], a[104:107], v[48:63]
    ds_read_b128 v[24:27], v6 offset:8192
    buffer_store_dwordx4 v[64:67], v12, s[4:7], s24 offen offset:0 sc1
    s_waitcnt lgkmcnt(7)
    v_mfma_f32_32x32x16_bf16 v[48:63], v[28:31], a[108:111], v[48:63]
    ds_read_b128 v[28:31], v7 offset:8192
    buffer_store_dwordx4 v[68:71], v12, s[4:7], s24 offen offset:512 sc1
    s_waitcnt lgkmcnt(7)
    v_mfma_f32_32x32x16_bf16 v[48:63], v[32:35], a[112:115], v[48:63]
    s_waitcnt lgkmcnt(6)
    v_mfma_f32_32x32x16_bf16 v[48:63], v[36:39], a[116:119], v[48:63]
    s_waitcnt lgkmcnt(5)
    v_mfma_f32_32x32x16_bf16 v[48:63], v[40:43], a[120:123], v[48:63]
    s_waitcnt lgkmcnt(4)
    v_mfma_f32_32x32x16_bf16 v[48:63], v[44:47], a[124:127], v[48:63]
    s_waitcnt lgkmcnt(3)
    v_mfma_f32_32x32x16_bf16 v[48:63], v[16:19], a[128:131], v[48:63]
    s_waitcnt lgkmcnt(2)
    v_mfma_f32_32x32x16_bf16 v[48:63], v[20:23], a[132:135], v[48:63]
    s_waitcnt lgkmcnt(1)
    v_mfma_f32_32x32x16_bf16 v[48:63], v[24:27], a[136:139], v[48:63]
    s_waitcnt lgkmcnt(0)
    v_mfma_f32_32x32x16_bf16 v[48:63], v[28:31], a[140:143], v[48:63]
    s_add_u32 s26, s26, 1
    s_cmp_eq_u32 s13, 0
    s_cbranch_scc0 L_np_101
    s_sub_u32 s17, s26, 2
    s_max_i32 s17, s17, 0
    v_mov_b32 v2, s17
    s_mov_b64 exec, 1
    buffer_store_dword v2, off, s[4:7], s30 sc1
    s_mov_b64 exec, -1
                L_np_101:
    s_mov_b32 s48, s22
    s_add_u32 s22, s22, 2
    s_cmp_gt_u32 s22, 63
    s_cbranch_scc1 L_g11_end0
    s_waitcnt vmcnt(11)
    s_branch L_g11_lp
L_g11_end0:
    s_nop 7
    s_nop 3
    s_lshl_b32 s24, s48, 19
    s_add_u32 s24, s24, s29
    v_cvt_pk_bf16_f32 v64, v48, v49
    v_cvt_pk_bf16_f32 v65, v50, v51
    v_cvt_pk_bf16_f32 v66, v56, v57
    v_cvt_pk_bf16_f32 v67, v58, v59
    v_cvt_pk_bf16_f32 v68, v52, v53
    v_cvt_pk_bf16_f32 v69, v54, v55
    v_cvt_pk_bf16_f32 v70, v60, v61
    v_cvt_pk_bf16_f32 v71, v62, v63
    s_add_u32 s24, s24, 8192
    buffer_store_dwordx4 v[64:67], v12, s[4:7], s24 offen offset:0 sc1
    buffer_store_dwordx4 v[68:71], v12, s[4:7], s24 offen offset:512 sc1
    s_branch L_g11_end
L_g11_end1:
    s_nop 7
    s_nop 3
    s_lshl_b32 s24, s48, 19
    s_add_u32 s24, s24, s29
    v_cvt_pk_bf16_f32 v64, v96, v97
    v_cvt_pk_bf16_f32 v65, v98, v99
    v_cvt_pk_bf16_f32 v66, v104, v105
    v_cvt_pk_bf16_f32 v67, v106, v107
    v_cvt_pk_bf16_f32 v68, v100, v101
    v_cvt_pk_bf16_f32 v69, v102, v103
    v_cvt_pk_bf16_f32 v70, v108, v109
    v_cvt_pk_bf16_f32 v71, v110, v111
    s_add_u32 s24, s24, 8192
    buffer_store_dwordx4 v[64:67], v12, s[4:7], s24 offen offset:0 sc1
    buffer_store_dwordx4 v[68:71], v12, s[4:7], s24 offen offset:512 sc1
L_g11_end:
    s_waitcnt vmcnt(0)
    s_barrier
    s_cmp_eq_u32 s13, 0
    s_cbranch_scc0 L_np_102
    v_mov_b32 v2, 255
    s_mov_b64 exec, 1
    buffer_store_dword v2, off, s[4:7], s30 sc1
    s_mov_b64 exec, -1
            L_np_102:
L_g1_done:
    s_lshl_b32 s17, s3, 2
    s_add_u32 s17, s17, 160
    s_waitcnt vmcnt(0) lgkmcnt(0)
    s_barrier
    v_mov_b32 v6, 163776
    s_cmp_eq_u32 s13, 0
    s_cbranch_scc0 L_clm_103
    s_mov_b64 exec, 1
    v_mov_b32 v2, 1
    buffer_atomic_add v2, off, s[8:11], s17 offset:0 sc0 sc1
    buffer_load_dwordx2 v[4:5], off, s[8:11], 0 offset:128 sc1
    s_waitcnt vmcnt(0)
    ds_write_b128 v6, v[2:5]
    s_waitcnt lgkmcnt(0)
    s_mov_b64 exec, -1
        L_clm_103:
    s_barrier
    ds_read_b128 v[2:5], v6
    s_waitcnt lgkmcnt(0)
    v_readfirstlane_b32 s29, v2
    v_readfirstlane_b32 s14, v4
    v_readfirstlane_b32 s15, v5
    s_cmp_lt_u32 s29, 14
    s_cbranch_scc0 L_next
    s_cmp_eq_u32 s14, 32
    s_cbranch_scc0 L_next
    s_waitcnt vmcnt(0) lgkmcnt(0)
    s_barrier
    v_mov_b32 v6, 163776
    s_cmp_eq_u32 s13, 0
    s_cbranch_scc0 L_clm_104
    s_mov_b64 exec, 1
    v_mov_b32 v2, 1
    buffer_atomic_add v2, off, s[8:11], 0 offset:76 sc0 sc1
    s_waitcnt vmcnt(0)
    ds_write_b128 v6, v[2:5]
    s_waitcnt lgkmcnt(0)
    s_mov_b64 exec, -1
        L_clm_104:
    s_barrier
    ds_read_b128 v[2:5], v6
    s_waitcnt lgkmcnt(0)
    v_readfirstlane_b32 s16, v2
    s_cmp_lt_u32 s16, 96
    s_cbranch_scc0 L_next
    s_mov_b32 s59, 1
    s_cmp_eq_u32 s13, 0
    s_cbranch_scc0 L_run4a
    s_lshl_b32 s17, s3, 2
    s_mov_b64 exec, 1
    v_mov_b32 v2, 1
    buffer_atomic_add v2, off, s[8:11], s17 offset:32 sc1
    s_mov_b64 exec, -1
    s_branch L_run4a
    L_chkslow:
    s_cmp_eq_u32 s14, 32
    s_cbranch_scc0 L_rescue
L_ph4:
    s_cmp_eq_u32 s13, 0
    s_cbranch_scc0 L_wfd_106
    s_mov_b32 s21, 0
        L_wf_105:
    buffer_load_dword v2, off, s[8:11], 0 offset:8 sc1
    s_add_u32 s21, s21, 1
    s_cmp_gt_u32 s21, 3000000
    s_cbranch_scc1 L_fail
    s_waitcnt vmcnt(0)
    v_cmp_gt_u32 vcc, 1, v2
    s_cbranch_vccz L_wfd_106
    s_sleep 2
    s_branch L_wf_105
        L_wfd_106:
    v_lshlrev_b32 v4, 2, v0
    v_cmp_gt_u32 vcc, 8, v0
    v_mov_b32 v5, 1073741824
    s_nop 0
    v_cndmask_b32 v4, v5, v4, vcc
    buffer_load_dword v2, v4, s[8:11], 0 offen offset:32 sc1
    s_waitcnt vmcnt(0)
    v_cmp_eq_u32 vcc, 32, v2
    s_nop 1
    v_mov_b32 v2, vcc_lo
    v_mov_b32 v3, 163776
    s_cmp_eq_u32 s13, 0
    s_cbranch_scc0 L_nb
    ds_write_b32 v3, v2
    s_waitcnt lgkmcnt(0)
    L_nb:
    s_barrier
    ds_read_b32 v2, v3
    s_waitcnt lgkmcnt(0)
    v_readfirstlane_b32 s15, v2
    s_cmp_eq_u32 s15, 0xfe
    s_cbranch_scc0 L_ph_4a
    s_cmp_eq_u32 s3, 0
    s_cbranch_scc1 L_ph_4a
    s_lshl_b32 s17, s3, 2
    s_add_u32 s17, s17, 96
    s_waitcnt vmcnt(0) lgkmcnt(0)
    s_barrier
    v_mov_b32 v6, 163776
    s_cmp_eq_u32 s13, 0
    s_cbranch_scc0 L_clm_107
    s_mov_b64 exec, 1
    v_mov_b32 v2, 1
    buffer_atomic_add v2, off, s[8:11], s17 offset:0 sc0 sc1
    s_waitcnt vmcnt(0)
    ds_write_b128 v6, v[2:5]
    s_waitcnt lgkmcnt(0)
    s_mov_b64 exec, -1
        L_clm_107:
    s_barrier
    ds_read_b128 v[2:5], v6
    s_waitcnt lgkmcnt(0)
    v_readfirstlane_b32 s29, v2
    s_sub_u32 s22, s3, 1
    s_cmp_lt_u32 s29, 18
    s_cselect_b32 s58, 1, 0
    s_cbranch_scc1 L_do4b
    s_branch L_ph_4a
    L_left:
    s_barrier
    v_mov_b32 v3, 163776
    s_cmp_eq_u32 s13, 0
    s_cbranch_scc0 L_left2
    v_and_b32 v4, 15, v0
    v_lshlrev_b32 v4, 2, v4
    buffer_load_dword v2, v4, s[8:11], 0 offen offset:64 sc1
    v_cmp_eq_u32 vcc, 0, v4
    v_mov_b32 v5, 0
    v_mov_b32 v6, 468
    v_cndmask_b32 v5, v5, v6, vcc
    v_cmp_eq_u32 vcc, 12, v4
    v_mov_b32 v6, 96
    v_mov_b32 v7, 18
    v_cndmask_b32 v5, v5, v6, vcc
    v_cmp_lt_u32 vcc, 32, v4
    s_nop 1
    v_cndmask_b32 v5, v5, v7, vcc
    s_waitcnt vmcnt(0)
    v_cmp_lt_u32 vcc, v2, v5
    s_nop 1
    v_mov_b32 v2, vcc_lo
    ds_write_b32 v3, v2
    s_waitcnt lgkmcnt(0)
    L_left2:
    s_barrier
    ds_read_b32 v2, v3
    s_waitcnt lgkmcnt(0)
    v_readfirstlane_b32 s17, v2
    s_cmp_eq_u32 s17, 0
    s_cbranch_scc1 L_alldone
    s_bitcmp1_b32 s17, 0
    s_cbranch_scc1 L_next
L_ph_4a:
    s_waitcnt vmcnt(0) lgkmcnt(0)
    s_barrier
    v_mov_b32 v6, 163776
    s_cmp_eq_u32 s13, 0
    s_cbranch_scc0 L_clm_108
    s_mov_b64 exec, 1
    v_mov_b32 v2, 1
    buffer_atomic_add v2, off, s[8:11], 0 offset:76 sc0 sc1
    s_waitcnt vmcnt(0)
    ds_write_b128 v6, v[2:5]
    s_waitcnt lgkmcnt(0)
    s_mov_b64 exec, -1
        L_clm_108:
    s_barrier
    ds_read_b128 v[2:5], v6
    s_waitcnt lgkmcnt(0)
    v_readfirstlane_b32 s16, v2
    s_cmp_ge_u32 s16, 96
    s_cbranch_scc1 L_steal
L_run4a:
    s_load_dwordx2 s[64:65], s[0:1], 40
    s_waitcnt lgkmcnt(0)
    s_and_b32 s65, s65, 0xffff
    s_mov_b32 s66, 4718592
    s_mov_b32 s67, 0x20000
    s_and_b32 s27, s16, 31
    s_lshr_b32 s22, s16, 5
    s_lshl_b32 s17, s27, 8
    v_and_b32 v1, 63, v0
    v_lshrrev_b32 v9, 4, v1
    v_and_b32 v10, 15, v1
    v_lshlrev_b32 v11, 2, v9
    v_xor_b32 v10, v10, v11
    v_mul_u32_u24 v9, 8192, v9
    v_lshl_add_u32 v9, v10, 4, v9
    s_mul_i32 s18, s13, 1179648
    s_add_u32 s17, s17, s18
    s_mul_i32 s18, s13, 36864
    s_mov_b32 m0, s18
    s_nop 0
    buffer_load_dwordx4 v9, s[64:67], s17 offen lds
    s_add_u32 m0, m0, 1024
    s_add_u32 s17, s17, 32768
    buffer_load_dwordx4 v9, s[64:67], s17 offen lds
    s_add_u32 m0, m0, 1024
    s_add_u32 s17, s17, 32768
    buffer_load_dwordx4 v9, s[64:67], s17 offen lds
    s_add_u32 m0, m0, 1024
    s_add_u32 s17, s17, 32768
    buffer_load_dwordx4 v9, s[64:67], s17 offen lds
    s_add_u32 m0, m0, 1024
    s_add_u32 s17, s17, 32768
    buffer_load_dwordx4 v9, s[64:67], s17 offen lds
    s_add_u32 m0, m0, 1024
    s_add_u32 s17, s17, 32768
    buffer_load_dwordx4 v9, s[64:67], s17 offen lds
    s_add_u32 m0, m0, 1024
    s_add_u32 s17, s17, 32768
    buffer_load_dwordx4 v9, s[64:67], s17 offen lds
    s_add_u32 m0, m0, 1024
    s_add_u32 s17, s17, 32768
    buffer_load_dwordx4 v9, s[64:67], s17 offen lds
    s_add_u32 m0, m0, 1024
    s_add_u32 s17, s17, 32768
    buffer_load_dwordx4 v9, s[64:67], s17 offen lds
    s_add_u32 m0, m0, 1024
    s_add_u32 s17, s17, 32768
    buffer_load_dwordx4 v9, s[64:67], s17 offen lds
    s_add_u32 m0, m0, 1024
    s_add_u32 s17, s17, 32768
    buffer_load_dwordx4 v9, s[64:67], s17 offen lds
    s_add_u32 m0, m0, 1024
    s_add_u32 s17, s17, 32768
    buffer_load_dwordx4 v9, s[64:67], s17 offen lds
    s_add_u32 m0, m0, 1024
    s_add_u32 s17, s17, 32768
    buffer_load_dwordx4 v9, s[64:67], s17 offen lds
    s_add_u32 m0, m0, 1024
    s_add_u32 s17, s17, 32768
    buffer_load_dwordx4 v9, s[64:67], s17 offen lds
    s_add_u32 m0, m0, 1024
    s_add_u32 s17, s17, 32768
    buffer_load_dwordx4 v9, s[64:67], s17 offen lds
    s_add_u32 m0, m0, 1024
    s_add_u32 s17, s17, 32768
    buffer_load_dwordx4 v9, s[64:67], s17 offen lds
    s_add_u32 m0, m0, 1024
    s_add_u32 s17, s17, 32768
    buffer_load_dwordx4 v9, s[64:67], s17 offen lds
    s_add_u32 m0, m0, 1024
    s_add_u32 s17, s17, 32768
    buffer_load_dwordx4 v9, s[64:67], s17 offen lds
    s_add_u32 m0, m0, 1024
    s_add_u32 s17, s17, 32768
    buffer_load_dwordx4 v9, s[64:67], s17 offen lds
    s_add_u32 m0, m0, 1024
    s_add_u32 s17, s17, 32768
    buffer_load_dwordx4 v9, s[64:67], s17 offen lds
    s_add_u32 m0, m0, 1024
    s_add_u32 s17, s17, 32768
    buffer_load_dwordx4 v9, s[64:67], s17 offen lds
    s_add_u32 m0, m0, 1024
    s_add_u32 s17, s17, 32768
    buffer_load_dwordx4 v9, s[64:67], s17 offen lds
    s_add_u32 m0, m0, 1024
    s_add_u32 s17, s17, 32768
    buffer_load_dwordx4 v9, s[64:67], s17 offen lds
    s_add_u32 m0, m0, 1024
    s_add_u32 s17, s17, 32768
    buffer_load_dwordx4 v9, s[64:67], s17 offen lds
    s_add_u32 m0, m0, 1024
    s_add_u32 s17, s17, 32768
    buffer_load_dwordx4 v9, s[64:67], s17 offen lds
    s_add_u32 m0, m0, 1024
    s_add_u32 s17, s17, 32768
    buffer_load_dwordx4 v9, s[64:67], s17 offen lds
    s_add_u32 m0, m0, 1024
    s_add_u32 s17, s17, 32768
    buffer_load_dwordx4 v9, s[64:67], s17 offen lds
    s_add_u32 m0, m0, 1024
    s_add_u32 s17, s17, 32768
    buffer_load_dwordx4 v9, s[64:67], s17 offen lds
    s_add_u32 m0, m0, 1024
    s_add_u32 s17, s17, 32768
    buffer_load_dwordx4 v9, s[64:67], s17 offen lds
    s_add_u32 m0, m0, 1024
    s_add_u32 s17, s17, 32768
    buffer_load_dwordx4 v9, s[64:67], s17 offen lds
    s_add_u32 m0, m0, 1024
    s_add_u32 s17, s17, 32768
    buffer_load_dwordx4 v9, s[64:67], s17 offen lds
    s_add_u32 m0, m0, 1024
    s_add_u32 s17, s17, 32768
    buffer_load_dwordx4 v9, s[64:67], s17 offen lds
    s_add_u32 m0, m0, 1024
    s_add_u32 s17, s17, 32768
    buffer_load_dwordx4 v9, s[64:67], s17 offen lds
    s_add_u32 m0, m0, 1024
    s_add_u32 s17, s17, 32768
    buffer_load_dwordx4 v9, s[64:67], s17 offen lds
    s_add_u32 m0, m0, 1024
    s_add_u32 s17, s17, 32768
    buffer_load_dwordx4 v9, s[64:67], s17 offen lds
    s_add_u32 m0, m0, 1024
    s_add_u32 s17, s17, 32768
    buffer_load_dwordx4 v9, s[64:67], s17 offen lds
    v_lshrrev_b32 v10, 5, v1
    v_bfe_u32 v11, v1, 2, 2
    v_lshl_add_u32 v10, v10, 3, v11
    v_lshlrev_b32 v10, 8, v10
    v_xor_b32 v11, s13, v11
    v_lshl_add_u32 v10, v11, 6, v10
    v_bfe_u32 v11, v1, 4, 1
    v_lshl_add_u32 v10, v11, 5, v10
    v_and_b32 v11, 3, v1
    v_lshl_add_u32 v10, v11, 3, v10
    v_add_u32 v11, 65536, v10
    v_add_u32 v12, 131072, v10
    s_waitcnt vmcnt(0)
    s_barrier
    ds_read_b64_tr_b16 a[0:1], v10 offset:0
    ds_read_b64_tr_b16 a[2:3], v10 offset:1024
    ds_read_b64_tr_b16 a[4:5], v10 offset:4096
    ds_read_b64_tr_b16 a[6:7], v10 offset:5120
    ds_read_b64_tr_b16 a[8:9], v10 offset:8192
    ds_read_b64_tr_b16 a[10:11], v10 offset:9216
    ds_read_b64_tr_b16 a[12:13], v10 offset:12288
    ds_read_b64_tr_b16 a[14:15], v10 offset:13312
    ds_read_b64_tr_b16 a[16:17], v10 offset:16384
    ds_read_b64_tr_b16 a[18:19], v10 offset:17408
    ds_read_b64_tr_b16 a[20:21], v10 offset:20480
    ds_read_b64_tr_b16 a[22:23], v10 offset:21504
    s_waitcnt lgkmcnt(0)
    ds_read_b64_tr_b16 a[24:25], v10 offset:24576
    ds_read_b64_tr_b16 a[26:27], v10 offset:25600
    ds_read_b64_tr_b16 a[28:29], v10 offset:28672
    ds_read_b64_tr_b16 a[30:31], v10 offset:29696
    ds_read_b64_tr_b16 a[32:33], v10 offset:32768
    ds_read_b64_tr_b16 a[34:35], v10 offset:33792
    ds_read_b64_tr_b16 a[36:37], v10 offset:36864
    ds_read_b64_tr_b16 a[38:39], v10 offset:37888
    ds_read_b64_tr_b16 a[40:41], v10 offset:40960
    ds_read_b64_tr_b16 a[42:43], v10 offset:41984
    ds_read_b64_tr_b16 a[44:45], v10 offset:45056
    ds_read_b64_tr_b16 a[46:47], v10 offset:46080
    s_waitcnt lgkmcnt(0)
    ds_read_b64_tr_b16 a[48:49], v10 offset:49152
    ds_read_b64_tr_b16 a[50:51], v10 offset:50176
    ds_read_b64_tr_b16 a[52:53], v10 offset:53248
    ds_read_b64_tr_b16 a[54:55], v10 offset:54272
    ds_read_b64_tr_b16 a[56:57], v10 offset:57344
    ds_read_b64_tr_b16 a[58:59], v10 offset:58368
    ds_read_b64_tr_b16 a[60:61], v10 offset:61440
    ds_read_b64_tr_b16 a[62:63], v10 offset:62464
    ds_read_b64_tr_b16 a[64:65], v11 offset:0
    ds_read_b64_tr_b16 a[66:67], v11 offset:1024
    ds_read_b64_tr_b16 a[68:69], v11 offset:4096
    ds_read_b64_tr_b16 a[70:71], v11 offset:5120
    s_waitcnt lgkmcnt(0)
    ds_read_b64_tr_b16 a[72:73], v11 offset:8192
    ds_read_b64_tr_b16 a[74:75], v11 offset:9216
    ds_read_b64_tr_b16 a[76:77], v11 offset:12288
    ds_read_b64_tr_b16 a[78:79], v11 offset:13312
    ds_read_b64_tr_b16 a[80:81], v11 offset:16384
    ds_read_b64_tr_b16 a[82:83], v11 offset:17408
    ds_read_b64_tr_b16 a[84:85], v11 offset:20480
    ds_read_b64_tr_b16 a[86:87], v11 offset:21504
    ds_read_b64_tr_b16 a[88:89], v11 offset:24576
    ds_read_b64_tr_b16 a[90:91], v11 offset:25600
    ds_read_b64_tr_b16 a[92:93], v11 offset:28672
    ds_read_b64_tr_b16 a[94:95], v11 offset:29696
    s_waitcnt lgkmcnt(0)
    ds_read_b64_tr_b16 a[96:97], v11 offset:32768
    ds_read_b64_tr_b16 a[98:99], v11 offset:33792
    ds_read_b64_tr_b16 a[100:101], v11 offset:36864
    ds_read_b64_tr_b16 a[102:103], v11 offset:37888
    ds_read_b64_tr_b16 a[104:105], v11 offset:40960
    ds_read_b64_tr_b16 a[106:107], v11 offset:41984
    ds_read_b64_tr_b16 a[108:109], v11 offset:45056
    ds_read_b64_tr_b16 a[110:111], v11 offset:46080
    ds_read_b64_tr_b16 a[112:113], v11 offset:49152
    ds_read_b64_tr_b16 a[114:115], v11 offset:50176
    ds_read_b64_tr_b16 a[116:117], v11 offset:53248
    ds_read_b64_tr_b16 a[118:119], v11 offset:54272
    s_waitcnt lgkmcnt(0)
    ds_read_b64_tr_b16 a[120:121], v11 offset:57344
    ds_read_b64_tr_b16 a[122:123], v11 offset:58368
    ds_read_b64_tr_b16 a[124:125], v11 offset:61440
    ds_read_b64_tr_b16 a[126:127], v11 offset:62464
    ds_read_b64_tr_b16 a[128:129], v12 offset:0
    ds_read_b64_tr_b16 a[130:131], v12 offset:1024
    ds_read_b64_tr_b16 a[132:133], v12 offset:4096
    ds_read_b64_tr_b16 a[134:135], v12 offset:5120
    ds_read_b64_tr_b16 a[136:137], v12 offset:8192
    ds_read_b64_tr_b16 a[138:139], v12 offset:9216
    ds_read_b64_tr_b16 a[140:141], v12 offset:12288
    ds_read_b64_tr_b16 a[142:143], v12 offset:13312
    s_waitcnt lgkmcnt(0)
    s_barrier
    s_load_dwordx2 s[68:69], s[0:1], 0
    s_waitcnt lgkmcnt(0)
    s_and_b32 s69, s69, 0xffff
    s_mov_b32 s70, 2359296
    s_mov_b32 s71, 0x20000
    v_and_b32 v1, 63, v0
    v_lshrrev_b32 v9, 3, v1
    v_lshrrev_b32 v10, 1, v9
    s_and_b32 s17, s13, 1
    s_lshl_b32 s17, s17, 2
    v_add_u32 v10, s17, v10
    v_and_b32 v11, 7, v1
    v_xor_b32 v10, v10, v11
    v_mul_u32_u24 v8, 1152, v9
    v_lshl_add_u32 v8, v10, 4, v8
    s_mul_i32 s17, s13, 9216
    v_add_u32 v8, s17, v8
    v_and_b32 v9, 31, v1
    v_lshrrev_b32 v10, 3, v9
    v_mul_u32_u24 v10, 9216, v10
    v_and_b32 v11, 7, v9
    v_lshl_add_u32 v10, v11, 7, v10
    v_bfe_u32 v11, v9, 1, 3
    v_lshrrev_b32 v12, 5, v1
    v_xor_b32 v11, v11, v12
    v_xor_b32 v12, 0, v11
    v_lshl_add_u32 v4, v12, 4, v10
    v_add_u32 v248, 65536, v4
    v_xor_b32 v12, 2, v11
    v_lshl_add_u32 v5, v12, 4, v10
    v_add_u32 v249, 65536, v5
    v_xor_b32 v12, 4, v11
    v_lshl_add_u32 v6, v12, 4, v10
    v_add_u32 v250, 65536, v6
    v_xor_b32 v12, 6, v11
    v_lshl_add_u32 v7, v12, 4, v10
    v_add_u32 v251, 65536, v7
    v_and_b32 v1, 63, v0
    v_bfe_u32 v9, v1, 4, 1
    v_lshlrev_b32 v9, 10, v9
    v_lshrrev_b32 v10, 5, v1
    v_lshl_add_u32 v9, v10, 8, v9
    v_and_b32 v10, 15, v1
    v_lshl_add_u32 v12, v10, 4, v9
    s_mov_b32 s30, 17408
    s_cmp_eq_u32 s13, 0
    s_cbranch_scc0 L_wfd_110
    s_mov_b32 s21, 0
        L_wf_109:
    buffer_load_dword v2, off, s[4:7], s30 offset:0 sc1
    s_add_u32 s21, s21, 1
    s_cmp_gt_u32 s21, 3000000
    s_cbranch_scc1 L_fail
    s_waitcnt vmcnt(0)
    v_cmp_gt_u32 vcc, 84, v2
    s_cbranch_vccz L_wfd_110
    s_sleep 2
    s_branch L_wf_109
        L_wfd_110:
    s_barrier
    s_lshl_b32 s30, s27, 7
    s_add_u32 s30, s30, 0
    s_mov_b32 s38, 255
    v_mov_b32 v145, 163744
    s_cmp_eq_u32 s13, 0
    s_cbranch_scc0 L_wkd_112
    s_mov_b32 s21, 0
    v_mbcnt_lo_u32_b32 v146, -1, 0
    v_min_u32 v146, 3, v146
    v_lshlrev_b32 v146, 2, v146
        L_wk_111:
    buffer_load_dword v144, v146, s[4:7], s30 offen sc1
    s_add_u32 s21, s21, 1
    s_cmp_gt_u32 s21, 3000000
    s_cbranch_scc1 L_fail
    s_waitcnt vmcnt(0)
    v_cmp_gt_u32 vcc, s38, v144
    s_cbranch_vccnz L_wk_111
    s_nop 0
    v_min_u32_dpp v144, v144, v144 quad_perm:[1,0,3,2] row_mask:0xf bank_mask:0xf
    s_nop 1
    v_min_u32_dpp v144, v144, v144 quad_perm:[2,3,0,1] row_mask:0xf bank_mask:0xf
    s_nop 1
    v_min_u32_dpp v144, v144, v144 row_half_mirror row_mask:0xf bank_mask:0xf
    s_mov_b64 exec, 1
    ds_write_b32 v145, v144
    s_mov_b64 exec, -1
    s_waitcnt lgkmcnt(0)
        L_wkd_112:
    s_barrier
    ds_read_b32 v144, v145
    s_waitcnt lgkmcnt(0)
    v_readfirstlane_b32 s39, v144
    s_lshl_b32 s31, s27, 7
    s_add_u32 s31, s31, 4096
    v_and_b32 v1, 63, v0
    v_and_b32 v9, 31, v1
    v_lshrrev_b32 v10, 5, v1
    v_lshlrev_b32 v13, 4, v9
    v_lshl_add_u32 v13, v10, 7, v13
    v_cmp_gt_u32 vcc, 8, v9
    v_mov_b32 v11, 1073741824
    v_and_b32 v14, 15, v1
    v_cndmask_b32 v13, v11, v13, vcc
    v_lshlrev_b32 v14, 6, v14
    v_lshl_add_u32 v14, v10, 5, v14
    v_bfe_u32 v11, v1, 4, 1
    v_lshl_add_u32 v14, v11, 3, v14
    v_lshlrev_b32 v15, 4, v1
    v_lshlrev_b32 v3, 3, v9
    s_mul_i32 s17, s13, 5120
    s_add_u32 s17, s17, 110592
    v_add_u32 v140, s17, v15
    v_add_u32 v141, 110592, v15
    s_mov_b32 s32, 0x3e0293ee
    s_mov_b32 s33, 0xff800000
    v_lshlrev_b32 v10, 2, v10
    v_add_u32 v11, 0, v10
    v_cmp_le_u32 s[72:73], v11, v9
    v_add_u32 v11, 1, v10
    v_cmp_le_u32 s[74:75], v11, v9
    v_add_u32 v11, 2, v10
    v_cmp_le_u32 s[76:77], v11, v9
    v_add_u32 v11, 3, v10
    v_cmp_le_u32 s[78:79], v11, v9
    v_add_u32 v11, 8, v10
    v_cmp_le_u32 s[80:81], v11, v9
    v_add_u32 v11, 9, v10
    v_cmp_le_u32 s[82:83], v11, v9
    v_add_u32 v11, 10, v10
    v_cmp_le_u32 s[84:85], v11, v9
    v_add_u32 v11, 11, v10
    v_cmp_le_u32 s[86:87], v11, v9
    v_add_u32 v11, 16, v10
    v_cmp_le_u32 s[88:89], v11, v9
    v_add_u32 v11, 17, v10
    v_cmp_le_u32 s[90:91], v11, v9
    v_add_u32 v11, 18, v10
    v_cmp_le_u32 s[92:93], v11, v9
    v_add_u32 v11, 19, v10
    v_cmp_le_u32 s[94:95], v11, v9
    v_add_u32 v11, 24, v10
    v_cmp_le_u32 s[96:97], v11, v9
    v_add_u32 v11, 25, v10
    v_cmp_le_u32 s[98:99], v11, v9
    v_add_u32 v11, 26, v10
    v_cmp_le_u32 s[44:45], v11, v9
    v_add_u32 v11, 27, v10
    v_cmp_le_u32 s[46:47], v11, v9
    s_mov_b32 s39, 0
    s_mov_b32 s40, 0
    s_mov_b32 s25, 0
    s_mul_i32 s17, s13, 9216
    s_add_u32 m0, s17, s25
    s_mul_i32 s23, s22, 36864
    buffer_load_dwordx4 v8, s[68:71], s23 offen lds
    s_add_u32 m0, m0, 1024
    s_add_u32 s23, s23, 128
    buffer_load_dwordx4 v8, s[68:71], s23 offen lds
    s_add_u32 m0, m0, 1024
    s_add_u32 s23, s23, 128
    buffer_load_dwordx4 v8, s[68:71], s23 offen lds
    s_add_u32 m0, m0, 1024
    s_add_u32 s23, s23, 128
    buffer_load_dwordx4 v8, s[68:71], s23 offen lds
    s_add_u32 m0, m0, 1024
    s_add_u32 s23, s23, 128
    buffer_load_dwordx4 v8, s[68:71], s23 offen lds
    s_add_u32 m0, m0, 1024
    s_add_u32 s23, s23, 128
    buffer_load_dwordx4 v8, s[68:71], s23 offen lds
    s_add_u32 m0, m0, 1024
    s_add_u32 s23, s23, 128
    buffer_load_dwordx4 v8, s[68:71], s23 offen lds
    s_add_u32 m0, m0, 1024
    s_add_u32 s23, s23, 128
    buffer_load_dwordx4 v8, s[68:71], s23 offen lds
    s_add_u32 m0, m0, 1024
    s_add_u32 s23, s23, 128
    buffer_load_dwordx4 v8, s[68:71], s23 offen lds
    s_add_u32 s28, s22, 3
    s_min_u32 s28, s28, 63
    s_mov_b32 s25, 36864
    s_mul_i32 s17, s13, 9216
    s_add_u32 m0, s17, s25
    s_mul_i32 s23, s28, 36864
    buffer_load_dwordx4 v8, s[68:71], s23 offen lds
    s_add_u32 m0, m0, 1024
    s_add_u32 s23, s23, 128
    buffer_load_dwordx4 v8, s[68:71], s23 offen lds
    s_add_u32 m0, m0, 1024
    s_add_u32 s23, s23, 128
    buffer_load_dwordx4 v8, s[68:71], s23 offen lds
    s_add_u32 m0, m0, 1024
    s_add_u32 s23, s23, 128
    buffer_load_dwordx4 v8, s[68:71], s23 offen lds
    s_add_u32 m0, m0, 1024
    s_add_u32 s23, s23, 128
    buffer_load_dwordx4 v8, s[68:71], s23 offen lds
    s_add_u32 m0, m0, 1024
    s_add_u32 s23, s23, 128
    buffer_load_dwordx4 v8, s[68:71], s23 offen lds
    s_add_u32 m0, m0, 1024
    s_add_u32 s23, s23, 128
    buffer_load_dwordx4 v8, s[68:71], s23 offen lds
    s_add_u32 m0, m0, 1024
    s_add_u32 s23, s23, 128
    buffer_load_dwordx4 v8, s[68:71], s23 offen lds
    s_add_u32 m0, m0, 1024
    s_add_u32 s23, s23, 128
    buffer_load_dwordx4 v8, s[68:71], s23 offen lds
    s_mov_b32 s26, 0
    s_waitcnt vmcnt(9)
L_b4a_lp:
    s_barrier
    s_add_u32 s28, s22, 6
    s_min_u32 s28, s28, 63
    s_mov_b32 s25, 73728
    s_lshl_b32 s34, s22, 5
    s_add_u32 s34, s34, s27
    s_lshl_b32 s35, s34, 14
    s_lshl_b32 s17, s13, 11
    s_add_u32 s35, s35, s17
    s_add_u32 s35, s35, 16777216
    s_add_u32 s36, s35, 8192
    s_lshl_b32 s37, s22, 8
    s_add_u32 s37, s37, 262148
    s_lshl_b32 s41, s34, 11
    s_lshl_b32 s17, s13, 9
    s_add_u32 s41, s41, s17
    s_lshl_b32 s42, s41, 1
    s_add_u32 s41, s41, 50331648
    s_add_u32 s42, s42, 54525952
    s_add_u32 s38, s22, 1
    s_cmp_ge_u32 s39, s38
    s_cbranch_scc0 L_ne_113
    buffer_load_dwordx4 v[80:83], v13, s[4:7], s41 offen sc1
    buffer_load_dwordx4 v[84:87], v13, s[4:7], s41 offen offset:256 sc1
    buffer_load_dwordx2 v[88:89], v14, s[4:7], s42 offen sc1
    buffer_load_dwordx2 v[90:91], v14, s[4:7], s42 offen offset:16 sc1
            L_ne_113:
    buffer_load_dwordx4 v[64:67], v12, s[4:7], s35 offen
    buffer_load_dwordx4 v[68:71], v12, s[4:7], s35 offen offset:512
    buffer_load_dwordx4 v[72:75], v12, s[4:7], s36 offen
    buffer_load_dwordx4 v[76:79], v12, s[4:7], s36 offen offset:512
    buffer_load_dword v142, v3, s[4:7], s37 offen sc1
    ds_read_b128 v[16:19], v4 offset:0
    s_mul_i32 s17, s13, 9216
    s_add_u32 m0, s17, s25
    s_mul_i32 s23, s28, 36864
    ds_read_b128 v[20:23], v5 offset:0
    ds_read_b128 v[24:27], v6 offset:0
    ds_read_b128 v[28:31], v7 offset:0
    ds_read_b128 v[32:35], v4 offset:1024
    ds_read_b128 v[36:39], v5 offset:1024
    ds_read_b128 v[40:43], v6 offset:1024
    ds_read_b128 v[44:47], v7 offset:1024
    s_waitcnt lgkmcnt(7)
    v_mfma_f32_32x32x16_bf16 v[48:63], a[0:3], v[16:19], 0
    ds_read_b128 v[16:19], v4 offset:2048
    s_waitcnt lgkmcnt(7)
    v_mfma_f32_32x32x16_bf16 v[48:63], a[4:7], v[20:23], v[48:63]
    ds_read_b128 v[20:23], v5 offset:2048
    buffer_load_dwordx4 v8, s[68:71], s23 offen lds
    s_add_u32 m0, m0, 1024
    s_add_u32 s23, s23, 128
    s_waitcnt lgkmcnt(7)
    v_mfma_f32_32x32x16_bf16 v[48:63], a[8:11], v[24:27], v[48:63]
    ds_read_b128 v[24:27], v6 offset:2048
    s_waitcnt lgkmcnt(7)
    v_mfma_f32_32x32x16_bf16 v[48:63], a[12:15], v[28:31], v[48:63]
    ds_read_b128 v[28:31], v7 offset:2048
    s_waitcnt lgkmcnt(7)
    v_mfma_f32_32x32x16_bf16 v[48:63], a[16:19], v[32:35], v[48:63]
    ds_read_b128 v[32:35], v4 offset:3072
    buffer_load_dwordx4 v8, s[68:71], s23 offen lds
    s_add_u32 m0, m0, 1024
    s_add_u32 s23, s23, 128
    s_waitcnt lgkmcnt(7)
    v_mfma_f32_32x32x16_bf16 v[48:63], a[20:23], v[36:39], v[48:63]
    ds_read_b128 v[36:39], v5 offset:3072
    s_waitcnt lgkmcnt(7)
    v_mfma_f32_32x32x16_bf16 v[48:63], a[24:27], v[40:43], v[48:63]
    ds_read_b128 v[40:43], v6 offset:3072
    s_waitcnt lgkmcnt(7)
    v_mfma_f32_32x32x16_bf16 v[48:63], a[28:31], v[44:47], v[48:63]
    ds_read_b128 v[44:47], v7 offset:3072
    buffer_load_dwordx4 v8, s[68:71], s23 offen lds
    s_add_u32 m0, m0, 1024
    s_add_u32 s23, s23, 128
    s_waitcnt lgkmcnt(7)
    v_mfma_f32_32x32x16_bf16 v[48:63], a[32:35], v[16:19], v[48:63]
    ds_read_b128 v[16:19], v4 offset:4096
    s_waitcnt lgkmcnt(7)
    v_mfma_f32_32x32x16_bf16 v[48:63], a[36:39], v[20:23], v[48:63]
    ds_read_b128 v[20:23], v5 offset:4096
    s_waitcnt lgkmcnt(7)
    v_mfma_f32_32x32x16_bf16 v[48:63], a[40:43], v[24:27], v[48:63]
    ds_read_b128 v[24:27], v6 offset:4096
    buffer_load_dwordx4 v8, s[68:71], s23 offen lds
    s_add_u32 m0, m0, 1024
    s_add_u32 s23, s23, 128
    s_waitcnt lgkmcnt(7)
    v_mfma_f32_32x32x16_bf16 v[48:63], a[44:47], v[28:31], v[48:63]
    ds_read_b128 v[28:31], v7 offset:4096
    s_waitcnt lgkmcnt(7)
    v_mfma_f32_32x32x16_bf16 v[48:63], a[48:51], v[32:35], v[48:63]
    ds_read_b128 v[32:35], v4 offset:5120
    s_waitcnt lgkmcnt(7)
    v_mfma_f32_32x32x16_bf16 v[48:63], a[52:55], v[36:39], v[48:63]
    ds_read_b128 v[36:39], v5 offset:5120
    buffer_load_dwordx4 v8, s[68:71], s23 offen lds
    s_add_u32 m0, m0, 1024
    s_add_u32 s23, s23, 128
    s_waitcnt lgkmcnt(7)
    v_mfma_f32_32x32x16_bf16 v[48:63], a[56:59], v[40:43], v[48:63]
    ds_read_b128 v[40:43], v6 offset:5120
    s_waitcnt lgkmcnt(7)
    v_mfma_f32_32x32x16_bf16 v[48:63], a[60:63], v[44:47], v[48:63]
    ds_read_b128 v[44:47], v7 offset:5120
    s_waitcnt lgkmcnt(7)
    v_mfma_f32_32x32x16_bf16 v[48:63], a[64:67], v[16:19], v[48:63]
    ds_read_b128 v[16:19], v4 offset:6144
    buffer_load_dwordx4 v8, s[68:71], s23 offen lds
    s_add_u32 m0, m0, 1024
    s_add_u32 s23, s23, 128
    s_waitcnt lgkmcnt(7)
    v_mfma_f32_32x32x16_bf16 v[48:63], a[68:71], v[20:23], v[48:63]
    ds_read_b128 v[20:23], v5 offset:6144
    s_waitcnt lgkmcnt(7)
    v_mfma_f32_32x32x16_bf16 v[48:63], a[72:75], v[24:27], v[48:63]
    ds_read_b128 v[24:27], v6 offset:6144
    s_waitcnt lgkmcnt(7)
    v_mfma_f32_32x32x16_bf16 v[48:63], a[76:79], v[28:31], v[48:63]
    buffer_load_dwordx4 v8, s[68:71], s23 offen lds
    s_add_u32 m0, m0, 1024
    s_add_u32 s23, s23, 128
    ds_read_b128 v[28:31], v7 offset:6144
    s_waitcnt lgkmcnt(7)
    v_mfma_f32_32x32x16_bf16 v[48:63], a[80:83], v[32:35], v[48:63]
    ds_read_b128 v[32:35], v4 offset:7168
    s_waitcnt lgkmcnt(7)
    v_mfma_f32_32x32x16_bf16 v[48:63], a[84:87], v[36:39], v[48:63]
    ds_read_b128 v[36:39], v5 offset:7168
    s_waitcnt lgkmcnt(7)
    v_mfma_f32_32x32x16_bf16 v[48:63], a[88:91], v[40:43], v[48:63]
    buffer_load_dwordx4 v8, s[68:71], s23 offen lds
    s_add_u32 m0, m0, 1024
    s_add_u32 s23, s23, 128
    ds_read_b128 v[40:43], v6 offset:7168
    s_waitcnt lgkmcnt(7)
    v_mfma_f32_32x32x16_bf16 v[48:63], a[92:95], v[44:47], v[48:63]
    ds_read_b128 v[44:47], v7 offset:7168
    s_waitcnt lgkmcnt(7)
    v_mfma_f32_32x32x16_bf16 v[48:63], a[96:99], v[16:19], v[48:63]
    ds_read_b128 v[16:19], v4 offset:8192
    s_waitcnt lgkmcnt(7)
    v_mfma_f32_32x32x16_bf16 v[48:63], a[100:103], v[20:23], v[48:63]
    buffer_load_dwordx4 v8, s[68:71], s23 offen lds
    ds_read_b128 v[20:23], v5 offset:8192
    s_waitcnt lgkmcnt(7)
    v_mfma_f32_32x32x16_bf16 v[48:63], a[104:107], v[24:27], v[48:63]
    ds_read_b128 v[24:27], v6 offset:8192
    s_waitcnt lgkmcnt(7)
    v_mfma_f32_32x32x16_bf16 v[48:63], a[108:111], v[28:31], v[48:63]
    ds_read_b128 v[28:31], v7 offset:8192
    s_waitcnt lgkmcnt(7)
    v_mfma_f32_32x32x16_bf16 v[48:63], a[112:115], v[32:35], v[48:63]
    s_waitcnt lgkmcnt(6)
    v_mfma_f32_32x32x16_bf16 v[48:63], a[116:119], v[36:39], v[48:63]
    s_waitcnt lgkmcnt(5)
    v_mfma_f32_32x32x16_bf16 v[48:63], a[120:123], v[40:43], v[48:63]
    s_waitcnt lgkmcnt(4)
    v_mfma_f32_32x32x16_bf16 v[48:63], a[124:127], v[44:47], v[48:63]
    s_waitcnt lgkmcnt(3)
    v_mfma_f32_32x32x16_bf16 v[48:63], a[128:131], v[16:19], v[48:63]
    s_waitcnt lgkmcnt(2)
    v_mfma_f32_32x32x16_bf16 v[48:63], a[132:135], v[20:23], v[48:63]
    s_waitcnt lgkmcnt(1)
    v_mfma_f32_32x32x16_bf16 v[48:63], a[136:139], v[24:27], v[48:63]
    s_waitcnt lgkmcnt(0)
    v_mfma_f32_32x32x16_bf16 v[48:63], a[140:143], v[28:31], v[48:63]
    s_cmp_eq_u32 s40, 0
    s_cbranch_scc1 L_ns_114
    s_waitcnt vmcnt(9)
    s_barrier
    s_cmp_eq_u32 s13, 0
    s_cbranch_scc0 L_sig_116
    s_mov_b64 exec, 1
    v_mov_b32 v2, 1
    buffer_atomic_add v2, off, s[4:7], s30 sc1
    s_mov_b64 exec, -1
        L_sig_116:
L_ns_114:
    s_nop 9
    v_cvt_pk_bf16_f32 v92, v48, v49
    v_cvt_pk_bf16_f32 v93, v50, v51
    v_cvt_pk_bf16_f32 v94, v56, v57
    v_cvt_pk_bf16_f32 v95, v58, v59
    v_cvt_pk_bf16_f32 v96, v52, v53
    v_cvt_pk_bf16_f32 v97, v54, v55
    v_cvt_pk_bf16_f32 v98, v60, v61
    v_cvt_pk_bf16_f32 v99, v62, v63
    s_waitcnt vmcnt(9)
    s_nop 0
    v_mfma_f32_32x32x16_bf16 v[100:115], v[64:67], v[92:95], 0
    v_mfma_f32_32x32x16_bf16 v[100:115], v[68:71], v[96:99], v[100:115]
    s_cmp_ge_u32 s39, s38
    s_cbranch_scc1 L_rd_115
    v_mov_b32 v143, 163760
    s_cmp_eq_u32 s13, 0
    s_cbranch_scc0 L_wvd_118
    s_mov_b32 s21, 0
        L_wv_117:
    buffer_load_dword v2, off, s[4:7], s31 sc1
    s_add_u32 s21, s21, 1
    s_cmp_gt_u32 s21, 3000000
    s_cbranch_scc1 L_fail
    s_waitcnt vmcnt(0)
    v_cmp_gt_u32 vcc, s38, v2
    s_cbranch_vccnz L_wv_117
    ds_write_b32 v143, v2
    s_waitcnt lgkmcnt(0)
        L_wvd_118:
    s_barrier
    ds_read_b32 v2, v143
    s_waitcnt lgkmcnt(0)
    v_readfirstlane_b32 s39, v2
    buffer_load_dwordx4 v[80:83], v13, s[4:7], s41 offen sc1
    buffer_load_dwordx4 v[84:87], v13, s[4:7], s41 offen offset:256 sc1
    buffer_load_dwordx2 v[88:89], v14, s[4:7], s42 offen sc1
    buffer_load_dwordx2 v[90:91], v14, s[4:7], s42 offen offset:16 sc1
    s_waitcnt vmcnt(0)
L_rd_115:
    s_nop 7
    s_nop 1
    ds_write_b128 v140, v[100:103] offset:0
    ds_write_b128 v140, v[104:107] offset:1024
    ds_write_b128 v140, v[108:111] offset:2048
    ds_write_b128 v140, v[112:115] offset:3072
    v_mfma_f32_32x32x16_bf16 v[116:131], v[80:83], v[92:95], 0
    v_mfma_f32_32x32x16_bf16 v[116:131], v[84:87], v[96:99], v[116:131]
    s_nop 7
    s_nop 3
    ds_write_b128 v140, v[116:119] offset:4096
    s_waitcnt lgkmcnt(0)
    s_barrier
    ds_read_b128 v[16:19], v141 offset:0
    ds_read_b128 v[20:23], v141 offset:1024
    ds_read_b128 v[24:27], v141 offset:2048
    ds_read_b128 v[28:31], v141 offset:3072
    ds_read_b128 v[32:35], v141 offset:4096
    ds_read_b128 v[144:147], v141 offset:5120
    ds_read_b128 v[148:151], v141 offset:6144
    ds_read_b128 v[152:155], v141 offset:7168
    ds_read_b128 v[156:159], v141 offset:8192
    ds_read_b128 v[160:163], v141 offset:9216
    ds_read_b128 v[164:167], v141 offset:10240
    ds_read_b128 v[168:171], v141 offset:11264
    ds_read_b128 v[172:175], v141 offset:12288
    ds_read_b128 v[176:179], v141 offset:13312
    ds_read_b128 v[180:183], v141 offset:14336
    ds_read_b128 v[184:187], v141 offset:15360
    ds_read_b128 v[188:191], v141 offset:16384
    ds_read_b128 v[192:195], v141 offset:17408
    ds_read_b128 v[196:199], v141 offset:18432
    ds_read_b128 v[200:203], v141 offset:19456
    s_waitcnt lgkmcnt(10)
    v_add_f32 v16, v16, v144
    v_add_f32 v17, v17, v145
    v_add_f32 v18, v18, v146
    v_add_f32 v19, v19, v147
    v_add_f32 v20, v20, v148
    v_add_f32 v21, v21, v149
    v_add_f32 v22, v22, v150
    v_add_f32 v23, v23, v151
    v_add_f32 v24, v24, v152
    v_add_f32 v25, v25, v153
    v_add_f32 v26, v26, v154
    v_add_f32 v27, v27, v155
    v_add_f32 v28, v28, v156
    v_add_f32 v29, v29, v157
    v_add_f32 v30, v30, v158
    v_add_f32 v31, v31, v159
    v_add_f32 v32, v32, v160
    v_add_f32 v33, v33, v161
    v_add_f32 v34, v34, v162
    v_add_f32 v35, v35, v163
    s_waitcnt lgkmcnt(5)
    v_add_f32 v16, v16, v164
    v_add_f32 v17, v17, v165
    v_add_f32 v18, v18, v166
    v_add_f32 v19, v19, v167
    v_add_f32 v20, v20, v168
    v_add_f32 v21, v21, v169
    v_add_f32 v22, v22, v170
    v_add_f32 v23, v23, v171
    v_add_f32 v24, v24, v172
    v_add_f32 v25, v25, v173
    v_add_f32 v26, v26, v174
    v_add_f32 v27, v27, v175
    v_add_f32 v28, v28, v176
    v_add_f32 v29, v29, v177
    v_add_f32 v30, v30, v178
    v_add_f32 v31, v31, v179
    v_add_f32 v32, v32, v180
    v_add_f32 v33, v33, v181
    v_add_f32 v34, v34, v182
    v_add_f32 v35, v35, v183
    s_waitcnt lgkmcnt(0)
    v_add_f32 v16, v16, v184
    v_add_f32 v17, v17, v185
    v_add_f32 v18, v18, v186
    v_add_f32 v19, v19, v187
    v_add_f32 v20, v20, v188
    v_add_f32 v21, v21, v189
    v_add_f32 v22, v22, v190
    v_add_f32 v23, v23, v191
    v_add_f32 v24, v24, v192
    v_add_f32 v25, v25, v193
    v_add_f32 v26, v26, v194
    v_add_f32 v27, v27, v195
    v_add_f32 v28, v28, v196
    v_add_f32 v29, v29, v197
    v_add_f32 v30, v30, v198
    v_add_f32 v31, v31, v199
    v_add_f32 v32, v32, v200
    v_add_f32 v33, v33, v201
    v_add_f32 v34, v34, v202
    v_add_f32 v35, v35, v203
    v_mov_b32 v36, s33
    v_mul_f32 v32, s32, v32
    v_mul_f32 v33, s32, v33
    v_mul_f32 v34, s32, v34
    v_mul_f32 v35, s32, v35
    v_cndmask_b32 v16, v36, v16, s[72:73]
    v_cndmask_b32 v17, v36, v17, s[74:75]
    v_cndmask_b32 v18, v36, v18, s[76:77]
    v_cndmask_b32 v19, v36, v19, s[78:79]
    v_cndmask_b32 v20, v36, v20, s[80:81]
    v_cndmask_b32 v21, v36, v21, s[82:83]
    v_cndmask_b32 v22, v36, v22, s[84:85]
    v_cndmask_b32 v23, v36, v23, s[86:87]
    v_cndmask_b32 v24, v36, v24, s[88:89]
    v_cndmask_b32 v25, v36, v25, s[90:91]
    v_cndmask_b32 v26, v36, v26, s[92:93]
    v_cndmask_b32 v27, v36, v27, s[94:95]
    v_cndmask_b32 v28, v36, v28, s[96:97]
    v_cndmask_b32 v29, v36, v29, s[98:99]
    v_cndmask_b32 v30, v36, v30, s[44:45]
    v_cndmask_b32 v31, v36, v31, s[46:47]
    v_max3_f32 v36, v16, v17, v18
    v_max3_f32 v36, v36, v19, v20
    v_max3_f32 v36, v36, v21, v22
    v_max3_f32 v36, v36, v23, v24
    v_max3_f32 v36, v36, v25, v26
    v_max3_f32 v36, v36, v27, v28
    v_max3_f32 v36, v36, v29, v30
    v_max3_f32 v36, v36, v31, v32
    v_max3_f32 v36, v36, v33, v34
    v_max_f32 v36, v36, v35
    v_mov_b32 v37, v36
    s_nop 1
    v_permlane32_swap_b32 v36, v37
    v_max_f32 v36, v36, v37
    v_sub_f32 v16, v16, v36
    v_sub_f32 v17, v17, v36
    v_sub_f32 v18, v18, v36
    v_sub_f32 v19, v19, v36
    v_sub_f32 v20, v20, v36
    v_sub_f32 v21, v21, v36
    v_sub_f32 v22, v22, v36
    v_sub_f32 v23, v23, v36
    v_sub_f32 v24, v24, v36
    v_sub_f32 v25, v25, v36
    v_sub_f32 v26, v26, v36
    v_sub_f32 v27, v27, v36
    v_sub_f32 v28, v28, v36
    v_sub_f32 v29, v29, v36
    v_sub_f32 v30, v30, v36
    v_sub_f32 v31, v31, v36
    v_sub_f32 v32, v32, v36
    v_sub_f32 v33, v33, v36
    v_sub_f32 v34, v34, v36
    v_sub_f32 v35, v35, v36
    v_exp_f32 v16, v16
    v_exp_f32 v17, v17
    v_exp_f32 v18, v18
    v_exp_f32 v19, v19
    v_exp_f32 v20, v20
    v_exp_f32 v21, v21
    v_exp_f32 v22, v22
    v_exp_f32 v23, v23
    v_exp_f32 v24, v24
    v_exp_f32 v25, v25
    v_exp_f32 v26, v26
    v_exp_f32 v27, v27
    v_exp_f32 v28, v28
    v_exp_f32 v29, v29
    v_exp_f32 v30, v30
    v_exp_f32 v31, v31
    v_exp_f32 v32, v32
    v_exp_f32 v33, v33
    v_exp_f32 v34, v34
    v_exp_f32 v35, v35
    s_nop 0
    v_cvt_pk_bf16_f32 v100, v16, v17
    v_cvt_pk_bf16_f32 v101, v18, v19
    v_cvt_pk_bf16_f32 v102, v24, v25
    v_cvt_pk_bf16_f32 v103, v26, v27
    v_cvt_pk_bf16_f32 v104, v20, v21
    v_cvt_pk_bf16_f32 v105, v22, v23
    v_cvt_pk_bf16_f32 v106, v28, v29
    v_cvt_pk_bf16_f32 v107, v30, v31
    v_cvt_pk_bf16_f32 v108, v32, v33
    v_cvt_pk_bf16_f32 v109, v32, v33
    v_cvt_pk_bf16_f32 v110, v34, v35
    v_cvt_pk_bf16_f32 v111, v34, v35
    s_nop 1
    v_mfma_f32_32x32x16_bf16 v[48:63], v[72:75], v[100:103], 0
    v_mfma_f32_32x32x16_bf16 v[48:63], v[76:79], v[104:107], v[48:63]
    v_mfma_f32_32x32x16_bf16 v[48:63], v[88:91], v[108:111], v[48:63]
    v_add_f32 v16, v16, v17
    v_add_f32 v18, v18, v19
    v_add_f32 v20, v20, v21
    v_add_f32 v22, v22, v23
    v_add_f32 v24, v24, v25
    v_add_f32 v26, v26, v27
    v_add_f32 v28, v28, v29
    v_add_f32 v30, v30, v31
    v_add_f32 v32, v32, v33
    v_add_f32 v34, v34, v35
    v_add_f32 v16, v16, v18
    v_add_f32 v20, v20, v22
    v_add_f32 v24, v24, v26
    v_add_f32 v28, v28, v30
    v_add_f32 v32, v32, v34
    v_add_f32 v16, v16, v20
    v_add_f32 v24, v24, v28
    v_add_f32 v16, v16, v32
    v_add_f32 v16, v16, v24
    v_mov_b32 v17, v16
    s_mul_i32 s24, s22, 299008
    s_lshl_b32 s17, s27, 13
    v_permlane32_swap_b32 v16, v17
    v_add_f32 v16, v16, v17
    v_rcp_f32 v16, v16
    s_add_u32 s24, s24, s17
    s_lshl_b32 s17, s13, 11
    v_mul_f32 v16, v16, v142
    s_add_u32 s24, s24, s17
    s_add_u32 s24, s24, 67108864
    v_mul_f32 v48, v48, v16
    v_mul_f32 v49, v49, v16
    v_mul_f32 v50, v50, v16
    v_mul_f32 v51, v51, v16
    v_mul_f32 v52, v52, v16
    v_mul_f32 v53, v53, v16
    v_mul_f32 v54, v54, v16
    v_mul_f32 v55, v55, v16
    v_mul_f32 v56, v56, v16
    v_mul_f32 v57, v57, v16
    v_mul_f32 v58, v58, v16
    v_mul_f32 v59, v59, v16
    v_mul_f32 v60, v60, v16
    v_mul_f32 v61, v61, v16
    v_mul_f32 v62, v62, v16
    v_mul_f32 v63, v63, v16
    v_cvt_pk_bf16_f32 v100, v48, v49
    v_cvt_pk_bf16_f32 v101, v50, v51
    v_cvt_pk_bf16_f32 v102, v52, v53
    v_cvt_pk_bf16_f32 v103, v54, v55
    v_cvt_pk_bf16_f32 v104, v56, v57
    v_cvt_pk_bf16_f32 v105, v58, v59
    v_cvt_pk_bf16_f32 v106, v60, v61
    v_cvt_pk_bf16_f32 v107, v62, v63
    buffer_store_dwordx4 v[100:103], v15, s[4:7], s24 offen offset:0 sc1
    buffer_store_dwordx4 v[104:107], v15, s[4:7], s24 offen offset:1024 sc1
    s_lshl_b32 s30, s22, 7
    s_add_u32 s30, s30, 8192
    s_mov_b32 s40, 1
    s_add_u32 s22, s22, 3
    s_cmp_gt_u32 s22, 63
    s_cbranch_scc1 L_b4a_end
    s_waitcnt vmcnt(11)
    s_barrier
    s_add_u32 s28, s22, 6
    s_min_u32 s28, s28, 63
    s_mov_b32 s25, 0
    s_lshl_b32 s34, s22, 5
    s_add_u32 s34, s34, s27
    s_lshl_b32 s35, s34, 14
    s_lshl_b32 s17, s13, 11
    s_add_u32 s35, s35, s17
    s_add_u32 s35, s35, 16777216
    s_add_u32 s36, s35, 8192
    s_lshl_b32 s37, s22, 8
    s_add_u32 s37, s37, 262148
    s_lshl_b32 s41, s34, 11
    s_lshl_b32 s17, s13, 9
    s_add_u32 s41, s41, s17
    s_lshl_b32 s42, s41, 1
    s_add_u32 s41, s41, 50331648
    s_add_u32 s42, s42, 54525952
    s_add_u32 s38, s22, 1
    s_cmp_ge_u32 s39, s38
    s_cbranch_scc0 L_ne_119
    buffer_load_dwordx4 v[80:83], v13, s[4:7], s41 offen sc1
    buffer_load_dwordx4 v[84:87], v13, s[4:7], s41 offen offset:256 sc1
    buffer_load_dwordx2 v[88:89], v14, s[4:7], s42 offen sc1
    buffer_load_dwordx2 v[90:91], v14, s[4:7], s42 offen offset:16 sc1
            L_ne_119:
    buffer_load_dwordx4 v[64:67], v12, s[4:7], s35 offen
    buffer_load_dwordx4 v[68:71], v12, s[4:7], s35 offen offset:512
    buffer_load_dwordx4 v[72:75], v12, s[4:7], s36 offen
    buffer_load_dwordx4 v[76:79], v12, s[4:7], s36 offen offset:512
    buffer_load_dword v142, v3, s[4:7], s37 offen sc1
    ds_read_b128 v[16:19], v4 offset:36864
    s_mul_i32 s17, s13, 9216
    s_add_u32 m0, s17, s25
    s_mul_i32 s23, s28, 36864
    ds_read_b128 v[20:23], v5 offset:36864
    ds_read_b128 v[24:27], v6 offset:36864
    ds_read_b128 v[28:31], v7 offset:36864
    ds_read_b128 v[32:35], v4 offset:37888
    ds_read_b128 v[36:39], v5 offset:37888
    ds_read_b128 v[40:43], v6 offset:37888
    ds_read_b128 v[44:47], v7 offset:37888
    s_waitcnt lgkmcnt(7)
    v_mfma_f32_32x32x16_bf16 v[48:63], a[0:3], v[16:19], 0
    ds_read_b128 v[16:19], v4 offset:38912
    s_waitcnt lgkmcnt(7)
    v_mfma_f32_32x32x16_bf16 v[48:63], a[4:7], v[20:23], v[48:63]
    ds_read_b128 v[20:23], v5 offset:38912
    buffer_load_dwordx4 v8, s[68:71], s23 offen lds
    s_add_u32 m0, m0, 1024
    s_add_u32 s23, s23, 128
    s_waitcnt lgkmcnt(7)
    v_mfma_f32_32x32x16_bf16 v[48:63], a[8:11], v[24:27], v[48:63]
    ds_read_b128 v[24:27], v6 offset:38912
    s_waitcnt lgkmcnt(7)
    v_mfma_f32_32x32x16_bf16 v[48:63], a[12:15], v[28:31], v[48:63]
    ds_read_b128 v[28:31], v7 offset:38912
    s_waitcnt lgkmcnt(7)
    v_mfma_f32_32x32x16_bf16 v[48:63], a[16:19], v[32:35], v[48:63]
    ds_read_b128 v[32:35], v4 offset:39936
    buffer_load_dwordx4 v8, s[68:71], s23 offen lds
    s_add_u32 m0, m0, 1024
    s_add_u32 s23, s23, 128
    s_waitcnt lgkmcnt(7)
    v_mfma_f32_32x32x16_bf16 v[48:63], a[20:23], v[36:39], v[48:63]
    ds_read_b128 v[36:39], v5 offset:39936
    s_waitcnt lgkmcnt(7)
    v_mfma_f32_32x32x16_bf16 v[48:63], a[24:27], v[40:43], v[48:63]
    ds_read_b128 v[40:43], v6 offset:39936
    s_waitcnt lgkmcnt(7)
    v_mfma_f32_32x32x16_bf16 v[48:63], a[28:31], v[44:47], v[48:63]
    ds_read_b128 v[44:47], v7 offset:39936
    buffer_load_dwordx4 v8, s[68:71], s23 offen lds
    s_add_u32 m0, m0, 1024
    s_add_u32 s23, s23, 128
    s_waitcnt lgkmcnt(7)
    v_mfma_f32_32x32x16_bf16 v[48:63], a[32:35], v[16:19], v[48:63]
    ds_read_b128 v[16:19], v4 offset:40960
    s_waitcnt lgkmcnt(7)
    v_mfma_f32_32x32x16_bf16 v[48:63], a[36:39], v[20:23], v[48:63]
    ds_read_b128 v[20:23], v5 offset:40960
    s_waitcnt lgkmcnt(7)
    v_mfma_f32_32x32x16_bf16 v[48:63], a[40:43], v[24:27], v[48:63]
    ds_read_b128 v[24:27], v6 offset:40960
    buffer_load_dwordx4 v8, s[68:71], s23 offen lds
    s_add_u32 m0, m0, 1024
    s_add_u32 s23, s23, 128
    s_waitcnt lgkmcnt(7)
    v_mfma_f32_32x32x16_bf16 v[48:63], a[44:47], v[28:31], v[48:63]
    ds_read_b128 v[28:31], v7 offset:40960
    s_waitcnt lgkmcnt(7)
    v_mfma_f32_32x32x16_bf16 v[48:63], a[48:51], v[32:35], v[48:63]
    ds_read_b128 v[32:35], v4 offset:41984
    s_waitcnt lgkmcnt(7)
    v_mfma_f32_32x32x16_bf16 v[48:63], a[52:55], v[36:39], v[48:63]
    ds_read_b128 v[36:39], v5 offset:41984
    buffer_load_dwordx4 v8, s[68:71], s23 offen lds
    s_add_u32 m0, m0, 1024
    s_add_u32 s23, s23, 128
    s_waitcnt lgkmcnt(7)
    v_mfma_f32_32x32x16_bf16 v[48:63], a[56:59], v[40:43], v[48:63]
    ds_read_b128 v[40:43], v6 offset:41984
    s_waitcnt lgkmcnt(7)
    v_mfma_f32_32x32x16_bf16 v[48:63], a[60:63], v[44:47], v[48:63]
    ds_read_b128 v[44:47], v7 offset:41984
    s_waitcnt lgkmcnt(7)
    v_mfma_f32_32x32x16_bf16 v[48:63], a[64:67], v[16:19], v[48:63]
    ds_read_b128 v[16:19], v4 offset:43008
    buffer_load_dwordx4 v8, s[68:71], s23 offen lds
    s_add_u32 m0, m0, 1024
    s_add_u32 s23, s23, 128
    s_waitcnt lgkmcnt(7)
    v_mfma_f32_32x32x16_bf16 v[48:63], a[68:71], v[20:23], v[48:63]
    ds_read_b128 v[20:23], v5 offset:43008
    s_waitcnt lgkmcnt(7)
    v_mfma_f32_32x32x16_bf16 v[48:63], a[72:75], v[24:27], v[48:63]
    ds_read_b128 v[24:27], v6 offset:43008
    s_waitcnt lgkmcnt(7)
    v_mfma_f32_32x32x16_bf16 v[48:63], a[76:79], v[28:31], v[48:63]
    buffer_load_dwordx4 v8, s[68:71], s23 offen lds
    s_add_u32 m0, m0, 1024
    s_add_u32 s23, s23, 128
    ds_read_b128 v[28:31], v7 offset:43008
    s_waitcnt lgkmcnt(7)
    v_mfma_f32_32x32x16_bf16 v[48:63], a[80:83], v[32:35], v[48:63]
    ds_read_b128 v[32:35], v4 offset:44032
    s_waitcnt lgkmcnt(7)
    v_mfma_f32_32x32x16_bf16 v[48:63], a[84:87], v[36:39], v[48:63]
    ds_read_b128 v[36:39], v5 offset:44032
    s_waitcnt lgkmcnt(7)
    v_mfma_f32_32x32x16_bf16 v[48:63], a[88:91], v[40:43], v[48:63]
    buffer_load_dwordx4 v8, s[68:71], s23 offen lds
    s_add_u32 m0, m0, 1024
    s_add_u32 s23, s23, 128
    ds_read_b128 v[40:43], v6 offset:44032
    s_waitcnt lgkmcnt(7)
    v_mfma_f32_32x32x16_bf16 v[48:63], a[92:95], v[44:47], v[48:63]
    ds_read_b128 v[44:47], v7 offset:44032
    s_waitcnt lgkmcnt(7)
    v_mfma_f32_32x32x16_bf16 v[48:63], a[96:99], v[16:19], v[48:63]
    ds_read_b128 v[16:19], v4 offset:45056
    s_waitcnt lgkmcnt(7)
    v_mfma_f32_32x32x16_bf16 v[48:63], a[100:103], v[20:23], v[48:63]
    buffer_load_dwordx4 v8, s[68:71], s23 offen lds
    ds_read_b128 v[20:23], v5 offset:45056
    s_waitcnt lgkmcnt(7)
    v_mfma_f32_32x32x16_bf16 v[48:63], a[104:107], v[24:27], v[48:63]
    ds_read_b128 v[24:27], v6 offset:45056
    s_waitcnt lgkmcnt(7)
    v_mfma_f32_32x32x16_bf16 v[48:63], a[108:111], v[28:31], v[48:63]
    ds_read_b128 v[28:31], v7 offset:45056
    s_waitcnt lgkmcnt(7)
    v_mfma_f32_32x32x16_bf16 v[48:63], a[112:115], v[32:35], v[48:63]
    s_waitcnt lgkmcnt(6)
    v_mfma_f32_32x32x16_bf16 v[48:63], a[116:119], v[36:39], v[48:63]
    s_waitcnt lgkmcnt(5)
    v_mfma_f32_32x32x16_bf16 v[48:63], a[120:123], v[40:43], v[48:63]
    s_waitcnt lgkmcnt(4)
    v_mfma_f32_32x32x16_bf16 v[48:63], a[124:127], v[44:47], v[48:63]
    s_waitcnt lgkmcnt(3)
    v_mfma_f32_32x32x16_bf16 v[48:63], a[128:131], v[16:19], v[48:63]
    s_waitcnt lgkmcnt(2)
    v_mfma_f32_32x32x16_bf16 v[48:63], a[132:135], v[20:23], v[48:63]
    s_waitcnt lgkmcnt(1)
    v_mfma_f32_32x32x16_bf16 v[48:63], a[136:139], v[24:27], v[48:63]
    s_waitcnt lgkmcnt(0)
    v_mfma_f32_32x32x16_bf16 v[48:63], a[140:143], v[28:31], v[48:63]
    s_cmp_eq_u32 s40, 0
    s_cbranch_scc1 L_ns_120
    s_waitcnt vmcnt(9)
    s_barrier
    s_cmp_eq_u32 s13, 0
    s_cbranch_scc0 L_sig_122
    s_mov_b64 exec, 1
    v_mov_b32 v2, 1
    buffer_atomic_add v2, off, s[4:7], s30 sc1
    s_mov_b64 exec, -1
        L_sig_122:
L_ns_120:
    s_nop 9
    v_cvt_pk_bf16_f32 v92, v48, v49
    v_cvt_pk_bf16_f32 v93, v50, v51
    v_cvt_pk_bf16_f32 v94, v56, v57
    v_cvt_pk_bf16_f32 v95, v58, v59
    v_cvt_pk_bf16_f32 v96, v52, v53
    v_cvt_pk_bf16_f32 v97, v54, v55
    v_cvt_pk_bf16_f32 v98, v60, v61
    v_cvt_pk_bf16_f32 v99, v62, v63
    s_waitcnt vmcnt(9)
    s_nop 0
    v_mfma_f32_32x32x16_bf16 v[100:115], v[64:67], v[92:95], 0
    v_mfma_f32_32x32x16_bf16 v[100:115], v[68:71], v[96:99], v[100:115]
    s_cmp_ge_u32 s39, s38
    s_cbranch_scc1 L_rd_121
    v_mov_b32 v143, 163760
    s_cmp_eq_u32 s13, 0
    s_cbranch_scc0 L_wvd_124
    s_mov_b32 s21, 0
        L_wv_123:
    buffer_load_dword v2, off, s[4:7], s31 sc1
    s_add_u32 s21, s21, 1
    s_cmp_gt_u32 s21, 3000000
    s_cbranch_scc1 L_fail
    s_waitcnt vmcnt(0)
    v_cmp_gt_u32 vcc, s38, v2
    s_cbranch_vccnz L_wv_123
    ds_write_b32 v143, v2
    s_waitcnt lgkmcnt(0)
        L_wvd_124:
    s_barrier
    ds_read_b32 v2, v143
    s_waitcnt lgkmcnt(0)
    v_readfirstlane_b32 s39, v2
    buffer_load_dwordx4 v[80:83], v13, s[4:7], s41 offen sc1
    buffer_load_dwordx4 v[84:87], v13, s[4:7], s41 offen offset:256 sc1
    buffer_load_dwordx2 v[88:89], v14, s[4:7], s42 offen sc1
    buffer_load_dwordx2 v[90:91], v14, s[4:7], s42 offen offset:16 sc1
    s_waitcnt vmcnt(0)
L_rd_121:
    s_nop 7
    s_nop 1
    ds_write_b128 v140, v[100:103] offset:0
    ds_write_b128 v140, v[104:107] offset:1024
    ds_write_b128 v140, v[108:111] offset:2048
    ds_write_b128 v140, v[112:115] offset:3072
    v_mfma_f32_32x32x16_bf16 v[116:131], v[80:83], v[92:95], 0
    v_mfma_f32_32x32x16_bf16 v[116:131], v[84:87], v[96:99], v[116:131]
    s_nop 7
    s_nop 3
    ds_write_b128 v140, v[116:119] offset:4096
    s_waitcnt lgkmcnt(0)
    s_barrier
    ds_read_b128 v[16:19], v141 offset:0
    ds_read_b128 v[20:23], v141 offset:1024
    ds_read_b128 v[24:27], v141 offset:2048
    ds_read_b128 v[28:31], v141 offset:3072
    ds_read_b128 v[32:35], v141 offset:4096
    ds_read_b128 v[144:147], v141 offset:5120
    ds_read_b128 v[148:151], v141 offset:6144
    ds_read_b128 v[152:155], v141 offset:7168
    ds_read_b128 v[156:159], v141 offset:8192
    ds_read_b128 v[160:163], v141 offset:9216
    ds_read_b128 v[164:167], v141 offset:10240
    ds_read_b128 v[168:171], v141 offset:11264
    ds_read_b128 v[172:175], v141 offset:12288
    ds_read_b128 v[176:179], v141 offset:13312
    ds_read_b128 v[180:183], v141 offset:14336
    ds_read_b128 v[184:187], v141 offset:15360
    ds_read_b128 v[188:191], v141 offset:16384
    ds_read_b128 v[192:195], v141 offset:17408
    ds_read_b128 v[196:199], v141 offset:18432
    ds_read_b128 v[200:203], v141 offset:19456
    s_waitcnt lgkmcnt(10)
    v_add_f32 v16, v16, v144
    v_add_f32 v17, v17, v145
    v_add_f32 v18, v18, v146
    v_add_f32 v19, v19, v147
    v_add_f32 v20, v20, v148
    v_add_f32 v21, v21, v149
    v_add_f32 v22, v22, v150
    v_add_f32 v23, v23, v151
    v_add_f32 v24, v24, v152
    v_add_f32 v25, v25, v153
    v_add_f32 v26, v26, v154
    v_add_f32 v27, v27, v155
    v_add_f32 v28, v28, v156
    v_add_f32 v29, v29, v157
    v_add_f32 v30, v30, v158
    v_add_f32 v31, v31, v159
    v_add_f32 v32, v32, v160
    v_add_f32 v33, v33, v161
    v_add_f32 v34, v34, v162
    v_add_f32 v35, v35, v163
    s_waitcnt lgkmcnt(5)
    v_add_f32 v16, v16, v164
    v_add_f32 v17, v17, v165
    v_add_f32 v18, v18, v166
    v_add_f32 v19, v19, v167
    v_add_f32 v20, v20, v168
    v_add_f32 v21, v21, v169
    v_add_f32 v22, v22, v170
    v_add_f32 v23, v23, v171
    v_add_f32 v24, v24, v172
    v_add_f32 v25, v25, v173
    v_add_f32 v26, v26, v174
    v_add_f32 v27, v27, v175
    v_add_f32 v28, v28, v176
    v_add_f32 v29, v29, v177
    v_add_f32 v30, v30, v178
    v_add_f32 v31, v31, v179
    v_add_f32 v32, v32, v180
    v_add_f32 v33, v33, v181
    v_add_f32 v34, v34, v182
    v_add_f32 v35, v35, v183
    s_waitcnt lgkmcnt(0)
    v_add_f32 v16, v16, v184
    v_add_f32 v17, v17, v185
    v_add_f32 v18, v18, v186
    v_add_f32 v19, v19, v187
    v_add_f32 v20, v20, v188
    v_add_f32 v21, v21, v189
    v_add_f32 v22, v22, v190
    v_add_f32 v23, v23, v191
    v_add_f32 v24, v24, v192
    v_add_f32 v25, v25, v193
    v_add_f32 v26, v26, v194
    v_add_f32 v27, v27, v195
    v_add_f32 v28, v28, v196
    v_add_f32 v29, v29, v197
    v_add_f32 v30, v30, v198
    v_add_f32 v31, v31, v199
    v_add_f32 v32, v32, v200
    v_add_f32 v33, v33, v201
    v_add_f32 v34, v34, v202
    v_add_f32 v35, v35, v203
    v_mov_b32 v36, s33
    v_mul_f32 v32, s32, v32
    v_mul_f32 v33, s32, v33
    v_mul_f32 v34, s32, v34
    v_mul_f32 v35, s32, v35
    v_cndmask_b32 v16, v36, v16, s[72:73]
    v_cndmask_b32 v17, v36, v17, s[74:75]
    v_cndmask_b32 v18, v36, v18, s[76:77]
    v_cndmask_b32 v19, v36, v19, s[78:79]
    v_cndmask_b32 v20, v36, v20, s[80:81]
    v_cndmask_b32 v21, v36, v21, s[82:83]
    v_cndmask_b32 v22, v36, v22, s[84:85]
    v_cndmask_b32 v23, v36, v23, s[86:87]
    v_cndmask_b32 v24, v36, v24, s[88:89]
    v_cndmask_b32 v25, v36, v25, s[90:91]
    v_cndmask_b32 v26, v36, v26, s[92:93]
    v_cndmask_b32 v27, v36, v27, s[94:95]
    v_cndmask_b32 v28, v36, v28, s[96:97]
    v_cndmask_b32 v29, v36, v29, s[98:99]
    v_cndmask_b32 v30, v36, v30, s[44:45]
    v_cndmask_b32 v31, v36, v31, s[46:47]
    v_max3_f32 v36, v16, v17, v18
    v_max3_f32 v36, v36, v19, v20
    v_max3_f32 v36, v36, v21, v22
    v_max3_f32 v36, v36, v23, v24
    v_max3_f32 v36, v36, v25, v26
    v_max3_f32 v36, v36, v27, v28
    v_max3_f32 v36, v36, v29, v30
    v_max3_f32 v36, v36, v31, v32
    v_max3_f32 v36, v36, v33, v34
    v_max_f32 v36, v36, v35
    v_mov_b32 v37, v36
    s_nop 1
    v_permlane32_swap_b32 v36, v37
    v_max_f32 v36, v36, v37
    v_sub_f32 v16, v16, v36
    v_sub_f32 v17, v17, v36
    v_sub_f32 v18, v18, v36
    v_sub_f32 v19, v19, v36
    v_sub_f32 v20, v20, v36
    v_sub_f32 v21, v21, v36
    v_sub_f32 v22, v22, v36
    v_sub_f32 v23, v23, v36
    v_sub_f32 v24, v24, v36
    v_sub_f32 v25, v25, v36
    v_sub_f32 v26, v26, v36
    v_sub_f32 v27, v27, v36
    v_sub_f32 v28, v28, v36
    v_sub_f32 v29, v29, v36
    v_sub_f32 v30, v30, v36
    v_sub_f32 v31, v31, v36
    v_sub_f32 v32, v32, v36
    v_sub_f32 v33, v33, v36
    v_sub_f32 v34, v34, v36
    v_sub_f32 v35, v35, v36
    v_exp_f32 v16, v16
    v_exp_f32 v17, v17
    v_exp_f32 v18, v18
    v_exp_f32 v19, v19
    v_exp_f32 v20, v20
    v_exp_f32 v21, v21
    v_exp_f32 v22, v22
    v_exp_f32 v23, v23
    v_exp_f32 v24, v24
    v_exp_f32 v25, v25
    v_exp_f32 v26, v26
    v_exp_f32 v27, v27
    v_exp_f32 v28, v28
    v_exp_f32 v29, v29
    v_exp_f32 v30, v30
    v_exp_f32 v31, v31
    v_exp_f32 v32, v32
    v_exp_f32 v33, v33
    v_exp_f32 v34, v34
    v_exp_f32 v35, v35
    s_nop 0
    v_cvt_pk_bf16_f32 v100, v16, v17
    v_cvt_pk_bf16_f32 v101, v18, v19
    v_cvt_pk_bf16_f32 v102, v24, v25
    v_cvt_pk_bf16_f32 v103, v26, v27
    v_cvt_pk_bf16_f32 v104, v20, v21
    v_cvt_pk_bf16_f32 v105, v22, v23
    v_cvt_pk_bf16_f32 v106, v28, v29
    v_cvt_pk_bf16_f32 v107, v30, v31
    v_cvt_pk_bf16_f32 v108, v32, v33
    v_cvt_pk_bf16_f32 v109, v32, v33
    v_cvt_pk_bf16_f32 v110, v34, v35
    v_cvt_pk_bf16_f32 v111, v34, v35
    s_nop 1
    v_mfma_f32_32x32x16_bf16 v[48:63], v[72:75], v[100:103], 0
    v_mfma_f32_32x32x16_bf16 v[48:63], v[76:79], v[104:107], v[48:63]
    v_mfma_f32_32x32x16_bf16 v[48:63], v[88:91], v[108:111], v[48:63]
    v_add_f32 v16, v16, v17
    v_add_f32 v18, v18, v19
    v_add_f32 v20, v20, v21
    v_add_f32 v22, v22, v23
    v_add_f32 v24, v24, v25
    v_add_f32 v26, v26, v27
    v_add_f32 v28, v28, v29
    v_add_f32 v30, v30, v31
    v_add_f32 v32, v32, v33
    v_add_f32 v34, v34, v35
    v_add_f32 v16, v16, v18
    v_add_f32 v20, v20, v22
    v_add_f32 v24, v24, v26
    v_add_f32 v28, v28, v30
    v_add_f32 v32, v32, v34
    v_add_f32 v16, v16, v20
    v_add_f32 v24, v24, v28
    v_add_f32 v16, v16, v32
    v_add_f32 v16, v16, v24
    v_mov_b32 v17, v16
    s_mul_i32 s24, s22, 299008
    s_lshl_b32 s17, s27, 13
    v_permlane32_swap_b32 v16, v17
    v_add_f32 v16, v16, v17
    v_rcp_f32 v16, v16
    s_add_u32 s24, s24, s17
    s_lshl_b32 s17, s13, 11
    v_mul_f32 v16, v16, v142
    s_add_u32 s24, s24, s17
    s_add_u32 s24, s24, 67108864
    v_mul_f32 v48, v48, v16
    v_mul_f32 v49, v49, v16
    v_mul_f32 v50, v50, v16
    v_mul_f32 v51, v51, v16
    v_mul_f32 v52, v52, v16
    v_mul_f32 v53, v53, v16
    v_mul_f32 v54, v54, v16
    v_mul_f32 v55, v55, v16
    v_mul_f32 v56, v56, v16
    v_mul_f32 v57, v57, v16
    v_mul_f32 v58, v58, v16
    v_mul_f32 v59, v59, v16
    v_mul_f32 v60, v60, v16
    v_mul_f32 v61, v61, v16
    v_mul_f32 v62, v62, v16
    v_mul_f32 v63, v63, v16
    v_cvt_pk_bf16_f32 v100, v48, v49
    v_cvt_pk_bf16_f32 v101, v50, v51
    v_cvt_pk_bf16_f32 v102, v52, v53
    v_cvt_pk_bf16_f32 v103, v54, v55
    v_cvt_pk_bf16_f32 v104, v56, v57
    v_cvt_pk_bf16_f32 v105, v58, v59
    v_cvt_pk_bf16_f32 v106, v60, v61
    v_cvt_pk_bf16_f32 v107, v62, v63
    buffer_store_dwordx4 v[100:103], v15, s[4:7], s24 offen offset:0 sc1
    buffer_store_dwordx4 v[104:107], v15, s[4:7], s24 offen offset:1024 sc1
    s_lshl_b32 s30, s22, 7
    s_add_u32 s30, s30, 8192
    s_mov_b32 s40, 1
    s_add_u32 s22, s22, 3
    s_cmp_gt_u32 s22, 63
    s_cbranch_scc1 L_b4a_end
    s_waitcnt vmcnt(11)
    s_barrier
    s_add_u32 s28, s22, 6
    s_min_u32 s28, s28, 63
    s_mov_b32 s25, 36864
    s_lshl_b32 s34, s22, 5
    s_add_u32 s34, s34, s27
    s_lshl_b32 s35, s34, 14
    s_lshl_b32 s17, s13, 11
    s_add_u32 s35, s35, s17
    s_add_u32 s35, s35, 16777216
    s_add_u32 s36, s35, 8192
    s_lshl_b32 s37, s22, 8
    s_add_u32 s37, s37, 262148
    s_lshl_b32 s41, s34, 11
    s_lshl_b32 s17, s13, 9
    s_add_u32 s41, s41, s17
    s_lshl_b32 s42, s41, 1
    s_add_u32 s41, s41, 50331648
    s_add_u32 s42, s42, 54525952
    s_add_u32 s38, s22, 1
    s_cmp_ge_u32 s39, s38
    s_cbranch_scc0 L_ne_125
    buffer_load_dwordx4 v[80:83], v13, s[4:7], s41 offen sc1
    buffer_load_dwordx4 v[84:87], v13, s[4:7], s41 offen offset:256 sc1
    buffer_load_dwordx2 v[88:89], v14, s[4:7], s42 offen sc1
    buffer_load_dwordx2 v[90:91], v14, s[4:7], s42 offen offset:16 sc1
            L_ne_125:
    buffer_load_dwordx4 v[64:67], v12, s[4:7], s35 offen
    buffer_load_dwordx4 v[68:71], v12, s[4:7], s35 offen offset:512
    buffer_load_dwordx4 v[72:75], v12, s[4:7], s36 offen
    buffer_load_dwordx4 v[76:79], v12, s[4:7], s36 offen offset:512
    buffer_load_dword v142, v3, s[4:7], s37 offen sc1
    ds_read_b128 v[16:19], v248 offset:8192
    s_mul_i32 s17, s13, 9216
    s_add_u32 m0, s17, s25
    s_mul_i32 s23, s28, 36864
    ds_read_b128 v[20:23], v249 offset:8192
    ds_read_b128 v[24:27], v250 offset:8192
    ds_read_b128 v[28:31], v251 offset:8192
    ds_read_b128 v[32:35], v248 offset:9216
    ds_read_b128 v[36:39], v249 offset:9216
    ds_read_b128 v[40:43], v250 offset:9216
    ds_read_b128 v[44:47], v251 offset:9216
    s_waitcnt lgkmcnt(7)
    v_mfma_f32_32x32x16_bf16 v[48:63], a[0:3], v[16:19], 0
    ds_read_b128 v[16:19], v248 offset:10240
    s_waitcnt lgkmcnt(7)
    v_mfma_f32_32x32x16_bf16 v[48:63], a[4:7], v[20:23], v[48:63]
    ds_read_b128 v[20:23], v249 offset:10240
    buffer_load_dwordx4 v8, s[68:71], s23 offen lds
    s_add_u32 m0, m0, 1024
    s_add_u32 s23, s23, 128
    s_waitcnt lgkmcnt(7)
    v_mfma_f32_32x32x16_bf16 v[48:63], a[8:11], v[24:27], v[48:63]
    ds_read_b128 v[24:27], v250 offset:10240
    s_waitcnt lgkmcnt(7)
    v_mfma_f32_32x32x16_bf16 v[48:63], a[12:15], v[28:31], v[48:63]
    ds_read_b128 v[28:31], v251 offset:10240
    s_waitcnt lgkmcnt(7)
    v_mfma_f32_32x32x16_bf16 v[48:63], a[16:19], v[32:35], v[48:63]
    ds_read_b128 v[32:35], v248 offset:11264
    buffer_load_dwordx4 v8, s[68:71], s23 offen lds
    s_add_u32 m0, m0, 1024
    s_add_u32 s23, s23, 128
    s_waitcnt lgkmcnt(7)
    v_mfma_f32_32x32x16_bf16 v[48:63], a[20:23], v[36:39], v[48:63]
    ds_read_b128 v[36:39], v249 offset:11264
    s_waitcnt lgkmcnt(7)
    v_mfma_f32_32x32x16_bf16 v[48:63], a[24:27], v[40:43], v[48:63]
    ds_read_b128 v[40:43], v250 offset:11264
    s_waitcnt lgkmcnt(7)
    v_mfma_f32_32x32x16_bf16 v[48:63], a[28:31], v[44:47], v[48:63]
    ds_read_b128 v[44:47], v251 offset:11264
    buffer_load_dwordx4 v8, s[68:71], s23 offen lds
    s_add_u32 m0, m0, 1024
    s_add_u32 s23, s23, 128
    s_waitcnt lgkmcnt(7)
    v_mfma_f32_32x32x16_bf16 v[48:63], a[32:35], v[16:19], v[48:63]
    ds_read_b128 v[16:19], v248 offset:12288
    s_waitcnt lgkmcnt(7)
    v_mfma_f32_32x32x16_bf16 v[48:63], a[36:39], v[20:23], v[48:63]
    ds_read_b128 v[20:23], v249 offset:12288
    s_waitcnt lgkmcnt(7)
    v_mfma_f32_32x32x16_bf16 v[48:63], a[40:43], v[24:27], v[48:63]
    ds_read_b128 v[24:27], v250 offset:12288
    buffer_load_dwordx4 v8, s[68:71], s23 offen lds
    s_add_u32 m0, m0, 1024
    s_add_u32 s23, s23, 128
    s_waitcnt lgkmcnt(7)
    v_mfma_f32_32x32x16_bf16 v[48:63], a[44:47], v[28:31], v[48:63]
    ds_read_b128 v[28:31], v251 offset:12288
    s_waitcnt lgkmcnt(7)
    v_mfma_f32_32x32x16_bf16 v[48:63], a[48:51], v[32:35], v[48:63]
    ds_read_b128 v[32:35], v248 offset:13312
    s_waitcnt lgkmcnt(7)
    v_mfma_f32_32x32x16_bf16 v[48:63], a[52:55], v[36:39], v[48:63]
    ds_read_b128 v[36:39], v249 offset:13312
    buffer_load_dwordx4 v8, s[68:71], s23 offen lds
    s_add_u32 m0, m0, 1024
    s_add_u32 s23, s23, 128
    s_waitcnt lgkmcnt(7)
    v_mfma_f32_32x32x16_bf16 v[48:63], a[56:59], v[40:43], v[48:63]
    ds_read_b128 v[40:43], v250 offset:13312
    s_waitcnt lgkmcnt(7)
    v_mfma_f32_32x32x16_bf16 v[48:63], a[60:63], v[44:47], v[48:63]
    ds_read_b128 v[44:47], v251 offset:13312
    s_waitcnt lgkmcnt(7)
    v_mfma_f32_32x32x16_bf16 v[48:63], a[64:67], v[16:19], v[48:63]
    ds_read_b128 v[16:19], v248 offset:14336
    buffer_load_dwordx4 v8, s[68:71], s23 offen lds
    s_add_u32 m0, m0, 1024
    s_add_u32 s23, s23, 128
    s_waitcnt lgkmcnt(7)
    v_mfma_f32_32x32x16_bf16 v[48:63], a[68:71], v[20:23], v[48:63]
    ds_read_b128 v[20:23], v249 offset:14336
    s_waitcnt lgkmcnt(7)
    v_mfma_f32_32x32x16_bf16 v[48:63], a[72:75], v[24:27], v[48:63]
    ds_read_b128 v[24:27], v250 offset:14336
    s_waitcnt lgkmcnt(7)
    v_mfma_f32_32x32x16_bf16 v[48:63], a[76:79], v[28:31], v[48:63]
    buffer_load_dwordx4 v8, s[68:71], s23 offen lds
    s_add_u32 m0, m0, 1024
    s_add_u32 s23, s23, 128
    ds_read_b128 v[28:31], v251 offset:14336
    s_waitcnt lgkmcnt(7)
    v_mfma_f32_32x32x16_bf16 v[48:63], a[80:83], v[32:35], v[48:63]
    ds_read_b128 v[32:35], v248 offset:15360
    s_waitcnt lgkmcnt(7)
    v_mfma_f32_32x32x16_bf16 v[48:63], a[84:87], v[36:39], v[48:63]
    ds_read_b128 v[36:39], v249 offset:15360
    s_waitcnt lgkmcnt(7)
    v_mfma_f32_32x32x16_bf16 v[48:63], a[88:91], v[40:43], v[48:63]
    buffer_load_dwordx4 v8, s[68:71], s23 offen lds
    s_add_u32 m0, m0, 1024
    s_add_u32 s23, s23, 128
    ds_read_b128 v[40:43], v250 offset:15360
    s_waitcnt lgkmcnt(7)
    v_mfma_f32_32x32x16_bf16 v[48:63], a[92:95], v[44:47], v[48:63]
    ds_read_b128 v[44:47], v251 offset:15360
    s_waitcnt lgkmcnt(7)
    v_mfma_f32_32x32x16_bf16 v[48:63], a[96:99], v[16:19], v[48:63]
    ds_read_b128 v[16:19], v248 offset:16384
    s_waitcnt lgkmcnt(7)
    v_mfma_f32_32x32x16_bf16 v[48:63], a[100:103], v[20:23], v[48:63]
    buffer_load_dwordx4 v8, s[68:71], s23 offen lds
    ds_read_b128 v[20:23], v249 offset:16384
    s_waitcnt lgkmcnt(7)
    v_mfma_f32_32x32x16_bf16 v[48:63], a[104:107], v[24:27], v[48:63]
    ds_read_b128 v[24:27], v250 offset:16384
    s_waitcnt lgkmcnt(7)
    v_mfma_f32_32x32x16_bf16 v[48:63], a[108:111], v[28:31], v[48:63]
    ds_read_b128 v[28:31], v251 offset:16384
    s_waitcnt lgkmcnt(7)
    v_mfma_f32_32x32x16_bf16 v[48:63], a[112:115], v[32:35], v[48:63]
    s_waitcnt lgkmcnt(6)
    v_mfma_f32_32x32x16_bf16 v[48:63], a[116:119], v[36:39], v[48:63]
    s_waitcnt lgkmcnt(5)
    v_mfma_f32_32x32x16_bf16 v[48:63], a[120:123], v[40:43], v[48:63]
    s_waitcnt lgkmcnt(4)
    v_mfma_f32_32x32x16_bf16 v[48:63], a[124:127], v[44:47], v[48:63]
    s_waitcnt lgkmcnt(3)
    v_mfma_f32_32x32x16_bf16 v[48:63], a[128:131], v[16:19], v[48:63]
    s_waitcnt lgkmcnt(2)
    v_mfma_f32_32x32x16_bf16 v[48:63], a[132:135], v[20:23], v[48:63]
    s_waitcnt lgkmcnt(1)
    v_mfma_f32_32x32x16_bf16 v[48:63], a[136:139], v[24:27], v[48:63]
    s_waitcnt lgkmcnt(0)
    v_mfma_f32_32x32x16_bf16 v[48:63], a[140:143], v[28:31], v[48:63]
    s_cmp_eq_u32 s40, 0
    s_cbranch_scc1 L_ns_126
    s_waitcnt vmcnt(9)
    s_barrier
    s_cmp_eq_u32 s13, 0
    s_cbranch_scc0 L_sig_128
    s_mov_b64 exec, 1
    v_mov_b32 v2, 1
    buffer_atomic_add v2, off, s[4:7], s30 sc1
    s_mov_b64 exec, -1
        L_sig_128:
L_ns_126:
    s_nop 9
    v_cvt_pk_bf16_f32 v92, v48, v49
    v_cvt_pk_bf16_f32 v93, v50, v51
    v_cvt_pk_bf16_f32 v94, v56, v57
    v_cvt_pk_bf16_f32 v95, v58, v59
    v_cvt_pk_bf16_f32 v96, v52, v53
    v_cvt_pk_bf16_f32 v97, v54, v55
    v_cvt_pk_bf16_f32 v98, v60, v61
    v_cvt_pk_bf16_f32 v99, v62, v63
    s_waitcnt vmcnt(9)
    s_nop 0
    v_mfma_f32_32x32x16_bf16 v[100:115], v[64:67], v[92:95], 0
    v_mfma_f32_32x32x16_bf16 v[100:115], v[68:71], v[96:99], v[100:115]
    s_cmp_ge_u32 s39, s38
    s_cbranch_scc1 L_rd_127
    v_mov_b32 v143, 163760
    s_cmp_eq_u32 s13, 0
    s_cbranch_scc0 L_wvd_130
    s_mov_b32 s21, 0
        L_wv_129:
    buffer_load_dword v2, off, s[4:7], s31 sc1
    s_add_u32 s21, s21, 1
    s_cmp_gt_u32 s21, 3000000
    s_cbranch_scc1 L_fail
    s_waitcnt vmcnt(0)
    v_cmp_gt_u32 vcc, s38, v2
    s_cbranch_vccnz L_wv_129
    ds_write_b32 v143, v2
    s_waitcnt lgkmcnt(0)
        L_wvd_130:
    s_barrier
    ds_read_b32 v2, v143
    s_waitcnt lgkmcnt(0)
    v_readfirstlane_b32 s39, v2
    buffer_load_dwordx4 v[80:83], v13, s[4:7], s41 offen sc1
    buffer_load_dwordx4 v[84:87], v13, s[4:7], s41 offen offset:256 sc1
    buffer_load_dwordx2 v[88:89], v14, s[4:7], s42 offen sc1
    buffer_load_dwordx2 v[90:91], v14, s[4:7], s42 offen offset:16 sc1
    s_waitcnt vmcnt(0)
L_rd_127:
    s_nop 7
    s_nop 1
    ds_write_b128 v140, v[100:103] offset:0
    ds_write_b128 v140, v[104:107] offset:1024
    ds_write_b128 v140, v[108:111] offset:2048
    ds_write_b128 v140, v[112:115] offset:3072
    v_mfma_f32_32x32x16_bf16 v[116:131], v[80:83], v[92:95], 0
    v_mfma_f32_32x32x16_bf16 v[116:131], v[84:87], v[96:99], v[116:131]
    s_nop 7
    s_nop 3
    ds_write_b128 v140, v[116:119] offset:4096
    s_waitcnt lgkmcnt(0)
    s_barrier
    ds_read_b128 v[16:19], v141 offset:0
    ds_read_b128 v[20:23], v141 offset:1024
    ds_read_b128 v[24:27], v141 offset:2048
    ds_read_b128 v[28:31], v141 offset:3072
    ds_read_b128 v[32:35], v141 offset:4096
    ds_read_b128 v[144:147], v141 offset:5120
    ds_read_b128 v[148:151], v141 offset:6144
    ds_read_b128 v[152:155], v141 offset:7168
    ds_read_b128 v[156:159], v141 offset:8192
    ds_read_b128 v[160:163], v141 offset:9216
    ds_read_b128 v[164:167], v141 offset:10240
    ds_read_b128 v[168:171], v141 offset:11264
    ds_read_b128 v[172:175], v141 offset:12288
    ds_read_b128 v[176:179], v141 offset:13312
    ds_read_b128 v[180:183], v141 offset:14336
    ds_read_b128 v[184:187], v141 offset:15360
    ds_read_b128 v[188:191], v141 offset:16384
    ds_read_b128 v[192:195], v141 offset:17408
    ds_read_b128 v[196:199], v141 offset:18432
    ds_read_b128 v[200:203], v141 offset:19456
    s_waitcnt lgkmcnt(10)
    v_add_f32 v16, v16, v144
    v_add_f32 v17, v17, v145
    v_add_f32 v18, v18, v146
    v_add_f32 v19, v19, v147
    v_add_f32 v20, v20, v148
    v_add_f32 v21, v21, v149
    v_add_f32 v22, v22, v150
    v_add_f32 v23, v23, v151
    v_add_f32 v24, v24, v152
    v_add_f32 v25, v25, v153
    v_add_f32 v26, v26, v154
    v_add_f32 v27, v27, v155
    v_add_f32 v28, v28, v156
    v_add_f32 v29, v29, v157
    v_add_f32 v30, v30, v158
    v_add_f32 v31, v31, v159
    v_add_f32 v32, v32, v160
    v_add_f32 v33, v33, v161
    v_add_f32 v34, v34, v162
    v_add_f32 v35, v35, v163
    s_waitcnt lgkmcnt(5)
    v_add_f32 v16, v16, v164
    v_add_f32 v17, v17, v165
    v_add_f32 v18, v18, v166
    v_add_f32 v19, v19, v167
    v_add_f32 v20, v20, v168
    v_add_f32 v21, v21, v169
    v_add_f32 v22, v22, v170
    v_add_f32 v23, v23, v171
    v_add_f32 v24, v24, v172
    v_add_f32 v25, v25, v173
    v_add_f32 v26, v26, v174
    v_add_f32 v27, v27, v175
    v_add_f32 v28, v28, v176
    v_add_f32 v29, v29, v177
    v_add_f32 v30, v30, v178
    v_add_f32 v31, v31, v179
    v_add_f32 v32, v32, v180
    v_add_f32 v33, v33, v181
    v_add_f32 v34, v34, v182
    v_add_f32 v35, v35, v183
    s_waitcnt lgkmcnt(0)
    v_add_f32 v16, v16, v184
    v_add_f32 v17, v17, v185
    v_add_f32 v18, v18, v186
    v_add_f32 v19, v19, v187
    v_add_f32 v20, v20, v188
    v_add_f32 v21, v21, v189
    v_add_f32 v22, v22, v190
    v_add_f32 v23, v23, v191
    v_add_f32 v24, v24, v192
    v_add_f32 v25, v25, v193
    v_add_f32 v26, v26, v194
    v_add_f32 v27, v27, v195
    v_add_f32 v28, v28, v196
    v_add_f32 v29, v29, v197
    v_add_f32 v30, v30, v198
    v_add_f32 v31, v31, v199
    v_add_f32 v32, v32, v200
    v_add_f32 v33, v33, v201
    v_add_f32 v34, v34, v202
    v_add_f32 v35, v35, v203
    v_mov_b32 v36, s33
    v_mul_f32 v32, s32, v32
    v_mul_f32 v33, s32, v33
    v_mul_f32 v34, s32, v34
    v_mul_f32 v35, s32, v35
    v_cndmask_b32 v16, v36, v16, s[72:73]
    v_cndmask_b32 v17, v36, v17, s[74:75]
    v_cndmask_b32 v18, v36, v18, s[76:77]
    v_cndmask_b32 v19, v36, v19, s[78:79]
    v_cndmask_b32 v20, v36, v20, s[80:81]
    v_cndmask_b32 v21, v36, v21, s[82:83]
    v_cndmask_b32 v22, v36, v22, s[84:85]
    v_cndmask_b32 v23, v36, v23, s[86:87]
    v_cndmask_b32 v24, v36, v24, s[88:89]
    v_cndmask_b32 v25, v36, v25, s[90:91]
    v_cndmask_b32 v26, v36, v26, s[92:93]
    v_cndmask_b32 v27, v36, v27, s[94:95]
    v_cndmask_b32 v28, v36, v28, s[96:97]
    v_cndmask_b32 v29, v36, v29, s[98:99]
    v_cndmask_b32 v30, v36, v30, s[44:45]
    v_cndmask_b32 v31, v36, v31, s[46:47]
    v_max3_f32 v36, v16, v17, v18
    v_max3_f32 v36, v36, v19, v20
    v_max3_f32 v36, v36, v21, v22
    v_max3_f32 v36, v36, v23, v24
    v_max3_f32 v36, v36, v25, v26
    v_max3_f32 v36, v36, v27, v28
    v_max3_f32 v36, v36, v29, v30
    v_max3_f32 v36, v36, v31, v32
    v_max3_f32 v36, v36, v33, v34
    v_max_f32 v36, v36, v35
    v_mov_b32 v37, v36
    s_nop 1
    v_permlane32_swap_b32 v36, v37
    v_max_f32 v36, v36, v37
    v_sub_f32 v16, v16, v36
    v_sub_f32 v17, v17, v36
    v_sub_f32 v18, v18, v36
    v_sub_f32 v19, v19, v36
    v_sub_f32 v20, v20, v36
    v_sub_f32 v21, v21, v36
    v_sub_f32 v22, v22, v36
    v_sub_f32 v23, v23, v36
    v_sub_f32 v24, v24, v36
    v_sub_f32 v25, v25, v36
    v_sub_f32 v26, v26, v36
    v_sub_f32 v27, v27, v36
    v_sub_f32 v28, v28, v36
    v_sub_f32 v29, v29, v36
    v_sub_f32 v30, v30, v36
    v_sub_f32 v31, v31, v36
    v_sub_f32 v32, v32, v36
    v_sub_f32 v33, v33, v36
    v_sub_f32 v34, v34, v36
    v_sub_f32 v35, v35, v36
    v_exp_f32 v16, v16
    v_exp_f32 v17, v17
    v_exp_f32 v18, v18
    v_exp_f32 v19, v19
    v_exp_f32 v20, v20
    v_exp_f32 v21, v21
    v_exp_f32 v22, v22
    v_exp_f32 v23, v23
    v_exp_f32 v24, v24
    v_exp_f32 v25, v25
    v_exp_f32 v26, v26
    v_exp_f32 v27, v27
    v_exp_f32 v28, v28
    v_exp_f32 v29, v29
    v_exp_f32 v30, v30
    v_exp_f32 v31, v31
    v_exp_f32 v32, v32
    v_exp_f32 v33, v33
    v_exp_f32 v34, v34
    v_exp_f32 v35, v35
    s_nop 0
    v_cvt_pk_bf16_f32 v100, v16, v17
    v_cvt_pk_bf16_f32 v101, v18, v19
    v_cvt_pk_bf16_f32 v102, v24, v25
    v_cvt_pk_bf16_f32 v103, v26, v27
    v_cvt_pk_bf16_f32 v104, v20, v21
    v_cvt_pk_bf16_f32 v105, v22, v23
    v_cvt_pk_bf16_f32 v106, v28, v29
    v_cvt_pk_bf16_f32 v107, v30, v31
    v_cvt_pk_bf16_f32 v108, v32, v33
    v_cvt_pk_bf16_f32 v109, v32, v33
    v_cvt_pk_bf16_f32 v110, v34, v35
    v_cvt_pk_bf16_f32 v111, v34, v35
    s_nop 1
    v_mfma_f32_32x32x16_bf16 v[48:63], v[72:75], v[100:103], 0
    v_mfma_f32_32x32x16_bf16 v[48:63], v[76:79], v[104:107], v[48:63]
    v_mfma_f32_32x32x16_bf16 v[48:63], v[88:91], v[108:111], v[48:63]
    v_add_f32 v16, v16, v17
    v_add_f32 v18, v18, v19
    v_add_f32 v20, v20, v21
    v_add_f32 v22, v22, v23
    v_add_f32 v24, v24, v25
    v_add_f32 v26, v26, v27
    v_add_f32 v28, v28, v29
    v_add_f32 v30, v30, v31
    v_add_f32 v32, v32, v33
    v_add_f32 v34, v34, v35
    v_add_f32 v16, v16, v18
    v_add_f32 v20, v20, v22
    v_add_f32 v24, v24, v26
    v_add_f32 v28, v28, v30
    v_add_f32 v32, v32, v34
    v_add_f32 v16, v16, v20
    v_add_f32 v24, v24, v28
    v_add_f32 v16, v16, v32
    v_add_f32 v16, v16, v24
    v_mov_b32 v17, v16
    s_mul_i32 s24, s22, 299008
    s_lshl_b32 s17, s27, 13
    v_permlane32_swap_b32 v16, v17
    v_add_f32 v16, v16, v17
    v_rcp_f32 v16, v16
    s_add_u32 s24, s24, s17
    s_lshl_b32 s17, s13, 11
    v_mul_f32 v16, v16, v142
    s_add_u32 s24, s24, s17
    s_add_u32 s24, s24, 67108864
    v_mul_f32 v48, v48, v16
    v_mul_f32 v49, v49, v16
    v_mul_f32 v50, v50, v16
    v_mul_f32 v51, v51, v16
    v_mul_f32 v52, v52, v16
    v_mul_f32 v53, v53, v16
    v_mul_f32 v54, v54, v16
    v_mul_f32 v55, v55, v16
    v_mul_f32 v56, v56, v16
    v_mul_f32 v57, v57, v16
    v_mul_f32 v58, v58, v16
    v_mul_f32 v59, v59, v16
    v_mul_f32 v60, v60, v16
    v_mul_f32 v61, v61, v16
    v_mul_f32 v62, v62, v16
    v_mul_f32 v63, v63, v16
    v_cvt_pk_bf16_f32 v100, v48, v49
    v_cvt_pk_bf16_f32 v101, v50, v51
    v_cvt_pk_bf16_f32 v102, v52, v53
    v_cvt_pk_bf16_f32 v103, v54, v55
    v_cvt_pk_bf16_f32 v104, v56, v57
    v_cvt_pk_bf16_f32 v105, v58, v59
    v_cvt_pk_bf16_f32 v106, v60, v61
    v_cvt_pk_bf16_f32 v107, v62, v63
    buffer_store_dwordx4 v[100:103], v15, s[4:7], s24 offen offset:0 sc1
    buffer_store_dwordx4 v[104:107], v15, s[4:7], s24 offen offset:1024 sc1
    s_lshl_b32 s30, s22, 7
    s_add_u32 s30, s30, 8192
    s_mov_b32 s40, 1
    s_add_u32 s22, s22, 3
    s_cmp_gt_u32 s22, 63
    s_cbranch_scc1 L_b4a_end
    s_waitcnt vmcnt(11)
    s_branch L_b4a_lp
L_b4a_end:
    s_waitcnt vmcnt(0)
    s_barrier
    s_cmp_eq_u32 s13, 0
    s_cbranch_scc0 L_sig_131
    s_mov_b64 exec, 1
    v_mov_b32 v2, 1
    buffer_atomic_add v2, off, s[4:7], s30 sc1
    s_mov_b64 exec, -1
        L_sig_131:
    s_branch L_left
    L_steal:
    s_mov_b32 s63, 1
    L_steal_lp:
    s_lshl_b32 s17, s63, 2
    s_add_u32 s17, s17, 96
    s_waitcnt vmcnt(0) lgkmcnt(0)
    s_barrier
    v_mov_b32 v6, 163776
    s_cmp_eq_u32 s13, 0
    s_cbranch_scc0 L_clm_132
    s_mov_b64 exec, 1
    v_mov_b32 v2, 1
    buffer_atomic_add v2, off, s[8:11], s17 offset:0 sc0 sc1
    s_waitcnt vmcnt(0)
    ds_write_b128 v6, v[2:5]
    s_waitcnt lgkmcnt(0)
    s_mov_b64 exec, -1
        L_clm_132:
    s_barrier
    ds_read_b128 v[2:5], v6
    s_waitcnt lgkmcnt(0)
    v_readfirstlane_b32 s29, v2
    s_sub_u32 s22, s63, 1
    s_cmp_lt_u32 s29, 18
    s_cbranch_scc1 L_do4b
    s_add_u32 s63, s63, 1
    s_cmp_le_u32 s63, 7
    s_cbranch_scc1 L_steal_lp
L_alldone:
    s_branch L_end
L_do4b:
    v_and_b32 v1, 63, v0
    v_lshrrev_b32 v9, 2, v1
    v_and_b32 v10, 3, v1
    v_mul_u32_u24 v4, 1152, v9
    v_lshl_add_u32 v4, v10, 4, v4
    s_lshl_b32 s17, s13, 12
    v_lshlrev_b32 v5, 4, v1
    v_add_u32 v5, s17, v5
    v_lshrrev_b32 v9, 5, v1
    v_bfe_u32 v10, v1, 2, 2
    v_bfe_u32 v11, v1, 4, 1
    v_and_b32 v12, 3, v1
    v_lshlrev_b32 v11, 5, v11
    v_lshl_add_u32 v11, v12, 3, v11
    v_add_u32 v11, s17, v11
    v_lshl_add_u32 v12, v9, 2, v10
    v_lshl_add_u32 v6, v12, 6, v11
    v_lshl_add_u32 v12, v9, 3, v10
    v_lshl_add_u32 v7, v12, 6, v11
    s_lshl_b32 s34, s29, 6
    s_load_dwordx2 s[64:65], s[0:1], 64
    s_waitcnt lgkmcnt(0)
    s_and_b32 s65, s65, 0xffff
    s_mov_b32 s66, 4718592
    s_mov_b32 s67, 0x20000
    s_load_dwordx2 s[68:69], s[0:1], 16
    s_waitcnt lgkmcnt(0)
    s_and_b32 s69, s69, 0xffff
    s_mov_b32 s70, 663552
    s_mov_b32 s71, 0x20000
    s_mul_i32 s35, s13, 73
    s_add_u32 s17, s35, 0
    s_cmp_ge_u32 s17, 256
    s_cbranch_scc1 L_wa_133
    s_mul_i32 s17, s17, 18432
    s_add_u32 s17, s17, s34
    buffer_load_dwordx4 v[16:19], v4, s[64:67], s17 offen
    s_branch L_wb_134
                L_wa_133:
    s_sub_u32 s17, s17, 256
    s_mul_i32 s17, s17, 18432
    s_add_u32 s17, s17, s34
    buffer_load_dwordx4 v[16:19], v4, s[68:71], s17 offen
                L_wb_134:
    s_add_u32 s17, s35, 1
    s_cmp_ge_u32 s17, 256
    s_cbranch_scc1 L_wa_135
    s_mul_i32 s17, s17, 18432
    s_add_u32 s17, s17, s34
    buffer_load_dwordx4 v[20:23], v4, s[64:67], s17 offen
    s_branch L_wb_136
                L_wa_135:
    s_sub_u32 s17, s17, 256
    s_mul_i32 s17, s17, 18432
    s_add_u32 s17, s17, s34
    buffer_load_dwordx4 v[20:23], v4, s[68:71], s17 offen
                L_wb_136:
    s_add_u32 s17, s35, 2
    s_cmp_ge_u32 s17, 256
    s_cbranch_scc1 L_wa_137
    s_mul_i32 s17, s17, 18432
    s_add_u32 s17, s17, s34
    buffer_load_dwordx4 v[24:27], v4, s[64:67], s17 offen
    s_branch L_wb_138
                L_wa_137:
    s_sub_u32 s17, s17, 256
    s_mul_i32 s17, s17, 18432
    s_add_u32 s17, s17, s34
    buffer_load_dwordx4 v[24:27], v4, s[68:71], s17 offen
                L_wb_138:
    s_add_u32 s17, s35, 3
    s_cmp_ge_u32 s17, 256
    s_cbranch_scc1 L_wa_139
    s_mul_i32 s17, s17, 18432
    s_add_u32 s17, s17, s34
    buffer_load_dwordx4 v[28:31], v4, s[64:67], s17 offen
    s_branch L_wb_140
                L_wa_139:
    s_sub_u32 s17, s17, 256
    s_mul_i32 s17, s17, 18432
    s_add_u32 s17, s17, s34
    buffer_load_dwordx4 v[28:31], v4, s[68:71], s17 offen
                L_wb_140:
    s_add_u32 s17, s35, 4
    s_cmp_ge_u32 s17, 256
    s_cbranch_scc1 L_wa_141
    s_mul_i32 s17, s17, 18432
    s_add_u32 s17, s17, s34
    buffer_load_dwordx4 v[32:35], v4, s[64:67], s17 offen
    s_branch L_wb_142
                L_wa_141:
    s_sub_u32 s17, s17, 256
    s_mul_i32 s17, s17, 18432
    s_add_u32 s17, s17, s34
    buffer_load_dwordx4 v[32:35], v4, s[68:71], s17 offen
                L_wb_142:
    s_add_u32 s17, s35, 5
    s_cmp_ge_u32 s17, 256
    s_cbranch_scc1 L_wa_143
    s_mul_i32 s17, s17, 18432
    s_add_u32 s17, s17, s34
    buffer_load_dwordx4 v[36:39], v4, s[64:67], s17 offen
    s_branch L_wb_144
                L_wa_143:
    s_sub_u32 s17, s17, 256
    s_mul_i32 s17, s17, 18432
    s_add_u32 s17, s17, s34
    buffer_load_dwordx4 v[36:39], v4, s[68:71], s17 offen
                L_wb_144:
    s_add_u32 s17, s35, 6
    s_cmp_ge_u32 s17, 256
    s_cbranch_scc1 L_wa_145
    s_mul_i32 s17, s17, 18432
    s_add_u32 s17, s17, s34
    buffer_load_dwordx4 v[40:43], v4, s[64:67], s17 offen
    s_branch L_wb_146
                L_wa_145:
    s_sub_u32 s17, s17, 256
    s_mul_i32 s17, s17, 18432
    s_add_u32 s17, s17, s34
    buffer_load_dwordx4 v[40:43], v4, s[68:71], s17 offen
                L_wb_146:
    s_add_u32 s17, s35, 7
    s_cmp_ge_u32 s17, 256
    s_cbranch_scc1 L_wa_147
    s_mul_i32 s17, s17, 18432
    s_add_u32 s17, s17, s34
    buffer_load_dwordx4 v[44:47], v4, s[64:67], s17 offen
    s_branch L_wb_148
                L_wa_147:
    s_sub_u32 s17, s17, 256
    s_mul_i32 s17, s17, 18432
    s_add_u32 s17, s17, s34
    buffer_load_dwordx4 v[44:47], v4, s[68:71], s17 offen
                L_wb_148:
    s_add_u32 s17, s35, 8
    s_cmp_ge_u32 s17, 256
    s_cbranch_scc1 L_wa_149
    s_mul_i32 s17, s17, 18432
    s_add_u32 s17, s17, s34
    buffer_load_dwordx4 v[48:51], v4, s[64:67], s17 offen
    s_branch L_wb_150
                L_wa_149:
    s_sub_u32 s17, s17, 256
    s_mul_i32 s17, s17, 18432
    s_add_u32 s17, s17, s34
    buffer_load_dwordx4 v[48:51], v4, s[68:71], s17 offen
                L_wb_150:
    s_add_u32 s17, s35, 9
    s_cmp_ge_u32 s17, 256
    s_cbranch_scc1 L_wa_151
    s_mul_i32 s17, s17, 18432
    s_add_u32 s17, s17, s34
    buffer_load_dwordx4 v[52:55], v4, s[64:67], s17 offen
    s_branch L_wb_152
                L_wa_151:
    s_sub_u32 s17, s17, 256
    s_mul_i32 s17, s17, 18432
    s_add_u32 s17, s17, s34
    buffer_load_dwordx4 v[52:55], v4, s[68:71], s17 offen
                L_wb_152:
    s_add_u32 s17, s35, 10
    s_cmp_ge_u32 s17, 256
    s_cbranch_scc1 L_wa_153
    s_mul_i32 s17, s17, 18432
    s_add_u32 s17, s17, s34
    buffer_load_dwordx4 v[56:59], v4, s[64:67], s17 offen
    s_branch L_wb_154
                L_wa_153:
    s_sub_u32 s17, s17, 256
    s_mul_i32 s17, s17, 18432
    s_add_u32 s17, s17, s34
    buffer_load_dwordx4 v[56:59], v4, s[68:71], s17 offen
                L_wb_154:
    s_add_u32 s17, s35, 11
    s_cmp_ge_u32 s17, 256
    s_cbranch_scc1 L_wa_155
    s_mul_i32 s17, s17, 18432
    s_add_u32 s17, s17, s34
    buffer_load_dwordx4 v[60:63], v4, s[64:67], s17 offen
    s_branch L_wb_156
                L_wa_155:
    s_sub_u32 s17, s17, 256
    s_mul_i32 s17, s17, 18432
    s_add_u32 s17, s17, s34
    buffer_load_dwordx4 v[60:63], v4, s[68:71], s17 offen
                L_wb_156:
    s_add_u32 s17, s35, 12
    s_cmp_ge_u32 s17, 256
    s_cbranch_scc1 L_wa_157
    s_mul_i32 s17, s17, 18432
    s_add_u32 s17, s17, s34
    buffer_load_dwordx4 v[64:67], v4, s[64:67], s17 offen
    s_branch L_wb_158
                L_wa_157:
    s_sub_u32 s17, s17, 256
    s_mul_i32 s17, s17, 18432
    s_add_u32 s17, s17, s34
    buffer_load_dwordx4 v[64:67], v4, s[68:71], s17 offen
                L_wb_158:
    s_add_u32 s17, s35, 13
    s_cmp_ge_u32 s17, 256
    s_cbranch_scc1 L_wa_159
    s_mul_i32 s17, s17, 18432
    s_add_u32 s17, s17, s34
    buffer_load_dwordx4 v[68:71], v4, s[64:67], s17 offen
    s_branch L_wb_160
                L_wa_159:
    s_sub_u32 s17, s17, 256
    s_mul_i32 s17, s17, 18432
    s_add_u32 s17, s17, s34
    buffer_load_dwordx4 v[68:71], v4, s[68:71], s17 offen
                L_wb_160:
    s_add_u32 s17, s35, 14
    s_cmp_ge_u32 s17, 256
    s_cbranch_scc1 L_wa_161
    s_mul_i32 s17, s17, 18432
    s_add_u32 s17, s17, s34
    buffer_load_dwordx4 v[72:75], v4, s[64:67], s17 offen
    s_branch L_wb_162
                L_wa_161:
    s_sub_u32 s17, s17, 256
    s_mul_i32 s17, s17, 18432
    s_add_u32 s17, s17, s34
    buffer_load_dwordx4 v[72:75], v4, s[68:71], s17 offen
                L_wb_162:
    s_add_u32 s17, s35, 15
    s_cmp_ge_u32 s17, 256
    s_cbranch_scc1 L_wa_163
    s_mul_i32 s17, s17, 18432
    s_add_u32 s17, s17, s34
    buffer_load_dwordx4 v[76:79], v4, s[64:67], s17 offen
    s_branch L_wb_164
                L_wa_163:
    s_sub_u32 s17, s17, 256
    s_mul_i32 s17, s17, 18432
    s_add_u32 s17, s17, s34
    buffer_load_dwordx4 v[76:79], v4, s[68:71], s17 offen
                L_wb_164:
    s_add_u32 s17, s35, 16
    s_cmp_ge_u32 s17, 256
    s_cbranch_scc1 L_wa_165
    s_mul_i32 s17, s17, 18432
    s_add_u32 s17, s17, s34
    buffer_load_dwordx4 v[80:83], v4, s[64:67], s17 offen
    s_branch L_wb_166
                L_wa_165:
    s_sub_u32 s17, s17, 256
    s_mul_i32 s17, s17, 18432
    s_add_u32 s17, s17, s34
    buffer_load_dwordx4 v[80:83], v4, s[68:71], s17 offen
                L_wb_166:
    s_add_u32 s17, s35, 17
    s_cmp_ge_u32 s17, 256
    s_cbranch_scc1 L_wa_167
    s_mul_i32 s17, s17, 18432
    s_add_u32 s17, s17, s34
    buffer_load_dwordx4 v[84:87], v4, s[64:67], s17 offen
    s_branch L_wb_168
                L_wa_167:
    s_sub_u32 s17, s17, 256
    s_mul_i32 s17, s17, 18432
    s_add_u32 s17, s17, s34
    buffer_load_dwordx4 v[84:87], v4, s[68:71], s17 offen
                L_wb_168:
    s_add_u32 s17, s35, 18
    s_cmp_ge_u32 s17, 256
    s_cbranch_scc1 L_wa_169
    s_mul_i32 s17, s17, 18432
    s_add_u32 s17, s17, s34
    buffer_load_dwordx4 v[88:91], v4, s[64:67], s17 offen
    s_branch L_wb_170
                L_wa_169:
    s_sub_u32 s17, s17, 256
    s_mul_i32 s17, s17, 18432
    s_add_u32 s17, s17, s34
    buffer_load_dwordx4 v[88:91], v4, s[68:71], s17 offen
                L_wb_170:
    s_add_u32 s17, s35, 19
    s_cmp_ge_u32 s17, 256
    s_cbranch_scc1 L_wa_171
    s_mul_i32 s17, s17, 18432
    s_add_u32 s17, s17, s34
    buffer_load_dwordx4 v[92:95], v4, s[64:67], s17 offen
    s_branch L_wb_172
                L_wa_171:
    s_sub_u32 s17, s17, 256
    s_mul_i32 s17, s17, 18432
    s_add_u32 s17, s17, s34
    buffer_load_dwordx4 v[92:95], v4, s[68:71], s17 offen
                L_wb_172:
    s_add_u32 s17, s35, 20
    s_cmp_ge_u32 s17, 256
    s_cbranch_scc1 L_wa_173
    s_mul_i32 s17, s17, 18432
    s_add_u32 s17, s17, s34
    buffer_load_dwordx4 v[96:99], v4, s[64:67], s17 offen
    s_branch L_wb_174
                L_wa_173:
    s_sub_u32 s17, s17, 256
    s_mul_i32 s17, s17, 18432
    s_add_u32 s17, s17, s34
    buffer_load_dwordx4 v[96:99], v4, s[68:71], s17 offen
                L_wb_174:
    s_add_u32 s17, s35, 21
    s_cmp_ge_u32 s17, 256
    s_cbranch_scc1 L_wa_175
    s_mul_i32 s17, s17, 18432
    s_add_u32 s17, s17, s34
    buffer_load_dwordx4 v[100:103], v4, s[64:67], s17 offen
    s_branch L_wb_176
                L_wa_175:
    s_sub_u32 s17, s17, 256
    s_mul_i32 s17, s17, 18432
    s_add_u32 s17, s17, s34
    buffer_load_dwordx4 v[100:103], v4, s[68:71], s17 offen
                L_wb_176:
    s_add_u32 s17, s35, 22
    s_cmp_ge_u32 s17, 256
    s_cbranch_scc1 L_wa_177
    s_mul_i32 s17, s17, 18432
    s_add_u32 s17, s17, s34
    buffer_load_dwordx4 v[104:107], v4, s[64:67], s17 offen
    s_branch L_wb_178
                L_wa_177:
    s_sub_u32 s17, s17, 256
    s_mul_i32 s17, s17, 18432
    s_add_u32 s17, s17, s34
    buffer_load_dwordx4 v[104:107], v4, s[68:71], s17 offen
                L_wb_178:
    s_add_u32 s17, s35, 23
    s_cmp_ge_u32 s17, 256
    s_cbranch_scc1 L_wa_179
    s_mul_i32 s17, s17, 18432
    s_add_u32 s17, s17, s34
    buffer_load_dwordx4 v[108:111], v4, s[64:67], s17 offen
    s_branch L_wb_180
                L_wa_179:
    s_sub_u32 s17, s17, 256
    s_mul_i32 s17, s17, 18432
    s_add_u32 s17, s17, s34
    buffer_load_dwordx4 v[108:111], v4, s[68:71], s17 offen
                L_wb_180:
    s_add_u32 s17, s35, 24
    s_cmp_ge_u32 s17, 256
    s_cbranch_scc1 L_wa_181
    s_mul_i32 s17, s17, 18432
    s_add_u32 s17, s17, s34
    buffer_load_dwordx4 v[112:115], v4, s[64:67], s17 offen
    s_branch L_wb_182
                L_wa_181:
    s_sub_u32 s17, s17, 256
    s_mul_i32 s17, s17, 18432
    s_add_u32 s17, s17, s34
    buffer_load_dwordx4 v[112:115], v4, s[68:71], s17 offen
                L_wb_182:
    s_add_u32 s17, s35, 25
    s_cmp_ge_u32 s17, 256
    s_cbranch_scc1 L_wa_183
    s_mul_i32 s17, s17, 18432
    s_add_u32 s17, s17, s34
    buffer_load_dwordx4 v[116:119], v4, s[64:67], s17 offen
    s_branch L_wb_184
                L_wa_183:
    s_sub_u32 s17, s17, 256
    s_mul_i32 s17, s17, 18432
    s_add_u32 s17, s17, s34
    buffer_load_dwordx4 v[116:119], v4, s[68:71], s17 offen
                L_wb_184:
    s_add_u32 s17, s35, 26
    s_cmp_ge_u32 s17, 256
    s_cbranch_scc1 L_wa_185
    s_mul_i32 s17, s17, 18432
    s_add_u32 s17, s17, s34
    buffer_load_dwordx4 v[120:123], v4, s[64:67], s17 offen
    s_branch L_wb_186
                L_wa_185:
    s_sub_u32 s17, s17, 256
    s_mul_i32 s17, s17, 18432
    s_add_u32 s17, s17, s34
    buffer_load_dwordx4 v[120:123], v4, s[68:71], s17 offen
                L_wb_186:
    s_add_u32 s17, s35, 27
    s_cmp_ge_u32 s17, 256
    s_cbranch_scc1 L_wa_187
    s_mul_i32 s17, s17, 18432
    s_add_u32 s17, s17, s34
    buffer_load_dwordx4 v[124:127], v4, s[64:67], s17 offen
    s_branch L_wb_188
                L_wa_187:
    s_sub_u32 s17, s17, 256
    s_mul_i32 s17, s17, 18432
    s_add_u32 s17, s17, s34
    buffer_load_dwordx4 v[124:127], v4, s[68:71], s17 offen
                L_wb_188:
    s_add_u32 s17, s35, 28
    s_cmp_ge_u32 s17, 256
    s_cbranch_scc1 L_wa_189
    s_mul_i32 s17, s17, 18432
    s_add_u32 s17, s17, s34
    buffer_load_dwordx4 v[128:131], v4, s[64:67], s17 offen
    s_branch L_wb_190
                L_wa_189:
    s_sub_u32 s17, s17, 256
    s_mul_i32 s17, s17, 18432
    s_add_u32 s17, s17, s34
    buffer_load_dwordx4 v[128:131], v4, s[68:71], s17 offen
                L_wb_190:
    s_add_u32 s17, s35, 29
    s_cmp_ge_u32 s17, 256
    s_cbranch_scc1 L_wa_191
    s_mul_i32 s17, s17, 18432
    s_add_u32 s17, s17, s34
    buffer_load_dwordx4 v[132:135], v4, s[64:67], s17 offen
    s_branch L_wb_192
                L_wa_191:
    s_sub_u32 s17, s17, 256
    s_mul_i32 s17, s17, 18432
    s_add_u32 s17, s17, s34
    buffer_load_dwordx4 v[132:135], v4, s[68:71], s17 offen
                L_wb_192:
    s_add_u32 s17, s35, 30
    s_cmp_ge_u32 s17, 256
    s_cbranch_scc1 L_wa_193
    s_mul_i32 s17, s17, 18432
    s_add_u32 s17, s17, s34
    buffer_load_dwordx4 v[136:139], v4, s[64:67], s17 offen
    s_branch L_wb_194
                L_wa_193:
    s_sub_u32 s17, s17, 256
    s_mul_i32 s17, s17, 18432
    s_add_u32 s17, s17, s34
    buffer_load_dwordx4 v[136:139], v4, s[68:71], s17 offen
                L_wb_194:
    s_add_u32 s17, s35, 31
    s_cmp_ge_u32 s17, 256
    s_cbranch_scc1 L_wa_195
    s_mul_i32 s17, s17, 18432
    s_add_u32 s17, s17, s34
    buffer_load_dwordx4 v[140:143], v4, s[64:67], s17 offen
    s_branch L_wb_196
                L_wa_195:
    s_sub_u32 s17, s17, 256
    s_mul_i32 s17, s17, 18432
    s_add_u32 s17, s17, s34
    buffer_load_dwordx4 v[140:143], v4, s[68:71], s17 offen
                L_wb_196:
    s_waitcnt vmcnt(28)
    ds_write_b128 v5, v[16:19] offset:0
    ds_write_b128 v5, v[20:23] offset:1024
    ds_write_b128 v5, v[24:27] offset:2048
    ds_write_b128 v5, v[28:31] offset:3072
    s_add_u32 s17, s35, 0
    s_cmp_ge_u32 s17, 256
    s_cselect_b64 vcc, -1, 0
    s_cselect_b32 s20, 4, 8
    v_cndmask_b32 v8, v6, v7, vcc
    v_lshl_add_u32 v9, s20, 6, v8
    ds_read_b64_tr_b16 a[0:1], v8 offset:0
    ds_read_b64_tr_b16 a[2:3], v9 offset:0
    s_add_u32 s17, s35, 1
    s_cmp_ge_u32 s17, 256
    s_cselect_b64 vcc, -1, 0
    s_cselect_b32 s20, 4, 8
    v_cndmask_b32 v8, v6, v7, vcc
    v_lshl_add_u32 v9, s20, 6, v8
    ds_read_b64_tr_b16 a[4:5], v8 offset:1024
    ds_read_b64_tr_b16 a[6:7], v9 offset:1024
    s_add_u32 s17, s35, 2
    s_cmp_ge_u32 s17, 256
    s_cselect_b64 vcc, -1, 0
    s_cselect_b32 s20, 4, 8
    v_cndmask_b32 v8, v6, v7, vcc
    v_lshl_add_u32 v9, s20, 6, v8
    ds_read_b64_tr_b16 a[8:9], v8 offset:2048
    ds_read_b64_tr_b16 a[10:11], v9 offset:2048
    s_add_u32 s17, s35, 3
    s_cmp_ge_u32 s17, 256
    s_cselect_b64 vcc, -1, 0
    s_cselect_b32 s20, 4, 8
    v_cndmask_b32 v8, v6, v7, vcc
    v_lshl_add_u32 v9, s20, 6, v8
    ds_read_b64_tr_b16 a[12:13], v8 offset:3072
    ds_read_b64_tr_b16 a[14:15], v9 offset:3072
    s_waitcnt lgkmcnt(0)
    s_add_u32 s17, s35, 32
    s_cmp_ge_u32 s17, 256
    s_cbranch_scc1 L_wa_197
    s_mul_i32 s17, s17, 18432
    s_add_u32 s17, s17, s34
    buffer_load_dwordx4 v[16:19], v4, s[64:67], s17 offen
    s_branch L_wb_198
                L_wa_197:
    s_sub_u32 s17, s17, 256
    s_mul_i32 s17, s17, 18432
    s_add_u32 s17, s17, s34
    buffer_load_dwordx4 v[16:19], v4, s[68:71], s17 offen
                L_wb_198:
    s_add_u32 s17, s35, 33
    s_cmp_ge_u32 s17, 256
    s_cbranch_scc1 L_wa_199
    s_mul_i32 s17, s17, 18432
    s_add_u32 s17, s17, s34
    buffer_load_dwordx4 v[20:23], v4, s[64:67], s17 offen
    s_branch L_wb_200
                L_wa_199:
    s_sub_u32 s17, s17, 256
    s_mul_i32 s17, s17, 18432
    s_add_u32 s17, s17, s34
    buffer_load_dwordx4 v[20:23], v4, s[68:71], s17 offen
                L_wb_200:
    s_add_u32 s17, s35, 34
    s_cmp_ge_u32 s17, 256
    s_cbranch_scc1 L_wa_201
    s_mul_i32 s17, s17, 18432
    s_add_u32 s17, s17, s34
    buffer_load_dwordx4 v[24:27], v4, s[64:67], s17 offen
    s_branch L_wb_202
                L_wa_201:
    s_sub_u32 s17, s17, 256
    s_mul_i32 s17, s17, 18432
    s_add_u32 s17, s17, s34
    buffer_load_dwordx4 v[24:27], v4, s[68:71], s17 offen
                L_wb_202:
    s_add_u32 s17, s35, 35
    s_cmp_ge_u32 s17, 256
    s_cbranch_scc1 L_wa_203
    s_mul_i32 s17, s17, 18432
    s_add_u32 s17, s17, s34
    buffer_load_dwordx4 v[28:31], v4, s[64:67], s17 offen
    s_branch L_wb_204
                L_wa_203:
    s_sub_u32 s17, s17, 256
    s_mul_i32 s17, s17, 18432
    s_add_u32 s17, s17, s34
    buffer_load_dwordx4 v[28:31], v4, s[68:71], s17 offen
                L_wb_204:
    s_waitcnt vmcnt(28)
    ds_write_b128 v5, v[32:35] offset:0
    ds_write_b128 v5, v[36:39] offset:1024
    ds_write_b128 v5, v[40:43] offset:2048
    ds_write_b128 v5, v[44:47] offset:3072
    s_add_u32 s17, s35, 4
    s_cmp_ge_u32 s17, 256
    s_cselect_b64 vcc, -1, 0
    s_cselect_b32 s20, 4, 8
    v_cndmask_b32 v8, v6, v7, vcc
    v_lshl_add_u32 v9, s20, 6, v8
    ds_read_b64_tr_b16 a[16:17], v8 offset:0
    ds_read_b64_tr_b16 a[18:19], v9 offset:0
    s_add_u32 s17, s35, 5
    s_cmp_ge_u32 s17, 256
    s_cselect_b64 vcc, -1, 0
    s_cselect_b32 s20, 4, 8
    v_cndmask_b32 v8, v6, v7, vcc
    v_lshl_add_u32 v9, s20, 6, v8
    ds_read_b64_tr_b16 a[20:21], v8 offset:1024
    ds_read_b64_tr_b16 a[22:23], v9 offset:1024
    s_add_u32 s17, s35, 6
    s_cmp_ge_u32 s17, 256
    s_cselect_b64 vcc, -1, 0
    s_cselect_b32 s20, 4, 8
    v_cndmask_b32 v8, v6, v7, vcc
    v_lshl_add_u32 v9, s20, 6, v8
    ds_read_b64_tr_b16 a[24:25], v8 offset:2048
    ds_read_b64_tr_b16 a[26:27], v9 offset:2048
    s_add_u32 s17, s35, 7
    s_cmp_ge_u32 s17, 256
    s_cselect_b64 vcc, -1, 0
    s_cselect_b32 s20, 4, 8
    v_cndmask_b32 v8, v6, v7, vcc
    v_lshl_add_u32 v9, s20, 6, v8
    ds_read_b64_tr_b16 a[28:29], v8 offset:3072
    ds_read_b64_tr_b16 a[30:31], v9 offset:3072
    s_waitcnt lgkmcnt(0)
    s_add_u32 s17, s35, 36
    s_cmp_ge_u32 s17, 256
    s_cbranch_scc1 L_wa_205
    s_mul_i32 s17, s17, 18432
    s_add_u32 s17, s17, s34
    buffer_load_dwordx4 v[32:35], v4, s[64:67], s17 offen
    s_branch L_wb_206
                L_wa_205:
    s_sub_u32 s17, s17, 256
    s_mul_i32 s17, s17, 18432
    s_add_u32 s17, s17, s34
    buffer_load_dwordx4 v[32:35], v4, s[68:71], s17 offen
                L_wb_206:
    s_add_u32 s17, s35, 37
    s_cmp_ge_u32 s17, 256
    s_cbranch_scc1 L_wa_207
    s_mul_i32 s17, s17, 18432
    s_add_u32 s17, s17, s34
    buffer_load_dwordx4 v[36:39], v4, s[64:67], s17 offen
    s_branch L_wb_208
                L_wa_207:
    s_sub_u32 s17, s17, 256
    s_mul_i32 s17, s17, 18432
    s_add_u32 s17, s17, s34
    buffer_load_dwordx4 v[36:39], v4, s[68:71], s17 offen
                L_wb_208:
    s_add_u32 s17, s35, 38
    s_cmp_ge_u32 s17, 256
    s_cbranch_scc1 L_wa_209
    s_mul_i32 s17, s17, 18432
    s_add_u32 s17, s17, s34
    buffer_load_dwordx4 v[40:43], v4, s[64:67], s17 offen
    s_branch L_wb_210
                L_wa_209:
    s_sub_u32 s17, s17, 256
    s_mul_i32 s17, s17, 18432
    s_add_u32 s17, s17, s34
    buffer_load_dwordx4 v[40:43], v4, s[68:71], s17 offen
                L_wb_210:
    s_add_u32 s17, s35, 39
    s_cmp_ge_u32 s17, 256
    s_cbranch_scc1 L_wa_211
    s_mul_i32 s17, s17, 18432
    s_add_u32 s17, s17, s34
    buffer_load_dwordx4 v[44:47], v4, s[64:67], s17 offen
    s_branch L_wb_212
                L_wa_211:
    s_sub_u32 s17, s17, 256
    s_mul_i32 s17, s17, 18432
    s_add_u32 s17, s17, s34
    buffer_load_dwordx4 v[44:47], v4, s[68:71], s17 offen
                L_wb_212:
    s_waitcnt vmcnt(28)
    ds_write_b128 v5, v[48:51] offset:0
    ds_write_b128 v5, v[52:55] offset:1024
    ds_write_b128 v5, v[56:59] offset:2048
    ds_write_b128 v5, v[60:63] offset:3072
    s_add_u32 s17, s35, 8
    s_cmp_ge_u32 s17, 256
    s_cselect_b64 vcc, -1, 0
    s_cselect_b32 s20, 4, 8
    v_cndmask_b32 v8, v6, v7, vcc
    v_lshl_add_u32 v9, s20, 6, v8
    ds_read_b64_tr_b16 a[32:33], v8 offset:0
    ds_read_b64_tr_b16 a[34:35], v9 offset:0
    s_add_u32 s17, s35, 9
    s_cmp_ge_u32 s17, 256
    s_cselect_b64 vcc, -1, 0
    s_cselect_b32 s20, 4, 8
    v_cndmask_b32 v8, v6, v7, vcc
    v_lshl_add_u32 v9, s20, 6, v8
    ds_read_b64_tr_b16 a[36:37], v8 offset:1024
    ds_read_b64_tr_b16 a[38:39], v9 offset:1024
    s_add_u32 s17, s35, 10
    s_cmp_ge_u32 s17, 256
    s_cselect_b64 vcc, -1, 0
    s_cselect_b32 s20, 4, 8
    v_cndmask_b32 v8, v6, v7, vcc
    v_lshl_add_u32 v9, s20, 6, v8
    ds_read_b64_tr_b16 a[40:41], v8 offset:2048
    ds_read_b64_tr_b16 a[42:43], v9 offset:2048
    s_add_u32 s17, s35, 11
    s_cmp_ge_u32 s17, 256
    s_cselect_b64 vcc, -1, 0
    s_cselect_b32 s20, 4, 8
    v_cndmask_b32 v8, v6, v7, vcc
    v_lshl_add_u32 v9, s20, 6, v8
    ds_read_b64_tr_b16 a[44:45], v8 offset:3072
    ds_read_b64_tr_b16 a[46:47], v9 offset:3072
    s_waitcnt lgkmcnt(0)
    s_add_u32 s17, s35, 40
    s_cmp_ge_u32 s17, 256
    s_cbranch_scc1 L_wa_213
    s_mul_i32 s17, s17, 18432
    s_add_u32 s17, s17, s34
    buffer_load_dwordx4 v[48:51], v4, s[64:67], s17 offen
    s_branch L_wb_214
                L_wa_213:
    s_sub_u32 s17, s17, 256
    s_mul_i32 s17, s17, 18432
    s_add_u32 s17, s17, s34
    buffer_load_dwordx4 v[48:51], v4, s[68:71], s17 offen
                L_wb_214:
    s_add_u32 s17, s35, 41
    s_cmp_ge_u32 s17, 256
    s_cbranch_scc1 L_wa_215
    s_mul_i32 s17, s17, 18432
    s_add_u32 s17, s17, s34
    buffer_load_dwordx4 v[52:55], v4, s[64:67], s17 offen
    s_branch L_wb_216
                L_wa_215:
    s_sub_u32 s17, s17, 256
    s_mul_i32 s17, s17, 18432
    s_add_u32 s17, s17, s34
    buffer_load_dwordx4 v[52:55], v4, s[68:71], s17 offen
                L_wb_216:
    s_add_u32 s17, s35, 42
    s_cmp_ge_u32 s17, 256
    s_cbranch_scc1 L_wa_217
    s_mul_i32 s17, s17, 18432
    s_add_u32 s17, s17, s34
    buffer_load_dwordx4 v[56:59], v4, s[64:67], s17 offen
    s_branch L_wb_218
                L_wa_217:
    s_sub_u32 s17, s17, 256
    s_mul_i32 s17, s17, 18432
    s_add_u32 s17, s17, s34
    buffer_load_dwordx4 v[56:59], v4, s[68:71], s17 offen
                L_wb_218:
    s_add_u32 s17, s35, 43
    s_cmp_ge_u32 s17, 256
    s_cbranch_scc1 L_wa_219
    s_mul_i32 s17, s17, 18432
    s_add_u32 s17, s17, s34
    buffer_load_dwordx4 v[60:63], v4, s[64:67], s17 offen
    s_branch L_wb_220
                L_wa_219:
    s_sub_u32 s17, s17, 256
    s_mul_i32 s17, s17, 18432
    s_add_u32 s17, s17, s34
    buffer_load_dwordx4 v[60:63], v4, s[68:71], s17 offen
                L_wb_220:
    s_waitcnt vmcnt(28)
    ds_write_b128 v5, v[64:67] offset:0
    ds_write_b128 v5, v[68:71] offset:1024
    ds_write_b128 v5, v[72:75] offset:2048
    ds_write_b128 v5, v[76:79] offset:3072
    s_add_u32 s17, s35, 12
    s_cmp_ge_u32 s17, 256
    s_cselect_b64 vcc, -1, 0
    s_cselect_b32 s20, 4, 8
    v_cndmask_b32 v8, v6, v7, vcc
    v_lshl_add_u32 v9, s20, 6, v8
    ds_read_b64_tr_b16 a[48:49], v8 offset:0
    ds_read_b64_tr_b16 a[50:51], v9 offset:0
    s_add_u32 s17, s35, 13
    s_cmp_ge_u32 s17, 256
    s_cselect_b64 vcc, -1, 0
    s_cselect_b32 s20, 4, 8
    v_cndmask_b32 v8, v6, v7, vcc
    v_lshl_add_u32 v9, s20, 6, v8
    ds_read_b64_tr_b16 a[52:53], v8 offset:1024
    ds_read_b64_tr_b16 a[54:55], v9 offset:1024
    s_add_u32 s17, s35, 14
    s_cmp_ge_u32 s17, 256
    s_cselect_b64 vcc, -1, 0
    s_cselect_b32 s20, 4, 8
    v_cndmask_b32 v8, v6, v7, vcc
    v_lshl_add_u32 v9, s20, 6, v8
    ds_read_b64_tr_b16 a[56:57], v8 offset:2048
    ds_read_b64_tr_b16 a[58:59], v9 offset:2048
    s_add_u32 s17, s35, 15
    s_cmp_ge_u32 s17, 256
    s_cselect_b64 vcc, -1, 0
    s_cselect_b32 s20, 4, 8
    v_cndmask_b32 v8, v6, v7, vcc
    v_lshl_add_u32 v9, s20, 6, v8
    ds_read_b64_tr_b16 a[60:61], v8 offset:3072
    ds_read_b64_tr_b16 a[62:63], v9 offset:3072
    s_waitcnt lgkmcnt(0)
    s_add_u32 s17, s35, 44
    s_cmp_ge_u32 s17, 256
    s_cbranch_scc1 L_wa_221
    s_mul_i32 s17, s17, 18432
    s_add_u32 s17, s17, s34
    buffer_load_dwordx4 v[64:67], v4, s[64:67], s17 offen
    s_branch L_wb_222
                L_wa_221:
    s_sub_u32 s17, s17, 256
    s_mul_i32 s17, s17, 18432
    s_add_u32 s17, s17, s34
    buffer_load_dwordx4 v[64:67], v4, s[68:71], s17 offen
                L_wb_222:
    s_add_u32 s17, s35, 45
    s_cmp_ge_u32 s17, 256
    s_cbranch_scc1 L_wa_223
    s_mul_i32 s17, s17, 18432
    s_add_u32 s17, s17, s34
    buffer_load_dwordx4 v[68:71], v4, s[64:67], s17 offen
    s_branch L_wb_224
                L_wa_223:
    s_sub_u32 s17, s17, 256
    s_mul_i32 s17, s17, 18432
    s_add_u32 s17, s17, s34
    buffer_load_dwordx4 v[68:71], v4, s[68:71], s17 offen
                L_wb_224:
    s_add_u32 s17, s35, 46
    s_cmp_ge_u32 s17, 256
    s_cbranch_scc1 L_wa_225
    s_mul_i32 s17, s17, 18432
    s_add_u32 s17, s17, s34
    buffer_load_dwordx4 v[72:75], v4, s[64:67], s17 offen
    s_branch L_wb_226
                L_wa_225:
    s_sub_u32 s17, s17, 256
    s_mul_i32 s17, s17, 18432
    s_add_u32 s17, s17, s34
    buffer_load_dwordx4 v[72:75], v4, s[68:71], s17 offen
                L_wb_226:
    s_add_u32 s17, s35, 47
    s_cmp_ge_u32 s17, 256
    s_cbranch_scc1 L_wa_227
    s_mul_i32 s17, s17, 18432
    s_add_u32 s17, s17, s34
    buffer_load_dwordx4 v[76:79], v4, s[64:67], s17 offen
    s_branch L_wb_228
                L_wa_227:
    s_sub_u32 s17, s17, 256
    s_mul_i32 s17, s17, 18432
    s_add_u32 s17, s17, s34
    buffer_load_dwordx4 v[76:79], v4, s[68:71], s17 offen
                L_wb_228:
    s_waitcnt vmcnt(28)
    ds_write_b128 v5, v[80:83] offset:0
    ds_write_b128 v5, v[84:87] offset:1024
    ds_write_b128 v5, v[88:91] offset:2048
    ds_write_b128 v5, v[92:95] offset:3072
    s_add_u32 s17, s35, 16
    s_cmp_ge_u32 s17, 256
    s_cselect_b64 vcc, -1, 0
    s_cselect_b32 s20, 4, 8
    v_cndmask_b32 v8, v6, v7, vcc
    v_lshl_add_u32 v9, s20, 6, v8
    ds_read_b64_tr_b16 a[64:65], v8 offset:0
    ds_read_b64_tr_b16 a[66:67], v9 offset:0
    s_add_u32 s17, s35, 17
    s_cmp_ge_u32 s17, 256
    s_cselect_b64 vcc, -1, 0
    s_cselect_b32 s20, 4, 8
    v_cndmask_b32 v8, v6, v7, vcc
    v_lshl_add_u32 v9, s20, 6, v8
    ds_read_b64_tr_b16 a[68:69], v8 offset:1024
    ds_read_b64_tr_b16 a[70:71], v9 offset:1024
    s_add_u32 s17, s35, 18
    s_cmp_ge_u32 s17, 256
    s_cselect_b64 vcc, -1, 0
    s_cselect_b32 s20, 4, 8
    v_cndmask_b32 v8, v6, v7, vcc
    v_lshl_add_u32 v9, s20, 6, v8
    ds_read_b64_tr_b16 a[72:73], v8 offset:2048
    ds_read_b64_tr_b16 a[74:75], v9 offset:2048
    s_add_u32 s17, s35, 19
    s_cmp_ge_u32 s17, 256
    s_cselect_b64 vcc, -1, 0
    s_cselect_b32 s20, 4, 8
    v_cndmask_b32 v8, v6, v7, vcc
    v_lshl_add_u32 v9, s20, 6, v8
    ds_read_b64_tr_b16 a[76:77], v8 offset:3072
    ds_read_b64_tr_b16 a[78:79], v9 offset:3072
    s_waitcnt lgkmcnt(0)
    s_add_u32 s17, s35, 48
    s_cmp_ge_u32 s17, 256
    s_cbranch_scc1 L_wa_229
    s_mul_i32 s17, s17, 18432
    s_add_u32 s17, s17, s34
    buffer_load_dwordx4 v[80:83], v4, s[64:67], s17 offen
    s_branch L_wb_230
                L_wa_229:
    s_sub_u32 s17, s17, 256
    s_mul_i32 s17, s17, 18432
    s_add_u32 s17, s17, s34
    buffer_load_dwordx4 v[80:83], v4, s[68:71], s17 offen
                L_wb_230:
    s_add_u32 s17, s35, 49
    s_cmp_ge_u32 s17, 256
    s_cbranch_scc1 L_wa_231
    s_mul_i32 s17, s17, 18432
    s_add_u32 s17, s17, s34
    buffer_load_dwordx4 v[84:87], v4, s[64:67], s17 offen
    s_branch L_wb_232
                L_wa_231:
    s_sub_u32 s17, s17, 256
    s_mul_i32 s17, s17, 18432
    s_add_u32 s17, s17, s34
    buffer_load_dwordx4 v[84:87], v4, s[68:71], s17 offen
                L_wb_232:
    s_add_u32 s17, s35, 50
    s_cmp_ge_u32 s17, 256
    s_cbranch_scc1 L_wa_233
    s_mul_i32 s17, s17, 18432
    s_add_u32 s17, s17, s34
    buffer_load_dwordx4 v[88:91], v4, s[64:67], s17 offen
    s_branch L_wb_234
                L_wa_233:
    s_sub_u32 s17, s17, 256
    s_mul_i32 s17, s17, 18432
    s_add_u32 s17, s17, s34
    buffer_load_dwordx4 v[88:91], v4, s[68:71], s17 offen
                L_wb_234:
    s_add_u32 s17, s35, 51
    s_cmp_ge_u32 s17, 256
    s_cbranch_scc1 L_wa_235
    s_mul_i32 s17, s17, 18432
    s_add_u32 s17, s17, s34
    buffer_load_dwordx4 v[92:95], v4, s[64:67], s17 offen
    s_branch L_wb_236
                L_wa_235:
    s_sub_u32 s17, s17, 256
    s_mul_i32 s17, s17, 18432
    s_add_u32 s17, s17, s34
    buffer_load_dwordx4 v[92:95], v4, s[68:71], s17 offen
                L_wb_236:
    s_waitcnt vmcnt(28)
    ds_write_b128 v5, v[96:99] offset:0
    ds_write_b128 v5, v[100:103] offset:1024
    ds_write_b128 v5, v[104:107] offset:2048
    ds_write_b128 v5, v[108:111] offset:3072
    s_add_u32 s17, s35, 20
    s_cmp_ge_u32 s17, 256
    s_cselect_b64 vcc, -1, 0
    s_cselect_b32 s20, 4, 8
    v_cndmask_b32 v8, v6, v7, vcc
    v_lshl_add_u32 v9, s20, 6, v8
    ds_read_b64_tr_b16 a[80:81], v8 offset:0
    ds_read_b64_tr_b16 a[82:83], v9 offset:0
    s_add_u32 s17, s35, 21
    s_cmp_ge_u32 s17, 256
    s_cselect_b64 vcc, -1, 0
    s_cselect_b32 s20, 4, 8
    v_cndmask_b32 v8, v6, v7, vcc
    v_lshl_add_u32 v9, s20, 6, v8
    ds_read_b64_tr_b16 a[84:85], v8 offset:1024
    ds_read_b64_tr_b16 a[86:87], v9 offset:1024
    s_add_u32 s17, s35, 22
    s_cmp_ge_u32 s17, 256
    s_cselect_b64 vcc, -1, 0
    s_cselect_b32 s20, 4, 8
    v_cndmask_b32 v8, v6, v7, vcc
    v_lshl_add_u32 v9, s20, 6, v8
    ds_read_b64_tr_b16 a[88:89], v8 offset:2048
    ds_read_b64_tr_b16 a[90:91], v9 offset:2048
    s_add_u32 s17, s35, 23
    s_cmp_ge_u32 s17, 256
    s_cselect_b64 vcc, -1, 0
    s_cselect_b32 s20, 4, 8
    v_cndmask_b32 v8, v6, v7, vcc
    v_lshl_add_u32 v9, s20, 6, v8
    ds_read_b64_tr_b16 a[92:93], v8 offset:3072
    ds_read_b64_tr_b16 a[94:95], v9 offset:3072
    s_waitcnt lgkmcnt(0)
    s_add_u32 s17, s35, 52
    s_cmp_ge_u32 s17, 256
    s_cbranch_scc1 L_wa_237
    s_mul_i32 s17, s17, 18432
    s_add_u32 s17, s17, s34
    buffer_load_dwordx4 v[96:99], v4, s[64:67], s17 offen
    s_branch L_wb_238
                L_wa_237:
    s_sub_u32 s17, s17, 256
    s_mul_i32 s17, s17, 18432
    s_add_u32 s17, s17, s34
    buffer_load_dwordx4 v[96:99], v4, s[68:71], s17 offen
                L_wb_238:
    s_add_u32 s17, s35, 53
    s_cmp_ge_u32 s17, 256
    s_cbranch_scc1 L_wa_239
    s_mul_i32 s17, s17, 18432
    s_add_u32 s17, s17, s34
    buffer_load_dwordx4 v[100:103], v4, s[64:67], s17 offen
    s_branch L_wb_240
                L_wa_239:
    s_sub_u32 s17, s17, 256
    s_mul_i32 s17, s17, 18432
    s_add_u32 s17, s17, s34
    buffer_load_dwordx4 v[100:103], v4, s[68:71], s17 offen
                L_wb_240:
    s_add_u32 s17, s35, 54
    s_cmp_ge_u32 s17, 256
    s_cbranch_scc1 L_wa_241
    s_mul_i32 s17, s17, 18432
    s_add_u32 s17, s17, s34
    buffer_load_dwordx4 v[104:107], v4, s[64:67], s17 offen
    s_branch L_wb_242
                L_wa_241:
    s_sub_u32 s17, s17, 256
    s_mul_i32 s17, s17, 18432
    s_add_u32 s17, s17, s34
    buffer_load_dwordx4 v[104:107], v4, s[68:71], s17 offen
                L_wb_242:
    s_add_u32 s17, s35, 55
    s_cmp_ge_u32 s17, 256
    s_cbranch_scc1 L_wa_243
    s_mul_i32 s17, s17, 18432
    s_add_u32 s17, s17, s34
    buffer_load_dwordx4 v[108:111], v4, s[64:67], s17 offen
    s_branch L_wb_244
                L_wa_243:
    s_sub_u32 s17, s17, 256
    s_mul_i32 s17, s17, 18432
    s_add_u32 s17, s17, s34
    buffer_load_dwordx4 v[108:111], v4, s[68:71], s17 offen
                L_wb_244:
    s_waitcnt vmcnt(28)
    ds_write_b128 v5, v[112:115] offset:0
    ds_write_b128 v5, v[116:119] offset:1024
    ds_write_b128 v5, v[120:123] offset:2048
    ds_write_b128 v5, v[124:127] offset:3072
    s_add_u32 s17, s35, 24
    s_cmp_ge_u32 s17, 256
    s_cselect_b64 vcc, -1, 0
    s_cselect_b32 s20, 4, 8
    v_cndmask_b32 v8, v6, v7, vcc
    v_lshl_add_u32 v9, s20, 6, v8
    ds_read_b64_tr_b16 a[96:97], v8 offset:0
    ds_read_b64_tr_b16 a[98:99], v9 offset:0
    s_add_u32 s17, s35, 25
    s_cmp_ge_u32 s17, 256
    s_cselect_b64 vcc, -1, 0
    s_cselect_b32 s20, 4, 8
    v_cndmask_b32 v8, v6, v7, vcc
    v_lshl_add_u32 v9, s20, 6, v8
    ds_read_b64_tr_b16 a[100:101], v8 offset:1024
    ds_read_b64_tr_b16 a[102:103], v9 offset:1024
    s_add_u32 s17, s35, 26
    s_cmp_ge_u32 s17, 256
    s_cselect_b64 vcc, -1, 0
    s_cselect_b32 s20, 4, 8
    v_cndmask_b32 v8, v6, v7, vcc
    v_lshl_add_u32 v9, s20, 6, v8
    ds_read_b64_tr_b16 a[104:105], v8 offset:2048
    ds_read_b64_tr_b16 a[106:107], v9 offset:2048
    s_add_u32 s17, s35, 27
    s_cmp_ge_u32 s17, 256
    s_cselect_b64 vcc, -1, 0
    s_cselect_b32 s20, 4, 8
    v_cndmask_b32 v8, v6, v7, vcc
    v_lshl_add_u32 v9, s20, 6, v8
    ds_read_b64_tr_b16 a[108:109], v8 offset:3072
    ds_read_b64_tr_b16 a[110:111], v9 offset:3072
    s_waitcnt lgkmcnt(0)
    s_add_u32 s17, s35, 56
    s_cmp_ge_u32 s17, 256
    s_cbranch_scc1 L_wa_245
    s_mul_i32 s17, s17, 18432
    s_add_u32 s17, s17, s34
    buffer_load_dwordx4 v[112:115], v4, s[64:67], s17 offen
    s_branch L_wb_246
                L_wa_245:
    s_sub_u32 s17, s17, 256
    s_mul_i32 s17, s17, 18432
    s_add_u32 s17, s17, s34
    buffer_load_dwordx4 v[112:115], v4, s[68:71], s17 offen
                L_wb_246:
    s_add_u32 s17, s35, 57
    s_cmp_ge_u32 s17, 256
    s_cbranch_scc1 L_wa_247
    s_mul_i32 s17, s17, 18432
    s_add_u32 s17, s17, s34
    buffer_load_dwordx4 v[116:119], v4, s[64:67], s17 offen
    s_branch L_wb_248
                L_wa_247:
    s_sub_u32 s17, s17, 256
    s_mul_i32 s17, s17, 18432
    s_add_u32 s17, s17, s34
    buffer_load_dwordx4 v[116:119], v4, s[68:71], s17 offen
                L_wb_248:
    s_add_u32 s17, s35, 58
    s_cmp_ge_u32 s17, 256
    s_cbranch_scc1 L_wa_249
    s_mul_i32 s17, s17, 18432
    s_add_u32 s17, s17, s34
    buffer_load_dwordx4 v[120:123], v4, s[64:67], s17 offen
    s_branch L_wb_250
                L_wa_249:
    s_sub_u32 s17, s17, 256
    s_mul_i32 s17, s17, 18432
    s_add_u32 s17, s17, s34
    buffer_load_dwordx4 v[120:123], v4, s[68:71], s17 offen
                L_wb_250:
    s_add_u32 s17, s35, 59
    s_cmp_ge_u32 s17, 256
    s_cbranch_scc1 L_wa_251
    s_mul_i32 s17, s17, 18432
    s_add_u32 s17, s17, s34
    buffer_load_dwordx4 v[124:127], v4, s[64:67], s17 offen
    s_branch L_wb_252
                L_wa_251:
    s_sub_u32 s17, s17, 256
    s_mul_i32 s17, s17, 18432
    s_add_u32 s17, s17, s34
    buffer_load_dwordx4 v[124:127], v4, s[68:71], s17 offen
                L_wb_252:
    s_waitcnt vmcnt(28)
    ds_write_b128 v5, v[128:131] offset:0
    ds_write_b128 v5, v[132:135] offset:1024
    ds_write_b128 v5, v[136:139] offset:2048
    ds_write_b128 v5, v[140:143] offset:3072
    s_add_u32 s17, s35, 28
    s_cmp_ge_u32 s17, 256
    s_cselect_b64 vcc, -1, 0
    s_cselect_b32 s20, 4, 8
    v_cndmask_b32 v8, v6, v7, vcc
    v_lshl_add_u32 v9, s20, 6, v8
    ds_read_b64_tr_b16 a[112:113], v8 offset:0
    ds_read_b64_tr_b16 a[114:115], v9 offset:0
    s_add_u32 s17, s35, 29
    s_cmp_ge_u32 s17, 256
    s_cselect_b64 vcc, -1, 0
    s_cselect_b32 s20, 4, 8
    v_cndmask_b32 v8, v6, v7, vcc
    v_lshl_add_u32 v9, s20, 6, v8
    ds_read_b64_tr_b16 a[116:117], v8 offset:1024
    ds_read_b64_tr_b16 a[118:119], v9 offset:1024
    s_add_u32 s17, s35, 30
    s_cmp_ge_u32 s17, 256
    s_cselect_b64 vcc, -1, 0
    s_cselect_b32 s20, 4, 8
    v_cndmask_b32 v8, v6, v7, vcc
    v_lshl_add_u32 v9, s20, 6, v8
    ds_read_b64_tr_b16 a[120:121], v8 offset:2048
    ds_read_b64_tr_b16 a[122:123], v9 offset:2048
    s_add_u32 s17, s35, 31
    s_cmp_ge_u32 s17, 256
    s_cselect_b64 vcc, -1, 0
    s_cselect_b32 s20, 4, 8
    v_cndmask_b32 v8, v6, v7, vcc
    v_lshl_add_u32 v9, s20, 6, v8
    ds_read_b64_tr_b16 a[124:125], v8 offset:3072
    ds_read_b64_tr_b16 a[126:127], v9 offset:3072
    s_waitcnt lgkmcnt(0)
    s_add_u32 s17, s35, 60
    s_cmp_ge_u32 s17, 256
    s_cbranch_scc1 L_wa_253
    s_mul_i32 s17, s17, 18432
    s_add_u32 s17, s17, s34
    buffer_load_dwordx4 v[128:131], v4, s[64:67], s17 offen
    s_branch L_wb_254
                L_wa_253:
    s_sub_u32 s17, s17, 256
    s_mul_i32 s17, s17, 18432
    s_add_u32 s17, s17, s34
    buffer_load_dwordx4 v[128:131], v4, s[68:71], s17 offen
                L_wb_254:
    s_add_u32 s17, s35, 61
    s_cmp_ge_u32 s17, 256
    s_cbranch_scc1 L_wa_255
    s_mul_i32 s17, s17, 18432
    s_add_u32 s17, s17, s34
    buffer_load_dwordx4 v[132:135], v4, s[64:67], s17 offen
    s_branch L_wb_256
                L_wa_255:
    s_sub_u32 s17, s17, 256
    s_mul_i32 s17, s17, 18432
    s_add_u32 s17, s17, s34
    buffer_load_dwordx4 v[132:135], v4, s[68:71], s17 offen
                L_wb_256:
    s_add_u32 s17, s35, 62
    s_cmp_ge_u32 s17, 256
    s_cbranch_scc1 L_wa_257
    s_mul_i32 s17, s17, 18432
    s_add_u32 s17, s17, s34
    buffer_load_dwordx4 v[136:139], v4, s[64:67], s17 offen
    s_branch L_wb_258
                L_wa_257:
    s_sub_u32 s17, s17, 256
    s_mul_i32 s17, s17, 18432
    s_add_u32 s17, s17, s34
    buffer_load_dwordx4 v[136:139], v4, s[68:71], s17 offen
                L_wb_258:
    s_add_u32 s17, s35, 63
    s_cmp_ge_u32 s17, 256
    s_cbranch_scc1 L_wa_259
    s_mul_i32 s17, s17, 18432
    s_add_u32 s17, s17, s34
    buffer_load_dwordx4 v[140:143], v4, s[64:67], s17 offen
    s_branch L_wb_260
                L_wa_259:
    s_sub_u32 s17, s17, 256
    s_mul_i32 s17, s17, 18432
    s_add_u32 s17, s17, s34
    buffer_load_dwordx4 v[140:143], v4, s[68:71], s17 offen
                L_wb_260:
    s_waitcnt vmcnt(28)
    ds_write_b128 v5, v[16:19] offset:0
    ds_write_b128 v5, v[20:23] offset:1024
    ds_write_b128 v5, v[24:27] offset:2048
    ds_write_b128 v5, v[28:31] offset:3072
    s_add_u32 s17, s35, 32
    s_cmp_ge_u32 s17, 256
    s_cselect_b64 vcc, -1, 0
    s_cselect_b32 s20, 4, 8
    v_cndmask_b32 v8, v6, v7, vcc
    v_lshl_add_u32 v9, s20, 6, v8
    ds_read_b64_tr_b16 a[128:129], v8 offset:0
    ds_read_b64_tr_b16 a[130:131], v9 offset:0
    s_add_u32 s17, s35, 33
    s_cmp_ge_u32 s17, 256
    s_cselect_b64 vcc, -1, 0
    s_cselect_b32 s20, 4, 8
    v_cndmask_b32 v8, v6, v7, vcc
    v_lshl_add_u32 v9, s20, 6, v8
    ds_read_b64_tr_b16 a[132:133], v8 offset:1024
    ds_read_b64_tr_b16 a[134:135], v9 offset:1024
    s_add_u32 s17, s35, 34
    s_cmp_ge_u32 s17, 256
    s_cselect_b64 vcc, -1, 0
    s_cselect_b32 s20, 4, 8
    v_cndmask_b32 v8, v6, v7, vcc
    v_lshl_add_u32 v9, s20, 6, v8
    ds_read_b64_tr_b16 a[136:137], v8 offset:2048
    ds_read_b64_tr_b16 a[138:139], v9 offset:2048
    s_add_u32 s17, s35, 35
    s_cmp_ge_u32 s17, 256
    s_cselect_b64 vcc, -1, 0
    s_cselect_b32 s20, 4, 8
    v_cndmask_b32 v8, v6, v7, vcc
    v_lshl_add_u32 v9, s20, 6, v8
    ds_read_b64_tr_b16 a[140:141], v8 offset:3072
    ds_read_b64_tr_b16 a[142:143], v9 offset:3072
    s_waitcnt lgkmcnt(0)
    s_add_u32 s17, s35, 64
    s_cmp_ge_u32 s17, 256
    s_cbranch_scc1 L_wa_261
    s_mul_i32 s17, s17, 18432
    s_add_u32 s17, s17, s34
    buffer_load_dwordx4 v[16:19], v4, s[64:67], s17 offen
    s_branch L_wb_262
                L_wa_261:
    s_sub_u32 s17, s17, 256
    s_mul_i32 s17, s17, 18432
    s_add_u32 s17, s17, s34
    buffer_load_dwordx4 v[16:19], v4, s[68:71], s17 offen
                L_wb_262:
    s_add_u32 s17, s35, 65
    s_cmp_ge_u32 s17, 256
    s_cbranch_scc1 L_wa_263
    s_mul_i32 s17, s17, 18432
    s_add_u32 s17, s17, s34
    buffer_load_dwordx4 v[20:23], v4, s[64:67], s17 offen
    s_branch L_wb_264
                L_wa_263:
    s_sub_u32 s17, s17, 256
    s_mul_i32 s17, s17, 18432
    s_add_u32 s17, s17, s34
    buffer_load_dwordx4 v[20:23], v4, s[68:71], s17 offen
                L_wb_264:
    s_add_u32 s17, s35, 66
    s_cmp_ge_u32 s17, 256
    s_cbranch_scc1 L_wa_265
    s_mul_i32 s17, s17, 18432
    s_add_u32 s17, s17, s34
    buffer_load_dwordx4 v[24:27], v4, s[64:67], s17 offen
    s_branch L_wb_266
                L_wa_265:
    s_sub_u32 s17, s17, 256
    s_mul_i32 s17, s17, 18432
    s_add_u32 s17, s17, s34
    buffer_load_dwordx4 v[24:27], v4, s[68:71], s17 offen
                L_wb_266:
    s_add_u32 s17, s35, 67
    s_cmp_ge_u32 s17, 256
    s_cbranch_scc1 L_wa_267
    s_mul_i32 s17, s17, 18432
    s_add_u32 s17, s17, s34
    buffer_load_dwordx4 v[28:31], v4, s[64:67], s17 offen
    s_branch L_wb_268
                L_wa_267:
    s_sub_u32 s17, s17, 256
    s_mul_i32 s17, s17, 18432
    s_add_u32 s17, s17, s34
    buffer_load_dwordx4 v[28:31], v4, s[68:71], s17 offen
                L_wb_268:
    s_waitcnt vmcnt(28)
    ds_write_b128 v5, v[32:35] offset:0
    ds_write_b128 v5, v[36:39] offset:1024
    ds_write_b128 v5, v[40:43] offset:2048
    ds_write_b128 v5, v[44:47] offset:3072
    s_add_u32 s17, s35, 36
    s_cmp_ge_u32 s17, 256
    s_cselect_b64 vcc, -1, 0
    s_cselect_b32 s20, 4, 8
    v_cndmask_b32 v8, v6, v7, vcc
    v_lshl_add_u32 v9, s20, 6, v8
    ds_read_b64_tr_b16 a[144:145], v8 offset:0
    ds_read_b64_tr_b16 a[146:147], v9 offset:0
    s_add_u32 s17, s35, 37
    s_cmp_ge_u32 s17, 256
    s_cselect_b64 vcc, -1, 0
    s_cselect_b32 s20, 4, 8
    v_cndmask_b32 v8, v6, v7, vcc
    v_lshl_add_u32 v9, s20, 6, v8
    ds_read_b64_tr_b16 a[148:149], v8 offset:1024
    ds_read_b64_tr_b16 a[150:151], v9 offset:1024
    s_add_u32 s17, s35, 38
    s_cmp_ge_u32 s17, 256
    s_cselect_b64 vcc, -1, 0
    s_cselect_b32 s20, 4, 8
    v_cndmask_b32 v8, v6, v7, vcc
    v_lshl_add_u32 v9, s20, 6, v8
    ds_read_b64_tr_b16 a[152:153], v8 offset:2048
    ds_read_b64_tr_b16 a[154:155], v9 offset:2048
    s_add_u32 s17, s35, 39
    s_cmp_ge_u32 s17, 256
    s_cselect_b64 vcc, -1, 0
    s_cselect_b32 s20, 4, 8
    v_cndmask_b32 v8, v6, v7, vcc
    v_lshl_add_u32 v9, s20, 6, v8
    ds_read_b64_tr_b16 a[156:157], v8 offset:3072
    ds_read_b64_tr_b16 a[158:159], v9 offset:3072
    s_waitcnt lgkmcnt(0)
    s_add_u32 s17, s35, 68
    s_cmp_ge_u32 s17, 256
    s_cbranch_scc1 L_wa_269
    s_mul_i32 s17, s17, 18432
    s_add_u32 s17, s17, s34
    buffer_load_dwordx4 v[32:35], v4, s[64:67], s17 offen
    s_branch L_wb_270
                L_wa_269:
    s_sub_u32 s17, s17, 256
    s_mul_i32 s17, s17, 18432
    s_add_u32 s17, s17, s34
    buffer_load_dwordx4 v[32:35], v4, s[68:71], s17 offen
                L_wb_270:
    s_add_u32 s17, s35, 69
    s_cmp_ge_u32 s17, 256
    s_cbranch_scc1 L_wa_271
    s_mul_i32 s17, s17, 18432
    s_add_u32 s17, s17, s34
    buffer_load_dwordx4 v[36:39], v4, s[64:67], s17 offen
    s_branch L_wb_272
                L_wa_271:
    s_sub_u32 s17, s17, 256
    s_mul_i32 s17, s17, 18432
    s_add_u32 s17, s17, s34
    buffer_load_dwordx4 v[36:39], v4, s[68:71], s17 offen
                L_wb_272:
    s_add_u32 s17, s35, 70
    s_cmp_ge_u32 s17, 256
    s_cbranch_scc1 L_wa_273
    s_mul_i32 s17, s17, 18432
    s_add_u32 s17, s17, s34
    buffer_load_dwordx4 v[40:43], v4, s[64:67], s17 offen
    s_branch L_wb_274
                L_wa_273:
    s_sub_u32 s17, s17, 256
    s_mul_i32 s17, s17, 18432
    s_add_u32 s17, s17, s34
    buffer_load_dwordx4 v[40:43], v4, s[68:71], s17 offen
                L_wb_274:
    s_add_u32 s17, s35, 71
    s_cmp_ge_u32 s17, 256
    s_cbranch_scc1 L_wa_275
    s_mul_i32 s17, s17, 18432
    s_add_u32 s17, s17, s34
    buffer_load_dwordx4 v[44:47], v4, s[64:67], s17 offen
    s_branch L_wb_276
                L_wa_275:
    s_sub_u32 s17, s17, 256
    s_mul_i32 s17, s17, 18432
    s_add_u32 s17, s17, s34
    buffer_load_dwordx4 v[44:47], v4, s[68:71], s17 offen
                L_wb_276:
    s_waitcnt vmcnt(28)
    ds_write_b128 v5, v[48:51] offset:0
    ds_write_b128 v5, v[52:55] offset:1024
    ds_write_b128 v5, v[56:59] offset:2048
    ds_write_b128 v5, v[60:63] offset:3072
    s_add_u32 s17, s35, 40
    s_cmp_ge_u32 s17, 256
    s_cselect_b64 vcc, -1, 0
    s_cselect_b32 s20, 4, 8
    v_cndmask_b32 v8, v6, v7, vcc
    v_lshl_add_u32 v9, s20, 6, v8
    ds_read_b64_tr_b16 a[160:161], v8 offset:0
    ds_read_b64_tr_b16 a[162:163], v9 offset:0
    s_add_u32 s17, s35, 41
    s_cmp_ge_u32 s17, 256
    s_cselect_b64 vcc, -1, 0
    s_cselect_b32 s20, 4, 8
    v_cndmask_b32 v8, v6, v7, vcc
    v_lshl_add_u32 v9, s20, 6, v8
    ds_read_b64_tr_b16 a[164:165], v8 offset:1024
    ds_read_b64_tr_b16 a[166:167], v9 offset:1024
    s_add_u32 s17, s35, 42
    s_cmp_ge_u32 s17, 256
    s_cselect_b64 vcc, -1, 0
    s_cselect_b32 s20, 4, 8
    v_cndmask_b32 v8, v6, v7, vcc
    v_lshl_add_u32 v9, s20, 6, v8
    ds_read_b64_tr_b16 a[168:169], v8 offset:2048
    ds_read_b64_tr_b16 a[170:171], v9 offset:2048
    s_add_u32 s17, s35, 43
    s_cmp_ge_u32 s17, 256
    s_cselect_b64 vcc, -1, 0
    s_cselect_b32 s20, 4, 8
    v_cndmask_b32 v8, v6, v7, vcc
    v_lshl_add_u32 v9, s20, 6, v8
    ds_read_b64_tr_b16 a[172:173], v8 offset:3072
    ds_read_b64_tr_b16 a[174:175], v9 offset:3072
    s_waitcnt lgkmcnt(0)
    s_add_u32 s17, s35, 72
    s_cmp_ge_u32 s17, 256
    s_cbranch_scc1 L_wa_277
    s_mul_i32 s17, s17, 18432
    s_add_u32 s17, s17, s34
    buffer_load_dwordx4 v[48:51], v4, s[64:67], s17 offen
    s_branch L_wb_278
                L_wa_277:
    s_sub_u32 s17, s17, 256
    s_mul_i32 s17, s17, 18432
    s_add_u32 s17, s17, s34
    buffer_load_dwordx4 v[48:51], v4, s[68:71], s17 offen
                L_wb_278:
    s_waitcnt vmcnt(25)
    ds_write_b128 v5, v[64:67] offset:0
    ds_write_b128 v5, v[68:71] offset:1024
    ds_write_b128 v5, v[72:75] offset:2048
    ds_write_b128 v5, v[76:79] offset:3072
    s_add_u32 s17, s35, 44
    s_cmp_ge_u32 s17, 256
    s_cselect_b64 vcc, -1, 0
    s_cselect_b32 s20, 4, 8
    v_cndmask_b32 v8, v6, v7, vcc
    v_lshl_add_u32 v9, s20, 6, v8
    ds_read_b64_tr_b16 a[176:177], v8 offset:0
    ds_read_b64_tr_b16 a[178:179], v9 offset:0
    s_add_u32 s17, s35, 45
    s_cmp_ge_u32 s17, 256
    s_cselect_b64 vcc, -1, 0
    s_cselect_b32 s20, 4, 8
    v_cndmask_b32 v8, v6, v7, vcc
    v_lshl_add_u32 v9, s20, 6, v8
    ds_read_b64_tr_b16 a[180:181], v8 offset:1024
    ds_read_b64_tr_b16 a[182:183], v9 offset:1024
    s_add_u32 s17, s35, 46
    s_cmp_ge_u32 s17, 256
    s_cselect_b64 vcc, -1, 0
    s_cselect_b32 s20, 4, 8
    v_cndmask_b32 v8, v6, v7, vcc
    v_lshl_add_u32 v9, s20, 6, v8
    ds_read_b64_tr_b16 a[184:185], v8 offset:2048
    ds_read_b64_tr_b16 a[186:187], v9 offset:2048
    s_add_u32 s17, s35, 47
    s_cmp_ge_u32 s17, 256
    s_cselect_b64 vcc, -1, 0
    s_cselect_b32 s20, 4, 8
    v_cndmask_b32 v8, v6, v7, vcc
    v_lshl_add_u32 v9, s20, 6, v8
    ds_read_b64_tr_b16 a[188:189], v8 offset:3072
    ds_read_b64_tr_b16 a[190:191], v9 offset:3072
    s_waitcnt lgkmcnt(0)
    s_waitcnt vmcnt(21)
    ds_write_b128 v5, v[80:83] offset:0
    ds_write_b128 v5, v[84:87] offset:1024
    ds_write_b128 v5, v[88:91] offset:2048
    ds_write_b128 v5, v[92:95] offset:3072
    s_add_u32 s17, s35, 48
    s_cmp_ge_u32 s17, 256
    s_cselect_b64 vcc, -1, 0
    s_cselect_b32 s20, 4, 8
    v_cndmask_b32 v8, v6, v7, vcc
    v_lshl_add_u32 v9, s20, 6, v8
    ds_read_b64_tr_b16 a[192:193], v8 offset:0
    ds_read_b64_tr_b16 a[194:195], v9 offset:0
    s_add_u32 s17, s35, 49
    s_cmp_ge_u32 s17, 256
    s_cselect_b64 vcc, -1, 0
    s_cselect_b32 s20, 4, 8
    v_cndmask_b32 v8, v6, v7, vcc
    v_lshl_add_u32 v9, s20, 6, v8
    ds_read_b64_tr_b16 a[196:197], v8 offset:1024
    ds_read_b64_tr_b16 a[198:199], v9 offset:1024
    s_add_u32 s17, s35, 50
    s_cmp_ge_u32 s17, 256
    s_cselect_b64 vcc, -1, 0
    s_cselect_b32 s20, 4, 8
    v_cndmask_b32 v8, v6, v7, vcc
    v_lshl_add_u32 v9, s20, 6, v8
    ds_read_b64_tr_b16 a[200:201], v8 offset:2048
    ds_read_b64_tr_b16 a[202:203], v9 offset:2048
    s_add_u32 s17, s35, 51
    s_cmp_ge_u32 s17, 256
    s_cselect_b64 vcc, -1, 0
    s_cselect_b32 s20, 4, 8
    v_cndmask_b32 v8, v6, v7, vcc
    v_lshl_add_u32 v9, s20, 6, v8
    ds_read_b64_tr_b16 a[204:205], v8 offset:3072
    ds_read_b64_tr_b16 a[206:207], v9 offset:3072
    s_waitcnt lgkmcnt(0)
    s_waitcnt vmcnt(17)
    ds_write_b128 v5, v[96:99] offset:0
    ds_write_b128 v5, v[100:103] offset:1024
    ds_write_b128 v5, v[104:107] offset:2048
    ds_write_b128 v5, v[108:111] offset:3072
    s_add_u32 s17, s35, 52
    s_cmp_ge_u32 s17, 256
    s_cselect_b64 vcc, -1, 0
    s_cselect_b32 s20, 4, 8
    v_cndmask_b32 v8, v6, v7, vcc
    v_lshl_add_u32 v9, s20, 6, v8
    ds_read_b64_tr_b16 a[208:209], v8 offset:0
    ds_read_b64_tr_b16 a[210:211], v9 offset:0
    s_add_u32 s17, s35, 53
    s_cmp_ge_u32 s17, 256
    s_cselect_b64 vcc, -1, 0
    s_cselect_b32 s20, 4, 8
    v_cndmask_b32 v8, v6, v7, vcc
    v_lshl_add_u32 v9, s20, 6, v8
    ds_read_b64_tr_b16 a[212:213], v8 offset:1024
    ds_read_b64_tr_b16 a[214:215], v9 offset:1024
    s_add_u32 s17, s35, 54
    s_cmp_ge_u32 s17, 256
    s_cselect_b64 vcc, -1, 0
    s_cselect_b32 s20, 4, 8
    v_cndmask_b32 v8, v6, v7, vcc
    v_lshl_add_u32 v9, s20, 6, v8
    ds_read_b64_tr_b16 a[216:217], v8 offset:2048
    ds_read_b64_tr_b16 a[218:219], v9 offset:2048
    s_add_u32 s17, s35, 55
    s_cmp_ge_u32 s17, 256
    s_cselect_b64 vcc, -1, 0
    s_cselect_b32 s20, 4, 8
    v_cndmask_b32 v8, v6, v7, vcc
    v_lshl_add_u32 v9, s20, 6, v8
    ds_read_b64_tr_b16 a[220:221], v8 offset:3072
    ds_read_b64_tr_b16 a[222:223], v9 offset:3072
    s_waitcnt lgkmcnt(0)
    s_waitcnt vmcnt(13)
    ds_write_b128 v5, v[112:115] offset:0
    ds_write_b128 v5, v[116:119] offset:1024
    ds_write_b128 v5, v[120:123] offset:2048
    ds_write_b128 v5, v[124:127] offset:3072
    s_add_u32 s17, s35, 56
    s_cmp_ge_u32 s17, 256
    s_cselect_b64 vcc, -1, 0
    s_cselect_b32 s20, 4, 8
    v_cndmask_b32 v8, v6, v7, vcc
    v_lshl_add_u32 v9, s20, 6, v8
    ds_read_b64_tr_b16 a[224:225], v8 offset:0
    ds_read_b64_tr_b16 a[226:227], v9 offset:0
    s_add_u32 s17, s35, 57
    s_cmp_ge_u32 s17, 256
    s_cselect_b64 vcc, -1, 0
    s_cselect_b32 s20, 4, 8
    v_cndmask_b32 v8, v6, v7, vcc
    v_lshl_add_u32 v9, s20, 6, v8
    ds_read_b64_tr_b16 a[228:229], v8 offset:1024
    ds_read_b64_tr_b16 a[230:231], v9 offset:1024
    s_add_u32 s17, s35, 58
    s_cmp_ge_u32 s17, 256
    s_cselect_b64 vcc, -1, 0
    s_cselect_b32 s20, 4, 8
    v_cndmask_b32 v8, v6, v7, vcc
    v_lshl_add_u32 v9, s20, 6, v8
    ds_read_b64_tr_b16 a[232:233], v8 offset:2048
    ds_read_b64_tr_b16 a[234:235], v9 offset:2048
    s_add_u32 s17, s35, 59
    s_cmp_ge_u32 s17, 256
    s_cselect_b64 vcc, -1, 0
    s_cselect_b32 s20, 4, 8
    v_cndmask_b32 v8, v6, v7, vcc
    v_lshl_add_u32 v9, s20, 6, v8
    ds_read_b64_tr_b16 a[236:237], v8 offset:3072
    ds_read_b64_tr_b16 a[238:239], v9 offset:3072
    s_waitcnt lgkmcnt(0)
    s_waitcnt vmcnt(9)
    ds_write_b128 v5, v[128:131] offset:0
    ds_write_b128 v5, v[132:135] offset:1024
    ds_write_b128 v5, v[136:139] offset:2048
    ds_write_b128 v5, v[140:143] offset:3072
    s_add_u32 s17, s35, 60
    s_cmp_ge_u32 s17, 256
    s_cselect_b64 vcc, -1, 0
    s_cselect_b32 s20, 4, 8
    v_cndmask_b32 v8, v6, v7, vcc
    v_lshl_add_u32 v9, s20, 6, v8
    ds_read_b64_tr_b16 a[240:241], v8 offset:0
    ds_read_b64_tr_b16 a[242:243], v9 offset:0
    s_add_u32 s17, s35, 61
    s_cmp_ge_u32 s17, 256
    s_cselect_b64 vcc, -1, 0
    s_cselect_b32 s20, 4, 8
    v_cndmask_b32 v8, v6, v7, vcc
    v_lshl_add_u32 v9, s20, 6, v8
    ds_read_b64_tr_b16 a[244:245], v8 offset:1024
    ds_read_b64_tr_b16 a[246:247], v9 offset:1024
    s_add_u32 s17, s35, 62
    s_cmp_ge_u32 s17, 256
    s_cselect_b64 vcc, -1, 0
    s_cselect_b32 s20, 4, 8
    v_cndmask_b32 v8, v6, v7, vcc
    v_lshl_add_u32 v9, s20, 6, v8
    ds_read_b64_tr_b16 a[248:249], v8 offset:2048
    ds_read_b64_tr_b16 a[250:251], v9 offset:2048
    s_add_u32 s17, s35, 63
    s_cmp_ge_u32 s17, 256
    s_cselect_b64 vcc, -1, 0
    s_cselect_b32 s20, 4, 8
    v_cndmask_b32 v8, v6, v7, vcc
    v_lshl_add_u32 v9, s20, 6, v8
    ds_read_b64_tr_b16 a[252:253], v8 offset:3072
    ds_read_b64_tr_b16 a[254:255], v9 offset:3072
    s_waitcnt lgkmcnt(0)
    s_waitcnt vmcnt(5)
    ds_write_b128 v5, v[16:19] offset:0
    ds_write_b128 v5, v[20:23] offset:1024
    ds_write_b128 v5, v[24:27] offset:2048
    ds_write_b128 v5, v[28:31] offset:3072
    s_add_u32 s17, s35, 64
    s_cmp_ge_u32 s17, 256
    s_cselect_b64 vcc, -1, 0
    s_cselect_b32 s20, 4, 8
    v_cndmask_b32 v8, v6, v7, vcc
    v_lshl_add_u32 v9, s20, 6, v8
    ds_read_b64_tr_b16 v[220:221], v8 offset:0
    ds_read_b64_tr_b16 v[222:223], v9 offset:0
    s_add_u32 s17, s35, 65
    s_cmp_ge_u32 s17, 256
    s_cselect_b64 vcc, -1, 0
    s_cselect_b32 s20, 4, 8
    v_cndmask_b32 v8, v6, v7, vcc
    v_lshl_add_u32 v9, s20, 6, v8
    ds_read_b64_tr_b16 v[224:225], v8 offset:1024
    ds_read_b64_tr_b16 v[226:227], v9 offset:1024
    s_add_u32 s17, s35, 66
    s_cmp_ge_u32 s17, 256
    s_cselect_b64 vcc, -1, 0
    s_cselect_b32 s20, 4, 8
    v_cndmask_b32 v8, v6, v7, vcc
    v_lshl_add_u32 v9, s20, 6, v8
    ds_read_b64_tr_b16 v[228:229], v8 offset:2048
    ds_read_b64_tr_b16 v[230:231], v9 offset:2048
    s_add_u32 s17, s35, 67
    s_cmp_ge_u32 s17, 256
    s_cselect_b64 vcc, -1, 0
    s_cselect_b32 s20, 4, 8
    v_cndmask_b32 v8, v6, v7, vcc
    v_lshl_add_u32 v9, s20, 6, v8
    ds_read_b64_tr_b16 v[232:233], v8 offset:3072
    ds_read_b64_tr_b16 v[234:235], v9 offset:3072
    s_waitcnt lgkmcnt(0)
    s_waitcnt vmcnt(1)
    ds_write_b128 v5, v[32:35] offset:0
    ds_write_b128 v5, v[36:39] offset:1024
    ds_write_b128 v5, v[40:43] offset:2048
    ds_write_b128 v5, v[44:47] offset:3072
    s_add_u32 s17, s35, 68
    s_cmp_ge_u32 s17, 256
    s_cselect_b64 vcc, -1, 0
    s_cselect_b32 s20, 4, 8
    v_cndmask_b32 v8, v6, v7, vcc
    v_lshl_add_u32 v9, s20, 6, v8
    ds_read_b64_tr_b16 v[236:237], v8 offset:0
    ds_read_b64_tr_b16 v[238:239], v9 offset:0
    s_add_u32 s17, s35, 69
    s_cmp_ge_u32 s17, 256
    s_cselect_b64 vcc, -1, 0
    s_cselect_b32 s20, 4, 8
    v_cndmask_b32 v8, v6, v7, vcc
    v_lshl_add_u32 v9, s20, 6, v8
    ds_read_b64_tr_b16 v[240:241], v8 offset:1024
    ds_read_b64_tr_b16 v[242:243], v9 offset:1024
    s_add_u32 s17, s35, 70
    s_cmp_ge_u32 s17, 256
    s_cselect_b64 vcc, -1, 0
    s_cselect_b32 s20, 4, 8
    v_cndmask_b32 v8, v6, v7, vcc
    v_lshl_add_u32 v9, s20, 6, v8
    ds_read_b64_tr_b16 v[244:245], v8 offset:2048
    ds_read_b64_tr_b16 v[246:247], v9 offset:2048
    s_add_u32 s17, s35, 71
    s_cmp_ge_u32 s17, 256
    s_cselect_b64 vcc, -1, 0
    s_cselect_b32 s20, 4, 8
    v_cndmask_b32 v8, v6, v7, vcc
    v_lshl_add_u32 v9, s20, 6, v8
    ds_read_b64_tr_b16 v[248:249], v8 offset:3072
    ds_read_b64_tr_b16 v[250:251], v9 offset:3072
    s_waitcnt lgkmcnt(0)
    s_waitcnt vmcnt(0)
    ds_write_b128 v5, v[48:51] offset:0
    s_add_u32 s17, s35, 72
    s_cmp_ge_u32 s17, 256
    s_cselect_b64 vcc, -1, 0
    s_cselect_b32 s20, 4, 8
    v_cndmask_b32 v8, v6, v7, vcc
    v_lshl_add_u32 v9, s20, 6, v8
    ds_read_b64_tr_b16 v[252:253], v8 offset:0
    ds_read_b64_tr_b16 v[254:255], v9 offset:0
    s_waitcnt lgkmcnt(0)
    s_load_dwordx2 s[68:69], s[0:1], 88
    s_waitcnt lgkmcnt(0)
    s_and_b32 s69, s69, 0xffff
    s_mov_b32 s70, 2359296
    s_mov_b32 s71, 0x20000
    v_lshlrev_b32 v4, 4, v1
    s_lshl_b32 s17, s13, 12
    s_add_u32 s17, s17, 110592
    v_and_b32 v9, 31, v1
    v_lshrrev_b32 v10, 5, v1
    v_lshlrev_b32 v5, 7, v9
    v_lshl_add_u32 v5, v10, 4, v5
    v_add_u32 v5, s17, v5
    v_and_b32 v11, 7, v9
    v_lshlrev_b32 v11, 4, v11
    v_xor_b32 v5, v5, v11
    v_lshrrev_b32 v9, 3, v0
    v_and_b32 v10, 7, v0
    v_and_b32 v11, 7, v9
    v_xor_b32 v11, v11, v10
    v_lshlrev_b32 v6, 7, v9
    v_lshl_add_u32 v6, v11, 4, v6
    v_add_u32 v6, 110592, v6
    v_mul_u32_u24 v7, 1152, v9
    v_lshl_add_u32 v7, v10, 3, v7
    v_add_u32 v7, s34, v7
    v_xor_b32 v200, 32, v5
    v_xor_b32 v201, 64, v5
    v_xor_b32 v202, 96, v5
    s_mul_i32 s35, s13, 74752
    s_add_u32 s35, s35, 67108864
    s_mov_b32 s37, 0
        L_b4b_oa:
    s_lshl_b32 s30, s37, 7
    s_add_u32 s30, s30, 16384
    s_cmp_eq_u32 s13, 0
    s_cbranch_scc0 L_wfd_280
    s_mov_b32 s21, 0
        L_wf_279:
    buffer_load_dword v2, off, s[4:7], s30 offset:0 sc1
    s_add_u32 s21, s21, 1
    s_cmp_gt_u32 s21, 3000000
    s_cbranch_scc1 L_fail
    s_waitcnt vmcnt(0)
    v_cmp_gt_u32 vcc, 32, v2
    s_cbranch_vccz L_wfd_280
    s_sleep 2
    s_branch L_wf_279
        L_wfd_280:
    s_add_u32 s37, s37, 1
        L_b4b_lp:
    s_lshr_b32 s30, s22, 3
    s_cmp_ge_u32 s30, s37
    s_cbranch_scc1 L_b4b_oa
    s_lshl_b32 s30, s22, 7
    s_add_u32 s30, s30, 8192
    s_cmp_eq_u32 s13, 0
    s_cbranch_scc0 L_wfd_282
    s_mov_b32 s21, 0
        L_wf_281:
    buffer_load_dword v2, off, s[4:7], s30 offset:0 sc1
    s_add_u32 s21, s21, 1
    s_cmp_gt_u32 s21, 3000000
    s_cbranch_scc1 L_fail
    s_waitcnt vmcnt(0)
    v_cmp_gt_u32 vcc, 32, v2
    s_cbranch_vccz L_wfd_282
    s_sleep 2
    s_branch L_wf_281
        L_wfd_282:
    s_barrier
    s_mul_i32 s36, s22, 299008
    s_add_u32 s36, s36, s35
    buffer_load_dwordx4 v[32:35], v4, s[4:7], s36 offen offset:0
    buffer_load_dwordx4 v[36:39], v4, s[4:7], s36 offen offset:1024
    buffer_load_dwordx4 v[40:43], v4, s[4:7], s36 offen offset:2048
    buffer_load_dwordx4 v[44:47], v4, s[4:7], s36 offen offset:3072
    s_add_u32 s36, s36, 4096
    buffer_load_dwordx4 v[48:51], v4, s[4:7], s36 offen offset:0
    buffer_load_dwordx4 v[52:55], v4, s[4:7], s36 offen offset:1024
    buffer_load_dwordx4 v[56:59], v4, s[4:7], s36 offen offset:2048
    buffer_load_dwordx4 v[60:63], v4, s[4:7], s36 offen offset:3072
    s_add_u32 s36, s36, 4096
    buffer_load_dwordx4 v[64:67], v4, s[4:7], s36 offen offset:0
    buffer_load_dwordx4 v[68:71], v4, s[4:7], s36 offen offset:1024
    buffer_load_dwordx4 v[72:75], v4, s[4:7], s36 offen offset:2048
    buffer_load_dwordx4 v[76:79], v4, s[4:7], s36 offen offset:3072
    s_add_u32 s36, s36, 4096
    buffer_load_dwordx4 v[80:83], v4, s[4:7], s36 offen offset:0
    buffer_load_dwordx4 v[84:87], v4, s[4:7], s36 offen offset:1024
    buffer_load_dwordx4 v[88:91], v4, s[4:7], s36 offen offset:2048
    buffer_load_dwordx4 v[92:95], v4, s[4:7], s36 offen offset:3072
    s_add_u32 s36, s36, 4096
    buffer_load_dwordx4 v[96:99], v4, s[4:7], s36 offen offset:0
    buffer_load_dwordx4 v[100:103], v4, s[4:7], s36 offen offset:1024
    buffer_load_dwordx4 v[104:107], v4, s[4:7], s36 offen offset:2048
    buffer_load_dwordx4 v[108:111], v4, s[4:7], s36 offen offset:3072
    s_add_u32 s36, s36, 4096
    buffer_load_dwordx4 v[112:115], v4, s[4:7], s36 offen offset:0
    buffer_load_dwordx4 v[116:119], v4, s[4:7], s36 offen offset:1024
    buffer_load_dwordx4 v[120:123], v4, s[4:7], s36 offen offset:2048
    buffer_load_dwordx4 v[124:127], v4, s[4:7], s36 offen offset:3072
    s_add_u32 s36, s36, 4096
    buffer_load_dwordx4 v[128:131], v4, s[4:7], s36 offen offset:0
    buffer_load_dwordx4 v[132:135], v4, s[4:7], s36 offen offset:1024
    buffer_load_dwordx4 v[136:139], v4, s[4:7], s36 offen offset:2048
    buffer_load_dwordx4 v[140:143], v4, s[4:7], s36 offen offset:3072
    s_add_u32 s36, s36, 4096
    buffer_load_dwordx4 v[144:147], v4, s[4:7], s36 offen offset:0
    buffer_load_dwordx4 v[148:151], v4, s[4:7], s36 offen offset:1024
    buffer_load_dwordx4 v[152:155], v4, s[4:7], s36 offen offset:2048
    buffer_load_dwordx4 v[156:159], v4, s[4:7], s36 offen offset:3072
    s_add_u32 s36, s36, 4096
    buffer_load_dwordx4 v[160:163], v4, s[4:7], s36 offen offset:0
    buffer_load_dwordx4 v[164:167], v4, s[4:7], s36 offen offset:1024
    buffer_load_dwordx4 v[168:171], v4, s[4:7], s36 offen offset:2048
    buffer_load_dwordx4 v[172:175], v4, s[4:7], s36 offen offset:3072
    s_add_u32 s36, s36, 4096
    buffer_load_dwordx4 v[176:179], v4, s[4:7], s36 offen offset:0
    buffer_load_dwordx4 v[180:183], v4, s[4:7], s36 offen offset:1024
    buffer_load_dwordx4 v[184:187], v4, s[4:7], s36 offen offset:2048
    buffer_load_dwordx4 v[188:191], v4, s[4:7], s36 offen offset:3072
    s_waitcnt vmcnt(39)
    v_mfma_f32_32x32x16_bf16 v[16:31], a[0:3], v[32:35], 0
    s_add_u32 s36, s36, 4096
    buffer_load_dwordx4 v[32:35], v4, s[4:7], s36 offen offset:0
    s_waitcnt vmcnt(39)
    v_mfma_f32_32x32x16_bf16 v[16:31], a[4:7], v[36:39], v[16:31]
    buffer_load_dwordx4 v[36:39], v4, s[4:7], s36 offen offset:1024
    s_waitcnt vmcnt(39)
    v_mfma_f32_32x32x16_bf16 v[16:31], a[8:11], v[40:43], v[16:31]
    buffer_load_dwordx4 v[40:43], v4, s[4:7], s36 offen offset:2048
    s_waitcnt vmcnt(39)
    v_mfma_f32_32x32x16_bf16 v[16:31], a[12:15], v[44:47], v[16:31]
    buffer_load_dwordx4 v[44:47], v4, s[4:7], s36 offen offset:3072
    s_waitcnt vmcnt(39)
    v_mfma_f32_32x32x16_bf16 v[16:31], a[16:19], v[48:51], v[16:31]
    s_add_u32 s36, s36, 4096
    buffer_load_dwordx4 v[48:51], v4, s[4:7], s36 offen offset:0
    s_waitcnt vmcnt(39)
    v_mfma_f32_32x32x16_bf16 v[16:31], a[20:23], v[52:55], v[16:31]
    buffer_load_dwordx4 v[52:55], v4, s[4:7], s36 offen offset:1024
    s_waitcnt vmcnt(39)
    v_mfma_f32_32x32x16_bf16 v[16:31], a[24:27], v[56:59], v[16:31]
    buffer_load_dwordx4 v[56:59], v4, s[4:7], s36 offen offset:2048
    s_waitcnt vmcnt(39)
    v_mfma_f32_32x32x16_bf16 v[16:31], a[28:31], v[60:63], v[16:31]
    buffer_load_dwordx4 v[60:63], v4, s[4:7], s36 offen offset:3072
    s_waitcnt vmcnt(39)
    v_mfma_f32_32x32x16_bf16 v[16:31], a[32:35], v[64:67], v[16:31]
    s_add_u32 s36, s36, 4096
    buffer_load_dwordx4 v[64:67], v4, s[4:7], s36 offen offset:0
    s_waitcnt vmcnt(39)
    v_mfma_f32_32x32x16_bf16 v[16:31], a[36:39], v[68:71], v[16:31]
    buffer_load_dwordx4 v[68:71], v4, s[4:7], s36 offen offset:1024
    s_waitcnt vmcnt(39)
    v_mfma_f32_32x32x16_bf16 v[16:31], a[40:43], v[72:75], v[16:31]
    buffer_load_dwordx4 v[72:75], v4, s[4:7], s36 offen offset:2048
    s_waitcnt vmcnt(39)
    v_mfma_f32_32x32x16_bf16 v[16:31], a[44:47], v[76:79], v[16:31]
    buffer_load_dwordx4 v[76:79], v4, s[4:7], s36 offen offset:3072
    s_waitcnt vmcnt(39)
    v_mfma_f32_32x32x16_bf16 v[16:31], a[48:51], v[80:83], v[16:31]
    s_add_u32 s36, s36, 4096
    buffer_load_dwordx4 v[80:83], v4, s[4:7], s36 offen offset:0
    s_waitcnt vmcnt(39)
    v_mfma_f32_32x32x16_bf16 v[16:31], a[52:55], v[84:87], v[16:31]
    buffer_load_dwordx4 v[84:87], v4, s[4:7], s36 offen offset:1024
    s_waitcnt vmcnt(39)
    v_mfma_f32_32x32x16_bf16 v[16:31], a[56:59], v[88:91], v[16:31]
    buffer_load_dwordx4 v[88:91], v4, s[4:7], s36 offen offset:2048
    s_waitcnt vmcnt(39)
    v_mfma_f32_32x32x16_bf16 v[16:31], a[60:63], v[92:95], v[16:31]
    buffer_load_dwordx4 v[92:95], v4, s[4:7], s36 offen offset:3072
    s_waitcnt vmcnt(39)
    v_mfma_f32_32x32x16_bf16 v[16:31], a[64:67], v[96:99], v[16:31]
    s_add_u32 s36, s36, 4096
    buffer_load_dwordx4 v[96:99], v4, s[4:7], s36 offen offset:0
    s_waitcnt vmcnt(39)
    v_mfma_f32_32x32x16_bf16 v[16:31], a[68:71], v[100:103], v[16:31]
    buffer_load_dwordx4 v[100:103], v4, s[4:7], s36 offen offset:1024
    s_waitcnt vmcnt(39)
    v_mfma_f32_32x32x16_bf16 v[16:31], a[72:75], v[104:107], v[16:31]
    buffer_load_dwordx4 v[104:107], v4, s[4:7], s36 offen offset:2048
    s_waitcnt vmcnt(39)
    v_mfma_f32_32x32x16_bf16 v[16:31], a[76:79], v[108:111], v[16:31]
    buffer_load_dwordx4 v[108:111], v4, s[4:7], s36 offen offset:3072
    s_waitcnt vmcnt(39)
    v_mfma_f32_32x32x16_bf16 v[16:31], a[80:83], v[112:115], v[16:31]
    s_add_u32 s36, s36, 4096
    buffer_load_dwordx4 v[112:115], v4, s[4:7], s36 offen offset:0
    s_waitcnt vmcnt(39)
    v_mfma_f32_32x32x16_bf16 v[16:31], a[84:87], v[116:119], v[16:31]
    buffer_load_dwordx4 v[116:119], v4, s[4:7], s36 offen offset:1024
    s_waitcnt vmcnt(39)
    v_mfma_f32_32x32x16_bf16 v[16:31], a[88:91], v[120:123], v[16:31]
    buffer_load_dwordx4 v[120:123], v4, s[4:7], s36 offen offset:2048
    s_waitcnt vmcnt(39)
    v_mfma_f32_32x32x16_bf16 v[16:31], a[92:95], v[124:127], v[16:31]
    buffer_load_dwordx4 v[124:127], v4, s[4:7], s36 offen offset:3072
    s_waitcnt vmcnt(39)
    v_mfma_f32_32x32x16_bf16 v[16:31], a[96:99], v[128:131], v[16:31]
    s_add_u32 s36, s36, 4096
    buffer_load_dwordx4 v[128:131], v4, s[4:7], s36 offen offset:0
    s_waitcnt vmcnt(39)
    v_mfma_f32_32x32x16_bf16 v[16:31], a[100:103], v[132:135], v[16:31]
    buffer_load_dwordx4 v[132:135], v4, s[4:7], s36 offen offset:1024
    s_waitcnt vmcnt(39)
    v_mfma_f32_32x32x16_bf16 v[16:31], a[104:107], v[136:139], v[16:31]
    buffer_load_dwordx4 v[136:139], v4, s[4:7], s36 offen offset:2048
    s_waitcnt vmcnt(39)
    v_mfma_f32_32x32x16_bf16 v[16:31], a[108:111], v[140:143], v[16:31]
    buffer_load_dwordx4 v[140:143], v4, s[4:7], s36 offen offset:3072
    s_waitcnt vmcnt(39)
    v_mfma_f32_32x32x16_bf16 v[16:31], a[112:115], v[144:147], v[16:31]
    s_add_u32 s36, s36, 4096
    buffer_load_dwordx4 v[144:147], v4, s[4:7], s36 offen offset:0
    s_waitcnt vmcnt(39)
    v_mfma_f32_32x32x16_bf16 v[16:31], a[116:119], v[148:151], v[16:31]
    buffer_load_dwordx4 v[148:151], v4, s[4:7], s36 offen offset:1024
    s_waitcnt vmcnt(39)
    v_mfma_f32_32x32x16_bf16 v[16:31], a[120:123], v[152:155], v[16:31]
    buffer_load_dwordx4 v[152:155], v4, s[4:7], s36 offen offset:2048
    s_waitcnt vmcnt(39)
    v_mfma_f32_32x32x16_bf16 v[16:31], a[124:127], v[156:159], v[16:31]
    buffer_load_dwordx4 v[156:159], v4, s[4:7], s36 offen offset:3072
    s_waitcnt vmcnt(39)
    v_mfma_f32_32x32x16_bf16 v[16:31], a[128:131], v[160:163], v[16:31]
    s_add_u32 s36, s36, 4096
    buffer_load_dwordx4 v[160:163], v4, s[4:7], s36 offen offset:0
    s_waitcnt vmcnt(39)
    v_mfma_f32_32x32x16_bf16 v[16:31], a[132:135], v[164:167], v[16:31]
    s_waitcnt vmcnt(38)
    v_mfma_f32_32x32x16_bf16 v[16:31], a[136:139], v[168:171], v[16:31]
    s_waitcnt vmcnt(37)
    v_mfma_f32_32x32x16_bf16 v[16:31], a[140:143], v[172:175], v[16:31]
    s_waitcnt vmcnt(36)
    v_mfma_f32_32x32x16_bf16 v[16:31], a[144:147], v[176:179], v[16:31]
    s_waitcnt vmcnt(35)
    v_mfma_f32_32x32x16_bf16 v[16:31], a[148:151], v[180:183], v[16:31]
    s_waitcnt vmcnt(34)
    v_mfma_f32_32x32x16_bf16 v[16:31], a[152:155], v[184:187], v[16:31]
    s_waitcnt vmcnt(33)
    v_mfma_f32_32x32x16_bf16 v[16:31], a[156:159], v[188:191], v[16:31]
    s_waitcnt vmcnt(32)
    v_mfma_f32_32x32x16_bf16 v[16:31], a[160:163], v[32:35], v[16:31]
    s_waitcnt vmcnt(31)
    v_mfma_f32_32x32x16_bf16 v[16:31], a[164:167], v[36:39], v[16:31]
    s_waitcnt vmcnt(30)
    v_mfma_f32_32x32x16_bf16 v[16:31], a[168:171], v[40:43], v[16:31]
    s_waitcnt vmcnt(29)
    v_mfma_f32_32x32x16_bf16 v[16:31], a[172:175], v[44:47], v[16:31]
    s_waitcnt vmcnt(28)
    v_mfma_f32_32x32x16_bf16 v[16:31], a[176:179], v[48:51], v[16:31]
    s_waitcnt vmcnt(27)
    v_mfma_f32_32x32x16_bf16 v[16:31], a[180:183], v[52:55], v[16:31]
    s_waitcnt vmcnt(26)
    v_mfma_f32_32x32x16_bf16 v[16:31], a[184:187], v[56:59], v[16:31]
    s_waitcnt vmcnt(25)
    v_mfma_f32_32x32x16_bf16 v[16:31], a[188:191], v[60:63], v[16:31]
    s_waitcnt vmcnt(24)
    v_mfma_f32_32x32x16_bf16 v[16:31], a[192:195], v[64:67], v[16:31]
    s_waitcnt vmcnt(23)
    v_mfma_f32_32x32x16_bf16 v[16:31], a[196:199], v[68:71], v[16:31]
    s_waitcnt vmcnt(22)
    v_mfma_f32_32x32x16_bf16 v[16:31], a[200:203], v[72:75], v[16:31]
    s_waitcnt vmcnt(21)
    v_mfma_f32_32x32x16_bf16 v[16:31], a[204:207], v[76:79], v[16:31]
    s_waitcnt vmcnt(20)
    v_mfma_f32_32x32x16_bf16 v[16:31], a[208:211], v[80:83], v[16:31]
    s_waitcnt vmcnt(19)
    v_mfma_f32_32x32x16_bf16 v[16:31], a[212:215], v[84:87], v[16:31]
    s_waitcnt vmcnt(18)
    v_mfma_f32_32x32x16_bf16 v[16:31], a[216:219], v[88:91], v[16:31]
    s_waitcnt vmcnt(17)
    v_mfma_f32_32x32x16_bf16 v[16:31], a[220:223], v[92:95], v[16:31]
    s_waitcnt vmcnt(16)
    v_mfma_f32_32x32x16_bf16 v[16:31], a[224:227], v[96:99], v[16:31]
    s_waitcnt vmcnt(15)
    v_mfma_f32_32x32x16_bf16 v[16:31], a[228:231], v[100:103], v[16:31]
    s_waitcnt vmcnt(14)
    v_mfma_f32_32x32x16_bf16 v[16:31], a[232:235], v[104:107], v[16:31]
    s_waitcnt vmcnt(13)
    v_mfma_f32_32x32x16_bf16 v[16:31], a[236:239], v[108:111], v[16:31]
    s_waitcnt vmcnt(12)
    v_mfma_f32_32x32x16_bf16 v[16:31], a[240:243], v[112:115], v[16:31]
    s_waitcnt vmcnt(11)
    v_mfma_f32_32x32x16_bf16 v[16:31], a[244:247], v[116:119], v[16:31]
    s_waitcnt vmcnt(10)
    v_mfma_f32_32x32x16_bf16 v[16:31], a[248:251], v[120:123], v[16:31]
    s_waitcnt vmcnt(9)
    v_mfma_f32_32x32x16_bf16 v[16:31], a[252:255], v[124:127], v[16:31]
    s_waitcnt vmcnt(8)
    v_mfma_f32_32x32x16_bf16 v[16:31], v[220:223], v[128:131], v[16:31]
    s_waitcnt vmcnt(7)
    v_mfma_f32_32x32x16_bf16 v[16:31], v[224:227], v[132:135], v[16:31]
    s_waitcnt vmcnt(6)
    v_mfma_f32_32x32x16_bf16 v[16:31], v[228:231], v[136:139], v[16:31]
    s_waitcnt vmcnt(5)
    v_mfma_f32_32x32x16_bf16 v[16:31], v[232:235], v[140:143], v[16:31]
    s_waitcnt vmcnt(4)
    v_mfma_f32_32x32x16_bf16 v[16:31], v[236:239], v[144:147], v[16:31]
    s_waitcnt vmcnt(3)
    v_mfma_f32_32x32x16_bf16 v[16:31], v[240:243], v[148:151], v[16:31]
    s_waitcnt vmcnt(2)
    v_mfma_f32_32x32x16_bf16 v[16:31], v[244:247], v[152:155], v[16:31]
    s_waitcnt vmcnt(1)
    v_mfma_f32_32x32x16_bf16 v[16:31], v[248:251], v[156:159], v[16:31]
    s_waitcnt vmcnt(0)
    v_mfma_f32_32x32x16_bf16 v[16:31], v[252:255], v[160:163], v[16:31]
    s_mul_i32 s36, s22, 36864
    s_nop 7
    s_nop 2
    ds_write_b128 v5, v[16:19]
    ds_write_b128 v200, v[20:23]
    ds_write_b128 v201, v[24:27]
    ds_write_b128 v202, v[28:31]
    s_waitcnt lgkmcnt(0)
    s_barrier
    ds_read_b128 v[16:19], v6
    ds_read_b128 v[20:23], v6 offset:4096
    ds_read_b128 v[24:27], v6 offset:8192
    ds_read_b128 v[28:31], v6 offset:12288
    s_waitcnt lgkmcnt(0)
    v_add_f32 v16, v16, v20
    v_add_f32 v24, v24, v28
    v_add_f32 v17, v17, v21
    v_add_f32 v25, v25, v29
    v_add_f32 v18, v18, v22
    v_add_f32 v26, v26, v30
    v_add_f32 v19, v19, v23
    v_add_f32 v27, v27, v31
    v_add_f32 v16, v16, v24
    v_add_f32 v17, v17, v25
    v_add_f32 v18, v18, v26
    v_add_f32 v19, v19, v27
    v_cvt_pk_bf16_f32 v16, v16, v17
    v_cvt_pk_bf16_f32 v17, v18, v19
    buffer_store_dwordx2 v[16:17], v7, s[68:71], s36 offen
    s_add_u32 s22, s22, 7
    s_cmp_lt_u32 s22, 63
    s_cbranch_scc1 L_b4b_lp
    s_sub_u32 s38, s22, 63
    s_cmp_gt_u32 s38, 1
    s_cbranch_scc1 L_b4b_end
    s_mov_b32 s22, 63
    v_bfe_u32 v9, v0, 4, 1
    v_cmp_eq_u32 vcc, s38, v9
    v_mov_b32 v10, 1073741824
    v_lshrrev_b32 v9, 7, v0
    v_cndmask_b32 v4, v10, v4, vcc
    v_cmp_eq_u32 vcc, s38, v9
    s_nop 1
    v_cndmask_b32 v7, v10, v7, vcc
    s_branch L_b4b_lp
            L_b4b_end:
    s_cmp_eq_u32 s58, 1
    s_cbranch_scc1 L_alldone
    s_branch L_left
    L_rescue:
    s_mov_b32 s21, 0
    L_res:
    buffer_load_dword v3, off, s[8:11], 0 offset:128 sc1
    s_add_u32 s21, s21, 1
    s_cmp_gt_u32 s21, 100000
    s_cbranch_scc1 L_fail
    s_waitcnt vmcnt(0)
    v_readfirstlane_b32 s17, v3
    s_cmp_ge_u32 s17, 0x10000
    s_cbranch_scc1 L_joinslow
    s_cmp_ge_u32 s17, 32
    s_cbranch_scc1 L_ph4
    v_or_b32 v2, 0x10000, v3
    s_mov_b64 exec, 1
    buffer_atomic_cmpswap v[2:3], off, s[8:11], 0 offset:128 sc1
    s_mov_b64 exec, -1
    s_waitcnt vmcnt(0)
    s_branch L_res
    L_joinslow:
    s_waitcnt vmcnt(0) lgkmcnt(0)
    s_barrier
    v_mov_b32 v6, 163776
    s_cmp_eq_u32 s13, 0
    s_cbranch_scc0 L_clm_283
    s_mov_b64 exec, 1
    v_mov_b32 v2, 1
    buffer_atomic_add v2, off, s[8:11], 0 offset:4 sc0 sc1
    s_waitcnt vmcnt(0)
    ds_write_b128 v6, v[2:5]
    s_waitcnt lgkmcnt(0)
    s_mov_b64 exec, -1
        L_clm_283:
    s_barrier
    ds_read_b128 v[2:5], v6
    s_waitcnt lgkmcnt(0)
    v_readfirstlane_b32 s14, v2
    s_cmp_lt_u32 s14, 32
    s_cbranch_scc0 L_ph4
    s_branch L_slow
L_slow:
    s_mov_b32 s12, s14
    s_load_dwordx2 s[64:65], s[0:1], 40
    s_waitcnt lgkmcnt(0)
    s_and_b32 s65, s65, 0xffff
    s_mov_b32 s66, 4718592
    s_mov_b32 s67, 0x20000
    s_load_dwordx2 s[68:69], s[0:1], 48
    s_waitcnt lgkmcnt(0)
    s_and_b32 s69, s69, 0xffff
    s_mov_b32 s70, 4718592
    s_mov_b32 s71, 0x20000
    s_load_dwordx2 s[72:73], s[0:1], 56
    s_waitcnt lgkmcnt(0)
    s_and_b32 s73, s73, 0xffff
    s_mov_b32 s74, 4718592
    s_mov_b32 s75, 0x20000
    s_load_dwordx2 s[76:77], s[0:1], 64
    s_waitcnt lgkmcnt(0)
    s_and_b32 s77, s77, 0xffff
    s_mov_b32 s78, 4718592
    s_mov_b32 s79, 0x20000
    s_load_dwordx2 s[80:81], s[0:1], 32
    s_waitcnt lgkmcnt(0)
    s_and_b32 s81, s81, 0xffff
    s_mov_b32 s82, 9216
    s_mov_b32 s83, 0x20000
    s_mov_b32 s50, 3145728
    s_mov_b32 s51, 5308416
    s_mov_b32 s52, 5308416
    s_mov_b32 s14, 0
    s_mov_b32 s15, 64
    s_lshl_b32 s53, s12, 7
    s_add_u32 s53, s53, 4096
    s_lshl_b32 s58, s12, 7
    s_add_u32 s58, s58, 0
    v_and_b32 v11, 63, v0
    v_lshrrev_b32 v12, 4, v11
    v_and_b32 v13, 15, v11
    v_lshlrev_b32 v1, 13, v12
    v_lshl_add_u32 v1, v13, 4, v1
    s_lshl_b32 s46, s13, 10
    v_lshlrev_b32 v14, 8, v12
    v_add_u32 v14, s46, v14
    v_bfe_u32 v15, v13, 1, 1
    v_and_b32 v16, 1, v12
    v_xor_b32 v15, v15, v16
    v_lshl_add_u32 v14, v15, 5, v14
    v_and_b32 v15, 1, v13
    v_lshl_add_u32 v14, v15, 4, v14
    v_lshrrev_b32 v15, 2, v13
    v_lshl_add_u32 v3, v15, 12, v14
    v_add_u32 v3, 147456, v3
    v_mul_u32_u24 v15, 36864, v15
    v_add_u32 v19, v15, v14
    v_add_u32 v19, 20480, v19
    v_lshrrev_b32 v12, 3, v11
    v_and_b32 v13, 7, v11
    v_mul_u32_u24 v2, 1152, v12
    v_lshl_add_u32 v2, v13, 4, v2
    v_lshlrev_b32 v14, 5, v12
    v_add_u32 v14, s46, v14
    v_and_b32 v15, 1, v13
    v_lshl_add_u32 v14, v15, 4, v14
    v_lshrrev_b32 v15, 1, v13
    v_lshl_add_u32 v4, v15, 12, v14
    v_add_u32 v4, 147456, v4
    v_mul_u32_u24 v15, 36864, v15
    v_add_u32 v20, v15, v14
    v_add_u32 v20, 20480, v20
    v_lshrrev_b32 v12, 4, v11
    v_bfe_u32 v13, v11, 2, 2
    v_and_b32 v14, 3, v11
    v_lshrrev_b32 v17, 1, v12
    v_and_b32 v18, 1, v12
    v_and_b32 v15, 1, v13
    v_lshrrev_b32 v16, 1, v13
    v_lshlrev_b32 v9, 4, v17
    v_lshl_add_u32 v9, v15, 2, v9
    v_lshl_add_u32 v9, v16, 1, v9
    v_add_u32 v9, v9, v18
    v_lshlrev_b32 v9, 6, v9
    v_lshl_add_u32 v9, v15, 5, v9
    v_lshl_add_u32 v9, v14, 3, v9
    s_lshl_b32 s47, s13, 12
    s_add_u32 s47, s47, 147456
    s_mul_i32 s48, s13, 36864
    v_add_u32 v5, s47, v9
    v_xor_b32 v6, 32, v5
    v_add_u32 v21, s48, v9
    v_add_u32 v21, 20480, v21
    v_xor_b32 v22, 32, v21
    v_lshlrev_b32 v9, 4, v18
    v_lshl_add_u32 v9, v17, 3, v9
    v_lshl_add_u32 v9, v16, 2, v9
    v_add_u32 v9, v9, v15
    v_lshlrev_b32 v9, 5, v9
    v_lshl_add_u32 v9, v14, 3, v9
    v_add_u32 v7, s47, v9
    v_add_u32 v23, s48, v9
    v_add_u32 v23, 20480, v23
    v_lshlrev_b32 v10, 4, v11
    v_add_u32 v10, s48, v10
    s_lshl_b32 s49, s12, 8
    s_lshl_b32 s47, s13, 17
    s_add_u32 s49, s49, s47
    s_mul_i32 s48, s12, 147456
    s_mul_i32 s47, s13, 36864
    s_add_u32 s48, s48, s47
    v_mov_b32 v28, -1
    v_mov_b32 v29, -1
    v_mov_b32 v30, -1
    v_mov_b32 v31, -1
    v_lshrrev_b32 v11, 1, v0
    v_and_b32 v12, 1, v0
    s_bfe_u32 s46, s12, 0x20001
    s_mul_i32 s46, s46, 2304
    s_lshr_b32 s47, s12, 3
    s_lshl_b32 s47, s47, 5
    s_add_u32 s46, s46, s47
    s_and_b32 s47, s12, 1
    s_lshl_b32 s47, s47, 4
    s_add_u32 s46, s46, s47
    v_mul_u32_u24 v13, 1152, v12
    v_lshl_add_u32 v13, v11, 7, v13
    v_cmp_gt_u32 vcc, 9, v11
    s_and_saveexec_b64 s[84:85], vcc
    buffer_load_dwordx4 v[28:31], v13, s[80:83], s46 offen
    s_mov_b64 exec, s[84:85]
    s_add_u32 s46, s49, 0
    buffer_load_dwordx4 v[96:99], v1, s[68:71], s46 offen
    s_add_u32 s46, s49, 32768
    buffer_load_dwordx4 v[100:103], v1, s[68:71], s46 offen
    s_add_u32 s46, s49, 65536
    buffer_load_dwordx4 v[104:107], v1, s[68:71], s46 offen
    s_add_u32 s46, s49, 98304
    buffer_load_dwordx4 v[108:111], v1, s[68:71], s46 offen
    s_add_u32 s46, s49, 524288
    buffer_load_dwordx4 v[128:131], v1, s[68:71], s46 offen
    s_add_u32 s46, s49, 557056
    buffer_load_dwordx4 v[132:135], v1, s[68:71], s46 offen
    s_add_u32 s46, s49, 589824
    buffer_load_dwordx4 v[136:139], v1, s[68:71], s46 offen
    s_add_u32 s46, s49, 622592
    buffer_load_dwordx4 v[140:143], v1, s[68:71], s46 offen
    s_add_u32 s46, s49, 1048576
    buffer_load_dwordx4 v[160:163], v1, s[68:71], s46 offen
    s_add_u32 s46, s49, 1081344
    buffer_load_dwordx4 v[164:167], v1, s[68:71], s46 offen
    s_add_u32 s46, s49, 1114112
    buffer_load_dwordx4 v[168:171], v1, s[68:71], s46 offen
    s_add_u32 s46, s49, 1146880
    buffer_load_dwordx4 v[172:175], v1, s[68:71], s46 offen
    s_add_u32 s46, s49, 0
    buffer_load_dwordx4 v[32:35], v1, s[72:75], s46 offen
    s_add_u32 s46, s49, 32768
    buffer_load_dwordx4 v[36:39], v1, s[72:75], s46 offen
    s_add_u32 s46, s49, 65536
    buffer_load_dwordx4 v[40:43], v1, s[72:75], s46 offen
    s_add_u32 s46, s49, 98304
    buffer_load_dwordx4 v[44:47], v1, s[72:75], s46 offen
    s_waitcnt vmcnt(16)
    v_lshrrev_b32 v11, 1, v0
    v_cmp_gt_u32 vcc, 9, v11
    v_min_u32 v12, -2, v28
    v_min_u32 v13, -2, v29
    v_min_u32 v14, -2, v30
    v_min_u32 v15, -2, v31
    v_cndmask_b32 v28, v28, v12, vcc
    v_cndmask_b32 v29, v29, v13, vcc
    v_cndmask_b32 v30, v30, v14, vcc
    v_cndmask_b32 v31, v31, v15, vcc
    v_and_b32 v12, 1, v0
    v_lshlrev_b32 v13, 10, v11
    v_lshl_add_u32 v13, v12, 4, v13
    v_cmp_gt_u32 vcc, 27, v11
    v_mov_b32 v18, 1073741824
    s_lshl_b32 s46, s12, 5
    v_cndmask_b32 v13, v18, v13, vcc
    s_add_u32 s46, s46, s51
    buffer_store_dwordx4 v[28:31], v13, s[4:7], s46 offen sc1
    v_mov_b32 v24, 1
    v_mov_b32 v25, 1
    v_mov_b32 v26, 1
    v_mov_b32 v27, 1
    v_lshrrev_b32 v14, 7, v0
    v_lshlrev_b32 v15, 4, v0
    v_and_b32 v15, 0x7f0, v15
    s_mov_b32 s46, 294912
    v_mul_lo_u32 v14, v14, s46
    v_add_u32 v14, v15, v14
    s_lshl_b32 s46, s12, 11
    s_add_u32 s46, s46, s50
    buffer_store_dwordx4 v[24:27], v14, s[4:7], s46 offen sc1
    s_add_u32 s46, s46, 65536
    buffer_store_dwordx4 v[24:27], v14, s[4:7], s46 offen sc1
    s_add_u32 s46, s46, 65536
    buffer_store_dwordx4 v[24:27], v14, s[4:7], s46 offen sc1
    s_add_u32 s46, s46, 65536
    buffer_store_dwordx4 v[24:27], v14, s[4:7], s46 offen sc1
    v_cmp_gt_u32 vcc, 0x400, v15
    s_lshl_b32 s46, s12, 10
    s_add_u32 s46, s46, s50
    v_cndmask_b32 v16, v18, v14, vcc
    s_add_u32 s46, s46, 262144
    buffer_store_dwordx4 v[24:27], v16, s[4:7], s46 offen sc1
    s_waitcnt vmcnt(18)
    ds_write_b128 v19, v[96:99] offset:0
    ds_write_b128 v19, v[100:103] offset:64
    ds_write_b128 v19, v[104:107] offset:128
    ds_write_b128 v19, v[108:111] offset:192
    s_waitcnt lgkmcnt(0)
    s_barrier
    ds_read_b64_tr_b16 v[96:97], v21 offset:0
    ds_read_b64_tr_b16 v[98:99], v21 offset:512
    ds_read_b64_tr_b16 v[100:101], v21 offset:2048
    ds_read_b64_tr_b16 v[102:103], v21 offset:2560
    ds_read_b64_tr_b16 v[104:105], v22 offset:0
    ds_read_b64_tr_b16 v[106:107], v22 offset:512
    ds_read_b64_tr_b16 v[108:109], v22 offset:2048
    ds_read_b64_tr_b16 v[110:111], v22 offset:2560
    s_waitcnt lgkmcnt(0)
    s_add_u32 s46, s49, 1572864
    buffer_load_dwordx4 v[192:195], v1, s[68:71], s46 offen
    s_add_u32 s46, s49, 1605632
    buffer_load_dwordx4 v[196:199], v1, s[68:71], s46 offen
    s_add_u32 s46, s49, 1638400
    buffer_load_dwordx4 v[200:203], v1, s[68:71], s46 offen
    s_add_u32 s46, s49, 1671168
    buffer_load_dwordx4 v[204:207], v1, s[68:71], s46 offen
    s_waitcnt vmcnt(18)
    ds_write_b128 v3, v[128:131] offset:0
    ds_write_b128 v3, v[132:135] offset:64
    ds_write_b128 v3, v[136:139] offset:128
    ds_write_b128 v3, v[140:143] offset:192
    s_waitcnt lgkmcnt(0)
    s_barrier
    ds_read_b64_tr_b16 v[128:129], v5 offset:0
    ds_read_b64_tr_b16 v[130:131], v5 offset:512
    ds_read_b64_tr_b16 v[132:133], v5 offset:2048
    ds_read_b64_tr_b16 v[134:135], v5 offset:2560
    ds_read_b64_tr_b16 v[136:137], v6 offset:0
    ds_read_b64_tr_b16 v[138:139], v6 offset:512
    ds_read_b64_tr_b16 v[140:141], v6 offset:2048
    ds_read_b64_tr_b16 v[142:143], v6 offset:2560
    s_waitcnt lgkmcnt(0)
    s_add_u32 s46, s49, 2097152
    buffer_load_dwordx4 v[224:227], v1, s[68:71], s46 offen
    s_add_u32 s46, s49, 2129920
    buffer_load_dwordx4 v[228:231], v1, s[68:71], s46 offen
    s_add_u32 s46, s49, 2162688
    buffer_load_dwordx4 v[232:235], v1, s[68:71], s46 offen
    s_add_u32 s46, s49, 2195456
    buffer_load_dwordx4 v[236:239], v1, s[68:71], s46 offen
    s_waitcnt vmcnt(18)
    ds_write_b128 v19, v[160:163] offset:0
    ds_write_b128 v19, v[164:167] offset:64
    ds_write_b128 v19, v[168:171] offset:128
    ds_write_b128 v19, v[172:175] offset:192
    s_waitcnt lgkmcnt(0)
    s_barrier
    ds_read_b64_tr_b16 v[160:161], v21 offset:0
    ds_read_b64_tr_b16 v[162:163], v21 offset:512
    ds_read_b64_tr_b16 v[164:165], v21 offset:2048
    ds_read_b64_tr_b16 v[166:167], v21 offset:2560
    ds_read_b64_tr_b16 v[168:169], v22 offset:0
    ds_read_b64_tr_b16 v[170:171], v22 offset:512
    ds_read_b64_tr_b16 v[172:173], v22 offset:2048
    ds_read_b64_tr_b16 v[174:175], v22 offset:2560
    s_waitcnt lgkmcnt(0)
    s_add_u32 s46, s49, 2621440
    buffer_load_dwordx4 a[0:3], v1, s[68:71], s46 offen
    s_add_u32 s46, s49, 2654208
    buffer_load_dwordx4 a[4:7], v1, s[68:71], s46 offen
    s_add_u32 s46, s49, 2686976
    buffer_load_dwordx4 a[8:11], v1, s[68:71], s46 offen
    s_add_u32 s46, s49, 2719744
    buffer_load_dwordx4 a[12:15], v1, s[68:71], s46 offen
    s_waitcnt vmcnt(18)
    ds_write_b128 v3, v[32:35] offset:0
    ds_write_b128 v3, v[36:39] offset:64
    ds_write_b128 v3, v[40:43] offset:128
    ds_write_b128 v3, v[44:47] offset:192
    s_waitcnt lgkmcnt(0)
    s_barrier
    ds_read_b64_tr_b16 v[32:33], v5 offset:0
    ds_read_b64_tr_b16 v[34:35], v5 offset:512
    ds_read_b64_tr_b16 v[36:37], v5 offset:2048
    ds_read_b64_tr_b16 v[38:39], v5 offset:2560
    ds_read_b64_tr_b16 v[40:41], v6 offset:0
    ds_read_b64_tr_b16 v[42:43], v6 offset:512
    ds_read_b64_tr_b16 v[44:45], v6 offset:2048
    ds_read_b64_tr_b16 v[46:47], v6 offset:2560
    s_waitcnt lgkmcnt(0)
    ds_write_b128 v10, v[32:35] offset:12288
    ds_write_b128 v10, v[36:39] offset:13312
    ds_write_b128 v10, v[40:43] offset:14336
    ds_write_b128 v10, v[44:47] offset:15360
    s_waitcnt lgkmcnt(0)
    s_add_u32 s46, s49, 524288
    buffer_load_dwordx4 v[48:51], v1, s[72:75], s46 offen
    s_add_u32 s46, s49, 557056
    buffer_load_dwordx4 v[52:55], v1, s[72:75], s46 offen
    s_add_u32 s46, s49, 589824
    buffer_load_dwordx4 v[56:59], v1, s[72:75], s46 offen
    s_add_u32 s46, s49, 622592
    buffer_load_dwordx4 v[60:63], v1, s[72:75], s46 offen
    s_waitcnt vmcnt(12)
    ds_write_b128 v19, v[192:195] offset:0
    ds_write_b128 v19, v[196:199] offset:64
    ds_write_b128 v19, v[200:203] offset:128
    ds_write_b128 v19, v[204:207] offset:192
    s_waitcnt lgkmcnt(0)
    s_barrier
    s_cmp_eq_u32 s13, 0
    s_cbranch_scc0 L_arr_284
    s_mov_b64 exec, 1
    v_mov_b32 v11, 1
    buffer_atomic_add v11, off, s[8:11], 0 offset:136 sc1
    s_mov_b64 exec, -1
            L_arr_284:
    ds_read_b64_tr_b16 v[192:193], v21 offset:0
    ds_read_b64_tr_b16 v[194:195], v21 offset:512
    ds_read_b64_tr_b16 v[196:197], v21 offset:2048
    ds_read_b64_tr_b16 v[198:199], v21 offset:2560
    ds_read_b64_tr_b16 v[200:201], v22 offset:0
    ds_read_b64_tr_b16 v[202:203], v22 offset:512
    ds_read_b64_tr_b16 v[204:205], v22 offset:2048
    ds_read_b64_tr_b16 v[206:207], v22 offset:2560
    s_waitcnt lgkmcnt(0)
    s_add_u32 s46, s49, 3145728
    buffer_load_dwordx4 a[32:35], v1, s[68:71], s46 offen
    s_add_u32 s46, s49, 3178496
    buffer_load_dwordx4 a[36:39], v1, s[68:71], s46 offen
    s_add_u32 s46, s49, 3211264
    buffer_load_dwordx4 a[40:43], v1, s[68:71], s46 offen
    s_add_u32 s46, s49, 3244032
    buffer_load_dwordx4 a[44:47], v1, s[68:71], s46 offen
    s_waitcnt vmcnt(12)
    ds_write_b128 v3, v[224:227] offset:0
    ds_write_b128 v3, v[228:231] offset:64
    ds_write_b128 v3, v[232:235] offset:128
    ds_write_b128 v3, v[236:239] offset:192
    s_waitcnt lgkmcnt(0)
    s_barrier
    ds_read_b64_tr_b16 v[224:225], v5 offset:0
    ds_read_b64_tr_b16 v[226:227], v5 offset:512
    ds_read_b64_tr_b16 v[228:229], v5 offset:2048
    ds_read_b64_tr_b16 v[230:231], v5 offset:2560
    ds_read_b64_tr_b16 v[232:233], v6 offset:0
    ds_read_b64_tr_b16 v[234:235], v6 offset:512
    ds_read_b64_tr_b16 v[236:237], v6 offset:2048
    ds_read_b64_tr_b16 v[238:239], v6 offset:2560
    s_waitcnt lgkmcnt(0)
    s_add_u32 s46, s49, 3670016
    buffer_load_dwordx4 a[64:67], v1, s[68:71], s46 offen
    s_add_u32 s46, s49, 3702784
    buffer_load_dwordx4 a[68:71], v1, s[68:71], s46 offen
    s_add_u32 s46, s49, 3735552
    buffer_load_dwordx4 a[72:75], v1, s[68:71], s46 offen
    s_add_u32 s46, s49, 3768320
    buffer_load_dwordx4 a[76:79], v1, s[68:71], s46 offen
    s_waitcnt vmcnt(12)
    ds_write_b128 v19, a[0:3] offset:0
    ds_write_b128 v19, a[4:7] offset:64
    ds_write_b128 v19, a[8:11] offset:128
    ds_write_b128 v19, a[12:15] offset:192
    s_waitcnt lgkmcnt(0)
    s_barrier
    ds_read_b64_tr_b16 a[0:1], v21 offset:0
    ds_read_b64_tr_b16 a[2:3], v21 offset:512
    ds_read_b64_tr_b16 a[4:5], v21 offset:2048
    ds_read_b64_tr_b16 a[6:7], v21 offset:2560
    ds_read_b64_tr_b16 a[8:9], v22 offset:0
    ds_read_b64_tr_b16 a[10:11], v22 offset:512
    ds_read_b64_tr_b16 a[12:13], v22 offset:2048
    ds_read_b64_tr_b16 a[14:15], v22 offset:2560
    s_waitcnt lgkmcnt(0)
    s_add_u32 s46, s49, 4194304
    buffer_load_dwordx4 a[96:99], v1, s[68:71], s46 offen
    s_add_u32 s46, s49, 4227072
    buffer_load_dwordx4 a[100:103], v1, s[68:71], s46 offen
    s_add_u32 s46, s49, 4259840
    buffer_load_dwordx4 a[104:107], v1, s[68:71], s46 offen
    s_add_u32 s46, s49, 4292608
    buffer_load_dwordx4 a[108:111], v1, s[68:71], s46 offen
    s_waitcnt vmcnt(12)
    ds_write_b128 v3, v[48:51] offset:0
    ds_write_b128 v3, v[52:55] offset:64
    ds_write_b128 v3, v[56:59] offset:128
    ds_write_b128 v3, v[60:63] offset:192
    s_waitcnt lgkmcnt(0)
    s_barrier
    ds_read_b64_tr_b16 v[48:49], v5 offset:0
    ds_read_b64_tr_b16 v[50:51], v5 offset:512
    ds_read_b64_tr_b16 v[52:53], v5 offset:2048
    ds_read_b64_tr_b16 v[54:55], v5 offset:2560
    ds_read_b64_tr_b16 v[56:57], v6 offset:0
    ds_read_b64_tr_b16 v[58:59], v6 offset:512
    ds_read_b64_tr_b16 v[60:61], v6 offset:2048
    ds_read_b64_tr_b16 v[62:63], v6 offset:2560
    s_waitcnt lgkmcnt(0)
    ds_write_b128 v10, v[48:51] offset:32768
    ds_write_b128 v10, v[52:55] offset:33792
    ds_write_b128 v10, v[56:59] offset:34816
    ds_write_b128 v10, v[60:63] offset:35840
    s_waitcnt lgkmcnt(0)
    s_add_u32 s46, s49, 1048576
    buffer_load_dwordx4 v[64:67], v1, s[72:75], s46 offen
    s_add_u32 s46, s49, 1081344
    buffer_load_dwordx4 v[68:71], v1, s[72:75], s46 offen
    s_add_u32 s46, s49, 1114112
    buffer_load_dwordx4 v[72:75], v1, s[72:75], s46 offen
    s_add_u32 s46, s49, 1146880
    buffer_load_dwordx4 v[76:79], v1, s[72:75], s46 offen
    s_waitcnt vmcnt(12)
    ds_write_b128 v19, a[32:35] offset:0
    ds_write_b128 v19, a[36:39] offset:64
    ds_write_b128 v19, a[40:43] offset:128
    ds_write_b128 v19, a[44:47] offset:192
    s_waitcnt lgkmcnt(0)
    s_barrier
    ds_read_b64_tr_b16 a[32:33], v21 offset:0
    ds_read_b64_tr_b16 a[34:35], v21 offset:512
    ds_read_b64_tr_b16 a[36:37], v21 offset:2048
    ds_read_b64_tr_b16 a[38:39], v21 offset:2560
    ds_read_b64_tr_b16 a[40:41], v22 offset:0
    ds_read_b64_tr_b16 a[42:43], v22 offset:512
    ds_read_b64_tr_b16 a[44:45], v22 offset:2048
    ds_read_b64_tr_b16 a[46:47], v22 offset:2560
    s_waitcnt lgkmcnt(0)
    s_add_u32 s46, s49, 2097152
    buffer_load_dwordx4 a[112:115], v1, s[72:75], s46 offen
    s_add_u32 s46, s49, 2129920
    buffer_load_dwordx4 a[116:119], v1, s[72:75], s46 offen
    s_add_u32 s46, s49, 2162688
    buffer_load_dwordx4 a[120:123], v1, s[72:75], s46 offen
    s_add_u32 s46, s49, 2195456
    buffer_load_dwordx4 a[124:127], v1, s[72:75], s46 offen
    s_waitcnt vmcnt(12)
    ds_write_b128 v3, a[64:67] offset:0
    ds_write_b128 v3, a[68:71] offset:64
    ds_write_b128 v3, a[72:75] offset:128
    ds_write_b128 v3, a[76:79] offset:192
    s_waitcnt lgkmcnt(0)
    s_barrier
    ds_read_b64_tr_b16 a[64:65], v5 offset:0
    ds_read_b64_tr_b16 a[66:67], v5 offset:512
    ds_read_b64_tr_b16 a[68:69], v5 offset:2048
    ds_read_b64_tr_b16 a[70:71], v5 offset:2560
    ds_read_b64_tr_b16 a[72:73], v6 offset:0
    ds_read_b64_tr_b16 a[74:75], v6 offset:512
    ds_read_b64_tr_b16 a[76:77], v6 offset:2048
    ds_read_b64_tr_b16 a[78:79], v6 offset:2560
    s_waitcnt lgkmcnt(0)
    s_add_u32 s46, s49, 2621440
    buffer_load_dwordx4 a[128:131], v1, s[72:75], s46 offen
    s_add_u32 s46, s49, 2654208
    buffer_load_dwordx4 a[132:135], v1, s[72:75], s46 offen
    s_add_u32 s46, s49, 2686976
    buffer_load_dwordx4 a[136:139], v1, s[72:75], s46 offen
    s_add_u32 s46, s49, 2719744
    buffer_load_dwordx4 a[140:143], v1, s[72:75], s46 offen
    s_waitcnt vmcnt(12)
    ds_write_b128 v19, a[96:99] offset:0
    ds_write_b128 v19, a[100:103] offset:64
    ds_write_b128 v19, a[104:107] offset:128
    ds_write_b128 v19, a[108:111] offset:192
    s_waitcnt lgkmcnt(0)
    s_barrier
    ds_read_b64_tr_b16 a[96:97], v21 offset:0
    ds_read_b64_tr_b16 a[98:99], v21 offset:512
    ds_read_b64_tr_b16 a[100:101], v21 offset:2048
    ds_read_b64_tr_b16 a[102:103], v21 offset:2560
    ds_read_b64_tr_b16 a[104:105], v22 offset:0
    ds_read_b64_tr_b16 a[106:107], v22 offset:512
    ds_read_b64_tr_b16 a[108:109], v22 offset:2048
    ds_read_b64_tr_b16 a[110:111], v22 offset:2560
    s_waitcnt lgkmcnt(0)
    s_add_u32 s46, s49, 3145728
    buffer_load_dwordx4 a[144:147], v1, s[72:75], s46 offen
    s_add_u32 s46, s49, 3178496
    buffer_load_dwordx4 a[148:151], v1, s[72:75], s46 offen
    s_add_u32 s46, s49, 3211264
    buffer_load_dwordx4 a[152:155], v1, s[72:75], s46 offen
    s_add_u32 s46, s49, 3244032
    buffer_load_dwordx4 a[156:159], v1, s[72:75], s46 offen
    s_waitcnt vmcnt(12)
    ds_write_b128 v3, v[64:67] offset:0
    ds_write_b128 v3, v[68:71] offset:64
    ds_write_b128 v3, v[72:75] offset:128
    ds_write_b128 v3, v[76:79] offset:192
    s_waitcnt lgkmcnt(0)
    s_barrier
    ds_read_b64_tr_b16 v[64:65], v5 offset:0
    ds_read_b64_tr_b16 v[66:67], v5 offset:512
    ds_read_b64_tr_b16 v[68:69], v5 offset:2048
    ds_read_b64_tr_b16 v[70:71], v5 offset:2560
    ds_read_b64_tr_b16 v[72:73], v6 offset:0
    ds_read_b64_tr_b16 v[74:75], v6 offset:512
    ds_read_b64_tr_b16 v[76:77], v6 offset:2048
    ds_read_b64_tr_b16 v[78:79], v6 offset:2560
    s_waitcnt lgkmcnt(0)
    ds_write_b128 v10, v[64:67] offset:16384
    ds_write_b128 v10, v[68:71] offset:17408
    ds_write_b128 v10, v[72:75] offset:18432
    ds_write_b128 v10, v[76:79] offset:19456
    s_waitcnt lgkmcnt(0)
    s_add_u32 s46, s48, 0
    buffer_load_dwordx4 v[32:35], v2, s[76:79], s46 offen
    s_add_u32 s46, s48, 9216
    buffer_load_dwordx4 v[36:39], v2, s[76:79], s46 offen
    s_add_u32 s46, s48, 18432
    buffer_load_dwordx4 v[40:43], v2, s[76:79], s46 offen
    s_add_u32 s46, s48, 27648
    buffer_load_dwordx4 v[44:47], v2, s[76:79], s46 offen
    s_waitcnt vmcnt(12)
    ds_write_b128 v19, a[112:115] offset:0
    ds_write_b128 v19, a[116:119] offset:64
    ds_write_b128 v19, a[120:123] offset:128
    ds_write_b128 v19, a[124:127] offset:192
    s_waitcnt lgkmcnt(0)
    s_barrier
    ds_read_b64_tr_b16 a[112:113], v21 offset:0
    ds_read_b64_tr_b16 a[114:115], v21 offset:512
    ds_read_b64_tr_b16 a[116:117], v21 offset:2048
    ds_read_b64_tr_b16 a[118:119], v21 offset:2560
    ds_read_b64_tr_b16 a[120:121], v22 offset:0
    ds_read_b64_tr_b16 a[122:123], v22 offset:512
    ds_read_b64_tr_b16 a[124:125], v22 offset:2048
    ds_read_b64_tr_b16 a[126:127], v22 offset:2560
    s_waitcnt lgkmcnt(0)
    s_add_u32 s46, s49, 3670016
    buffer_load_dwordx4 a[160:163], v1, s[72:75], s46 offen
    s_add_u32 s46, s49, 3702784
    buffer_load_dwordx4 a[164:167], v1, s[72:75], s46 offen
    s_add_u32 s46, s49, 3735552
    buffer_load_dwordx4 a[168:171], v1, s[72:75], s46 offen
    s_add_u32 s46, s49, 3768320
    buffer_load_dwordx4 a[172:175], v1, s[72:75], s46 offen
    s_waitcnt vmcnt(12)
    ds_write_b128 v3, a[128:131] offset:0
    ds_write_b128 v3, a[132:135] offset:64
    ds_write_b128 v3, a[136:139] offset:128
    ds_write_b128 v3, a[140:143] offset:192
    s_waitcnt lgkmcnt(0)
    s_barrier
    ds_read_b64_tr_b16 a[128:129], v5 offset:0
    ds_read_b64_tr_b16 a[130:131], v5 offset:512
    ds_read_b64_tr_b16 a[132:133], v5 offset:2048
    ds_read_b64_tr_b16 a[134:135], v5 offset:2560
    ds_read_b64_tr_b16 a[136:137], v6 offset:0
    ds_read_b64_tr_b16 a[138:139], v6 offset:512
    ds_read_b64_tr_b16 a[140:141], v6 offset:2048
    ds_read_b64_tr_b16 a[142:143], v6 offset:2560
    s_waitcnt lgkmcnt(0)
    s_add_u32 s46, s49, 4194304
    buffer_load_dwordx4 a[176:179], v1, s[72:75], s46 offen
    s_add_u32 s46, s49, 4227072
    buffer_load_dwordx4 a[180:183], v1, s[72:75], s46 offen
    s_add_u32 s46, s49, 4259840
    buffer_load_dwordx4 a[184:187], v1, s[72:75], s46 offen
    s_add_u32 s46, s49, 4292608
    buffer_load_dwordx4 a[188:191], v1, s[72:75], s46 offen
    s_waitcnt vmcnt(12)
    ds_write_b128 v19, a[144:147] offset:0
    ds_write_b128 v19, a[148:151] offset:64
    ds_write_b128 v19, a[152:155] offset:128
    ds_write_b128 v19, a[156:159] offset:192
    s_waitcnt lgkmcnt(0)
    s_barrier
    ds_read_b64_tr_b16 a[144:145], v21 offset:0
    ds_read_b64_tr_b16 a[146:147], v21 offset:512
    ds_read_b64_tr_b16 a[148:149], v21 offset:2048
    ds_read_b64_tr_b16 a[150:151], v21 offset:2560
    ds_read_b64_tr_b16 a[152:153], v22 offset:0
    ds_read_b64_tr_b16 a[154:155], v22 offset:512
    ds_read_b64_tr_b16 a[156:157], v22 offset:2048
    ds_read_b64_tr_b16 a[158:159], v22 offset:2560
    s_waitcnt lgkmcnt(0)
    s_add_u32 s46, s48, 384
    buffer_load_dwordx4 a[192:195], v2, s[76:79], s46 offen
    s_add_u32 s46, s48, 9600
    buffer_load_dwordx4 a[196:199], v2, s[76:79], s46 offen
    s_add_u32 s46, s48, 18816
    buffer_load_dwordx4 a[200:203], v2, s[76:79], s46 offen
    s_add_u32 s46, s48, 28032
    buffer_load_dwordx4 a[204:207], v2, s[76:79], s46 offen
    s_waitcnt vmcnt(12)
    ds_write_b128 v4, v[32:35] offset:0
    ds_write_b128 v4, v[36:39] offset:256
    ds_write_b128 v4, v[40:43] offset:512
    ds_write_b128 v4, v[44:47] offset:768
    s_waitcnt lgkmcnt(0)
    s_barrier
    ds_read_b64_tr_b16 v[32:33], v7 offset:0
    ds_read_b64_tr_b16 v[34:35], v7 offset:64
    ds_read_b64_tr_b16 v[36:37], v7 offset:1024
    ds_read_b64_tr_b16 v[38:39], v7 offset:1088
    ds_read_b64_tr_b16 v[40:41], v7 offset:2048
    ds_read_b64_tr_b16 v[42:43], v7 offset:2112
    ds_read_b64_tr_b16 v[44:45], v7 offset:3072
    ds_read_b64_tr_b16 v[46:47], v7 offset:3136
    s_waitcnt lgkmcnt(0)
    ds_write_b128 v10, v[32:35] offset:0
    ds_write_b128 v10, v[36:39] offset:1024
    ds_write_b128 v10, v[40:43] offset:2048
    ds_write_b128 v10, v[44:47] offset:3072
    s_waitcnt lgkmcnt(0)
    s_add_u32 s46, s48, 128
    buffer_load_dwordx4 v[48:51], v2, s[76:79], s46 offen
    s_add_u32 s46, s48, 9344
    buffer_load_dwordx4 v[52:55], v2, s[76:79], s46 offen
    s_add_u32 s46, s48, 18560
    buffer_load_dwordx4 v[56:59], v2, s[76:79], s46 offen
    s_add_u32 s46, s48, 27776
    buffer_load_dwordx4 v[60:63], v2, s[76:79], s46 offen
    s_waitcnt vmcnt(12)
    ds_write_b128 v19, a[160:163] offset:0
    ds_write_b128 v19, a[164:167] offset:64
    ds_write_b128 v19, a[168:171] offset:128
    ds_write_b128 v19, a[172:175] offset:192
    s_waitcnt lgkmcnt(0)
    s_barrier
    ds_read_b64_tr_b16 a[160:161], v21 offset:0
    ds_read_b64_tr_b16 a[162:163], v21 offset:512
    ds_read_b64_tr_b16 a[164:165], v21 offset:2048
    ds_read_b64_tr_b16 a[166:167], v21 offset:2560
    ds_read_b64_tr_b16 a[168:169], v22 offset:0
    ds_read_b64_tr_b16 a[170:171], v22 offset:512
    ds_read_b64_tr_b16 a[172:173], v22 offset:2048
    ds_read_b64_tr_b16 a[174:175], v22 offset:2560
    s_waitcnt lgkmcnt(0)
    s_add_u32 s46, s48, 1024
    buffer_load_dwordx4 a[208:211], v2, s[76:79], s46 offen
    s_add_u32 s46, s48, 10240
    buffer_load_dwordx4 a[212:215], v2, s[76:79], s46 offen
    s_add_u32 s46, s48, 19456
    buffer_load_dwordx4 a[216:219], v2, s[76:79], s46 offen
    s_add_u32 s46, s48, 28672
    buffer_load_dwordx4 a[220:223], v2, s[76:79], s46 offen
    s_waitcnt vmcnt(12)
    ds_write_b128 v3, a[176:179] offset:0
    ds_write_b128 v3, a[180:183] offset:64
    ds_write_b128 v3, a[184:187] offset:128
    ds_write_b128 v3, a[188:191] offset:192
    s_waitcnt lgkmcnt(0)
    s_barrier
    ds_read_b64_tr_b16 a[176:177], v5 offset:0
    ds_read_b64_tr_b16 a[178:179], v5 offset:512
    ds_read_b64_tr_b16 a[180:181], v5 offset:2048
    ds_read_b64_tr_b16 a[182:183], v5 offset:2560
    ds_read_b64_tr_b16 a[184:185], v6 offset:0
    ds_read_b64_tr_b16 a[186:187], v6 offset:512
    ds_read_b64_tr_b16 a[188:189], v6 offset:2048
    ds_read_b64_tr_b16 a[190:191], v6 offset:2560
    s_waitcnt lgkmcnt(0)
    s_add_u32 s46, s48, 512
    buffer_load_dwordx4 a[224:227], v2, s[76:79], s46 offen
    s_add_u32 s46, s48, 9728
    buffer_load_dwordx4 a[228:231], v2, s[76:79], s46 offen
    s_add_u32 s46, s48, 18944
    buffer_load_dwordx4 a[232:235], v2, s[76:79], s46 offen
    s_add_u32 s46, s48, 28160
    buffer_load_dwordx4 a[236:239], v2, s[76:79], s46 offen
    s_waitcnt vmcnt(12)
    ds_write_b128 v20, a[192:195] offset:0
    ds_write_b128 v20, a[196:199] offset:256
    ds_write_b128 v20, a[200:203] offset:512
    ds_write_b128 v20, a[204:207] offset:768
    s_waitcnt lgkmcnt(0)
    s_barrier
    ds_read_b64_tr_b16 a[192:193], v23 offset:0
    ds_read_b64_tr_b16 a[194:195], v23 offset:64
    ds_read_b64_tr_b16 a[196:197], v23 offset:1024
    ds_read_b64_tr_b16 a[198:199], v23 offset:1088
    ds_read_b64_tr_b16 a[200:201], v23 offset:2048
    ds_read_b64_tr_b16 a[202:203], v23 offset:2112
    ds_read_b64_tr_b16 a[204:205], v23 offset:3072
    ds_read_b64_tr_b16 a[206:207], v23 offset:3136
    s_waitcnt lgkmcnt(0)
    s_add_u32 s46, s48, 640
    buffer_load_dwordx4 a[240:243], v2, s[76:79], s46 offen
    s_add_u32 s46, s48, 9856
    buffer_load_dwordx4 a[244:247], v2, s[76:79], s46 offen
    s_add_u32 s46, s48, 19072
    buffer_load_dwordx4 a[248:251], v2, s[76:79], s46 offen
    s_add_u32 s46, s48, 28288
    buffer_load_dwordx4 a[252:255], v2, s[76:79], s46 offen
    s_waitcnt vmcnt(12)
    ds_write_b128 v4, v[48:51] offset:0
    ds_write_b128 v4, v[52:55] offset:256
    ds_write_b128 v4, v[56:59] offset:512
    ds_write_b128 v4, v[60:63] offset:768
    s_waitcnt lgkmcnt(0)
    s_barrier
    ds_read_b64_tr_b16 v[48:49], v7 offset:0
    ds_read_b64_tr_b16 v[50:51], v7 offset:64
    ds_read_b64_tr_b16 v[52:53], v7 offset:1024
    ds_read_b64_tr_b16 v[54:55], v7 offset:1088
    ds_read_b64_tr_b16 v[56:57], v7 offset:2048
    ds_read_b64_tr_b16 v[58:59], v7 offset:2112
    ds_read_b64_tr_b16 v[60:61], v7 offset:3072
    ds_read_b64_tr_b16 v[62:63], v7 offset:3136
    s_waitcnt lgkmcnt(0)
    ds_write_b128 v10, v[48:51] offset:4096
    ds_write_b128 v10, v[52:55] offset:5120
    ds_write_b128 v10, v[56:59] offset:6144
    ds_write_b128 v10, v[60:63] offset:7168
    s_waitcnt lgkmcnt(0)
    s_add_u32 s46, s48, 256
    buffer_load_dwordx4 v[64:67], v2, s[76:79], s46 offen
    s_add_u32 s46, s48, 9472
    buffer_load_dwordx4 v[68:71], v2, s[76:79], s46 offen
    s_add_u32 s46, s48, 18688
    buffer_load_dwordx4 v[72:75], v2, s[76:79], s46 offen
    s_add_u32 s46, s48, 27904
    buffer_load_dwordx4 v[76:79], v2, s[76:79], s46 offen
    s_waitcnt vmcnt(12)
    ds_write_b128 v20, a[208:211] offset:0
    ds_write_b128 v20, a[212:215] offset:256
    ds_write_b128 v20, a[216:219] offset:512
    ds_write_b128 v20, a[220:223] offset:768
    s_waitcnt lgkmcnt(0)
    s_barrier
    ds_read_b64_tr_b16 a[208:209], v23 offset:0
    ds_read_b64_tr_b16 a[210:211], v23 offset:64
    ds_read_b64_tr_b16 a[212:213], v23 offset:1024
    ds_read_b64_tr_b16 a[214:215], v23 offset:1088
    ds_read_b64_tr_b16 a[216:217], v23 offset:2048
    ds_read_b64_tr_b16 a[218:219], v23 offset:2112
    ds_read_b64_tr_b16 a[220:221], v23 offset:3072
    ds_read_b64_tr_b16 a[222:223], v23 offset:3136
    s_waitcnt lgkmcnt(0)
    s_add_u32 s46, s49, 0
    buffer_load_dwordx4 v[80:83], v1, s[64:67], s46 offen
    s_add_u32 s46, s49, 32768
    buffer_load_dwordx4 v[84:87], v1, s[64:67], s46 offen
    s_add_u32 s46, s49, 65536
    buffer_load_dwordx4 v[88:91], v1, s[64:67], s46 offen
    s_add_u32 s46, s49, 98304
    buffer_load_dwordx4 v[92:95], v1, s[64:67], s46 offen
    s_waitcnt vmcnt(12)
    ds_write_b128 v4, a[224:227] offset:0
    ds_write_b128 v4, a[228:231] offset:256
    ds_write_b128 v4, a[232:235] offset:512
    ds_write_b128 v4, a[236:239] offset:768
    s_waitcnt lgkmcnt(0)
    s_barrier
    ds_read_b64_tr_b16 a[224:225], v7 offset:0
    ds_read_b64_tr_b16 a[226:227], v7 offset:64
    ds_read_b64_tr_b16 a[228:229], v7 offset:1024
    ds_read_b64_tr_b16 a[230:231], v7 offset:1088
    ds_read_b64_tr_b16 a[232:233], v7 offset:2048
    ds_read_b64_tr_b16 a[234:235], v7 offset:2112
    ds_read_b64_tr_b16 a[236:237], v7 offset:3072
    ds_read_b64_tr_b16 a[238:239], v7 offset:3136
    s_waitcnt lgkmcnt(0)
    s_add_u32 s46, s49, 524288
    buffer_load_dwordx4 v[112:115], v1, s[64:67], s46 offen
    s_add_u32 s46, s49, 557056
    buffer_load_dwordx4 v[116:119], v1, s[64:67], s46 offen
    s_add_u32 s46, s49, 589824
    buffer_load_dwordx4 v[120:123], v1, s[64:67], s46 offen
    s_add_u32 s46, s49, 622592
    buffer_load_dwordx4 v[124:127], v1, s[64:67], s46 offen
    s_waitcnt vmcnt(12)
    ds_write_b128 v20, a[240:243] offset:0
    ds_write_b128 v20, a[244:247] offset:256
    ds_write_b128 v20, a[248:251] offset:512
    ds_write_b128 v20, a[252:255] offset:768
    s_waitcnt lgkmcnt(0)
    s_barrier
    ds_read_b64_tr_b16 a[240:241], v23 offset:0
    ds_read_b64_tr_b16 a[242:243], v23 offset:64
    ds_read_b64_tr_b16 a[244:245], v23 offset:1024
    ds_read_b64_tr_b16 a[246:247], v23 offset:1088
    ds_read_b64_tr_b16 a[248:249], v23 offset:2048
    ds_read_b64_tr_b16 a[250:251], v23 offset:2112
    ds_read_b64_tr_b16 a[252:253], v23 offset:3072
    ds_read_b64_tr_b16 a[254:255], v23 offset:3136
    s_waitcnt lgkmcnt(0)
    s_add_u32 s46, s49, 1048576
    buffer_load_dwordx4 v[144:147], v1, s[64:67], s46 offen
    s_add_u32 s46, s49, 1081344
    buffer_load_dwordx4 v[148:151], v1, s[64:67], s46 offen
    s_add_u32 s46, s49, 1114112
    buffer_load_dwordx4 v[152:155], v1, s[64:67], s46 offen
    s_add_u32 s46, s49, 1146880
    buffer_load_dwordx4 v[156:159], v1, s[64:67], s46 offen
    s_waitcnt vmcnt(12)
    ds_write_b128 v4, v[64:67] offset:0
    ds_write_b128 v4, v[68:71] offset:256
    ds_write_b128 v4, v[72:75] offset:512
    ds_write_b128 v4, v[76:79] offset:768
    s_waitcnt lgkmcnt(0)
    s_barrier
    ds_read_b64_tr_b16 v[64:65], v7 offset:0
    ds_read_b64_tr_b16 v[66:67], v7 offset:64
    ds_read_b64_tr_b16 v[68:69], v7 offset:1024
    ds_read_b64_tr_b16 v[70:71], v7 offset:1088
    ds_read_b64_tr_b16 v[72:73], v7 offset:2048
    ds_read_b64_tr_b16 v[74:75], v7 offset:2112
    ds_read_b64_tr_b16 v[76:77], v7 offset:3072
    ds_read_b64_tr_b16 v[78:79], v7 offset:3136
    s_waitcnt lgkmcnt(0)
    ds_write_b128 v10, v[64:67] offset:8192
    ds_write_b128 v10, v[68:71] offset:9216
    ds_write_b128 v10, v[72:75] offset:10240
    ds_write_b128 v10, v[76:79] offset:11264
    s_waitcnt lgkmcnt(0)
    s_add_u32 s46, s48, 768
    buffer_load_dwordx4 v[32:35], v2, s[76:79], s46 offen
    s_add_u32 s46, s48, 9984
    buffer_load_dwordx4 v[36:39], v2, s[76:79], s46 offen
    s_add_u32 s46, s48, 19200
    buffer_load_dwordx4 v[40:43], v2, s[76:79], s46 offen
    s_add_u32 s46, s48, 28416
    buffer_load_dwordx4 v[44:47], v2, s[76:79], s46 offen
    s_waitcnt vmcnt(12)
    ds_write_b128 v19, v[80:83] offset:0
    ds_write_b128 v19, v[84:87] offset:64
    ds_write_b128 v19, v[88:91] offset:128
    ds_write_b128 v19, v[92:95] offset:192
    s_waitcnt lgkmcnt(0)
    s_barrier
    ds_read_b64_tr_b16 v[80:81], v21 offset:0
    ds_read_b64_tr_b16 v[82:83], v21 offset:512
    ds_read_b64_tr_b16 v[84:85], v21 offset:2048
    ds_read_b64_tr_b16 v[86:87], v21 offset:2560
    ds_read_b64_tr_b16 v[88:89], v22 offset:0
    ds_read_b64_tr_b16 v[90:91], v22 offset:512
    ds_read_b64_tr_b16 v[92:93], v22 offset:2048
    ds_read_b64_tr_b16 v[94:95], v22 offset:2560
    s_waitcnt lgkmcnt(0)
    s_add_u32 s46, s49, 1572864
    buffer_load_dwordx4 v[176:179], v1, s[64:67], s46 offen
    s_add_u32 s46, s49, 1605632
    buffer_load_dwordx4 v[180:183], v1, s[64:67], s46 offen
    s_add_u32 s46, s49, 1638400
    buffer_load_dwordx4 v[184:187], v1, s[64:67], s46 offen
    s_add_u32 s46, s49, 1671168
    buffer_load_dwordx4 v[188:191], v1, s[64:67], s46 offen
    s_waitcnt vmcnt(12)
    ds_write_b128 v3, v[112:115] offset:0
    ds_write_b128 v3, v[116:119] offset:64
    ds_write_b128 v3, v[120:123] offset:128
    ds_write_b128 v3, v[124:127] offset:192
    s_waitcnt lgkmcnt(0)
    s_barrier
    ds_read_b64_tr_b16 v[112:113], v5 offset:0
    ds_read_b64_tr_b16 v[114:115], v5 offset:512
    ds_read_b64_tr_b16 v[116:117], v5 offset:2048
    ds_read_b64_tr_b16 v[118:119], v5 offset:2560
    ds_read_b64_tr_b16 v[120:121], v6 offset:0
    ds_read_b64_tr_b16 v[122:123], v6 offset:512
    ds_read_b64_tr_b16 v[124:125], v6 offset:2048
    ds_read_b64_tr_b16 v[126:127], v6 offset:2560
    s_waitcnt lgkmcnt(0)
    s_add_u32 s46, s49, 2097152
    buffer_load_dwordx4 v[208:211], v1, s[64:67], s46 offen
    s_add_u32 s46, s49, 2129920
    buffer_load_dwordx4 v[212:215], v1, s[64:67], s46 offen
    s_add_u32 s46, s49, 2162688
    buffer_load_dwordx4 v[216:219], v1, s[64:67], s46 offen
    s_add_u32 s46, s49, 2195456
    buffer_load_dwordx4 v[220:223], v1, s[64:67], s46 offen
    s_waitcnt vmcnt(12)
    ds_write_b128 v19, v[144:147] offset:0
    ds_write_b128 v19, v[148:151] offset:64
    ds_write_b128 v19, v[152:155] offset:128
    ds_write_b128 v19, v[156:159] offset:192
    s_waitcnt lgkmcnt(0)
    s_barrier
    ds_read_b64_tr_b16 v[144:145], v21 offset:0
    ds_read_b64_tr_b16 v[146:147], v21 offset:512
    ds_read_b64_tr_b16 v[148:149], v21 offset:2048
    ds_read_b64_tr_b16 v[150:151], v21 offset:2560
    ds_read_b64_tr_b16 v[152:153], v22 offset:0
    ds_read_b64_tr_b16 v[154:155], v22 offset:512
    ds_read_b64_tr_b16 v[156:157], v22 offset:2048
    ds_read_b64_tr_b16 v[158:159], v22 offset:2560
    s_waitcnt lgkmcnt(0)
    s_add_u32 s46, s49, 2621440
    buffer_load_dwordx4 v[240:243], v1, s[64:67], s46 offen
    s_add_u32 s46, s49, 2654208
    buffer_load_dwordx4 v[244:247], v1, s[64:67], s46 offen
    s_add_u32 s46, s49, 2686976
    buffer_load_dwordx4 v[248:251], v1, s[64:67], s46 offen
    s_add_u32 s46, s49, 2719744
    buffer_load_dwordx4 v[252:255], v1, s[64:67], s46 offen
    s_waitcnt vmcnt(12)
    ds_write_b128 v4, v[32:35] offset:0
    ds_write_b128 v4, v[36:39] offset:256
    ds_write_b128 v4, v[40:43] offset:512
    ds_write_b128 v4, v[44:47] offset:768
    s_waitcnt lgkmcnt(0)
    s_barrier
    ds_read_b64_tr_b16 v[32:33], v7 offset:0
    ds_read_b64_tr_b16 v[34:35], v7 offset:64
    ds_read_b64_tr_b16 v[36:37], v7 offset:1024
    ds_read_b64_tr_b16 v[38:39], v7 offset:1088
    ds_read_b64_tr_b16 v[40:41], v7 offset:2048
    ds_read_b64_tr_b16 v[42:43], v7 offset:2112
    ds_read_b64_tr_b16 v[44:45], v7 offset:3072
    ds_read_b64_tr_b16 v[46:47], v7 offset:3136
    s_waitcnt lgkmcnt(0)
    ds_write_b128 v10, v[32:35] offset:24576
    ds_write_b128 v10, v[36:39] offset:25600
    ds_write_b128 v10, v[40:43] offset:26624
    ds_write_b128 v10, v[44:47] offset:27648
    s_waitcnt lgkmcnt(0)
    s_add_u32 s46, s48, 896
    buffer_load_dwordx4 v[48:51], v2, s[76:79], s46 offen
    s_add_u32 s46, s48, 10112
    buffer_load_dwordx4 v[52:55], v2, s[76:79], s46 offen
    s_add_u32 s46, s48, 19328
    buffer_load_dwordx4 v[56:59], v2, s[76:79], s46 offen
    s_add_u32 s46, s48, 28544
    buffer_load_dwordx4 v[60:63], v2, s[76:79], s46 offen
    s_waitcnt vmcnt(12)
    ds_write_b128 v19, v[176:179] offset:0
    ds_write_b128 v19, v[180:183] offset:64
    ds_write_b128 v19, v[184:187] offset:128
    ds_write_b128 v19, v[188:191] offset:192
    s_waitcnt lgkmcnt(0)
    s_barrier
    ds_read_b64_tr_b16 v[176:177], v21 offset:0
    ds_read_b64_tr_b16 v[178:179], v21 offset:512
    ds_read_b64_tr_b16 v[180:181], v21 offset:2048
    ds_read_b64_tr_b16 v[182:183], v21 offset:2560
    ds_read_b64_tr_b16 v[184:185], v22 offset:0
    ds_read_b64_tr_b16 v[186:187], v22 offset:512
    ds_read_b64_tr_b16 v[188:189], v22 offset:2048
    ds_read_b64_tr_b16 v[190:191], v22 offset:2560
    s_waitcnt lgkmcnt(0)
    s_add_u32 s46, s49, 3145728
    buffer_load_dwordx4 a[16:19], v1, s[64:67], s46 offen
    s_add_u32 s46, s49, 3178496
    buffer_load_dwordx4 a[20:23], v1, s[64:67], s46 offen
    s_add_u32 s46, s49, 3211264
    buffer_load_dwordx4 a[24:27], v1, s[64:67], s46 offen
    s_add_u32 s46, s49, 3244032
    buffer_load_dwordx4 a[28:31], v1, s[64:67], s46 offen
    s_waitcnt vmcnt(12)
    ds_write_b128 v3, v[208:211] offset:0
    ds_write_b128 v3, v[212:215] offset:64
    ds_write_b128 v3, v[216:219] offset:128
    ds_write_b128 v3, v[220:223] offset:192
    s_waitcnt lgkmcnt(0)
    s_barrier
    ds_read_b64_tr_b16 v[208:209], v5 offset:0
    ds_read_b64_tr_b16 v[210:211], v5 offset:512
    ds_read_b64_tr_b16 v[212:213], v5 offset:2048
    ds_read_b64_tr_b16 v[214:215], v5 offset:2560
    ds_read_b64_tr_b16 v[216:217], v6 offset:0
    ds_read_b64_tr_b16 v[218:219], v6 offset:512
    ds_read_b64_tr_b16 v[220:221], v6 offset:2048
    ds_read_b64_tr_b16 v[222:223], v6 offset:2560
    s_waitcnt lgkmcnt(0)
    s_add_u32 s46, s49, 3670016
    buffer_load_dwordx4 a[48:51], v1, s[64:67], s46 offen
    s_add_u32 s46, s49, 3702784
    buffer_load_dwordx4 a[52:55], v1, s[64:67], s46 offen
    s_add_u32 s46, s49, 3735552
    buffer_load_dwordx4 a[56:59], v1, s[64:67], s46 offen
    s_add_u32 s46, s49, 3768320
    buffer_load_dwordx4 a[60:63], v1, s[64:67], s46 offen
    s_waitcnt vmcnt(12)
    ds_write_b128 v19, v[240:243] offset:0
    ds_write_b128 v19, v[244:247] offset:64
    ds_write_b128 v19, v[248:251] offset:128
    ds_write_b128 v19, v[252:255] offset:192
    s_waitcnt lgkmcnt(0)
    s_barrier
    ds_read_b64_tr_b16 v[240:241], v21 offset:0
    ds_read_b64_tr_b16 v[242:243], v21 offset:512
    ds_read_b64_tr_b16 v[244:245], v21 offset:2048
    ds_read_b64_tr_b16 v[246:247], v21 offset:2560
    ds_read_b64_tr_b16 v[248:249], v22 offset:0
    ds_read_b64_tr_b16 v[250:251], v22 offset:512
    ds_read_b64_tr_b16 v[252:253], v22 offset:2048
    ds_read_b64_tr_b16 v[254:255], v22 offset:2560
    s_waitcnt lgkmcnt(0)
    s_add_u32 s46, s49, 4194304
    buffer_load_dwordx4 a[80:83], v1, s[64:67], s46 offen
    s_add_u32 s46, s49, 4227072
    buffer_load_dwordx4 a[84:87], v1, s[64:67], s46 offen
    s_add_u32 s46, s49, 4259840
    buffer_load_dwordx4 a[88:91], v1, s[64:67], s46 offen
    s_add_u32 s46, s49, 4292608
    buffer_load_dwordx4 a[92:95], v1, s[64:67], s46 offen
    s_waitcnt vmcnt(12)
    ds_write_b128 v4, v[48:51] offset:0
    ds_write_b128 v4, v[52:55] offset:256
    ds_write_b128 v4, v[56:59] offset:512
    ds_write_b128 v4, v[60:63] offset:768
    s_waitcnt lgkmcnt(0)
    s_barrier
    ds_read_b64_tr_b16 v[48:49], v7 offset:0
    ds_read_b64_tr_b16 v[50:51], v7 offset:64
    ds_read_b64_tr_b16 v[52:53], v7 offset:1024
    ds_read_b64_tr_b16 v[54:55], v7 offset:1088
    ds_read_b64_tr_b16 v[56:57], v7 offset:2048
    ds_read_b64_tr_b16 v[58:59], v7 offset:2112
    ds_read_b64_tr_b16 v[60:61], v7 offset:3072
    ds_read_b64_tr_b16 v[62:63], v7 offset:3136
    s_waitcnt lgkmcnt(0)
    ds_write_b128 v10, v[48:51] offset:28672
    ds_write_b128 v10, v[52:55] offset:29696
    ds_write_b128 v10, v[56:59] offset:30720
    ds_write_b128 v10, v[60:63] offset:31744
    s_waitcnt lgkmcnt(0)
    s_add_u32 s46, s49, 1572864
    buffer_load_dwordx4 v[64:67], v1, s[72:75], s46 offen
    s_add_u32 s46, s49, 1605632
    buffer_load_dwordx4 v[68:71], v1, s[72:75], s46 offen
    s_add_u32 s46, s49, 1638400
    buffer_load_dwordx4 v[72:75], v1, s[72:75], s46 offen
    s_add_u32 s46, s49, 1671168
    buffer_load_dwordx4 v[76:79], v1, s[72:75], s46 offen
    s_waitcnt vmcnt(12)
    ds_write_b128 v19, a[16:19] offset:0
    ds_write_b128 v19, a[20:23] offset:64
    ds_write_b128 v19, a[24:27] offset:128
    ds_write_b128 v19, a[28:31] offset:192
    s_waitcnt lgkmcnt(0)
    s_barrier
    ds_read_b64_tr_b16 a[16:17], v21 offset:0
    ds_read_b64_tr_b16 a[18:19], v21 offset:512
    ds_read_b64_tr_b16 a[20:21], v21 offset:2048
    ds_read_b64_tr_b16 a[22:23], v21 offset:2560
    ds_read_b64_tr_b16 a[24:25], v22 offset:0
    ds_read_b64_tr_b16 a[26:27], v22 offset:512
    ds_read_b64_tr_b16 a[28:29], v22 offset:2048
    ds_read_b64_tr_b16 a[30:31], v22 offset:2560
    s_waitcnt lgkmcnt(0)
    s_waitcnt vmcnt(8)
    ds_write_b128 v3, a[48:51] offset:0
    ds_write_b128 v3, a[52:55] offset:64
    ds_write_b128 v3, a[56:59] offset:128
    ds_write_b128 v3, a[60:63] offset:192
    s_waitcnt lgkmcnt(0)
    s_barrier
    ds_read_b64_tr_b16 a[48:49], v5 offset:0
    ds_read_b64_tr_b16 a[50:51], v5 offset:512
    ds_read_b64_tr_b16 a[52:53], v5 offset:2048
    ds_read_b64_tr_b16 a[54:55], v5 offset:2560
    ds_read_b64_tr_b16 a[56:57], v6 offset:0
    ds_read_b64_tr_b16 a[58:59], v6 offset:512
    ds_read_b64_tr_b16 a[60:61], v6 offset:2048
    ds_read_b64_tr_b16 a[62:63], v6 offset:2560
    s_waitcnt lgkmcnt(0)
    s_waitcnt vmcnt(4)
    ds_write_b128 v19, a[80:83] offset:0
    ds_write_b128 v19, a[84:87] offset:64
    ds_write_b128 v19, a[88:91] offset:128
    ds_write_b128 v19, a[92:95] offset:192
    s_waitcnt lgkmcnt(0)
    s_barrier
    ds_read_b64_tr_b16 a[80:81], v21 offset:0
    ds_read_b64_tr_b16 a[82:83], v21 offset:512
    ds_read_b64_tr_b16 a[84:85], v21 offset:2048
    ds_read_b64_tr_b16 a[86:87], v21 offset:2560
    ds_read_b64_tr_b16 a[88:89], v22 offset:0
    ds_read_b64_tr_b16 a[90:91], v22 offset:512
    ds_read_b64_tr_b16 a[92:93], v22 offset:2048
    ds_read_b64_tr_b16 a[94:95], v22 offset:2560
    s_waitcnt lgkmcnt(0)
    s_waitcnt vmcnt(0)
    ds_write_b128 v3, v[64:67] offset:0
    ds_write_b128 v3, v[68:71] offset:64
    ds_write_b128 v3, v[72:75] offset:128
    ds_write_b128 v3, v[76:79] offset:192
    s_waitcnt lgkmcnt(0)
    s_barrier
    ds_read_b64_tr_b16 v[64:65], v5 offset:0
    ds_read_b64_tr_b16 v[66:67], v5 offset:512
    ds_read_b64_tr_b16 v[68:69], v5 offset:2048
    ds_read_b64_tr_b16 v[70:71], v5 offset:2560
    ds_read_b64_tr_b16 v[72:73], v6 offset:0
    ds_read_b64_tr_b16 v[74:75], v6 offset:512
    ds_read_b64_tr_b16 v[76:77], v6 offset:2048
    ds_read_b64_tr_b16 v[78:79], v6 offset:2560
    s_waitcnt lgkmcnt(0)
    s_barrier
    ds_write_b128 v10, v[64:67] offset:20480
    ds_write_b128 v10, v[68:71] offset:21504
    ds_write_b128 v10, v[72:75] offset:22528
    ds_write_b128 v10, v[76:79] offset:23552
    s_waitcnt lgkmcnt(0)
    v_mov_b32 v6, 163728
    s_cmp_eq_u32 s13, 0
    s_cbranch_scc0 L_twd_286
    s_mov_b32 s21, 0
        L_tw_285:
    buffer_load_dword v2, off, s[8:11], 0 offset:8 sc1
    buffer_load_dword v3, off, s[8:11], 0 offset:136 sc1
    buffer_load_dword v4, off, s[8:11], 0 offset:128 sc1
    s_add_u32 s21, s21, 1
    s_cmp_gt_u32 s21, 3000000
    s_cbranch_scc1 L_fail
    s_waitcnt vmcnt(0)
    v_readfirstlane_b32 s60, v2
    v_readfirstlane_b32 s61, v3
    v_readfirstlane_b32 s62, v4
    s_cmp_lt_u32 s61, 32
    s_cbranch_scc1 L_tw_285
    s_cmp_eq_u32 s60, 0
    s_cbranch_scc1 L_tw_285
        L_tw_285_out:
    ds_write_b32 v6, v4
    s_waitcnt lgkmcnt(0)
        L_twd_286:
    s_mov_b32 s60, 3
    s_mov_b32 s15, 5
    v_mov_b32 v3, 163744
    s_cmp_eq_u32 s13, 0
    s_cbranch_scc0 L_wkd_288
    s_mov_b32 s21, 0
    v_mbcnt_lo_u32_b32 v4, -1, 0
    v_min_u32 v4, 3, v4
    v_lshlrev_b32 v4, 2, v4
        L_wk_287:
    buffer_load_dword v2, v4, s[4:7], s58 offen sc1
    s_add_u32 s21, s21, 1
    s_cmp_gt_u32 s21, 3000000
    s_cbranch_scc1 L_fail
    s_waitcnt vmcnt(0)
    v_cmp_gt_u32 vcc, s60, v2
    s_cbranch_vccnz L_wk_287
    s_nop 0
    v_min_u32_dpp v2, v2, v2 quad_perm:[1,0,3,2] row_mask:0xf bank_mask:0xf
    s_nop 1
    v_min_u32_dpp v2, v2, v2 quad_perm:[2,3,0,1] row_mask:0xf bank_mask:0xf
    s_nop 1
    v_min_u32_dpp v2, v2, v2 row_half_mirror row_mask:0xf bank_mask:0xf
    s_mov_b64 exec, 1
    ds_write_b32 v3, v2
    s_mov_b64 exec, -1
    s_waitcnt lgkmcnt(0)
        L_wkd_288:
    s_barrier
    ds_read_b32 v2, v3
    s_waitcnt lgkmcnt(0)
    v_readfirstlane_b32 s61, v2
    v_and_b32 v1, 63, v0
    v_lshlrev_b32 v78, 4, v1
    v_add_u32 v78, 147456, v78
    v_and_b32 v2, 15, v1
    v_lshrrev_b32 v3, 4, v1
    v_mov_b32 v20, 1073741824
    v_mov_b32 v21, 0x3f80
    v_mov_b32 v22, 0x3f800000
    v_mov_b32 v23, 0
    v_and_b32 v4, 2, v2
    v_cmp_ne_u32 vcc, 0, v4
    v_mov_b32 v5, 0x4444
    v_mov_b32 v6, 0xeeee
    v_cndmask_b32 v79, v5, v6, vcc
    v_lshrrev_b32 v4, 2, v2
    v_lshlrev_b32 v4, 1, v4
    v_and_b32 v7, 1, v2
    v_add_u32 v19, v4, v7
    v_lshlrev_b32 v5, 1, v3
    v_add_u32 v6, 1, v5
    v_cmp_eq_u32 vcc, v19, v5
    v_cmp_eq_u32 s[46:47], v19, v6
    s_nop 0
    v_cndmask_b32 v7, v23, v21, vcc
    v_cndmask_b32 v76, v7, v22, s[46:47]
    v_and_b32 v5, 1, v3
    v_lshl_add_u32 v4, v5, 1, v2
    v_lshlrev_b32 v4, 4, v4
    v_lshrrev_b32 v5, 1, v3
    v_lshl_add_u32 v4, v5, 8, v4
    v_add_u32 v4, 151552, v4
    v_and_b32 v5, 2, v2
    v_cmp_eq_u32 vcc, 0, v5
    v_mov_b32 v5, 160768
    v_lshl_add_u32 v6, v3, 3, v19
    v_cndmask_b32 v10, v5, v4, vcc
    v_lshlrev_b32 v6, 4, v6
    v_cndmask_b32 v12, v20, v6, vcc
    v_lshrrev_b32 v4, 3, v1
    v_lshlrev_b32 v4, 11, v4
    v_and_b32 v5, 7, v1
    v_lshl_add_u32 v11, v5, 3, v4
    v_lshlrev_b32 v4, 6, v2
    v_lshl_add_u32 v13, v3, 4, v4
    ds_write_b128 v78, v[10:13] offset:9216
    v_and_b32 v4, 3, v1
    v_bfe_u32 v5, v1, 2, 2
    v_lshl_add_u32 v6, v3, 2, v4
    v_lshlrev_b32 v6, 6, v6
    v_lshl_add_u32 v14, v5, 4, v6
    v_lshrrev_b32 v6, 1, v2
    v_lshlrev_b32 v6, 10, v6
    v_and_b32 v7, 1, v2
    v_lshl_add_u32 v6, v7, 4, v6
    v_lshl_add_u32 v6, v3, 2, v6
    v_cmp_gt_u32 vcc, 4, v2
    s_nop 1
    v_cndmask_b32 v15, v20, v6, vcc
    v_lshrrev_b32 v6, 1, v5
    v_lshl_add_u32 v6, v6, 2, v4
    v_lshl_add_u32 v6, v3, 3, v6
    v_lshlrev_b32 v6, 5, v6
    v_and_b32 v7, 1, v5
    v_lshl_add_u32 v16, v7, 4, v6
    v_and_b32 v6, 1, v2
    v_lshlrev_b32 v6, 4, v6
    v_lshrrev_b32 v7, 2, v2
    v_lshl_add_u32 v7, v3, 1, v7
    v_lshl_add_u32 v6, v7, 2, v6
    v_and_b32 v7, 0x2a, v1
    v_cmp_eq_u32 vcc, 0, v7
    s_nop 1
    v_cndmask_b32 v17, v20, v6, vcc
    ds_write_b128 v78, v[14:17] offset:10240
    v_and_b32 v4, 7, v2
    v_lshrrev_b32 v5, 1, v4
    v_and_b32 v6, 1, v4
    v_cmp_eq_u32 vcc, 1, v6
    s_nop 1
    v_cndmask_b32 v6, v21, v22, vcc
    v_cmp_eq_u32 vcc, 0, v5
    s_nop 1
    v_cndmask_b32 v24, v23, v6, vcc
    v_cmp_eq_u32 vcc, 1, v5
    s_nop 1
    v_cndmask_b32 v25, v23, v6, vcc
    v_cmp_eq_u32 vcc, 2, v5
    s_nop 1
    v_cndmask_b32 v26, v23, v6, vcc
    v_cmp_eq_u32 vcc, 3, v5
    s_nop 1
    v_cndmask_b32 v27, v23, v6, vcc
    ds_write_b128 v78, v[24:27] offset:11264
    v_mov_b32 v77, v76
    ds_write_b64 v78, v[76:77] offset:12288
    s_mov_b32 s22, 0xcccccccc
    s_mov_b32 s23, 0xcccccccc
    s_mov_b32 s56, 0x3f803f80
    s_mov_b32 s57, 0x3f803f80
    s_mov_b32 s42, 0x3e0293ee
    s_mov_b32 s44, 0x42700000
    s_lshl_b32 s46, s13, 14
    s_lshl_b32 s47, s12, 6
    s_add_u32 s46, s46, s47
    s_add_u32 s21, s46, s50
    s_mov_b32 m0, 162816
    s_sub_u32 s31, s52, 147456
    s_add_u32 s32, s31, 4096
    s_add_u32 s33, s31, 8192
    s_and_b32 s46, s14, 1
    s_mul_i32 s39, s46, 294912
    s_add_u32 s46, s14, 1
    s_mul_hi_u32 s47, s46, 0x55555556
    s_mul_i32 s47, s47, 3
    s_sub_u32 s46, s46, s47
    s_mul_i32 s40, s46, 9216
    s_add_u32 s41, s40, 9216
    s_cmp_eq_u32 s41, 27648
    s_cselect_b32 s41, 0, s41
    s_lshl_b32 s54, s14, 5
    s_add_u32 s54, s54, s12
    s_lshl_b32 s47, s54, 14
    s_lshl_b32 s48, s13, 11
    s_add_u32 s47, s47, s48
    s_add_u32 s34, s47, 16629760
    s_waitcnt lgkmcnt(0)
    s_barrier
        L_runS:
    s_cmp_eq_u32 s13, 1
    s_cbranch_scc1 L_entryS1
    s_cmp_eq_u32 s13, 2
    s_cbranch_scc1 L_entryS2
    s_cmp_eq_u32 s13, 3
    s_cbranch_scc1 L_entryS3
L_entryS0:
    ds_read_b128 v[8:11], v78 offset:10240
    v_mov_b32 v65, -1
    s_waitcnt lgkmcnt(0)
    v_mov_b32 v64, v9
    v_mov_b32 v66, v11
    s_branch L_stepS0
.p2align 6
L_stepS0:
    s_add_u32 s38, s34, 4294451200
    s_cmp_lt_u32 s14, 62
    s_cselect_b32 s38, s38, 1073741824
    s_lshl_b32 s47, s54, 11
    s_add_u32 s36, s47, 50331648
    s_lshl_b32 s47, s47, 1
    s_add_u32 s37, s47, 54525952
    s_add_u32 s16, s21, s39
    s_add_u32 s17, s16, 65536
    s_add_u32 s18, s16, 131072
    s_add_u32 s19, s16, 196608
    s_lshl_b32 s46, s12, 5
    s_add_u32 s48, s50, s39
    s_add_u32 s49, s48, s46
    s_add_u32 s20, s49, 262144
    s_add_u32 s46, s46, s51
    s_add_u32 s47, s46, s40
    s_add_u32 s27, s47, 0
    s_add_u32 s28, s47, 8192
    s_lshl_b32 s46, s12, 11
    s_add_u32 s46, s46, s48
    s_add_u32 s25, s46, 0
    s_lshl_b32 s46, s12, 10
    s_add_u32 s46, s46, s48
    s_add_u32 s26, s46, 262144
    s_bfe_u32 s24, s14, 0x10001
    s_waitcnt vmcnt(1)
    v_mov_b64 v[36:37], 0
    v_mov_b64 v[38:39], 0
    v_mov_b64 v[40:41], 0
    v_mov_b64 v[42:43], 0
    v_mov_b64 v[44:45], 0
    v_mov_b64 v[46:47], 0
    v_mov_b64 v[48:49], 0
    v_mov_b64 v[50:51], 0
    v_mov_b64 v[52:53], 0
    v_mov_b64 v[54:55], 0
    v_mov_b64 v[56:57], 0
    v_mov_b64 v[58:59], 0
    v_add_u32 v77, 4294819840, v78
    s_nop 15
    s_nop 3
    buffer_load_dwordx4 v[0:3], v78, s[4:7], s31 offen offset:0 sc1
    buffer_load_dwordx4 v[8:11], v78, s[4:7], s31 offen offset:2048 sc1
    s_nop 15
    s_nop 13
    buffer_load_dwordx4 v[68:71], v78, s[4:7], s31 offen offset:0 sc1
    buffer_load_dwordx4 v[72:75], v78, s[4:7], s31 offen offset:2048 sc1
    s_waitcnt vmcnt(2)
    v_max3_u32 v76, v0, v1, v2
    v_max3_u32 v76, v76, v3, v8
    v_max3_u32 v76, v76, v9, v10
    v_max_u32 v76, v76, v11
    v_cmp_eq_u32 vcc, -1, v76
    ds_write_b128 v78, v[0:3] offset:0
    ds_write_b128 v78, v[8:11] offset:2048
    s_cbranch_vccnz L_mpS0_289
L_mdS0_290:
    s_nop 0
    v_smfmac_f32_16x16x64_bf16 v[48:51], v[0:3], v[104:111], v79
    s_add_u32 s35, s34, 8192
    v_smfmac_f32_16x16x64_bf16 v[36:39], v[0:3], v[80:87], v79
    v_smfmac_f32_16x16x64_bf16 v[48:51], v[8:11], v[168:175], v79
    buffer_load_dwordx4 v[16:19], v78, s[4:7], s32 offen offset:0 sc1
    v_smfmac_f32_16x16x64_bf16 v[40:43], v[0:3], v[88:95], v79
    s_waitcnt lgkmcnt(0)
    s_barrier
    ds_read_b128 v[4:7], v78 offset:1024
    v_smfmac_f32_16x16x64_bf16 v[44:47], v[0:3], v[96:103], v79
    ds_read_b128 v[12:15], v78 offset:3072
    v_smfmac_f32_16x16x64_bf16 v[36:39], v[8:11], v[144:151], v79
    buffer_load_dwordx4 v[32:35], v78, s[4:7], s33 offen offset:0 sc1
    s_waitcnt vmcnt(2)
    ds_read_b128 v[68:71], v77 offset:12288
    v_smfmac_f32_16x16x64_bf16 v[40:43], v[8:11], v[152:159], v79
    ds_read_b128 v[72:75], v77 offset:13312
    v_smfmac_f32_16x16x64_bf16 v[44:47], v[8:11], v[160:167], v79
    ds_read_b128 v[24:27], v77 offset:14336
    ds_read_b128 v[28:31], v77 offset:15360
    buffer_store_dword v65, v64, s[4:7], s27 offen sc1
    s_waitcnt lgkmcnt(5)
    v_smfmac_f32_16x16x64_bf16 v[36:39], v[4:7], v[112:119], v79
    buffer_load_dwordx4 v[60:63], v78, s[4:7], s34 offen sc1
    v_smfmac_f32_16x16x64_bf16 v[40:43], v[4:7], v[120:127], v79
    s_waitcnt lgkmcnt(2)
    v_smfmac_f32_16x16x64_bf16 v[52:55], v[0:3], v[68:75], v79
    ds_read_b128 v[68:71], v77 offset:16384
    v_smfmac_f32_16x16x64_bf16 v[44:47], v[4:7], v[128:135], v79
    ds_read_b128 v[72:75], v77 offset:17408
    s_waitcnt lgkmcnt(2)
    v_smfmac_f32_16x16x64_bf16 v[56:59], v[0:3], v[24:31], v79
    ds_read_b128 v[24:27], v77 offset:18432
    buffer_load_dwordx4 v[64:67], v78, s[4:7], s34 offen offset:1024 sc1
    v_smfmac_f32_16x16x64_bf16 v[48:51], v[4:7], v[136:143], v79
    ds_read_b128 v[28:31], v77 offset:19456
    v_smfmac_f32_16x16x64_bf16 v[36:39], v[12:15], v[176:183], v79
    v_smfmac_f32_16x16x64_bf16 v[40:43], v[12:15], v[184:191], v79
    v_smfmac_f32_16x16x64_bf16 v[44:47], v[12:15], v[192:199], v79
    s_waitcnt lgkmcnt(2)
    v_smfmac_f32_16x16x64_bf16 v[52:55], v[8:11], v[68:75], v79
    ds_read_b128 v[68:71], v77 offset:32768
    v_smfmac_f32_16x16x64_bf16 v[48:51], v[12:15], v[200:207], v79
    ds_read_b128 v[72:75], v77 offset:33792
    s_waitcnt lgkmcnt(2)
    v_smfmac_f32_16x16x64_bf16 v[56:59], v[8:11], v[24:31], v79
    ds_read_b128 v[24:27], v77 offset:34816
    s_waitcnt vmcnt(4)
    v_max3_u32 v76, v16, v17, v18
    v_max_u32 v76, v76, v19
    ds_read_b128 v[28:31], v77 offset:35840
    v_cmp_eq_u32 vcc, -1, v76
    ds_write_b128 v78, v[16:19] offset:4096
    s_cbranch_vccnz L_rtS_294
L_bkS_295:
    s_waitcnt vmcnt(3)
    v_max3_u32 v76, v32, v33, v34
    v_max_u32 v76, v76, v35
    v_cmp_eq_u32 vcc, -1, v76
    s_waitcnt lgkmcnt(3)
    v_smfmac_f32_16x16x64_bf16 v[52:55], v[4:7], v[68:75], v79
    ds_read_b128 v[68:71], v77 offset:20480
    v_smfmac_f32_16x16x64_bf16 v[36:39], v[16:19], v[208:215], v79
    ds_read_b128 v[72:75], v77 offset:21504
    s_waitcnt lgkmcnt(3)
    v_smfmac_f32_16x16x64_bf16 v[56:59], v[4:7], v[24:31], v79
    ds_read_b128 v[24:27], v77 offset:22528
    s_cbranch_vccnz L_rtS_297
L_bkS_298:
    ds_read_b128 v[28:31], v77 offset:23552
    v_smfmac_f32_16x16x64_bf16 v[40:43], v[16:19], v[216:223], v79
    ds_read_b64 v[76:77], v78 offset:12288
    v_smfmac_f32_16x16x64_bf16 v[44:47], v[16:19], v[224:231], v79
    v_smfmac_f32_16x16x64_bf16 v[48:51], v[16:19], v[232:239], v79
    s_waitcnt lgkmcnt(3)
    v_smfmac_f32_16x16x64_bf16 v[52:55], v[12:15], v[68:75], v79
    buffer_load_dwordx4 v[68:71], v78, s[4:7], s35 offen sc1
    v_smfmac_f32_16x16x64_bf16 v[36:39], v[32:35], a[80:87], v79
    s_waitcnt lgkmcnt(1)
    v_smfmac_f32_16x16x64_bf16 v[56:59], v[12:15], v[24:31], v79
    v_smfmac_f32_16x16x64_bf16 v[40:43], v[32:35], a[88:95], v79
    v_smfmac_f32_16x16x64_bf16 v[44:47], v[32:35], a[96:103], v79
    buffer_load_dwordx4 v[72:75], v78, s[4:7], s35 offen offset:1024 sc1
    s_barrier
    ds_read_b128 v[20:23], v78 offset:5120
    v_smfmac_f32_16x16x64_bf16 v[48:51], v[32:35], a[104:111], v79
    ds_read_b128 v[24:27], v78 offset:6144
    v_smfmac_f32_16x16x64_bf16 v[52:55], v[16:19], a[112:119], v79
    ds_read_b128 v[28:31], v78 offset:7168
    v_smfmac_f32_16x16x64_bf16 v[56:59], v[16:19], a[120:127], v79
    v_smfmac_f32_16x16x64_bf16 v[52:55], v[32:35], a[176:183], v79
    v_smfmac_f32_16x16x64_bf16 v[56:59], v[32:35], a[184:191], v79
    ds_read_b128 v[32:35], v78 offset:9216
    s_waitcnt lgkmcnt(3)
    v_smfmac_f32_16x16x64_bf16 v[36:39], v[20:23], v[240:247], v79
    v_smfmac_f32_16x16x64_bf16 v[40:43], v[20:23], v[248:255], v79
    v_smfmac_f32_16x16x64_bf16 v[44:47], v[20:23], a[0:7], v79
    v_smfmac_f32_16x16x64_bf16 v[48:51], v[20:23], a[8:15], v79
    s_waitcnt lgkmcnt(2)
    v_smfmac_f32_16x16x64_bf16 v[36:39], v[24:27], a[16:23], v79
    v_smfmac_f32_16x16x64_bf16 v[40:43], v[24:27], a[24:31], v79
    v_smfmac_f32_16x16x64_bf16 v[44:47], v[24:27], a[32:39], v79
    v_smfmac_f32_16x16x64_bf16 v[48:51], v[24:27], a[40:47], v79
    s_waitcnt lgkmcnt(1)
    v_smfmac_f32_16x16x64_bf16 v[36:39], v[28:31], a[48:55], v79
    v_smfmac_f32_16x16x64_bf16 v[40:43], v[28:31], a[56:63], v79
    v_smfmac_f32_16x16x64_bf16 v[44:47], v[28:31], a[64:71], v79
    v_smfmac_f32_16x16x64_bf16 v[48:51], v[28:31], a[72:79], v79
    s_nop 1
    v_cvt_pk_bf16_f32 v36, v36, v37
    v_cvt_pk_bf16_f32 v37, v38, v39
    v_cvt_pk_bf16_f32 v40, v40, v41
    v_cvt_pk_bf16_f32 v41, v42, v43
    v_mfma_f32_16x16x16_bf16 v[0:3], v[36:37], v[76:77], 0
    v_cvt_pk_bf16_f32 v44, v44, v45
    v_cvt_pk_bf16_f32 v48, v48, v49
    v_mfma_f32_16x16x16_bf16 v[4:7], v[40:41], v[76:77], 0
    v_cvt_pk_bf16_f32 v45, v46, v47
    v_cvt_pk_bf16_f32 v49, v50, v51
    s_nop 0
    v_mfma_f32_16x16x16_bf16 v[8:11], v[44:45], v[76:77], 0
    v_cvt_pk_bf16_f32 v36, v0, v1
    v_cvt_pk_bf16_f32 v37, v2, v3
    v_mfma_f32_16x16x16_bf16 v[12:15], v[48:49], v[76:77], 0
    v_cvt_pk_bf16_f32 v38, v4, v5
    v_cvt_pk_bf16_f32 v39, v6, v7
    v_add_u32 v77, 4294819840, v78
    ds_read_b128 v[16:19], v77 offset:0
    v_cvt_pk_bf16_f32 v44, v8, v9
    v_cvt_pk_bf16_f32 v45, v10, v11
    s_waitcnt vmcnt(3)
    v_mfma_f32_16x16x32_bf16 v[0:3], v[60:63], v[36:39], 0
    v_cvt_pk_bf16_f32 v46, v12, v13
    v_cvt_pk_bf16_f32 v47, v14, v15
    s_waitcnt vmcnt(2)
    v_mfma_f32_16x16x32_bf16 v[4:7], v[64:67], v[36:39], 0
    v_lshrrev_b32 v64, 2, v78
    v_add_u32 v64, 118784, v64
    v_mfma_f32_16x16x32_bf16 v[48:51], v[44:47], v[36:39], 0
    ds_read_b128 v[36:39], v77 offset:8192
    s_nop 2
    v_cndmask_b32 v0, v0, v4, s[22:23]
    v_cndmask_b32 v1, v1, v5, s[22:23]
    v_cndmask_b32 v2, v2, v6, s[22:23]
    v_cndmask_b32 v3, v3, v7, s[22:23]
    ds_write_b128 v78, v[0:3] offset:0
    v_cndmask_b32 v48, v48, v49, s[22:23]
    v_smfmac_f32_16x16x64_bf16 v[52:55], v[20:23], a[128:135], v79
    ds_write_b32 v64, v48 offset:0
    s_waitcnt lgkmcnt(4)
    buffer_store_dwordx4 v[44:47], v34, s[4:7], s36 offen sc1
    v_smfmac_f32_16x16x64_bf16 v[56:59], v[20:23], a[136:143], v79
    ds_read_b128 v[20:23], v77 offset:1024
    v_smfmac_f32_16x16x64_bf16 v[52:55], v[24:27], a[144:151], v79
    s_waitcnt lgkmcnt(1)
    s_barrier
    ds_read_b128 v[4:7], v78 offset:1024
    v_smfmac_f32_16x16x64_bf16 v[56:59], v[24:27], a[152:159], v79
    ds_read_b128 v[8:11], v78 offset:2048
    v_smfmac_f32_16x16x64_bf16 v[52:55], v[28:31], a[160:167], v79
    ds_read_b128 v[12:15], v78 offset:3072
    v_smfmac_f32_16x16x64_bf16 v[56:59], v[28:31], a[168:175], v79
    ds_read_b32 v49, v64 offset:256
    ds_read_b32 v50, v64 offset:512
    ds_read_b32 v51, v64 offset:768
    ds_read_b128 v[24:27], v77 offset:2048
    s_nop 0
    v_cvt_pk_bf16_f32 v52, v52, v53
    v_cvt_pk_bf16_f32 v53, v54, v55
    ds_read_b128 v[28:31], v77 offset:3072
    v_cvt_pk_bf16_f32 v54, v56, v57
    v_cvt_pk_bf16_f32 v55, v58, v59
    s_waitcnt lgkmcnt(7)
    v_pk_add_f32 v[0:1], v[0:1], v[4:5]
    v_pk_add_f32 v[2:3], v[2:3], v[6:7]
    s_waitcnt lgkmcnt(4)
    v_add_f32 v48, v48, v49
    v_pk_add_f32 v[8:9], v[8:9], v[12:13]
    v_pk_add_f32 v[10:11], v[10:11], v[14:15]
    v_pk_add_f32 v[0:1], v[0:1], v[8:9]
    v_pk_add_f32 v[2:3], v[2:3], v[10:11]
    v_exp_f32 v4, v0
    v_exp_f32 v5, v1
    v_exp_f32 v6, v2
    v_exp_f32 v7, v3
    v_cvt_pk_bf16_f32 v8, v4, v5
    v_max3_f32 v40, |v0|, |v1|, |v2|
    v_cvt_pk_bf16_f32 v9, v6, v7
    v_mov_b32_dpp v10, v8 quad_perm:[2,3,0,1] row_mask:0xf bank_mask:0xf
    v_mov_b64 v[12:13], s[56:57]
    v_mov_b32_dpp v11, v9 quad_perm:[2,3,0,1] row_mask:0xf bank_mask:0xf
    v_mov_b64 v[14:15], s[56:57]
    s_waitcnt lgkmcnt(2)
    v_add_f32 v50, v50, v51
    v_add_f32 v48, v48, v50
    v_mul_f32 v48, s42, v48
    v_max3_f32 v40, v40, |v3|, |v48|
    v_cmp_lt_f32 vcc, s44, v40
    s_waitcnt vmcnt(2)
    v_mfma_f32_16x16x32_bf16 v[60:63], v[68:71], v[8:11], 0
    v_exp_f32 v49, v48
    s_waitcnt vmcnt(1)
    v_mfma_f32_16x16x32_bf16 v[64:67], v[72:75], v[8:11], 0
    v_mov_b32_dpp v50, v49 quad_perm:[2,3,0,1] row_mask:0xf bank_mask:0xf
    v_cvt_pk_bf16_f32 v51, v49, v50
    v_cvt_pk_bf16_f32 v50, v49, v50
    s_nop 1
    v_mfma_f32_16x16x16_bf16 v[60:63], v[52:53], v[50:51], v[60:63]
    v_mfma_f32_16x16x16_bf16 v[64:67], v[54:55], v[50:51], v[64:67]
    s_cbranch_vccnz L_fbS0_300
L_fbkS0_301:
    buffer_store_dwordx4 v[52:55], v35, s[4:7], s37 offen sc1
    ds_read_b128 v[0:3], v77 offset:4096
    v_mfma_f32_16x16x32_bf16 v[44:47], v[8:11], v[12:15], 0
    s_cmp_eq_u32 s14, 63
    v_cvt_pk_bf16_f32 v60, v60, v61
    v_cvt_pk_bf16_f32 v61, v62, v63
    v_cvt_pk_bf16_f32 v62, v64, v65
    v_cvt_pk_bf16_f32 v63, v66, v67
    v_mfma_f32_16x16x16_bf16 v[40:43], v[50:51], v[12:13], 0
    ds_write_b128 v32, v[60:63] offset:0
    v_mov_b64 v[68:69], 0
    v_mov_b64 v[70:71], 0
    ds_read_b128 v[4:7], v77 offset:5120
    v_mov_b64 v[72:73], 0
    v_mov_b64 v[74:75], 0
    v_mov_b64 v[64:65], 0
    ds_read_b128 v[8:11], v77 offset:6144
    v_fma_f32 v40, v40, 0.5, v44
    v_fma_f32 v41, v41, 0.5, v45
    ds_read_b128 v[12:15], v77 offset:7168
    v_rcp_f32 v34, v40
    v_rcp_f32 v35, v41
    ds_read_b128 v[40:43], v77 offset:9216
    v_mov_b64 v[66:67], 0
    s_waitcnt lgkmcnt(4)
    s_barrier
    ds_read_b128 v[52:55], v78 offset:4096
    ds_read_b128 v[56:59], v78 offset:5120
    s_cbranch_scc1 L_doneS
    ds_read_b128 v[44:47], v77 offset:10240
    ds_read_b128 v[48:51], v77 offset:11264
    s_waitcnt lgkmcnt(3)
    v_smfmac_f32_16x16x64_bf16 v[68:71], v[52:55], v[16:23], v79
    ds_read_b128 v[16:19], v77 offset:24576
    v_smfmac_f32_16x16x64_bf16 v[72:75], v[52:55], v[0:7], v79
    ds_read_b128 v[20:23], v77 offset:25600
    s_waitcnt lgkmcnt(4)
    v_smfmac_f32_16x16x64_bf16 v[68:71], v[56:59], v[24:31], v79
    ds_read_b128 v[24:27], v77 offset:26624
    v_smfmac_f32_16x16x64_bf16 v[72:75], v[56:59], v[8:15], v79
    ds_read_b128 v[28:31], v77 offset:27648
    ds_read_b128 v[8:11], v78 offset:10240
    v_smfmac_f32_16x16x64_bf16 v[64:67], v[52:55], v[36:43], v79
    ds_read_b128 v[36:39], v77 offset:28672
    v_add_f32 v68, v68, v70
    v_add_f32 v69, v69, v71
    v_mul_f32 v68, v68, v34
    v_add_f32 v72, v72, v74
    v_add_f32 v73, v73, v75
    v_mul_f32 v69, v69, v35
    v_mul_f32 v72, v72, v34
    v_mul_f32 v73, v73, v35
    v_cvt_pk_bf16_f32 v60, v68, v69
    v_cvt_pk_bf16_f32 v61, v72, v73
    v_mov_b64 v[68:69], 0
    v_mov_b64 v[70:71], 0
    v_mov_b64 v[72:73], 0
    v_mov_b64 v[74:75], 0
    v_smfmac_f32_16x16x64_bf16 v[68:71], v[52:55], a[192:199], v79
    ds_read_b128 v[40:43], v77 offset:29696
    v_and_or_b32 v60, v60, -2, s24
    v_smfmac_f32_16x16x64_bf16 v[72:75], v[52:55], a[208:215], v79
    ds_read_b128 v[12:15], v78 offset:11264
    v_and_or_b32 v61, v61, -2, s24
    s_waitcnt lgkmcnt(8)
    v_smfmac_f32_16x16x64_bf16 v[64:67], v[56:59], v[44:51], v79
    ds_read_b128 v[44:47], v77 offset:30720
    v_smfmac_f32_16x16x64_bf16 v[68:71], v[56:59], a[200:207], v79
    ds_read_b128 v[48:51], v77 offset:31744
    v_smfmac_f32_16x16x64_bf16 v[72:75], v[56:59], a[216:223], v79
    buffer_store_dwordx2 v[60:61], v33, s[4:7], s16 offen sc1
    s_nop 0
    v_add_f32 v64, v64, v66
    v_add_f32 v65, v65, v67
    v_mul_f32 v64, v64, v34
    v_add_f32 v68, v68, v70
    v_add_f32 v69, v69, v71
    v_mul_f32 v65, v65, v35
    v_add_f32 v72, v72, v74
    v_add_f32 v73, v73, v75
    v_mul_f32 v68, v68, v34
    v_mul_f32 v69, v69, v35
    v_mul_f32 v72, v72, v34
    v_mul_f32 v73, v73, v35
    v_cvt_pk_bf16_f32 v62, v64, v65
    v_cvt_pk_bf16_f32 v63, v68, v69
    v_cvt_pk_bf16_f32 v32, v72, v73
    v_and_or_b32 v62, v62, -2, s24
    v_and_or_b32 v63, v63, -2, s24
    v_and_or_b32 v32, v32, -2, s24
    v_lshrrev_b32 v72, 1, v33
    buffer_store_dwordx2 v[62:63], v33, s[4:7], s17 offen sc1
    v_mov_b64 v[64:65], 0
    v_mov_b64 v[66:67], 0
    v_mov_b64 v[68:69], 0
    v_mov_b64 v[70:71], 0
    v_smfmac_f32_16x16x64_bf16 v[64:67], v[52:55], a[224:231], v79
    v_smfmac_f32_16x16x64_bf16 v[68:71], v[52:55], a[240:247], v79
    v_mov_b64 v[74:75], 0
    buffer_store_dword v32, v72, s[4:7], s20 offen sc1
    v_smfmac_f32_16x16x64_bf16 v[64:67], v[56:59], a[232:239], v79
    v_mov_b64 v[72:73], 0
    v_smfmac_f32_16x16x64_bf16 v[68:71], v[56:59], a[248:255], v79
    s_nop 4
    v_add_f32 v64, v64, v66
    v_add_f32 v65, v65, v67
    v_mul_f32 v64, v64, v34
    v_mul_f32 v65, v65, v35
    v_add_f32 v68, v68, v70
    v_add_f32 v69, v69, v71
    v_cvt_pk_bf16_f32 v60, v64, v65
    v_mul_f32 v68, v68, v34
    v_mul_f32 v69, v69, v35
    v_mov_b64 v[64:65], 0
    v_mov_b64 v[66:67], 0
    v_cvt_pk_bf16_f32 v61, v68, v69
    v_and_or_b32 v60, v60, -2, s24
    v_and_or_b32 v61, v61, -2, s24
    s_waitcnt lgkmcnt(8)
    v_smfmac_f32_16x16x64_bf16 v[72:75], v[52:55], v[16:23], v79
    s_waitcnt lgkmcnt(3)
    v_smfmac_f32_16x16x64_bf16 v[64:67], v[52:55], v[36:43], v79
    buffer_store_dwordx2 v[60:61], v33, s[4:7], s18 offen sc1
    v_smfmac_f32_16x16x64_bf16 v[72:75], v[56:59], v[24:31], v79
    s_waitcnt lgkmcnt(0)
    v_smfmac_f32_16x16x64_bf16 v[64:67], v[56:59], v[44:51], v79
    s_nop 4
    v_add_f32 v72, v72, v74
    v_add_f32 v73, v73, v75
    v_mul_f32 v72, v72, v34
    v_mul_f32 v73, v73, v35
    v_add_f32 v64, v64, v66
    v_add_f32 v65, v65, v67
    v_mul_f32 v64, v64, v34
    v_mul_f32 v65, v65, v35
    v_cvt_pk_bf16_f32 v62, v72, v73
    v_cvt_pk_bf16_f32 v63, v64, v65
    v_and_or_b32 v62, v62, -2, s24
    v_and_or_b32 v63, v63, -2, s24
    buffer_store_dwordx2 v[62:63], v33, s[4:7], s19 offen sc1
    s_waitcnt lgkmcnt(0)
    s_add_u32 s54, s54, 32
    s_add_u32 s34, s34, 524288
    s_sub_u32 s31, s51, 147456
    s_add_u32 s31, s31, s40
    s_add_u32 s32, s31, 4096
    s_add_u32 s33, s31, 8192
    s_add_u32 s14, s14, 1
    s_xor_b32 s39, s39, 294912
    s_mov_b32 s40, s41
    s_add_u32 s41, s41, 9216
    s_cmp_eq_u32 s41, 27648
    s_cselect_b32 s41, 0, s41
    v_mov_b32 v65, -1
    s_nop 6
    buffer_load_dwordx4 v[0:3], v8, s[4:7], s25 offen sc1
    buffer_load_dwordx4 v[4:7], v8, s[4:7], s25 offen offset:1024 sc1
    s_waitcnt vmcnt(0)
    v_mfma_f32_16x16x32_bf16 v[20:23], v[0:3], v[12:15], 0
    v_mfma_f32_16x16x32_bf16 v[20:23], v[4:7], v[12:15], v[20:23]
    v_bitop3_b32 v16, v0, v1, s24 bitop3:0x7e
    v_bitop3_b32 v17, v2, v3, s24 bitop3:0x7e
    v_bitop3_b32 v18, v4, v5, s24 bitop3:0x7e
    v_bitop3_b32 v19, v6, v7, s24 bitop3:0x7e
    v_or3_b32 v16, v16, v17, v18
    v_bitop3_b32 v16, v16, v19, 1 bitop3:0xa8
    v_cmp_ne_u32 vcc, 0, v16
    s_nop 0
    v_add_f32 v20, v20, v21
    v_add_f32 v22, v22, v23
    v_add_f32 v20, v20, v22
    s_nop 1
    v_mov_b32_dpp v21, v20 row_shl:4 row_mask:0xf bank_mask:0xf
    v_cvt_pk_bf16_f32 v20, v20, v21
    v_min_u32 v20, -2, v20
    s_cbranch_vccnz L_rtS_302
L_bkS_303:
    buffer_store_dword v20, v9, s[4:7], s27 offen sc1
    v_mov_b32 v64, v9
    v_mov_b32 v66, v11
    s_cmp_eq_u32 s14, s15
    s_cbranch_scc0 L_stepS0
    s_branch L_doneS
L_entryS1:
    ds_read_b128 v[8:11], v78 offset:10240
    v_mov_b32 v65, -1
    s_waitcnt lgkmcnt(0)
    v_mov_b32 v64, v9
    v_mov_b32 v66, v11
    s_branch L_stepS1
.p2align 6
L_stepS1:
    s_add_u32 s38, s34, 4294457344
    s_cmp_lt_u32 s14, 62
    s_cselect_b32 s38, s38, 1073741824
    s_lshl_b32 s47, s54, 11
    s_add_u32 s36, s47, 50332160
    s_lshl_b32 s47, s47, 1
    s_add_u32 s37, s47, 54526976
    s_add_u32 s16, s21, s39
    s_add_u32 s17, s16, 65536
    s_add_u32 s18, s16, 131072
    s_add_u32 s19, s16, 196608
    s_lshl_b32 s46, s12, 5
    s_add_u32 s48, s50, s39
    s_add_u32 s49, s48, s46
    s_add_u32 s20, s49, 270336
    s_add_u32 s46, s46, s51
    s_add_u32 s47, s46, s40
    s_add_u32 s27, s47, 2048
    s_add_u32 s28, s47, 8192
    s_lshl_b32 s46, s12, 11
    s_add_u32 s46, s46, s48
    s_add_u32 s25, s46, 65536
    s_lshl_b32 s46, s12, 10
    s_add_u32 s46, s46, s48
    s_add_u32 s26, s46, 262144
    s_bfe_u32 s24, s14, 0x10001
    s_waitcnt vmcnt(1)
    v_mov_b64 v[36:37], 0
    v_mov_b64 v[38:39], 0
    v_mov_b64 v[40:41], 0
    v_mov_b64 v[42:43], 0
    v_mov_b64 v[44:45], 0
    v_mov_b64 v[46:47], 0
    v_mov_b64 v[48:49], 0
    v_mov_b64 v[50:51], 0
    v_mov_b64 v[52:53], 0
    v_mov_b64 v[54:55], 0
    v_mov_b64 v[56:57], 0
    v_mov_b64 v[58:59], 0
    v_add_u32 v77, 4294856704, v78
    s_nop 9
    buffer_load_dwordx4 v[4:7], v78, s[4:7], s31 offen offset:1024 sc1
    buffer_load_dwordx4 v[12:15], v78, s[4:7], s31 offen offset:3072 sc1
    s_nop 15
    s_nop 13
    buffer_load_dwordx4 v[68:71], v78, s[4:7], s31 offen offset:1024 sc1
    buffer_load_dwordx4 v[72:75], v78, s[4:7], s31 offen offset:3072 sc1
    s_waitcnt vmcnt(2)
    v_max3_u32 v76, v4, v5, v6
    v_max3_u32 v76, v76, v7, v12
    v_max3_u32 v76, v76, v13, v14
    v_max_u32 v76, v76, v15
    v_cmp_eq_u32 vcc, -1, v76
    ds_write_b128 v78, v[4:7] offset:1024
    ds_write_b128 v78, v[12:15] offset:3072
    s_cbranch_vccnz L_mpS1_305
L_mdS1_306:
    s_nop 0
    v_smfmac_f32_16x16x64_bf16 v[48:51], v[4:7], v[136:143], v79
    s_add_u32 s35, s34, 8192
    v_smfmac_f32_16x16x64_bf16 v[36:39], v[4:7], v[112:119], v79
    v_smfmac_f32_16x16x64_bf16 v[48:51], v[12:15], v[200:207], v79
    buffer_load_dwordx4 v[20:23], v78, s[4:7], s32 offen offset:1024 sc1
    v_smfmac_f32_16x16x64_bf16 v[40:43], v[4:7], v[120:127], v79
    s_waitcnt lgkmcnt(0)
    s_barrier
    ds_read_b128 v[8:11], v78 offset:2048
    v_smfmac_f32_16x16x64_bf16 v[44:47], v[4:7], v[128:135], v79
    ds_read_b128 v[0:3], v78 offset:0
    v_smfmac_f32_16x16x64_bf16 v[36:39], v[12:15], v[176:183], v79
    buffer_load_dwordx4 v[32:35], v78, s[4:7], s33 offen offset:0 sc1
    s_waitcnt vmcnt(2)
    ds_read_b128 v[68:71], v77 offset:32768
    v_smfmac_f32_16x16x64_bf16 v[40:43], v[12:15], v[184:191], v79
    ds_read_b128 v[72:75], v77 offset:33792
    v_smfmac_f32_16x16x64_bf16 v[44:47], v[12:15], v[192:199], v79
    ds_read_b128 v[24:27], v77 offset:34816
    ds_read_b128 v[28:31], v77 offset:35840
    buffer_store_dword v65, v64, s[4:7], s27 offen sc1
    s_waitcnt lgkmcnt(5)
    v_smfmac_f32_16x16x64_bf16 v[36:39], v[8:11], v[144:151], v79
    buffer_load_dwordx4 v[60:63], v78, s[4:7], s34 offen sc1
    v_smfmac_f32_16x16x64_bf16 v[40:43], v[8:11], v[152:159], v79
    s_waitcnt lgkmcnt(2)
    v_smfmac_f32_16x16x64_bf16 v[52:55], v[4:7], v[68:75], v79
    ds_read_b128 v[68:71], v77 offset:20480
    v_smfmac_f32_16x16x64_bf16 v[44:47], v[8:11], v[160:167], v79
    ds_read_b128 v[72:75], v77 offset:21504
    s_waitcnt lgkmcnt(2)
    v_smfmac_f32_16x16x64_bf16 v[56:59], v[4:7], v[24:31], v79
    ds_read_b128 v[24:27], v77 offset:22528
    buffer_load_dwordx4 v[64:67], v78, s[4:7], s34 offen offset:1024 sc1
    v_smfmac_f32_16x16x64_bf16 v[48:51], v[8:11], v[168:175], v79
    ds_read_b128 v[28:31], v77 offset:23552
    v_smfmac_f32_16x16x64_bf16 v[36:39], v[0:3], v[80:87], v79
    v_smfmac_f32_16x16x64_bf16 v[40:43], v[0:3], v[88:95], v79
    v_smfmac_f32_16x16x64_bf16 v[44:47], v[0:3], v[96:103], v79
    s_waitcnt lgkmcnt(2)
    v_smfmac_f32_16x16x64_bf16 v[52:55], v[12:15], v[68:75], v79
    ds_read_b128 v[68:71], v77 offset:16384
    v_smfmac_f32_16x16x64_bf16 v[48:51], v[0:3], v[104:111], v79
    ds_read_b128 v[72:75], v77 offset:17408
    s_waitcnt lgkmcnt(2)
    v_smfmac_f32_16x16x64_bf16 v[56:59], v[12:15], v[24:31], v79
    ds_read_b128 v[24:27], v77 offset:18432
    s_waitcnt vmcnt(4)
    v_max3_u32 v76, v20, v21, v22
    v_max_u32 v76, v76, v23
    ds_read_b128 v[28:31], v77 offset:19456
    v_cmp_eq_u32 vcc, -1, v76
    ds_write_b128 v78, v[20:23] offset:5120
    s_cbranch_vccnz L_rtS_310
L_bkS_311:
    s_waitcnt vmcnt(3)
    v_max3_u32 v76, v32, v33, v34
    v_max_u32 v76, v76, v35
    v_cmp_eq_u32 vcc, -1, v76
    s_waitcnt lgkmcnt(3)
    v_smfmac_f32_16x16x64_bf16 v[52:55], v[8:11], v[68:75], v79
    ds_read_b128 v[68:71], v77 offset:12288
    v_smfmac_f32_16x16x64_bf16 v[36:39], v[20:23], v[240:247], v79
    ds_read_b128 v[72:75], v77 offset:13312
    s_waitcnt lgkmcnt(3)
    v_smfmac_f32_16x16x64_bf16 v[56:59], v[8:11], v[24:31], v79
    ds_read_b128 v[24:27], v77 offset:14336
    s_cbranch_vccnz L_rtS_313
L_bkS_314:
    ds_read_b128 v[28:31], v77 offset:15360
    v_smfmac_f32_16x16x64_bf16 v[40:43], v[20:23], v[248:255], v79
    ds_read_b64 v[76:77], v78 offset:12288
    v_smfmac_f32_16x16x64_bf16 v[44:47], v[20:23], a[0:7], v79
    v_smfmac_f32_16x16x64_bf16 v[48:51], v[20:23], a[8:15], v79
    s_waitcnt lgkmcnt(3)
    v_smfmac_f32_16x16x64_bf16 v[52:55], v[0:3], v[68:75], v79
    buffer_load_dwordx4 v[68:71], v78, s[4:7], s35 offen sc1
    v_smfmac_f32_16x16x64_bf16 v[36:39], v[32:35], a[80:87], v79
    s_waitcnt lgkmcnt(1)
    v_smfmac_f32_16x16x64_bf16 v[56:59], v[0:3], v[24:31], v79
    v_lshlrev_b32 v0, 3, v78
    v_smfmac_f32_16x16x64_bf16 v[40:43], v[32:35], a[88:95], v79
    v_smfmac_f32_16x16x64_bf16 v[44:47], v[32:35], a[96:103], v79
    buffer_load_dwordx4 v[72:75], v78, s[4:7], s35 offen offset:1024 sc1
    s_barrier
    ds_read_b128 v[24:27], v78 offset:6144
    v_smfmac_f32_16x16x64_bf16 v[48:51], v[32:35], a[104:111], v79
    ds_read_b128 v[28:31], v78 offset:7168
    v_smfmac_f32_16x16x64_bf16 v[52:55], v[20:23], a[128:135], v79
    ds_read_b128 v[16:19], v78 offset:4096
    v_smfmac_f32_16x16x64_bf16 v[56:59], v[20:23], a[136:143], v79
    buffer_load_dword v0, s[4:7], s38 offen lds
    v_smfmac_f32_16x16x64_bf16 v[52:55], v[32:35], a[176:183], v79
    v_smfmac_f32_16x16x64_bf16 v[56:59], v[32:35], a[184:191], v79
    ds_read_b128 v[32:35], v78 offset:9216
    s_waitcnt lgkmcnt(3)
    v_smfmac_f32_16x16x64_bf16 v[36:39], v[24:27], a[16:23], v79
    v_smfmac_f32_16x16x64_bf16 v[40:43], v[24:27], a[24:31], v79
    v_smfmac_f32_16x16x64_bf16 v[44:47], v[24:27], a[32:39], v79
    v_smfmac_f32_16x16x64_bf16 v[48:51], v[24:27], a[40:47], v79
    s_waitcnt lgkmcnt(2)
    v_smfmac_f32_16x16x64_bf16 v[36:39], v[28:31], a[48:55], v79
    v_smfmac_f32_16x16x64_bf16 v[40:43], v[28:31], a[56:63], v79
    v_smfmac_f32_16x16x64_bf16 v[44:47], v[28:31], a[64:71], v79
    v_smfmac_f32_16x16x64_bf16 v[48:51], v[28:31], a[72:79], v79
    s_waitcnt lgkmcnt(1)
    v_smfmac_f32_16x16x64_bf16 v[36:39], v[16:19], v[208:215], v79
    v_smfmac_f32_16x16x64_bf16 v[40:43], v[16:19], v[216:223], v79
    v_smfmac_f32_16x16x64_bf16 v[44:47], v[16:19], v[224:231], v79
    v_smfmac_f32_16x16x64_bf16 v[48:51], v[16:19], v[232:239], v79
    s_nop 1
    v_cvt_pk_bf16_f32 v36, v36, v37
    v_cvt_pk_bf16_f32 v37, v38, v39
    v_cvt_pk_bf16_f32 v40, v40, v41
    v_cvt_pk_bf16_f32 v41, v42, v43
    v_mfma_f32_16x16x16_bf16 v[0:3], v[36:37], v[76:77], 0
    v_cvt_pk_bf16_f32 v44, v44, v45
    v_cvt_pk_bf16_f32 v48, v48, v49
    v_mfma_f32_16x16x16_bf16 v[4:7], v[40:41], v[76:77], 0
    v_cvt_pk_bf16_f32 v45, v46, v47
    v_cvt_pk_bf16_f32 v49, v50, v51
    s_nop 0
    v_mfma_f32_16x16x16_bf16 v[8:11], v[44:45], v[76:77], 0
    v_cvt_pk_bf16_f32 v36, v0, v1
    v_cvt_pk_bf16_f32 v37, v2, v3
    v_mfma_f32_16x16x16_bf16 v[12:15], v[48:49], v[76:77], 0
    v_cvt_pk_bf16_f32 v38, v4, v5
    v_cvt_pk_bf16_f32 v39, v6, v7
    v_add_u32 v77, 4294856704, v78
    ds_read_b128 v[20:23], v77 offset:1024
    v_cvt_pk_bf16_f32 v44, v8, v9
    v_cvt_pk_bf16_f32 v45, v10, v11
    s_waitcnt vmcnt(4)
    v_mfma_f32_16x16x32_bf16 v[0:3], v[60:63], v[36:39], 0
    v_cvt_pk_bf16_f32 v46, v12, v13
    v_cvt_pk_bf16_f32 v47, v14, v15
    s_waitcnt vmcnt(3)
    v_mfma_f32_16x16x32_bf16 v[4:7], v[64:67], v[36:39], 0
    v_lshrrev_b32 v64, 2, v78
    v_add_u32 v64, 118784, v64
    v_mfma_f32_16x16x32_bf16 v[48:51], v[44:47], v[36:39], 0
    ds_read_b128 v[36:39], v77 offset:8192
    s_nop 2
    v_cndmask_b32 v0, v0, v4, s[22:23]
    v_cndmask_b32 v1, v1, v5, s[22:23]
    v_cndmask_b32 v2, v2, v6, s[22:23]
    v_cndmask_b32 v3, v3, v7, s[22:23]
    ds_write_b128 v78, v[0:3] offset:1024
    v_cndmask_b32 v48, v48, v49, s[22:23]
    v_smfmac_f32_16x16x64_bf16 v[52:55], v[24:27], a[144:151], v79
    ds_write_b32 v64, v48 offset:256
    s_waitcnt lgkmcnt(4)
    buffer_store_dwordx4 v[44:47], v34, s[4:7], s36 offen sc1
    v_smfmac_f32_16x16x64_bf16 v[56:59], v[24:27], a[152:159], v79
    ds_read_b128 v[24:27], v77 offset:2048
    v_smfmac_f32_16x16x64_bf16 v[52:55], v[28:31], a[160:167], v79
    s_waitcnt lgkmcnt(1)
    s_barrier
    ds_read_b128 v[4:7], v78 offset:2048
    v_smfmac_f32_16x16x64_bf16 v[56:59], v[28:31], a[168:175], v79
    ds_read_b128 v[8:11], v78 offset:3072
    v_smfmac_f32_16x16x64_bf16 v[52:55], v[16:19], a[112:119], v79
    ds_read_b128 v[12:15], v78 offset:0
    v_smfmac_f32_16x16x64_bf16 v[56:59], v[16:19], a[120:127], v79
    ds_read_b32 v49, v64 offset:512
    ds_read_b32 v50, v64 offset:768
    ds_read_b32 v51, v64 offset:0
    ds_read_b128 v[16:19], v77 offset:0
    s_nop 0
    v_cvt_pk_bf16_f32 v52, v52, v53
    v_cvt_pk_bf16_f32 v53, v54, v55
    ds_read_b128 v[28:31], v77 offset:3072
    v_cvt_pk_bf16_f32 v54, v56, v57
    v_cvt_pk_bf16_f32 v55, v58, v59
    s_waitcnt lgkmcnt(7)
    v_pk_add_f32 v[0:1], v[0:1], v[4:5]
    v_pk_add_f32 v[2:3], v[2:3], v[6:7]
    s_waitcnt lgkmcnt(4)
    v_add_f32 v48, v48, v49
    v_pk_add_f32 v[8:9], v[8:9], v[12:13]
    v_pk_add_f32 v[10:11], v[10:11], v[14:15]
    v_pk_add_f32 v[0:1], v[0:1], v[8:9]
    v_pk_add_f32 v[2:3], v[2:3], v[10:11]
    v_exp_f32 v4, v0
    v_exp_f32 v5, v1
    v_exp_f32 v6, v2
    v_exp_f32 v7, v3
    v_cvt_pk_bf16_f32 v8, v4, v5
    v_max3_f32 v40, |v0|, |v1|, |v2|
    v_cvt_pk_bf16_f32 v9, v6, v7
    v_mov_b32_dpp v10, v8 quad_perm:[2,3,0,1] row_mask:0xf bank_mask:0xf
    v_mov_b64 v[12:13], s[56:57]
    v_mov_b32_dpp v11, v9 quad_perm:[2,3,0,1] row_mask:0xf bank_mask:0xf
    v_mov_b64 v[14:15], s[56:57]
    s_waitcnt lgkmcnt(2)
    v_add_f32 v50, v50, v51
    v_add_f32 v48, v48, v50
    v_mul_f32 v48, s42, v48
    v_max3_f32 v40, v40, |v3|, |v48|
    v_cmp_lt_f32 vcc, s44, v40
    s_waitcnt vmcnt(3)
    v_mfma_f32_16x16x32_bf16 v[60:63], v[68:71], v[8:11], 0
    v_exp_f32 v49, v48
    s_waitcnt vmcnt(2)
    v_mfma_f32_16x16x32_bf16 v[64:67], v[72:75], v[8:11], 0
    v_mov_b32_dpp v50, v49 quad_perm:[2,3,0,1] row_mask:0xf bank_mask:0xf
    v_cvt_pk_bf16_f32 v51, v49, v50
    v_cvt_pk_bf16_f32 v50, v49, v50
    s_nop 1
    v_mfma_f32_16x16x16_bf16 v[60:63], v[52:53], v[50:51], v[60:63]
    v_mfma_f32_16x16x16_bf16 v[64:67], v[54:55], v[50:51], v[64:67]
    s_cbranch_vccnz L_fbS1_316
L_fbkS1_317:
    buffer_store_dwordx4 v[52:55], v35, s[4:7], s37 offen sc1
    ds_read_b128 v[0:3], v77 offset:4096
    v_mfma_f32_16x16x32_bf16 v[44:47], v[8:11], v[12:15], 0
    s_cmp_eq_u32 s14, 63
    v_cvt_pk_bf16_f32 v60, v60, v61
    v_cvt_pk_bf16_f32 v61, v62, v63
    v_cvt_pk_bf16_f32 v62, v64, v65
    v_cvt_pk_bf16_f32 v63, v66, v67
    v_mfma_f32_16x16x16_bf16 v[40:43], v[50:51], v[12:13], 0
    ds_write_b128 v32, v[60:63] offset:512
    v_mov_b64 v[68:69], 0
    v_mov_b64 v[70:71], 0
    ds_read_b128 v[4:7], v77 offset:5120
    v_mov_b64 v[72:73], 0
    v_mov_b64 v[74:75], 0
    v_mov_b64 v[64:65], 0
    ds_read_b128 v[8:11], v77 offset:6144
    v_fma_f32 v40, v40, 0.5, v44
    v_fma_f32 v41, v41, 0.5, v45
    ds_read_b128 v[12:15], v77 offset:7168
    v_rcp_f32 v34, v40
    v_rcp_f32 v35, v41
    ds_read_b128 v[40:43], v77 offset:9216
    v_mov_b64 v[66:67], 0
    s_waitcnt lgkmcnt(4)
    s_barrier
    ds_read_b128 v[52:55], v78 offset:4096
    ds_read_b128 v[56:59], v78 offset:5120
    s_cbranch_scc1 L_doneS
    ds_read_b128 v[44:47], v77 offset:10240
    ds_read_b128 v[48:51], v77 offset:11264
    s_waitcnt lgkmcnt(3)
    v_smfmac_f32_16x16x64_bf16 v[68:71], v[52:55], v[16:23], v79
    ds_read_b128 v[16:19], v77 offset:24576
    v_smfmac_f32_16x16x64_bf16 v[72:75], v[52:55], v[0:7], v79
    ds_read_b128 v[20:23], v77 offset:25600
    s_waitcnt lgkmcnt(4)
    v_smfmac_f32_16x16x64_bf16 v[68:71], v[56:59], v[24:31], v79
    ds_read_b128 v[24:27], v77 offset:26624
    v_smfmac_f32_16x16x64_bf16 v[72:75], v[56:59], v[8:15], v79
    ds_read_b128 v[28:31], v77 offset:27648
    ds_read_b128 v[8:11], v78 offset:10240
    v_smfmac_f32_16x16x64_bf16 v[64:67], v[52:55], v[36:43], v79
    ds_read_b128 v[36:39], v77 offset:28672
    v_add_f32 v68, v68, v70
    v_add_f32 v69, v69, v71
    v_mul_f32 v68, v68, v34
    v_add_f32 v72, v72, v74
    v_add_f32 v73, v73, v75
    v_mul_f32 v69, v69, v35
    v_mul_f32 v72, v72, v34
    v_mul_f32 v73, v73, v35
    v_cvt_pk_bf16_f32 v60, v68, v69
    v_cvt_pk_bf16_f32 v61, v72, v73
    v_mov_b64 v[68:69], 0
    v_mov_b64 v[70:71], 0
    v_mov_b64 v[72:73], 0
    v_mov_b64 v[74:75], 0
    v_smfmac_f32_16x16x64_bf16 v[68:71], v[52:55], a[192:199], v79
    ds_read_b128 v[40:43], v77 offset:29696
    v_and_or_b32 v60, v60, -2, s24
    v_smfmac_f32_16x16x64_bf16 v[72:75], v[52:55], a[208:215], v79
    ds_read_b128 v[12:15], v78 offset:11264
    v_and_or_b32 v61, v61, -2, s24
    s_waitcnt lgkmcnt(8)
    v_smfmac_f32_16x16x64_bf16 v[64:67], v[56:59], v[44:51], v79
    ds_read_b128 v[44:47], v77 offset:30720
    v_smfmac_f32_16x16x64_bf16 v[68:71], v[56:59], a[200:207], v79
    ds_read_b128 v[48:51], v77 offset:31744
    v_smfmac_f32_16x16x64_bf16 v[72:75], v[56:59], a[216:223], v79
    buffer_store_dwordx2 v[60:61], v33, s[4:7], s16 offen sc1
    s_nop 0
    v_add_f32 v64, v64, v66
    v_add_f32 v65, v65, v67
    v_mul_f32 v64, v64, v34
    v_add_f32 v68, v68, v70
    v_add_f32 v69, v69, v71
    v_mul_f32 v65, v65, v35
    v_add_f32 v72, v72, v74
    v_add_f32 v73, v73, v75
    v_mul_f32 v68, v68, v34
    v_mul_f32 v69, v69, v35
    v_mul_f32 v72, v72, v34
    v_mul_f32 v73, v73, v35
    v_cvt_pk_bf16_f32 v62, v64, v65
    v_cvt_pk_bf16_f32 v63, v68, v69
    v_cvt_pk_bf16_f32 v32, v72, v73
    v_and_or_b32 v62, v62, -2, s24
    v_and_or_b32 v63, v63, -2, s24
    v_and_or_b32 v32, v32, -2, s24
    v_lshrrev_b32 v72, 1, v33
    buffer_store_dwordx2 v[62:63], v33, s[4:7], s17 offen sc1
    v_mov_b64 v[64:65], 0
    v_mov_b64 v[66:67], 0
    v_mov_b64 v[68:69], 0
    v_mov_b64 v[70:71], 0
    v_smfmac_f32_16x16x64_bf16 v[64:67], v[52:55], a[224:231], v79
    v_smfmac_f32_16x16x64_bf16 v[68:71], v[52:55], a[240:247], v79
    v_mov_b64 v[74:75], 0
    buffer_store_dword v32, v72, s[4:7], s20 offen sc1
    v_smfmac_f32_16x16x64_bf16 v[64:67], v[56:59], a[232:239], v79
    v_mov_b64 v[72:73], 0
    v_smfmac_f32_16x16x64_bf16 v[68:71], v[56:59], a[248:255], v79
    s_nop 4
    v_add_f32 v64, v64, v66
    v_add_f32 v65, v65, v67
    v_mul_f32 v64, v64, v34
    v_mul_f32 v65, v65, v35
    v_add_f32 v68, v68, v70
    v_add_f32 v69, v69, v71
    v_cvt_pk_bf16_f32 v60, v64, v65
    v_mul_f32 v68, v68, v34
    v_mul_f32 v69, v69, v35
    v_mov_b64 v[64:65], 0
    v_mov_b64 v[66:67], 0
    v_cvt_pk_bf16_f32 v61, v68, v69
    v_and_or_b32 v60, v60, -2, s24
    v_and_or_b32 v61, v61, -2, s24
    s_waitcnt lgkmcnt(8)
    v_smfmac_f32_16x16x64_bf16 v[72:75], v[52:55], v[16:23], v79
    s_waitcnt lgkmcnt(3)
    v_smfmac_f32_16x16x64_bf16 v[64:67], v[52:55], v[36:43], v79
    buffer_store_dwordx2 v[60:61], v33, s[4:7], s18 offen sc1
    v_smfmac_f32_16x16x64_bf16 v[72:75], v[56:59], v[24:31], v79
    s_waitcnt lgkmcnt(0)
    v_smfmac_f32_16x16x64_bf16 v[64:67], v[56:59], v[44:51], v79
    s_nop 4
    v_add_f32 v72, v72, v74
    v_add_f32 v73, v73, v75
    v_mul_f32 v72, v72, v34
    v_mul_f32 v73, v73, v35
    v_add_f32 v64, v64, v66
    v_add_f32 v65, v65, v67
    v_mul_f32 v64, v64, v34
    v_mul_f32 v65, v65, v35
    v_cvt_pk_bf16_f32 v62, v72, v73
    v_cvt_pk_bf16_f32 v63, v64, v65
    v_and_or_b32 v62, v62, -2, s24
    v_and_or_b32 v63, v63, -2, s24
    buffer_store_dwordx2 v[62:63], v33, s[4:7], s19 offen sc1
    s_waitcnt lgkmcnt(0)
    s_add_u32 s54, s54, 32
    s_add_u32 s34, s34, 524288
    s_sub_u32 s31, s51, 147456
    s_add_u32 s31, s31, s40
    s_add_u32 s32, s31, 4096
    s_add_u32 s33, s31, 8192
    s_add_u32 s14, s14, 1
    s_xor_b32 s39, s39, 294912
    s_mov_b32 s40, s41
    s_add_u32 s41, s41, 9216
    s_cmp_eq_u32 s41, 27648
    s_cselect_b32 s41, 0, s41
    v_mov_b32 v65, -1
    s_nop 15
    s_nop 0
    buffer_load_dwordx4 v[0:3], v8, s[4:7], s25 offen sc1
    buffer_load_dwordx4 v[4:7], v8, s[4:7], s25 offen offset:1024 sc1
    s_waitcnt vmcnt(0)
    v_mfma_f32_16x16x32_bf16 v[20:23], v[0:3], v[12:15], 0
    v_mfma_f32_16x16x32_bf16 v[20:23], v[4:7], v[12:15], v[20:23]
    v_bitop3_b32 v16, v0, v1, s24 bitop3:0x7e
    v_bitop3_b32 v17, v2, v3, s24 bitop3:0x7e
    v_bitop3_b32 v18, v4, v5, s24 bitop3:0x7e
    v_bitop3_b32 v19, v6, v7, s24 bitop3:0x7e
    v_or3_b32 v16, v16, v17, v18
    v_bitop3_b32 v16, v16, v19, 1 bitop3:0xa8
    v_cmp_ne_u32 vcc, 0, v16
    s_nop 0
    v_add_f32 v20, v20, v21
    v_add_f32 v22, v22, v23
    v_add_f32 v20, v20, v22
    s_nop 1
    v_mov_b32_dpp v21, v20 row_shl:4 row_mask:0xf bank_mask:0xf
    v_cvt_pk_bf16_f32 v20, v20, v21
    v_min_u32 v20, -2, v20
    s_cbranch_vccnz L_rtS_318
L_bkS_319:
    buffer_store_dword v20, v9, s[4:7], s27 offen sc1
    v_mov_b32 v64, v9
    v_mov_b32 v66, v11
    s_cmp_eq_u32 s14, s15
    s_cbranch_scc0 L_stepS1
    s_branch L_doneS
L_entryS2:
    ds_read_b128 v[8:11], v78 offset:10240
    v_mov_b32 v65, -1
    s_waitcnt lgkmcnt(0)
    v_mov_b32 v64, v9
    v_mov_b32 v66, v11
    s_branch L_stepS2
.p2align 6
L_stepS2:
    s_add_u32 s38, s34, 4294463488
    s_cmp_lt_u32 s14, 62
    s_cselect_b32 s38, s38, 1073741824
    s_lshl_b32 s47, s54, 11
    s_add_u32 s36, s47, 50332672
    s_lshl_b32 s47, s47, 1
    s_add_u32 s37, s47, 54528000
    s_add_u32 s16, s21, s39
    s_add_u32 s17, s16, 65536
    s_add_u32 s18, s16, 131072
    s_add_u32 s19, s16, 196608
    s_lshl_b32 s46, s12, 5
    s_add_u32 s48, s50, s39
    s_add_u32 s49, s48, s46
    s_add_u32 s20, s49, 278528
    s_add_u32 s46, s46, s51
    s_add_u32 s47, s46, s40
    s_add_u32 s27, s47, 4096
    s_add_u32 s28, s47, 8192
    s_lshl_b32 s46, s12, 11
    s_add_u32 s46, s46, s48
    s_add_u32 s25, s46, 131072
    s_lshl_b32 s46, s12, 10
    s_add_u32 s46, s46, s48
    s_add_u32 s26, s46, 262144
    s_bfe_u32 s24, s14, 0x10001
    s_waitcnt vmcnt(1)
    v_mov_b64 v[36:37], 0
    v_mov_b64 v[38:39], 0
    v_mov_b64 v[40:41], 0
    v_mov_b64 v[42:43], 0
    v_mov_b64 v[44:45], 0
    v_mov_b64 v[46:47], 0
    v_mov_b64 v[48:49], 0
    v_mov_b64 v[50:51], 0
    v_mov_b64 v[52:53], 0
    v_mov_b64 v[54:55], 0
    v_mov_b64 v[56:57], 0
    v_mov_b64 v[58:59], 0
    v_add_u32 v77, 4294893568, v78
    s_nop 0
    s_add_u32 s35, s34, 8192
    ds_read_b128 v[68:71], v77 offset:16384
    ds_read_b128 v[72:75], v77 offset:17408
    ds_read_b128 v[16:19], v77 offset:18432
    ds_read_b128 v[20:23], v77 offset:19456
    s_waitcnt lgkmcnt(4)
    s_barrier
    ds_read_b128 v[8:11], v78 offset:2048
    ds_read_b128 v[12:15], v78 offset:3072
    ds_read_b128 v[0:3], v78 offset:0
    ds_read_b128 v[4:7], v78 offset:1024
    s_waitcnt lgkmcnt(3)
    v_smfmac_f32_16x16x64_bf16 v[48:51], v[8:11], v[168:175], v79
    v_smfmac_f32_16x16x64_bf16 v[52:55], v[8:11], v[68:75], v79
    ds_read_b128 v[68:71], v77 offset:20480
    ds_read_b128 v[72:75], v77 offset:21504
    s_waitcnt lgkmcnt(4)
    v_smfmac_f32_16x16x64_bf16 v[48:51], v[12:15], v[200:207], v79
    buffer_load_dwordx4 v[24:27], v78, s[4:7], s32 offen offset:2048 sc1
    v_smfmac_f32_16x16x64_bf16 v[56:59], v[8:11], v[16:23], v79
    ds_read_b128 v[16:19], v77 offset:22528
    v_smfmac_f32_16x16x64_bf16 v[36:39], v[8:11], v[144:151], v79
    ds_read_b128 v[20:23], v77 offset:23552
    v_smfmac_f32_16x16x64_bf16 v[40:43], v[8:11], v[152:159], v79
    v_smfmac_f32_16x16x64_bf16 v[44:47], v[8:11], v[160:167], v79
    buffer_load_dwordx4 v[32:35], v78, s[4:7], s33 offen offset:0 sc1
    s_waitcnt lgkmcnt(2)
    v_smfmac_f32_16x16x64_bf16 v[52:55], v[12:15], v[68:75], v79
    ds_read_b128 v[68:71], v77 offset:12288
    v_smfmac_f32_16x16x64_bf16 v[36:39], v[12:15], v[176:183], v79
    ds_read_b128 v[72:75], v77 offset:13312
    s_waitcnt lgkmcnt(2)
    v_smfmac_f32_16x16x64_bf16 v[56:59], v[12:15], v[16:23], v79
    ds_read_b128 v[16:19], v77 offset:14336
    buffer_store_dword v65, v64, s[4:7], s27 offen sc1
    ds_read_b128 v[20:23], v77 offset:15360
    v_smfmac_f32_16x16x64_bf16 v[40:43], v[12:15], v[184:191], v79
    buffer_store_dword v65, v66, s[4:7], s28 offen sc1
    v_smfmac_f32_16x16x64_bf16 v[44:47], v[12:15], v[192:199], v79
    buffer_load_dwordx4 v[60:63], v78, s[4:7], s34 offen sc1
    v_smfmac_f32_16x16x64_bf16 v[36:39], v[0:3], v[80:87], v79
    s_waitcnt lgkmcnt(2)
    v_smfmac_f32_16x16x64_bf16 v[52:55], v[0:3], v[68:75], v79
    ds_read_b128 v[68:71], v77 offset:32768
    v_smfmac_f32_16x16x64_bf16 v[40:43], v[0:3], v[88:95], v79
    ds_read_b128 v[72:75], v77 offset:33792
    s_waitcnt lgkmcnt(2)
    v_smfmac_f32_16x16x64_bf16 v[56:59], v[0:3], v[16:23], v79
    ds_read_b128 v[16:19], v77 offset:34816
    buffer_load_dwordx4 v[64:67], v78, s[4:7], s34 offen offset:1024 sc1
    v_smfmac_f32_16x16x64_bf16 v[44:47], v[0:3], v[96:103], v79
    ds_read_b128 v[20:23], v77 offset:35840
    v_smfmac_f32_16x16x64_bf16 v[48:51], v[0:3], v[104:111], v79
    v_smfmac_f32_16x16x64_bf16 v[36:39], v[4:7], v[112:119], v79
    v_smfmac_f32_16x16x64_bf16 v[40:43], v[4:7], v[120:127], v79
    v_lshlrev_b32 v0, 3, v78
    s_waitcnt vmcnt(5)
    v_max3_u32 v76, v24, v25, v26
    v_max_u32 v76, v76, v27
    ds_write_b128 v78, v[24:27] offset:6144
    v_cmp_eq_u32 vcc, -1, v76
    v_smfmac_f32_16x16x64_bf16 v[44:47], v[4:7], v[128:135], v79
    s_cbranch_vccnz L_rtS_321
L_bkS_322:
    s_waitcnt vmcnt(4)
    v_max3_u32 v76, v32, v33, v34
    v_max_u32 v76, v76, v35
    v_cmp_eq_u32 vcc, -1, v76
    v_smfmac_f32_16x16x64_bf16 v[48:51], v[4:7], v[136:143], v79
    s_cbranch_vccnz L_rtS_324
L_bkS_325:
    ds_read_b64 v[76:77], v78 offset:12288
    s_waitcnt lgkmcnt(4)
    v_smfmac_f32_16x16x64_bf16 v[52:55], v[4:7], v[68:75], v79
    buffer_load_dwordx4 v[68:71], v78, s[4:7], s35 offen sc1
    v_smfmac_f32_16x16x64_bf16 v[36:39], v[24:27], a[16:23], v79
    v_smfmac_f32_16x16x64_bf16 v[40:43], v[24:27], a[24:31], v79
    v_smfmac_f32_16x16x64_bf16 v[44:47], v[24:27], a[32:39], v79
    v_smfmac_f32_16x16x64_bf16 v[48:51], v[24:27], a[40:47], v79
    buffer_load_dwordx4 v[72:75], v78, s[4:7], s35 offen offset:1024 sc1
    s_waitcnt lgkmcnt(1)
    s_barrier
    ds_read_b128 v[28:31], v78 offset:7168
    v_smfmac_f32_16x16x64_bf16 v[56:59], v[4:7], v[16:23], v79
    ds_read_b128 v[16:19], v78 offset:4096
    v_smfmac_f32_16x16x64_bf16 v[36:39], v[32:35], a[80:87], v79
    ds_read_b128 v[20:23], v78 offset:5120
    v_smfmac_f32_16x16x64_bf16 v[40:43], v[32:35], a[88:95], v79
    buffer_load_dword v0, s[4:7], s38 offen lds
    v_smfmac_f32_16x16x64_bf16 v[44:47], v[32:35], a[96:103], v79
    v_smfmac_f32_16x16x64_bf16 v[48:51], v[32:35], a[104:111], v79
    s_waitcnt lgkmcnt(2)
    v_smfmac_f32_16x16x64_bf16 v[36:39], v[28:31], a[48:55], v79
    v_smfmac_f32_16x16x64_bf16 v[40:43], v[28:31], a[56:63], v79
    v_smfmac_f32_16x16x64_bf16 v[44:47], v[28:31], a[64:71], v79
    v_smfmac_f32_16x16x64_bf16 v[48:51], v[28:31], a[72:79], v79
    s_waitcnt lgkmcnt(1)
    v_smfmac_f32_16x16x64_bf16 v[36:39], v[16:19], v[208:215], v79
    v_smfmac_f32_16x16x64_bf16 v[40:43], v[16:19], v[216:223], v79
    v_smfmac_f32_16x16x64_bf16 v[44:47], v[16:19], v[224:231], v79
    v_smfmac_f32_16x16x64_bf16 v[48:51], v[16:19], v[232:239], v79
    s_waitcnt lgkmcnt(0)
    v_smfmac_f32_16x16x64_bf16 v[36:39], v[20:23], v[240:247], v79
    v_smfmac_f32_16x16x64_bf16 v[40:43], v[20:23], v[248:255], v79
    v_smfmac_f32_16x16x64_bf16 v[44:47], v[20:23], a[0:7], v79
    v_smfmac_f32_16x16x64_bf16 v[48:51], v[20:23], a[8:15], v79
    s_nop 1
    v_cvt_pk_bf16_f32 v36, v36, v37
    v_cvt_pk_bf16_f32 v37, v38, v39
    v_cvt_pk_bf16_f32 v40, v40, v41
    v_cvt_pk_bf16_f32 v41, v42, v43
    v_mfma_f32_16x16x16_bf16 v[0:3], v[36:37], v[76:77], 0
    v_cvt_pk_bf16_f32 v44, v44, v45
    v_cvt_pk_bf16_f32 v48, v48, v49
    v_mfma_f32_16x16x16_bf16 v[4:7], v[40:41], v[76:77], 0
    v_cvt_pk_bf16_f32 v45, v46, v47
    v_cvt_pk_bf16_f32 v49, v50, v51
    s_nop 0
    v_mfma_f32_16x16x16_bf16 v[8:11], v[44:45], v[76:77], 0
    v_cvt_pk_bf16_f32 v36, v0, v1
    v_cvt_pk_bf16_f32 v37, v2, v3
    v_mfma_f32_16x16x16_bf16 v[12:15], v[48:49], v[76:77], 0
    v_cvt_pk_bf16_f32 v38, v4, v5
    v_cvt_pk_bf16_f32 v39, v6, v7
    v_add_u32 v77, 4294893568, v78
    s_waitcnt vmcnt(4)
    v_mfma_f32_16x16x32_bf16 v[0:3], v[60:63], v[36:39], 0
    v_cvt_pk_bf16_f32 v44, v8, v9
    v_cvt_pk_bf16_f32 v45, v10, v11
    v_cvt_pk_bf16_f32 v46, v12, v13
    v_cvt_pk_bf16_f32 v47, v14, v15
    s_waitcnt vmcnt(3)
    v_mfma_f32_16x16x32_bf16 v[4:7], v[64:67], v[36:39], 0
    v_lshrrev_b32 v64, 2, v78
    v_add_u32 v64, 118784, v64
    v_mfma_f32_16x16x32_bf16 v[48:51], v[44:47], v[36:39], 0
    ds_read_b128 v[36:39], v77 offset:8192
    s_nop 2
    v_cndmask_b32 v0, v0, v4, s[22:23]
    v_cndmask_b32 v1, v1, v5, s[22:23]
    v_cndmask_b32 v2, v2, v6, s[22:23]
    v_cndmask_b32 v3, v3, v7, s[22:23]
    ds_write_b128 v78, v[0:3] offset:2048
    v_cndmask_b32 v48, v48, v49, s[22:23]
    v_smfmac_f32_16x16x64_bf16 v[52:55], v[24:27], a[144:151], v79
    ds_write_b32 v64, v48 offset:512
    v_smfmac_f32_16x16x64_bf16 v[56:59], v[24:27], a[152:159], v79
    ds_read_b128 v[24:27], v77 offset:2048
    v_smfmac_f32_16x16x64_bf16 v[52:55], v[32:35], a[176:183], v79
    v_smfmac_f32_16x16x64_bf16 v[56:59], v[32:35], a[184:191], v79
    ds_read_b128 v[32:35], v78 offset:9216
    s_waitcnt lgkmcnt(2)
    s_barrier
    ds_read_b128 v[4:7], v78 offset:3072
    v_smfmac_f32_16x16x64_bf16 v[52:55], v[28:31], a[160:167], v79
    ds_read_b128 v[8:11], v78 offset:0
    v_smfmac_f32_16x16x64_bf16 v[56:59], v[28:31], a[168:175], v79
    ds_read_b128 v[12:15], v78 offset:1024
    v_smfmac_f32_16x16x64_bf16 v[52:55], v[16:19], a[112:119], v79
    ds_read_b32 v49, v64 offset:768
    ds_read_b32 v50, v64 offset:0
    v_smfmac_f32_16x16x64_bf16 v[56:59], v[16:19], a[120:127], v79
    ds_read_b32 v51, v64 offset:256
    s_waitcnt lgkmcnt(6)
    buffer_store_dwordx4 v[44:47], v34, s[4:7], s36 offen sc1
    ds_read_b128 v[16:19], v77 offset:0
    s_waitcnt lgkmcnt(6)
    v_pk_add_f32 v[0:1], v[0:1], v[4:5]
    v_pk_add_f32 v[2:3], v[2:3], v[6:7]
    ds_read_b128 v[28:31], v77 offset:3072
    s_waitcnt lgkmcnt(4)
    v_add_f32 v48, v48, v49
    v_pk_add_f32 v[8:9], v[8:9], v[12:13]
    v_pk_add_f32 v[10:11], v[10:11], v[14:15]
    v_pk_add_f32 v[0:1], v[0:1], v[8:9]
    v_pk_add_f32 v[2:3], v[2:3], v[10:11]
    v_exp_f32 v4, v0
    v_exp_f32 v5, v1
    v_exp_f32 v6, v2
    v_exp_f32 v7, v3
    v_cvt_pk_bf16_f32 v8, v4, v5
    v_max3_f32 v40, |v0|, |v1|, |v2|
    v_cvt_pk_bf16_f32 v9, v6, v7
    v_smfmac_f32_16x16x64_bf16 v[52:55], v[20:23], a[128:135], v79
    s_waitcnt lgkmcnt(2)
    v_add_f32 v50, v50, v51
    v_mov_b32_dpp v10, v8 quad_perm:[2,3,0,1] row_mask:0xf bank_mask:0xf
    v_mov_b32_dpp v11, v9 quad_perm:[2,3,0,1] row_mask:0xf bank_mask:0xf
    v_add_f32 v48, v48, v50
    v_mul_f32 v48, s42, v48
    v_max3_f32 v40, v40, |v3|, |v48|
    v_cmp_lt_f32 vcc, s44, v40
    v_cvt_pk_bf16_f32 v52, v52, v53
    v_cvt_pk_bf16_f32 v53, v54, v55
    v_mov_b64 v[12:13], s[56:57]
    v_mov_b64 v[14:15], s[56:57]
    s_waitcnt vmcnt(3)
    v_mfma_f32_16x16x32_bf16 v[60:63], v[68:71], v[8:11], 0
    v_exp_f32 v49, v48
    v_smfmac_f32_16x16x64_bf16 v[56:59], v[20:23], a[136:143], v79
    ds_read_b128 v[20:23], v77 offset:1024
    v_mov_b32_dpp v50, v49 quad_perm:[2,3,0,1] row_mask:0xf bank_mask:0xf
    v_cvt_pk_bf16_f32 v51, v49, v50
    v_cvt_pk_bf16_f32 v50, v49, v50
    s_waitcnt vmcnt(2)
    v_mfma_f32_16x16x32_bf16 v[64:67], v[72:75], v[8:11], 0
    s_nop 0
    v_cvt_pk_bf16_f32 v54, v56, v57
    v_cvt_pk_bf16_f32 v55, v58, v59
    v_mfma_f32_16x16x16_bf16 v[60:63], v[52:53], v[50:51], v[60:63]
    buffer_store_dwordx4 v[52:55], v35, s[4:7], s37 offen sc1
    v_mfma_f32_16x16x16_bf16 v[64:67], v[54:55], v[50:51], v[64:67]
    s_cbranch_vccnz L_fbS2_327
L_fbkS2_328:
    ds_read_b128 v[0:3], v77 offset:4096
    v_mfma_f32_16x16x32_bf16 v[44:47], v[8:11], v[12:15], 0
    s_cmp_eq_u32 s14, 63
    v_cvt_pk_bf16_f32 v60, v60, v61
    v_cvt_pk_bf16_f32 v61, v62, v63
    ds_read_b128 v[4:7], v77 offset:5120
    v_cvt_pk_bf16_f32 v62, v64, v65
    v_cvt_pk_bf16_f32 v63, v66, v67
    v_mfma_f32_16x16x16_bf16 v[40:43], v[50:51], v[12:13], 0
    ds_write_b128 v32, v[60:63] offset:1024
    v_mov_b64 v[68:69], 0
    v_mov_b64 v[70:71], 0
    ds_read_b128 v[8:11], v77 offset:6144
    v_mov_b64 v[72:73], 0
    v_mov_b64 v[74:75], 0
    v_mov_b64 v[64:65], 0
    ds_read_b128 v[12:15], v77 offset:7168
    v_fma_f32 v40, v40, 0.5, v44
    v_fma_f32 v41, v41, 0.5, v45
    v_rcp_f32 v34, v40
    v_rcp_f32 v35, v41
    ds_read_b128 v[40:43], v77 offset:9216
    v_mov_b64 v[66:67], 0
    s_waitcnt lgkmcnt(3)
    s_barrier
    ds_read_b128 v[52:55], v78 offset:4096
    ds_read_b128 v[56:59], v78 offset:5120
    s_cbranch_scc1 L_doneS
    ds_read_b128 v[44:47], v77 offset:10240
    ds_read_b128 v[48:51], v77 offset:11264
    s_waitcnt lgkmcnt(3)
    v_smfmac_f32_16x16x64_bf16 v[68:71], v[52:55], v[16:23], v79
    ds_read_b128 v[16:19], v77 offset:24576
    v_smfmac_f32_16x16x64_bf16 v[72:75], v[52:55], v[0:7], v79
    ds_read_b128 v[20:23], v77 offset:25600
    s_waitcnt lgkmcnt(4)
    v_smfmac_f32_16x16x64_bf16 v[68:71], v[56:59], v[24:31], v79
    ds_read_b128 v[24:27], v77 offset:26624
    v_smfmac_f32_16x16x64_bf16 v[72:75], v[56:59], v[8:15], v79
    ds_read_b128 v[28:31], v77 offset:27648
    ds_read_b128 v[8:11], v78 offset:10240
    v_smfmac_f32_16x16x64_bf16 v[64:67], v[52:55], v[36:43], v79
    ds_read_b128 v[36:39], v77 offset:28672
    v_add_f32 v68, v68, v70
    v_add_f32 v69, v69, v71
    v_mul_f32 v68, v68, v34
    v_add_f32 v72, v72, v74
    v_add_f32 v73, v73, v75
    v_mul_f32 v69, v69, v35
    v_mul_f32 v72, v72, v34
    v_mul_f32 v73, v73, v35
    v_cvt_pk_bf16_f32 v60, v68, v69
    v_cvt_pk_bf16_f32 v61, v72, v73
    v_mov_b64 v[68:69], 0
    v_mov_b64 v[70:71], 0
    v_mov_b64 v[72:73], 0
    v_mov_b64 v[74:75], 0
    v_smfmac_f32_16x16x64_bf16 v[68:71], v[52:55], a[192:199], v79
    ds_read_b128 v[40:43], v77 offset:29696
    v_and_or_b32 v60, v60, -2, s24
    v_smfmac_f32_16x16x64_bf16 v[72:75], v[52:55], a[208:215], v79
    ds_read_b128 v[12:15], v78 offset:11264
    v_and_or_b32 v61, v61, -2, s24
    s_waitcnt lgkmcnt(8)
    v_smfmac_f32_16x16x64_bf16 v[64:67], v[56:59], v[44:51], v79
    ds_read_b128 v[44:47], v77 offset:30720
    v_smfmac_f32_16x16x64_bf16 v[68:71], v[56:59], a[200:207], v79
    ds_read_b128 v[48:51], v77 offset:31744
    v_smfmac_f32_16x16x64_bf16 v[72:75], v[56:59], a[216:223], v79
    buffer_store_dwordx2 v[60:61], v33, s[4:7], s16 offen sc1
    s_nop 0
    v_add_f32 v64, v64, v66
    v_add_f32 v65, v65, v67
    v_mul_f32 v64, v64, v34
    v_add_f32 v68, v68, v70
    v_add_f32 v69, v69, v71
    v_mul_f32 v65, v65, v35
    v_add_f32 v72, v72, v74
    v_add_f32 v73, v73, v75
    v_mul_f32 v68, v68, v34
    v_mul_f32 v69, v69, v35
    v_mul_f32 v72, v72, v34
    v_mul_f32 v73, v73, v35
    v_cvt_pk_bf16_f32 v62, v64, v65
    v_cvt_pk_bf16_f32 v63, v68, v69
    v_cvt_pk_bf16_f32 v32, v72, v73
    v_and_or_b32 v62, v62, -2, s24
    v_and_or_b32 v63, v63, -2, s24
    v_and_or_b32 v32, v32, -2, s24
    v_lshrrev_b32 v72, 1, v33
    buffer_store_dwordx2 v[62:63], v33, s[4:7], s17 offen sc1
    v_mov_b64 v[64:65], 0
    v_mov_b64 v[66:67], 0
    v_mov_b64 v[68:69], 0
    v_mov_b64 v[70:71], 0
    v_smfmac_f32_16x16x64_bf16 v[64:67], v[52:55], a[224:231], v79
    v_smfmac_f32_16x16x64_bf16 v[68:71], v[52:55], a[240:247], v79
    v_mov_b64 v[74:75], 0
    buffer_store_dword v32, v72, s[4:7], s20 offen sc1
    v_smfmac_f32_16x16x64_bf16 v[64:67], v[56:59], a[232:239], v79
    v_mov_b64 v[72:73], 0
    v_smfmac_f32_16x16x64_bf16 v[68:71], v[56:59], a[248:255], v79
    s_nop 4
    v_add_f32 v64, v64, v66
    v_add_f32 v65, v65, v67
    v_mul_f32 v64, v64, v34
    v_mul_f32 v65, v65, v35
    v_add_f32 v68, v68, v70
    v_add_f32 v69, v69, v71
    v_cvt_pk_bf16_f32 v60, v64, v65
    v_mul_f32 v68, v68, v34
    v_mul_f32 v69, v69, v35
    v_mov_b64 v[64:65], 0
    v_mov_b64 v[66:67], 0
    v_cvt_pk_bf16_f32 v61, v68, v69
    v_and_or_b32 v60, v60, -2, s24
    v_and_or_b32 v61, v61, -2, s24
    s_waitcnt lgkmcnt(8)
    v_smfmac_f32_16x16x64_bf16 v[72:75], v[52:55], v[16:23], v79
    s_waitcnt lgkmcnt(3)
    v_smfmac_f32_16x16x64_bf16 v[64:67], v[52:55], v[36:43], v79
    buffer_store_dwordx2 v[60:61], v33, s[4:7], s18 offen sc1
    v_smfmac_f32_16x16x64_bf16 v[72:75], v[56:59], v[24:31], v79
    s_waitcnt lgkmcnt(0)
    v_smfmac_f32_16x16x64_bf16 v[64:67], v[56:59], v[44:51], v79
    s_nop 4
    v_add_f32 v72, v72, v74
    v_add_f32 v73, v73, v75
    v_mul_f32 v72, v72, v34
    v_mul_f32 v73, v73, v35
    v_add_f32 v64, v64, v66
    v_add_f32 v65, v65, v67
    v_mul_f32 v64, v64, v34
    v_mul_f32 v65, v65, v35
    v_cvt_pk_bf16_f32 v62, v72, v73
    v_cvt_pk_bf16_f32 v63, v64, v65
    v_and_or_b32 v62, v62, -2, s24
    v_and_or_b32 v63, v63, -2, s24
    buffer_store_dwordx2 v[62:63], v33, s[4:7], s19 offen sc1
    s_waitcnt lgkmcnt(0)
    buffer_load_dwordx4 v[0:3], v10, s[4:7], s26 offen sc1
    s_add_u32 s54, s54, 32
    s_add_u32 s34, s34, 524288
    s_sub_u32 s31, s51, 147456
    s_add_u32 s31, s31, s40
    s_add_u32 s32, s31, 4096
    s_add_u32 s33, s31, 8192
    s_add_u32 s14, s14, 1
    s_xor_b32 s39, s39, 294912
    s_mov_b32 s40, s41
    s_add_u32 s41, s41, 9216
    s_cmp_eq_u32 s41, 27648
    s_cselect_b32 s41, 0, s41
    v_mov_b32 v65, -1
    s_nop 15
    s_nop 15
    s_nop 15
    s_nop 8
    buffer_load_dwordx4 v[36:39], v8, s[4:7], s25 offen sc1
    buffer_load_dwordx4 v[40:43], v8, s[4:7], s25 offen offset:1024 sc1
    s_waitcnt vmcnt(2)
    v_mfma_f32_16x16x32_bf16 v[24:27], v[0:3], v[12:15], 0
    v_bitop3_b32 v28, v0, v1, s24 bitop3:0x7e
    v_bitop3_b32 v29, v2, v3, s24 bitop3:0x7e
    v_bitop3_b32 v28, v28, v29, 1 bitop3:0xa8
    v_cmp_ne_u32 vcc, 0, v28
    s_nop 2
    s_cbranch_vccnz L_rtS_329
L_bkS_330:
    v_add_f32 v24, v24, v25
    v_add_f32 v26, v26, v27
    v_add_f32 v24, v24, v26
    v_mov_b32 v25, v24
    s_nop 1
    v_permlane32_swap_b32 v24, v25
    v_add_f32 v24, v24, v25
    s_nop 1
    v_mov_b32_dpp v25, v24 row_shl:2 row_mask:0xf bank_mask:0xf
    v_cvt_pk_bf16_f32 v24, v24, v25
    v_min_u32 v24, -2, v24
    buffer_store_dword v24, v11, s[4:7], s28 offen sc1
    s_waitcnt vmcnt(1)
    v_mfma_f32_16x16x32_bf16 v[20:23], v[36:39], v[12:15], 0
    v_mfma_f32_16x16x32_bf16 v[20:23], v[40:43], v[12:15], v[20:23]
    v_bitop3_b32 v16, v36, v37, s24 bitop3:0x7e
    v_bitop3_b32 v17, v38, v39, s24 bitop3:0x7e
    v_bitop3_b32 v18, v40, v41, s24 bitop3:0x7e
    v_bitop3_b32 v19, v42, v43, s24 bitop3:0x7e
    v_or3_b32 v16, v16, v17, v18
    v_bitop3_b32 v16, v16, v19, 1 bitop3:0xa8
    v_cmp_ne_u32 vcc, 0, v16
    s_nop 0
    v_add_f32 v20, v20, v21
    v_add_f32 v22, v22, v23
    v_add_f32 v20, v20, v22
    s_nop 1
    v_mov_b32_dpp v21, v20 row_shl:4 row_mask:0xf bank_mask:0xf
    v_cvt_pk_bf16_f32 v20, v20, v21
    v_min_u32 v20, -2, v20
    s_cbranch_vccnz L_rtS_332
L_bkS_333:
    buffer_store_dword v20, v9, s[4:7], s27 offen sc1
    v_mov_b32 v64, v9
    v_mov_b32 v66, v11
    s_cmp_eq_u32 s14, s15
    s_cbranch_scc0 L_stepS2
    s_branch L_doneS
L_entryS3:
    ds_read_b128 v[8:11], v78 offset:10240
    v_mov_b32 v65, -1
    s_waitcnt lgkmcnt(0)
    v_mov_b32 v64, v9
    v_mov_b32 v66, v11
    s_branch L_stepS3
.p2align 6
L_stepS3:
    s_add_u32 s38, s34, 4294469632
    s_cmp_lt_u32 s14, 62
    s_cselect_b32 s38, s38, 1073741824
    s_lshl_b32 s47, s54, 11
    s_add_u32 s36, s47, 50333184
    s_lshl_b32 s47, s47, 1
    s_add_u32 s37, s47, 54529024
    s_add_u32 s16, s21, s39
    s_add_u32 s17, s16, 65536
    s_add_u32 s18, s16, 131072
    s_add_u32 s19, s16, 196608
    s_lshl_b32 s46, s12, 5
    s_add_u32 s48, s50, s39
    s_add_u32 s49, s48, s46
    s_add_u32 s20, s49, 286720
    s_add_u32 s46, s46, s51
    s_add_u32 s47, s46, s40
    s_add_u32 s27, s47, 6144
    s_add_u32 s28, s47, 8192
    s_lshl_b32 s46, s12, 11
    s_add_u32 s46, s46, s48
    s_add_u32 s25, s46, 196608
    s_lshl_b32 s46, s12, 10
    s_add_u32 s46, s46, s48
    s_add_u32 s26, s46, 262144
    s_bfe_u32 s24, s14, 0x10001
    s_waitcnt vmcnt(1)
    v_mov_b64 v[36:37], 0
    v_mov_b64 v[38:39], 0
    v_mov_b64 v[40:41], 0
    v_mov_b64 v[42:43], 0
    v_mov_b64 v[44:45], 0
    v_mov_b64 v[46:47], 0
    v_mov_b64 v[48:49], 0
    v_mov_b64 v[50:51], 0
    v_mov_b64 v[52:53], 0
    v_mov_b64 v[54:55], 0
    v_mov_b64 v[56:57], 0
    v_mov_b64 v[58:59], 0
    v_add_u32 v77, 4294930432, v78
    s_nop 0
    s_add_u32 s35, s34, 8192
    ds_read_b128 v[68:71], v77 offset:20480
    ds_read_b128 v[72:75], v77 offset:21504
    ds_read_b128 v[16:19], v77 offset:22528
    ds_read_b128 v[20:23], v77 offset:23552
    s_waitcnt lgkmcnt(4)
    s_barrier
    ds_read_b128 v[12:15], v78 offset:3072
    ds_read_b128 v[0:3], v78 offset:0
    ds_read_b128 v[4:7], v78 offset:1024
    ds_read_b128 v[8:11], v78 offset:2048
    s_waitcnt lgkmcnt(3)
    v_smfmac_f32_16x16x64_bf16 v[48:51], v[12:15], v[200:207], v79
    v_smfmac_f32_16x16x64_bf16 v[52:55], v[12:15], v[68:75], v79
    ds_read_b128 v[68:71], v77 offset:12288
    ds_read_b128 v[72:75], v77 offset:13312
    s_waitcnt lgkmcnt(4)
    v_smfmac_f32_16x16x64_bf16 v[48:51], v[0:3], v[104:111], v79
    buffer_load_dwordx4 v[28:31], v78, s[4:7], s32 offen offset:3072 sc1
    v_smfmac_f32_16x16x64_bf16 v[56:59], v[12:15], v[16:23], v79
    ds_read_b128 v[16:19], v77 offset:14336
    v_smfmac_f32_16x16x64_bf16 v[36:39], v[12:15], v[176:183], v79
    ds_read_b128 v[20:23], v77 offset:15360
    v_smfmac_f32_16x16x64_bf16 v[40:43], v[12:15], v[184:191], v79
    v_smfmac_f32_16x16x64_bf16 v[44:47], v[12:15], v[192:199], v79
    buffer_load_dwordx4 v[32:35], v78, s[4:7], s33 offen offset:0 sc1
    s_waitcnt lgkmcnt(2)
    v_smfmac_f32_16x16x64_bf16 v[52:55], v[0:3], v[68:75], v79
    ds_read_b128 v[68:71], v77 offset:32768
    v_smfmac_f32_16x16x64_bf16 v[36:39], v[0:3], v[80:87], v79
    ds_read_b128 v[72:75], v77 offset:33792
    s_waitcnt lgkmcnt(2)
    v_smfmac_f32_16x16x64_bf16 v[56:59], v[0:3], v[16:23], v79
    ds_read_b128 v[16:19], v77 offset:34816
    v_smfmac_f32_16x16x64_bf16 v[40:43], v[0:3], v[88:95], v79
    ds_read_b128 v[20:23], v77 offset:35840
    buffer_store_dword v65, v64, s[4:7], s27 offen sc1
    v_smfmac_f32_16x16x64_bf16 v[44:47], v[0:3], v[96:103], v79
    buffer_load_dwordx4 v[60:63], v78, s[4:7], s34 offen sc1
    v_smfmac_f32_16x16x64_bf16 v[36:39], v[4:7], v[112:119], v79
    s_waitcnt lgkmcnt(2)
    v_smfmac_f32_16x16x64_bf16 v[52:55], v[4:7], v[68:75], v79
    ds_read_b128 v[68:71], v77 offset:16384
    v_smfmac_f32_16x16x64_bf16 v[40:43], v[4:7], v[120:127], v79
    ds_read_b128 v[72:75], v77 offset:17408
    s_waitcnt lgkmcnt(2)
    v_smfmac_f32_16x16x64_bf16 v[56:59], v[4:7], v[16:23], v79
    ds_read_b128 v[16:19], v77 offset:18432
    buffer_load_dwordx4 v[64:67], v78, s[4:7], s34 offen offset:1024 sc1
    v_smfmac_f32_16x16x64_bf16 v[44:47], v[4:7], v[128:135], v79
    ds_read_b128 v[20:23], v77 offset:19456
    v_smfmac_f32_16x16x64_bf16 v[48:51], v[4:7], v[136:143], v79
    v_smfmac_f32_16x16x64_bf16 v[36:39], v[8:11], v[144:151], v79
    v_smfmac_f32_16x16x64_bf16 v[40:43], v[8:11], v[152:159], v79
    s_waitcnt lgkmcnt(2)
    v_smfmac_f32_16x16x64_bf16 v[52:55], v[8:11], v[68:75], v79
    buffer_load_dwordx4 v[68:71], v78, s[4:7], s35 offen sc1
    s_waitcnt vmcnt(5)
    v_max3_u32 v76, v28, v29, v30
    v_max_u32 v76, v76, v31
    ds_write_b128 v78, v[28:31] offset:7168
    v_cmp_eq_u32 vcc, -1, v76
    v_smfmac_f32_16x16x64_bf16 v[44:47], v[8:11], v[160:167], v79
    s_cbranch_vccnz L_rtS_335
L_bkS_336:
    buffer_load_dwordx4 v[72:75], v78, s[4:7], s35 offen offset:1024 sc1
    s_waitcnt vmcnt(5)
    v_max3_u32 v76, v32, v33, v34
    v_max_u32 v76, v76, v35
    v_cmp_eq_u32 vcc, -1, v76
    v_smfmac_f32_16x16x64_bf16 v[48:51], v[8:11], v[168:175], v79
    s_cbranch_vccnz L_rtS_338
L_bkS_339:
    v_smfmac_f32_16x16x64_bf16 v[36:39], v[28:31], a[48:55], v79
    s_waitcnt lgkmcnt(0)
    s_barrier
    v_smfmac_f32_16x16x64_bf16 v[56:59], v[8:11], v[16:23], v79
    ds_read_b128 v[16:19], v78 offset:4096
    v_mov_b32 v76, s14
    v_smfmac_f32_16x16x64_bf16 v[40:43], v[28:31], a[56:63], v79
    ds_read_b128 v[20:23], v78 offset:5120
    v_smfmac_f32_16x16x64_bf16 v[44:47], v[28:31], a[64:71], v79
    ds_read_b128 v[24:27], v78 offset:6144
    v_smfmac_f32_16x16x64_bf16 v[48:51], v[28:31], a[72:79], v79
    v_smfmac_f32_16x16x64_bf16 v[36:39], v[32:35], a[80:87], v79
    v_smfmac_f32_16x16x64_bf16 v[40:43], v[32:35], a[88:95], v79
    v_smfmac_f32_16x16x64_bf16 v[44:47], v[32:35], a[96:103], v79
    v_smfmac_f32_16x16x64_bf16 v[48:51], v[32:35], a[104:111], v79
    s_waitcnt lgkmcnt(2)
    v_smfmac_f32_16x16x64_bf16 v[36:39], v[16:19], v[208:215], v79
    v_smfmac_f32_16x16x64_bf16 v[40:43], v[16:19], v[216:223], v79
    v_smfmac_f32_16x16x64_bf16 v[44:47], v[16:19], v[224:231], v79
    v_smfmac_f32_16x16x64_bf16 v[48:51], v[16:19], v[232:239], v79
    s_waitcnt lgkmcnt(1)
    v_smfmac_f32_16x16x64_bf16 v[36:39], v[20:23], v[240:247], v79
    v_smfmac_f32_16x16x64_bf16 v[40:43], v[20:23], v[248:255], v79
    buffer_store_dword v76, off, s[4:7], s53 sc1
    ds_read_b64 v[76:77], v78 offset:12288
    v_smfmac_f32_16x16x64_bf16 v[44:47], v[20:23], a[0:7], v79
    v_smfmac_f32_16x16x64_bf16 v[48:51], v[20:23], a[8:15], v79
    s_waitcnt lgkmcnt(1)
    v_smfmac_f32_16x16x64_bf16 v[36:39], v[24:27], a[16:23], v79
    v_smfmac_f32_16x16x64_bf16 v[40:43], v[24:27], a[24:31], v79
    v_smfmac_f32_16x16x64_bf16 v[44:47], v[24:27], a[32:39], v79
    v_smfmac_f32_16x16x64_bf16 v[48:51], v[24:27], a[40:47], v79
    s_nop 1
    v_cvt_pk_bf16_f32 v36, v36, v37
    v_cvt_pk_bf16_f32 v37, v38, v39
    v_cvt_pk_bf16_f32 v40, v40, v41
    v_cvt_pk_bf16_f32 v41, v42, v43
    v_cvt_pk_bf16_f32 v44, v44, v45
    v_cvt_pk_bf16_f32 v45, v46, v47
    v_cvt_pk_bf16_f32 v48, v48, v49
    v_cvt_pk_bf16_f32 v49, v50, v51
    s_waitcnt lgkmcnt(0)
    v_mfma_f32_16x16x16_bf16 v[0:3], v[36:37], v[76:77], 0
    v_mfma_f32_16x16x16_bf16 v[4:7], v[40:41], v[76:77], 0
    v_mfma_f32_16x16x16_bf16 v[8:11], v[44:45], v[76:77], 0
    v_mfma_f32_16x16x16_bf16 v[12:15], v[48:49], v[76:77], 0
    v_add_u32 v77, 4294930432, v78
    s_nop 0
    v_cvt_pk_bf16_f32 v36, v0, v1
    v_cvt_pk_bf16_f32 v37, v2, v3
    v_cvt_pk_bf16_f32 v38, v4, v5
    v_cvt_pk_bf16_f32 v39, v6, v7
    v_cvt_pk_bf16_f32 v44, v8, v9
    v_cvt_pk_bf16_f32 v45, v10, v11
    v_cvt_pk_bf16_f32 v46, v12, v13
    v_cvt_pk_bf16_f32 v47, v14, v15
    s_waitcnt vmcnt(4)
    v_mfma_f32_16x16x32_bf16 v[0:3], v[60:63], v[36:39], 0
    s_waitcnt vmcnt(3)
    v_mfma_f32_16x16x32_bf16 v[4:7], v[64:67], v[36:39], 0
    v_lshrrev_b32 v64, 2, v78
    v_add_u32 v64, 118784, v64
    v_mfma_f32_16x16x32_bf16 v[48:51], v[44:47], v[36:39], 0
    ds_read_b128 v[36:39], v77 offset:8192
    s_nop 2
    v_cndmask_b32 v0, v0, v4, s[22:23]
    v_cndmask_b32 v1, v1, v5, s[22:23]
    v_cndmask_b32 v2, v2, v6, s[22:23]
    v_cndmask_b32 v3, v3, v7, s[22:23]
    ds_write_b128 v78, v[0:3] offset:3072
    v_cndmask_b32 v48, v48, v49, s[22:23]
    v_smfmac_f32_16x16x64_bf16 v[52:55], v[28:31], a[160:167], v79
    ds_write_b32 v64, v48 offset:768
    v_smfmac_f32_16x16x64_bf16 v[56:59], v[28:31], a[168:175], v79
    ds_read_b128 v[28:31], v77 offset:3072
    v_smfmac_f32_16x16x64_bf16 v[52:55], v[32:35], a[176:183], v79
    v_smfmac_f32_16x16x64_bf16 v[56:59], v[32:35], a[184:191], v79
    ds_read_b128 v[32:35], v78 offset:9216
    s_waitcnt lgkmcnt(2)
    s_barrier
    ds_read_b128 v[4:7], v78 offset:0
    v_smfmac_f32_16x16x64_bf16 v[52:55], v[16:19], a[112:119], v79
    ds_read_b128 v[8:11], v78 offset:1024
    v_smfmac_f32_16x16x64_bf16 v[56:59], v[16:19], a[120:127], v79
    ds_read_b128 v[12:15], v78 offset:2048
    v_smfmac_f32_16x16x64_bf16 v[52:55], v[20:23], a[128:135], v79
    ds_read_b32 v49, v64 offset:0
    ds_read_b32 v50, v64 offset:256
    v_smfmac_f32_16x16x64_bf16 v[56:59], v[20:23], a[136:143], v79
    ds_read_b32 v51, v64 offset:512
    s_waitcnt lgkmcnt(6)
    buffer_store_dwordx4 v[44:47], v34, s[4:7], s36 offen sc1
    ds_read_b128 v[16:19], v77 offset:0
    s_waitcnt lgkmcnt(6)
    v_pk_add_f32 v[0:1], v[0:1], v[4:5]
    v_pk_add_f32 v[2:3], v[2:3], v[6:7]
    ds_read_b128 v[20:23], v77 offset:1024
    s_waitcnt lgkmcnt(4)
    v_add_f32 v48, v48, v49
    v_pk_add_f32 v[8:9], v[8:9], v[12:13]
    v_pk_add_f32 v[10:11], v[10:11], v[14:15]
    v_pk_add_f32 v[0:1], v[0:1], v[8:9]
    v_pk_add_f32 v[2:3], v[2:3], v[10:11]
    v_exp_f32 v4, v0
    v_exp_f32 v5, v1
    v_exp_f32 v6, v2
    v_exp_f32 v7, v3
    v_cvt_pk_bf16_f32 v8, v4, v5
    v_max3_f32 v40, |v0|, |v1|, |v2|
    v_cvt_pk_bf16_f32 v9, v6, v7
    v_smfmac_f32_16x16x64_bf16 v[52:55], v[24:27], a[144:151], v79
    s_waitcnt lgkmcnt(2)
    v_add_f32 v50, v50, v51
    v_mov_b32_dpp v10, v8 quad_perm:[2,3,0,1] row_mask:0xf bank_mask:0xf
    v_mov_b32_dpp v11, v9 quad_perm:[2,3,0,1] row_mask:0xf bank_mask:0xf
    v_add_f32 v48, v48, v50
    v_mul_f32 v48, s42, v48
    v_max3_f32 v40, v40, |v3|, |v48|
    v_cmp_lt_f32 vcc, s44, v40
    v_cvt_pk_bf16_f32 v52, v52, v53
    v_cvt_pk_bf16_f32 v53, v54, v55
    v_mov_b64 v[12:13], s[56:57]
    v_mov_b64 v[14:15], s[56:57]
    s_waitcnt vmcnt(3)
    v_mfma_f32_16x16x32_bf16 v[60:63], v[68:71], v[8:11], 0
    v_exp_f32 v49, v48
    v_smfmac_f32_16x16x64_bf16 v[56:59], v[24:27], a[152:159], v79
    ds_read_b128 v[24:27], v77 offset:2048
    v_mov_b32_dpp v50, v49 quad_perm:[2,3,0,1] row_mask:0xf bank_mask:0xf
    v_cvt_pk_bf16_f32 v51, v49, v50
    v_cvt_pk_bf16_f32 v50, v49, v50
    s_waitcnt vmcnt(2)
    v_mfma_f32_16x16x32_bf16 v[64:67], v[72:75], v[8:11], 0
    s_nop 0
    v_cvt_pk_bf16_f32 v54, v56, v57
    v_cvt_pk_bf16_f32 v55, v58, v59
    v_mfma_f32_16x16x16_bf16 v[60:63], v[52:53], v[50:51], v[60:63]
    buffer_store_dwordx4 v[52:55], v35, s[4:7], s37 offen sc1
    v_mfma_f32_16x16x16_bf16 v[64:67], v[54:55], v[50:51], v[64:67]
    s_cbranch_vccnz L_fbS3_341
L_fbkS3_342:
    ds_read_b128 v[0:3], v77 offset:4096
    v_mfma_f32_16x16x32_bf16 v[44:47], v[8:11], v[12:15], 0
    s_cmp_eq_u32 s14, 63
    v_cvt_pk_bf16_f32 v60, v60, v61
    v_cvt_pk_bf16_f32 v61, v62, v63
    ds_read_b128 v[4:7], v77 offset:5120
    v_cvt_pk_bf16_f32 v62, v64, v65
    v_cvt_pk_bf16_f32 v63, v66, v67
    v_mfma_f32_16x16x16_bf16 v[40:43], v[50:51], v[12:13], 0
    ds_write_b128 v32, v[60:63] offset:1536
    v_mov_b64 v[68:69], 0
    v_mov_b64 v[70:71], 0
    ds_read_b128 v[8:11], v77 offset:6144
    v_mov_b64 v[72:73], 0
    v_mov_b64 v[74:75], 0
    v_mov_b64 v[64:65], 0
    ds_read_b128 v[12:15], v77 offset:7168
    v_fma_f32 v40, v40, 0.5, v44
    v_fma_f32 v41, v41, 0.5, v45
    v_rcp_f32 v34, v40
    v_rcp_f32 v35, v41
    ds_read_b128 v[40:43], v77 offset:9216
    v_mov_b64 v[66:67], 0
    s_waitcnt lgkmcnt(3)
    s_barrier
    ds_read_b128 v[52:55], v78 offset:4096
    ds_read_b128 v[56:59], v78 offset:5120
    s_cbranch_scc1 L_doneS
    ds_read_b128 v[44:47], v77 offset:10240
    ds_read_b128 v[48:51], v77 offset:11264
    s_waitcnt lgkmcnt(3)
    v_smfmac_f32_16x16x64_bf16 v[68:71], v[52:55], v[16:23], v79
    ds_read_b128 v[16:19], v77 offset:24576
    v_smfmac_f32_16x16x64_bf16 v[72:75], v[52:55], v[0:7], v79
    ds_read_b128 v[20:23], v77 offset:25600
    s_waitcnt lgkmcnt(4)
    v_smfmac_f32_16x16x64_bf16 v[68:71], v[56:59], v[24:31], v79
    ds_read_b128 v[24:27], v77 offset:26624
    v_smfmac_f32_16x16x64_bf16 v[72:75], v[56:59], v[8:15], v79
    ds_read_b128 v[28:31], v77 offset:27648
    ds_read_b128 v[8:11], v78 offset:10240
    v_smfmac_f32_16x16x64_bf16 v[64:67], v[52:55], v[36:43], v79
    ds_read_b128 v[36:39], v77 offset:28672
    v_add_f32 v68, v68, v70
    v_add_f32 v69, v69, v71
    v_mul_f32 v68, v68, v34
    v_add_f32 v72, v72, v74
    v_add_f32 v73, v73, v75
    v_mul_f32 v69, v69, v35
    v_mul_f32 v72, v72, v34
    v_mul_f32 v73, v73, v35
    v_cvt_pk_bf16_f32 v60, v68, v69
    v_cvt_pk_bf16_f32 v61, v72, v73
    v_mov_b64 v[68:69], 0
    v_mov_b64 v[70:71], 0
    v_mov_b64 v[72:73], 0
    v_mov_b64 v[74:75], 0
    v_smfmac_f32_16x16x64_bf16 v[68:71], v[52:55], a[192:199], v79
    ds_read_b128 v[40:43], v77 offset:29696
    v_and_or_b32 v60, v60, -2, s24
    v_smfmac_f32_16x16x64_bf16 v[72:75], v[52:55], a[208:215], v79
    ds_read_b128 v[12:15], v78 offset:11264
    v_and_or_b32 v61, v61, -2, s24
    s_waitcnt lgkmcnt(8)
    v_smfmac_f32_16x16x64_bf16 v[64:67], v[56:59], v[44:51], v79
    ds_read_b128 v[44:47], v77 offset:30720
    v_smfmac_f32_16x16x64_bf16 v[68:71], v[56:59], a[200:207], v79
    ds_read_b128 v[48:51], v77 offset:31744
    v_smfmac_f32_16x16x64_bf16 v[72:75], v[56:59], a[216:223], v79
    buffer_store_dwordx2 v[60:61], v33, s[4:7], s16 offen sc1
    s_nop 0
    v_add_f32 v64, v64, v66
    v_add_f32 v65, v65, v67
    v_mul_f32 v64, v64, v34
    v_add_f32 v68, v68, v70
    v_add_f32 v69, v69, v71
    v_mul_f32 v65, v65, v35
    v_add_f32 v72, v72, v74
    v_add_f32 v73, v73, v75
    v_mul_f32 v68, v68, v34
    v_mul_f32 v69, v69, v35
    v_mul_f32 v72, v72, v34
    v_mul_f32 v73, v73, v35
    v_cvt_pk_bf16_f32 v62, v64, v65
    v_cvt_pk_bf16_f32 v63, v68, v69
    v_cvt_pk_bf16_f32 v32, v72, v73
    v_and_or_b32 v62, v62, -2, s24
    v_and_or_b32 v63, v63, -2, s24
    v_and_or_b32 v32, v32, -2, s24
    v_lshrrev_b32 v72, 1, v33
    buffer_store_dwordx2 v[62:63], v33, s[4:7], s17 offen sc1
    v_mov_b64 v[64:65], 0
    v_mov_b64 v[66:67], 0
    v_mov_b64 v[68:69], 0
    v_mov_b64 v[70:71], 0
    v_smfmac_f32_16x16x64_bf16 v[64:67], v[52:55], a[224:231], v79
    v_smfmac_f32_16x16x64_bf16 v[68:71], v[52:55], a[240:247], v79
    v_mov_b64 v[74:75], 0
    buffer_store_dword v32, v72, s[4:7], s20 offen sc1
    v_smfmac_f32_16x16x64_bf16 v[64:67], v[56:59], a[232:239], v79
    v_mov_b64 v[72:73], 0
    v_smfmac_f32_16x16x64_bf16 v[68:71], v[56:59], a[248:255], v79
    s_nop 4
    v_add_f32 v64, v64, v66
    v_add_f32 v65, v65, v67
    v_mul_f32 v64, v64, v34
    v_mul_f32 v65, v65, v35
    v_add_f32 v68, v68, v70
    v_add_f32 v69, v69, v71
    v_cvt_pk_bf16_f32 v60, v64, v65
    v_mul_f32 v68, v68, v34
    v_mul_f32 v69, v69, v35
    v_mov_b64 v[64:65], 0
    v_mov_b64 v[66:67], 0
    v_cvt_pk_bf16_f32 v61, v68, v69
    v_and_or_b32 v60, v60, -2, s24
    v_and_or_b32 v61, v61, -2, s24
    s_waitcnt lgkmcnt(8)
    v_smfmac_f32_16x16x64_bf16 v[72:75], v[52:55], v[16:23], v79
    s_waitcnt lgkmcnt(3)
    v_smfmac_f32_16x16x64_bf16 v[64:67], v[52:55], v[36:43], v79
    buffer_store_dwordx2 v[60:61], v33, s[4:7], s18 offen sc1
    v_smfmac_f32_16x16x64_bf16 v[72:75], v[56:59], v[24:31], v79
    s_waitcnt lgkmcnt(0)
    v_smfmac_f32_16x16x64_bf16 v[64:67], v[56:59], v[44:51], v79
    s_nop 4
    v_add_f32 v72, v72, v74
    v_add_f32 v73, v73, v75
    v_mul_f32 v72, v72, v34
    v_mul_f32 v73, v73, v35
    v_add_f32 v64, v64, v66
    v_add_f32 v65, v65, v67
    v_mul_f32 v64, v64, v34
    v_mul_f32 v65, v65, v35
    v_cvt_pk_bf16_f32 v62, v72, v73
    v_cvt_pk_bf16_f32 v63, v64, v65
    v_and_or_b32 v62, v62, -2, s24
    v_and_or_b32 v63, v63, -2, s24
    buffer_store_dwordx2 v[62:63], v33, s[4:7], s19 offen sc1
    s_waitcnt lgkmcnt(0)
    s_add_u32 s54, s54, 32
    s_add_u32 s34, s34, 524288
    s_sub_u32 s31, s51, 147456
    s_add_u32 s31, s31, s40
    s_add_u32 s32, s31, 4096
    s_add_u32 s33, s31, 8192
    s_add_u32 s14, s14, 1
    s_xor_b32 s39, s39, 294912
    s_mov_b32 s40, s41
    s_add_u32 s41, s41, 9216
    s_cmp_eq_u32 s41, 27648
    s_cselect_b32 s41, 0, s41
    v_mov_b32 v65, -1
    s_nop 15
    s_nop 15
    s_nop 15
    s_nop 15
    s_nop 12
    buffer_load_dwordx4 v[0:3], v8, s[4:7], s25 offen sc1
    buffer_load_dwordx4 v[4:7], v8, s[4:7], s25 offen offset:1024 sc1
    s_waitcnt vmcnt(0)
    v_mfma_f32_16x16x32_bf16 v[20:23], v[0:3], v[12:15], 0
    v_mfma_f32_16x16x32_bf16 v[20:23], v[4:7], v[12:15], v[20:23]
    v_bitop3_b32 v16, v0, v1, s24 bitop3:0x7e
    v_bitop3_b32 v17, v2, v3, s24 bitop3:0x7e
    v_bitop3_b32 v18, v4, v5, s24 bitop3:0x7e
    v_bitop3_b32 v19, v6, v7, s24 bitop3:0x7e
    v_or3_b32 v16, v16, v17, v18
    v_bitop3_b32 v16, v16, v19, 1 bitop3:0xa8
    v_cmp_ne_u32 vcc, 0, v16
    s_nop 0
    v_add_f32 v20, v20, v21
    v_add_f32 v22, v22, v23
    v_add_f32 v20, v20, v22
    s_nop 1
    v_mov_b32_dpp v21, v20 row_shl:4 row_mask:0xf bank_mask:0xf
    v_cvt_pk_bf16_f32 v20, v20, v21
    v_min_u32 v20, -2, v20
    s_cbranch_vccnz L_rtS_343
L_bkS_344:
    buffer_store_dword v20, v9, s[4:7], s27 offen sc1
    v_mov_b32 v64, v9
    v_mov_b32 v66, v11
    s_cmp_eq_u32 s14, s15
    s_cbranch_scc0 L_stepS3
    s_branch L_doneS
L_mpS0_289:
    s_mov_b32 s43, 0
L_mqS0_291:
    buffer_load_dwordx4 v[16:19], v78, s[4:7], s31 offen offset:0 sc1
    buffer_load_dwordx4 v[20:23], v78, s[4:7], s31 offen offset:2048 sc1
    s_waitcnt vmcnt(2)
    v_max3_u32 v76, v68, v69, v70
    v_max3_u32 v76, v76, v71, v72
    v_max3_u32 v76, v76, v73, v74
    v_max_u32 v76, v76, v75
    v_cmp_eq_u32 vcc, -1, v76
    s_cbranch_vccz L_moS0_292
    buffer_load_dwordx4 v[68:71], v78, s[4:7], s31 offen offset:0 sc1
    buffer_load_dwordx4 v[72:75], v78, s[4:7], s31 offen offset:2048 sc1
    s_waitcnt vmcnt(2)
    v_max3_u32 v76, v16, v17, v18
    v_max3_u32 v76, v76, v19, v20
    v_max3_u32 v76, v76, v21, v22
    v_max_u32 v76, v76, v23
    v_cmp_eq_u32 vcc, -1, v76
    s_cbranch_vccz L_moS0_293
    s_add_u32 s43, s43, 1
    s_cmp_gt_u32 s43, 2000000
    s_cbranch_scc1 L_fail
    s_branch L_mqS0_291
L_moS0_292:
    v_mov_b64 v[0:1], v[68:69]
    v_mov_b64 v[2:3], v[70:71]
    v_mov_b64 v[8:9], v[72:73]
    v_mov_b64 v[10:11], v[74:75]
    ds_write_b128 v78, v[0:3] offset:0
    ds_write_b128 v78, v[8:11] offset:2048
    s_nop 0
    s_branch L_mdS0_290
L_moS0_293:
    v_mov_b64 v[0:1], v[16:17]
    v_mov_b64 v[2:3], v[18:19]
    v_mov_b64 v[8:9], v[20:21]
    v_mov_b64 v[10:11], v[22:23]
    ds_write_b128 v78, v[0:3] offset:0
    ds_write_b128 v78, v[8:11] offset:2048
    s_nop 0
    s_branch L_mdS0_290
        L_rtS_294:
    s_mov_b32 s43, 0
        L_rlS_296:
    buffer_load_dwordx4 v[16:19], v78, s[4:7], s32 offen offset:0 sc1
    s_add_u32 s43, s43, 1
    s_cmp_gt_u32 s43, 2000000
    s_cbranch_scc1 L_fail
    s_waitcnt vmcnt(0)
    v_max3_u32 v76, v16, v17, v18
    v_max_u32 v76, v76, v19
    v_cmp_eq_u32 vcc, -1, v76
    s_cbranch_vccnz L_rlS_296
    ds_write_b128 v78, v[16:19] offset:4096
    s_branch L_bkS_295
        L_rtS_297:
    s_mov_b32 s43, 0
        L_rlS_299:
    buffer_load_dwordx4 v[32:35], v78, s[4:7], s33 offen offset:0 sc1
    s_add_u32 s43, s43, 1
    s_cmp_gt_u32 s43, 2000000
    s_cbranch_scc1 L_fail
    s_waitcnt vmcnt(0)
    v_max3_u32 v76, v32, v33, v34
    v_max_u32 v76, v76, v35
    v_cmp_eq_u32 vcc, -1, v76
    s_cbranch_vccnz L_rlS_299
    s_branch L_bkS_298
        L_fbS0_300:
    s_nop 7
    v_max3_f32 v40, v0, v1, v2
    v_max3_f32 v40, v40, v3, v48
    s_nop 1
    v_max_f32_dpp v40, v40, v40 quad_perm:[2,3,0,1] row_mask:0xf bank_mask:0xf
    v_mov_b32 v41, v40
    s_nop 1
    v_permlane16_swap_b32 v40, v41
    v_max_f32 v40, v40, v41
    v_mov_b32 v41, v40
    s_nop 1
    v_permlane32_swap_b32 v40, v41
    v_max_f32 v40, v40, v41
    v_sub_f32 v4, v0, v40
    v_sub_f32 v5, v1, v40
    v_sub_f32 v6, v2, v40
    v_sub_f32 v7, v3, v40
    v_sub_f32 v49, v48, v40
    v_exp_f32 v4, v4
    v_exp_f32 v5, v5
    v_exp_f32 v6, v6
    v_exp_f32 v7, v7
    v_exp_f32 v49, v49
    v_cvt_pk_bf16_f32 v8, v4, v5
    v_cvt_pk_bf16_f32 v9, v6, v7
    s_nop 1
    v_mov_b32_dpp v10, v8 quad_perm:[2,3,0,1] row_mask:0xf bank_mask:0xf
    v_mov_b32_dpp v11, v9 quad_perm:[2,3,0,1] row_mask:0xf bank_mask:0xf
    v_mov_b32_dpp v50, v49 quad_perm:[2,3,0,1] row_mask:0xf bank_mask:0xf
    v_cvt_pk_bf16_f32 v51, v49, v50
    v_cvt_pk_bf16_f32 v50, v49, v50
    s_nop 1
    v_mfma_f32_16x16x32_bf16 v[60:63], v[68:71], v[8:11], 0
    v_mfma_f32_16x16x32_bf16 v[64:67], v[72:75], v[8:11], 0
    s_nop 5
    v_mfma_f32_16x16x16_bf16 v[60:63], v[52:53], v[50:51], v[60:63]
    v_mfma_f32_16x16x16_bf16 v[64:67], v[54:55], v[50:51], v[64:67]
    s_nop 7
    s_branch L_fbkS0_301
        L_rtS_302:
    s_mov_b32 s43, 0
        L_rlS_304:
    buffer_load_dwordx4 v[0:3], v8, s[4:7], s25 offen sc1
    buffer_load_dwordx4 v[4:7], v8, s[4:7], s25 offen offset:1024 sc1
    s_add_u32 s43, s43, 1
    s_cmp_gt_u32 s43, 2000000
    s_cbranch_scc1 L_fail
    s_waitcnt vmcnt(0)
    v_bitop3_b32 v16, v0, v1, s24 bitop3:0x7e
    v_bitop3_b32 v17, v2, v3, s24 bitop3:0x7e
    v_bitop3_b32 v18, v4, v5, s24 bitop3:0x7e
    v_bitop3_b32 v19, v6, v7, s24 bitop3:0x7e
    v_or3_b32 v16, v16, v17, v18
    v_bitop3_b32 v16, v16, v19, 1 bitop3:0xa8
    v_cmp_ne_u32 vcc, 0, v16
    s_cbranch_vccnz L_rlS_304
    v_mfma_f32_16x16x32_bf16 v[20:23], v[0:3], v[12:15], 0
    v_mfma_f32_16x16x32_bf16 v[20:23], v[4:7], v[12:15], v[20:23]
    s_nop 7
    v_add_f32 v20, v20, v21
    v_add_f32 v22, v22, v23
    v_add_f32 v20, v20, v22
    s_nop 1
    v_mov_b32_dpp v21, v20 row_shl:4 row_mask:0xf bank_mask:0xf
    v_cvt_pk_bf16_f32 v20, v20, v21
    v_min_u32 v20, -2, v20
    s_branch L_bkS_303
L_mpS1_305:
    s_mov_b32 s43, 0
L_mqS1_307:
    buffer_load_dwordx4 v[16:19], v78, s[4:7], s31 offen offset:1024 sc1
    buffer_load_dwordx4 v[20:23], v78, s[4:7], s31 offen offset:3072 sc1
    s_waitcnt vmcnt(2)
    v_max3_u32 v76, v68, v69, v70
    v_max3_u32 v76, v76, v71, v72
    v_max3_u32 v76, v76, v73, v74
    v_max_u32 v76, v76, v75
    v_cmp_eq_u32 vcc, -1, v76
    s_cbranch_vccz L_moS1_308
    buffer_load_dwordx4 v[68:71], v78, s[4:7], s31 offen offset:1024 sc1
    buffer_load_dwordx4 v[72:75], v78, s[4:7], s31 offen offset:3072 sc1
    s_waitcnt vmcnt(2)
    v_max3_u32 v76, v16, v17, v18
    v_max3_u32 v76, v76, v19, v20
    v_max3_u32 v76, v76, v21, v22
    v_max_u32 v76, v76, v23
    v_cmp_eq_u32 vcc, -1, v76
    s_cbranch_vccz L_moS1_309
    s_add_u32 s43, s43, 1
    s_cmp_gt_u32 s43, 2000000
    s_cbranch_scc1 L_fail
    s_branch L_mqS1_307
L_moS1_308:
    v_mov_b64 v[4:5], v[68:69]
    v_mov_b64 v[6:7], v[70:71]
    v_mov_b64 v[12:13], v[72:73]
    v_mov_b64 v[14:15], v[74:75]
    ds_write_b128 v78, v[4:7] offset:1024
    ds_write_b128 v78, v[12:15] offset:3072
    s_nop 0
    s_branch L_mdS1_306
L_moS1_309:
    v_mov_b64 v[4:5], v[16:17]
    v_mov_b64 v[6:7], v[18:19]
    v_mov_b64 v[12:13], v[20:21]
    v_mov_b64 v[14:15], v[22:23]
    ds_write_b128 v78, v[4:7] offset:1024
    ds_write_b128 v78, v[12:15] offset:3072
    s_nop 0
    s_branch L_mdS1_306
        L_rtS_310:
    s_mov_b32 s43, 0
        L_rlS_312:
    buffer_load_dwordx4 v[20:23], v78, s[4:7], s32 offen offset:1024 sc1
    s_add_u32 s43, s43, 1
    s_cmp_gt_u32 s43, 2000000
    s_cbranch_scc1 L_fail
    s_waitcnt vmcnt(0)
    v_max3_u32 v76, v20, v21, v22
    v_max_u32 v76, v76, v23
    v_cmp_eq_u32 vcc, -1, v76
    s_cbranch_vccnz L_rlS_312
    ds_write_b128 v78, v[20:23] offset:5120
    s_branch L_bkS_311
        L_rtS_313:
    s_mov_b32 s43, 0
        L_rlS_315:
    buffer_load_dwordx4 v[32:35], v78, s[4:7], s33 offen offset:0 sc1
    s_add_u32 s43, s43, 1
    s_cmp_gt_u32 s43, 2000000
    s_cbranch_scc1 L_fail
    s_waitcnt vmcnt(0)
    v_max3_u32 v76, v32, v33, v34
    v_max_u32 v76, v76, v35
    v_cmp_eq_u32 vcc, -1, v76
    s_cbranch_vccnz L_rlS_315
    s_branch L_bkS_314
        L_fbS1_316:
    s_nop 7
    v_max3_f32 v40, v0, v1, v2
    v_max3_f32 v40, v40, v3, v48
    s_nop 1
    v_max_f32_dpp v40, v40, v40 quad_perm:[2,3,0,1] row_mask:0xf bank_mask:0xf
    v_mov_b32 v41, v40
    s_nop 1
    v_permlane16_swap_b32 v40, v41
    v_max_f32 v40, v40, v41
    v_mov_b32 v41, v40
    s_nop 1
    v_permlane32_swap_b32 v40, v41
    v_max_f32 v40, v40, v41
    v_sub_f32 v4, v0, v40
    v_sub_f32 v5, v1, v40
    v_sub_f32 v6, v2, v40
    v_sub_f32 v7, v3, v40
    v_sub_f32 v49, v48, v40
    v_exp_f32 v4, v4
    v_exp_f32 v5, v5
    v_exp_f32 v6, v6
    v_exp_f32 v7, v7
    v_exp_f32 v49, v49
    v_cvt_pk_bf16_f32 v8, v4, v5
    v_cvt_pk_bf16_f32 v9, v6, v7
    s_nop 1
    v_mov_b32_dpp v10, v8 quad_perm:[2,3,0,1] row_mask:0xf bank_mask:0xf
    v_mov_b32_dpp v11, v9 quad_perm:[2,3,0,1] row_mask:0xf bank_mask:0xf
    v_mov_b32_dpp v50, v49 quad_perm:[2,3,0,1] row_mask:0xf bank_mask:0xf
    v_cvt_pk_bf16_f32 v51, v49, v50
    v_cvt_pk_bf16_f32 v50, v49, v50
    s_nop 1
    v_mfma_f32_16x16x32_bf16 v[60:63], v[68:71], v[8:11], 0
    v_mfma_f32_16x16x32_bf16 v[64:67], v[72:75], v[8:11], 0
    s_nop 5
    v_mfma_f32_16x16x16_bf16 v[60:63], v[52:53], v[50:51], v[60:63]
    v_mfma_f32_16x16x16_bf16 v[64:67], v[54:55], v[50:51], v[64:67]
    s_nop 7
    s_branch L_fbkS1_317
        L_rtS_318:
    s_mov_b32 s43, 0
        L_rlS_320:
    buffer_load_dwordx4 v[0:3], v8, s[4:7], s25 offen sc1
    buffer_load_dwordx4 v[4:7], v8, s[4:7], s25 offen offset:1024 sc1
    s_add_u32 s43, s43, 1
    s_cmp_gt_u32 s43, 2000000
    s_cbranch_scc1 L_fail
    s_waitcnt vmcnt(0)
    v_bitop3_b32 v16, v0, v1, s24 bitop3:0x7e
    v_bitop3_b32 v17, v2, v3, s24 bitop3:0x7e
    v_bitop3_b32 v18, v4, v5, s24 bitop3:0x7e
    v_bitop3_b32 v19, v6, v7, s24 bitop3:0x7e
    v_or3_b32 v16, v16, v17, v18
    v_bitop3_b32 v16, v16, v19, 1 bitop3:0xa8
    v_cmp_ne_u32 vcc, 0, v16
    s_cbranch_vccnz L_rlS_320
    v_mfma_f32_16x16x32_bf16 v[20:23], v[0:3], v[12:15], 0
    v_mfma_f32_16x16x32_bf16 v[20:23], v[4:7], v[12:15], v[20:23]
    s_nop 7
    v_add_f32 v20, v20, v21
    v_add_f32 v22, v22, v23
    v_add_f32 v20, v20, v22
    s_nop 1
    v_mov_b32_dpp v21, v20 row_shl:4 row_mask:0xf bank_mask:0xf
    v_cvt_pk_bf16_f32 v20, v20, v21
    v_min_u32 v20, -2, v20
    s_branch L_bkS_319
        L_rtS_321:
    s_mov_b32 s43, 0
        L_rlS_323:
    buffer_load_dwordx4 v[24:27], v78, s[4:7], s32 offen offset:2048 sc1
    s_add_u32 s43, s43, 1
    s_cmp_gt_u32 s43, 2000000
    s_cbranch_scc1 L_fail
    s_waitcnt vmcnt(0)
    v_max3_u32 v76, v24, v25, v26
    v_max_u32 v76, v76, v27
    v_cmp_eq_u32 vcc, -1, v76
    s_cbranch_vccnz L_rlS_323
    ds_write_b128 v78, v[24:27] offset:6144
    s_branch L_bkS_322
        L_rtS_324:
    s_mov_b32 s43, 0
        L_rlS_326:
    buffer_load_dwordx4 v[32:35], v78, s[4:7], s33 offen offset:0 sc1
    s_add_u32 s43, s43, 1
    s_cmp_gt_u32 s43, 2000000
    s_cbranch_scc1 L_fail
    s_waitcnt vmcnt(0)
    v_max3_u32 v76, v32, v33, v34
    v_max_u32 v76, v76, v35
    v_cmp_eq_u32 vcc, -1, v76
    s_cbranch_vccnz L_rlS_326
    s_branch L_bkS_325
        L_fbS2_327:
    s_nop 7
    v_max3_f32 v40, v0, v1, v2
    v_max3_f32 v40, v40, v3, v48
    s_nop 1
    v_max_f32_dpp v40, v40, v40 quad_perm:[2,3,0,1] row_mask:0xf bank_mask:0xf
    v_mov_b32 v41, v40
    s_nop 1
    v_permlane16_swap_b32 v40, v41
    v_max_f32 v40, v40, v41
    v_mov_b32 v41, v40
    s_nop 1
    v_permlane32_swap_b32 v40, v41
    v_max_f32 v40, v40, v41
    v_sub_f32 v4, v0, v40
    v_sub_f32 v5, v1, v40
    v_sub_f32 v6, v2, v40
    v_sub_f32 v7, v3, v40
    v_sub_f32 v49, v48, v40
    v_exp_f32 v4, v4
    v_exp_f32 v5, v5
    v_exp_f32 v6, v6
    v_exp_f32 v7, v7
    v_exp_f32 v49, v49
    v_cvt_pk_bf16_f32 v8, v4, v5
    v_cvt_pk_bf16_f32 v9, v6, v7
    s_nop 1
    v_mov_b32_dpp v10, v8 quad_perm:[2,3,0,1] row_mask:0xf bank_mask:0xf
    v_mov_b32_dpp v11, v9 quad_perm:[2,3,0,1] row_mask:0xf bank_mask:0xf
    v_mov_b32_dpp v50, v49 quad_perm:[2,3,0,1] row_mask:0xf bank_mask:0xf
    v_cvt_pk_bf16_f32 v51, v49, v50
    v_cvt_pk_bf16_f32 v50, v49, v50
    s_nop 1
    v_mfma_f32_16x16x32_bf16 v[60:63], v[68:71], v[8:11], 0
    v_mfma_f32_16x16x32_bf16 v[64:67], v[72:75], v[8:11], 0
    s_nop 5
    v_mfma_f32_16x16x16_bf16 v[60:63], v[52:53], v[50:51], v[60:63]
    v_mfma_f32_16x16x16_bf16 v[64:67], v[54:55], v[50:51], v[64:67]
    s_nop 7
    s_branch L_fbkS2_328
        L_rtS_329:
    s_mov_b32 s43, 0
        L_rlS_331:
    buffer_load_dwordx4 v[0:3], v10, s[4:7], s26 offen sc1
    s_add_u32 s43, s43, 1
    s_cmp_gt_u32 s43, 2000000
    s_cbranch_scc1 L_fail
    s_waitcnt vmcnt(0)
    v_bitop3_b32 v28, v0, v1, s24 bitop3:0x7e
    v_bitop3_b32 v29, v2, v3, s24 bitop3:0x7e
    v_bitop3_b32 v28, v28, v29, 1 bitop3:0xa8
    v_cmp_ne_u32 vcc, 0, v28
    s_cbranch_vccnz L_rlS_331
    v_mfma_f32_16x16x32_bf16 v[24:27], v[0:3], v[12:15], 0
    s_nop 7
    s_branch L_bkS_330
        L_rtS_332:
    s_mov_b32 s43, 0
        L_rlS_334:
    buffer_load_dwordx4 v[36:39], v8, s[4:7], s25 offen sc1
    buffer_load_dwordx4 v[40:43], v8, s[4:7], s25 offen offset:1024 sc1
    s_add_u32 s43, s43, 1
    s_cmp_gt_u32 s43, 2000000
    s_cbranch_scc1 L_fail
    s_waitcnt vmcnt(0)
    v_bitop3_b32 v16, v36, v37, s24 bitop3:0x7e
    v_bitop3_b32 v17, v38, v39, s24 bitop3:0x7e
    v_bitop3_b32 v18, v40, v41, s24 bitop3:0x7e
    v_bitop3_b32 v19, v42, v43, s24 bitop3:0x7e
    v_or3_b32 v16, v16, v17, v18
    v_bitop3_b32 v16, v16, v19, 1 bitop3:0xa8
    v_cmp_ne_u32 vcc, 0, v16
    s_cbranch_vccnz L_rlS_334
    v_mfma_f32_16x16x32_bf16 v[20:23], v[36:39], v[12:15], 0
    v_mfma_f32_16x16x32_bf16 v[20:23], v[40:43], v[12:15], v[20:23]
    s_nop 7
    v_add_f32 v20, v20, v21
    v_add_f32 v22, v22, v23
    v_add_f32 v20, v20, v22
    s_nop 1
    v_mov_b32_dpp v21, v20 row_shl:4 row_mask:0xf bank_mask:0xf
    v_cvt_pk_bf16_f32 v20, v20, v21
    v_min_u32 v20, -2, v20
    s_branch L_bkS_333
        L_rtS_335:
    s_mov_b32 s43, 0
        L_rlS_337:
    buffer_load_dwordx4 v[28:31], v78, s[4:7], s32 offen offset:3072 sc1
    s_add_u32 s43, s43, 1
    s_cmp_gt_u32 s43, 2000000
    s_cbranch_scc1 L_fail
    s_waitcnt vmcnt(0)
    v_max3_u32 v76, v28, v29, v30
    v_max_u32 v76, v76, v31
    v_cmp_eq_u32 vcc, -1, v76
    s_cbranch_vccnz L_rlS_337
    ds_write_b128 v78, v[28:31] offset:7168
    s_branch L_bkS_336
        L_rtS_338:
    s_mov_b32 s43, 0
        L_rlS_340:
    buffer_load_dwordx4 v[32:35], v78, s[4:7], s33 offen offset:0 sc1
    s_add_u32 s43, s43, 1
    s_cmp_gt_u32 s43, 2000000
    s_cbranch_scc1 L_fail
    s_waitcnt vmcnt(0)
    v_max3_u32 v76, v32, v33, v34
    v_max_u32 v76, v76, v35
    v_cmp_eq_u32 vcc, -1, v76
    s_cbranch_vccnz L_rlS_340
    s_branch L_bkS_339
        L_fbS3_341:
    s_nop 7
    v_max3_f32 v40, v0, v1, v2
    v_max3_f32 v40, v40, v3, v48
    s_nop 1
    v_max_f32_dpp v40, v40, v40 quad_perm:[2,3,0,1] row_mask:0xf bank_mask:0xf
    v_mov_b32 v41, v40
    s_nop 1
    v_permlane16_swap_b32 v40, v41
    v_max_f32 v40, v40, v41
    v_mov_b32 v41, v40
    s_nop 1
    v_permlane32_swap_b32 v40, v41
    v_max_f32 v40, v40, v41
    v_sub_f32 v4, v0, v40
    v_sub_f32 v5, v1, v40
    v_sub_f32 v6, v2, v40
    v_sub_f32 v7, v3, v40
    v_sub_f32 v49, v48, v40
    v_exp_f32 v4, v4
    v_exp_f32 v5, v5
    v_exp_f32 v6, v6
    v_exp_f32 v7, v7
    v_exp_f32 v49, v49
    v_cvt_pk_bf16_f32 v8, v4, v5
    v_cvt_pk_bf16_f32 v9, v6, v7
    s_nop 1
    v_mov_b32_dpp v10, v8 quad_perm:[2,3,0,1] row_mask:0xf bank_mask:0xf
    v_mov_b32_dpp v11, v9 quad_perm:[2,3,0,1] row_mask:0xf bank_mask:0xf
    v_mov_b32_dpp v50, v49 quad_perm:[2,3,0,1] row_mask:0xf bank_mask:0xf
    v_cvt_pk_bf16_f32 v51, v49, v50
    v_cvt_pk_bf16_f32 v50, v49, v50
    s_nop 1
    v_mfma_f32_16x16x32_bf16 v[60:63], v[68:71], v[8:11], 0
    v_mfma_f32_16x16x32_bf16 v[64:67], v[72:75], v[8:11], 0
    s_nop 5
    v_mfma_f32_16x16x16_bf16 v[60:63], v[52:53], v[50:51], v[60:63]
    v_mfma_f32_16x16x16_bf16 v[64:67], v[54:55], v[50:51], v[64:67]
    s_nop 7
    s_branch L_fbkS3_342
        L_rtS_343:
    s_mov_b32 s43, 0
        L_rlS_345:
    buffer_load_dwordx4 v[0:3], v8, s[4:7], s25 offen sc1
    buffer_load_dwordx4 v[4:7], v8, s[4:7], s25 offen offset:1024 sc1
    s_add_u32 s43, s43, 1
    s_cmp_gt_u32 s43, 2000000
    s_cbranch_scc1 L_fail
    s_waitcnt vmcnt(0)
    v_bitop3_b32 v16, v0, v1, s24 bitop3:0x7e
    v_bitop3_b32 v17, v2, v3, s24 bitop3:0x7e
    v_bitop3_b32 v18, v4, v5, s24 bitop3:0x7e
    v_bitop3_b32 v19, v6, v7, s24 bitop3:0x7e
    v_or3_b32 v16, v16, v17, v18
    v_bitop3_b32 v16, v16, v19, 1 bitop3:0xa8
    v_cmp_ne_u32 vcc, 0, v16
    s_cbranch_vccnz L_rlS_345
    v_mfma_f32_16x16x32_bf16 v[20:23], v[0:3], v[12:15], 0
    v_mfma_f32_16x16x32_bf16 v[20:23], v[4:7], v[12:15], v[20:23]
    s_nop 7
    v_add_f32 v20, v20, v21
    v_add_f32 v22, v22, v23
    v_add_f32 v20, v20, v22
    s_nop 1
    v_mov_b32_dpp v21, v20 row_shl:4 row_mask:0xf bank_mask:0xf
    v_cvt_pk_bf16_f32 v20, v20, v21
    v_min_u32 v20, -2, v20
    s_branch L_bkS_344
        L_doneS:
    s_cmp_eq_u32 s15, 64
    s_cbranch_scc1 L_finS
    s_mov_b32 s55, s21
    s_mov_b32 s60, 255
    s_mov_b32 s61, 64
    s_cmp_eq_u32 s15, 5
    s_cselect_b32 s60, 8, s60
    s_cselect_b32 s61, 15, s61
    s_cmp_eq_u32 s15, 15
    s_cselect_b32 s60, 20, s60
    s_cselect_b32 s61, 39, s61
    s_mov_b32 s15, s61
    v_mov_b32 v3, 163744
    s_cmp_eq_u32 s13, 0
    s_cbranch_scc0 L_wkd_347
    s_mov_b32 s21, 0
    v_mbcnt_lo_u32_b32 v4, -1, 0
    v_min_u32 v4, 3, v4
    v_lshlrev_b32 v4, 2, v4
        L_wk_346:
    buffer_load_dword v2, v4, s[4:7], s58 offen sc1
    s_add_u32 s21, s21, 1
    s_cmp_gt_u32 s21, 3000000
    s_cbranch_scc1 L_fail
    s_waitcnt vmcnt(0)
    v_cmp_gt_u32 vcc, s60, v2
    s_cbranch_vccnz L_wk_346
    s_nop 0
    v_min_u32_dpp v2, v2, v2 quad_perm:[1,0,3,2] row_mask:0xf bank_mask:0xf
    s_nop 1
    v_min_u32_dpp v2, v2, v2 quad_perm:[2,3,0,1] row_mask:0xf bank_mask:0xf
    s_nop 1
    v_min_u32_dpp v2, v2, v2 row_half_mirror row_mask:0xf bank_mask:0xf
    s_mov_b64 exec, 1
    ds_write_b32 v3, v2
    s_mov_b64 exec, -1
    s_waitcnt lgkmcnt(0)
        L_wkd_347:
    s_barrier
    ds_read_b32 v2, v3
    s_waitcnt lgkmcnt(0)
    v_readfirstlane_b32 s61, v2
    s_mov_b32 s21, s55
    s_branch L_runS
L_finS:
    s_waitcnt vmcnt(0) lgkmcnt(0)
    s_barrier
    s_cmp_eq_u32 s13, 0
    s_cbranch_scc0 L_fin_348
    v_mov_b32 v2, 64
    s_mov_b64 exec, 1
    buffer_atomic_umax v2, off, s[4:7], s53 sc1
    s_mov_b64 exec, -1
        L_fin_348:
    s_branch L_work
    L_fail:
    s_mov_b64 exec, -1
    v_mov_b32 v4, 0xdead
    buffer_store_dword v4, off, s[8:11], 0 offset:20
    L_end:
    s_waitcnt vmcnt(0)
    s_endpgm

.section .rodata,"a"
.p2align 6
.amdhsa_kernel gated_mix__softmax_full_mha__memory_aug_recurrent_mem_tr__prompt_kernel
  .amdhsa_next_free_vgpr 512
  .amdhsa_next_free_sgpr 102
  .amdhsa_accum_offset 256
  .amdhsa_group_segment_fixed_size 0
  .amdhsa_kernarg_size 112
  .amdhsa_user_sgpr_count 2
  .amdhsa_user_sgpr_kernarg_segment_ptr 1
  .amdhsa_system_sgpr_workgroup_id_x 1
.end_amdhsa_kernel
```
